```python
import torch

def _softmax(x, axis=-1):
    return torch.softmax(x, dim=axis)
def _gelu(x):
    return torch.nn.functional.gelu(x, approximate="tanh")
def _silu(x):
    return torch.nn.functional.silu(x)
def _sigmoid(x):
    return torch.sigmoid(x)
def _layernorm(x, axis=-1, eps=1e-5):
    m = x.mean(dim=axis, keepdim=True)
    v = x.var(dim=axis, keepdim=True, unbiased=False)
    return (x - m) / torch.sqrt(v + eps)
def _scatter_add(tgt, idx, src, axis=0):
    return tgt.clone().index_add_(axis, idx, src)
def _segment_sum(src, seg, n):
    out = torch.zeros((n,) + src.shape[1:], dtype=src.dtype)
    return out.index_add_(0, seg, src)
def _pad(x, pw):
    flat = tuple(v for pair in reversed(pw) for v in pair)
    return torch.nn.functional.pad(x, flat)

kernel_name = 'standalone__weight_only_int_quip__prompt'

def setup_inputs():

    _w = (lambda a: (lambda t: t.to(torch.bfloat16) if t.is_floating_point() else t)(torch.as_tensor(a)))
    B, S, D, F = 1, 2048, 1024, 3584
    G = 64 if 64 > 0 else D
    D = (D // G) * G
    ng = D // G
    bits = 4 if 4 > 0 else 4
    qmax = 1 << bits
    qw = torch.randint(0, qmax, (D, F)).to(torch.int32)
    U, _ = (lambda *_a, **_k: torch.linalg.qr(*[torch.as_tensor(_x).float() for _x in _a], **_k))((lambda *s: torch.randn(*s, dtype=torch.bfloat16) * 0.05)(D, D))
    V, _ = (lambda *_a, **_k: torch.linalg.qr(*[torch.as_tensor(_x).float() for _x in _a], **_k))((lambda *s: torch.randn(*s, dtype=torch.bfloat16) * 0.05)(F, F))
    return {
        "x": _w((lambda *s: torch.randn(*s, dtype=torch.bfloat16) * 0.05)(B, S, D)),
        "qw": _w(qw),
        "scales": _w(torch.abs((lambda *s: torch.randn(*s, dtype=torch.bfloat16) * 0.05)(ng, F)) * 0.02 + 0.005),
        "zeros": _w(torch.full((ng, F), qmax / 2.0, dtype=float)),
        "U": _w(U.to(float)),
        "V": _w(V.to(float)),
    }

def reference(x, qw, scales, zeros, U, V):
    B, S, D = x.shape
    ng, F = scales.shape
    G = D // ng
    s = (lambda x, n, axis: torch.repeat_interleave(x, n, dim=axis))(scales, G, axis=0)
    z = (lambda x, n, axis: torch.repeat_interleave(x, n, dim=axis))(zeros, G, axis=0)
    wq = ((lambda x, dt: x.to(dt))(qw, x.dtype) - z) * s
    xr = torch.einsum("bsd,de->bse", x, U)
    h  = torch.einsum("bse,ef->bsf", xr, wq)
    y  = torch.einsum("bsf,fg->bsg", h, V)
    return y
```

```asm
; @launch grid=(256,1,1) block=(256,1,1) lds=163840
.amdgcn_target "amdgcn-amd-amdhsa--gfx950"
.text
.globl standalone__weight_only_int_quip__prompt_kernel
.p2align 8
.type standalone__weight_only_int_quip__prompt_kernel,@function
standalone__weight_only_int_quip__prompt_kernel:
s_load_dwordx2 s[16:17], s[0:1], 8
s_load_dwordx4 s[28:31], s[0:1], 16
s_load_dwordx2 s[8:9], s[0:1], 40
s_load_dwordx4 s[48:51], s[0:1], 56
s_cmp_lt_u32 s2, 256
s_cbranch_scc1 standalone__weight_only_int_quip__prompt_kernel_go
s_endpgm
standalone__weight_only_int_quip__prompt_kernel_go:
s_getpc_b64 s[52:53]
standalone__weight_only_int_quip__prompt_kernel_pc0:
s_lshr_b32 s20, s2, 3
v_lshrrev_b32 v1, 6, v0
v_and_b32 v2, 63, v0
s_and_b32 s26, s20, 15
s_lshl_b32 s26, s26, 13
v_lshlrev_b32 v3, 11, v1
v_lshl_add_u32 v3, v2, 7, v3
v_lshrrev_b32 v2, 4, v2
v_lshl_add_u32 v3, v2, 28, v3
s_mov_b32 s54, standalone__weight_only_int_quip__prompt_kernel_codeend-standalone__weight_only_int_quip__prompt_kernel_pc0
s_mov_b32 s55, 0x20000
buffer_load_dword v255, v3, s[52:55], s26 offen
s_cmp_lt_u32 s20, 4
s_cbranch_scc1 standalone__weight_only_int_quip__prompt_kernel_xr0
v_lshrrev_b32 v1, 6, v0
v_and_b32 v0, 63, v0
v_readfirstlane_b32 s21, v1
s_sub_u32 s20, s20, 4
s_and_b32 s27, s2, 1
s_and_b32 s22, s20, 3
s_bfe_u32 s23, s2, 0x20001
s_mul_i32 s23, s23, 7
s_lshr_b32 s26, s20, 2
s_add_u32 s23, s23, s26
v_lshrrev_b32 v2, 4, v0
v_and_b32 v3, 15, v0
s_mov_b32 s26, 14336
v_mul_lo_u32 v4, v2, s26
v_xor_b32 v5, v3, v2
v_xor_b32 v6, 0, v5
v_lshl_add_u32 v8, v6, 4, v4
v_xor_b32 v6, 4, v5
v_lshl_add_u32 v9, v6, 4, v4
v_add_u32 v9, 56320, v9
v_xor_b32 v6, 8, v5
v_lshl_add_u32 v10, v6, 4, v4
v_add_u32 v10, 112640, v10
v_xor_b32 v6, 12, v5
v_lshl_add_u32 v11, v6, 4, v4
v_add_u32 v11, 168960, v11
s_lshr_b32 s33, s23, 2
s_and_b32 s34, s23, 3
s_mul_i32 s35, s27, 1792
s_lshl_b32 s26, s33, 8
s_add_u32 s35, s35, s26
s_lshl_b32 s26, s21, 6
s_add_u32 s35, s35, s26
s_lshl_b32 s26, s22, 2
s_add_u32 s26, s26, s34
s_mul_i32 s56, s26, 917504
s_lshl_b32 s57, s35, 2
s_add_u32 s56, s56, s57
s_mul_i32 s57, s26, 7168
s_lshl_b32 s58, s35, 1
s_add_u32 s57, s57, s58
s_lshl_b32 s58, s21, 14
s_add_u32 s58, s58, 98304
v_lshlrev_b32 v7, 3, v2
s_mov_b32 m0, s58
s_mov_b32 s18, 14680064
s_mov_b32 s19, 0x20000
s_mov_b32 s38, 114688
s_mov_b32 s39, 0x20000
s_mov_b32 s42, 114688
s_mov_b32 s43, 0x20000
s_waitcnt lgkmcnt(0)
buffer_load_dwordx4 v8, s[16:19], s56 offen offset:0 nt lds
buffer_load_dwordx4 v9, s[16:19], s56 offen offset:1024 nt lds
buffer_load_dwordx4 v10, s[16:19], s56 offen offset:2048 nt lds
buffer_load_dwordx4 v11, s[16:19], s56 offen offset:3072 nt lds
s_mov_b32 s36, s28
s_mov_b32 s37, s29
s_mov_b32 s40, s30
s_mov_b32 s41, s31
buffer_load_dwordx2 v[16:17], v7, s[36:39], s57 offen offset:0
buffer_load_dwordx2 v[18:19], v7, s[40:43], s57 offen offset:0
buffer_load_dwordx2 v[20:21], v7, s[36:39], s57 offen offset:32
buffer_load_dwordx2 v[22:23], v7, s[40:43], s57 offen offset:32
buffer_load_dwordx2 v[24:25], v7, s[36:39], s57 offen offset:64
buffer_load_dwordx2 v[26:27], v7, s[40:43], s57 offen offset:64
buffer_load_dwordx2 v[28:29], v7, s[36:39], s57 offen offset:96
buffer_load_dwordx2 v[30:31], v7, s[40:43], s57 offen offset:96
s_add_u32 m0, s58, 4096
s_add_u32 s56, s56, 229376
buffer_load_dwordx4 v8, s[16:19], s56 offen offset:0 nt lds
buffer_load_dwordx4 v9, s[16:19], s56 offen offset:1024 nt lds
buffer_load_dwordx4 v10, s[16:19], s56 offen offset:2048 nt lds
buffer_load_dwordx4 v11, s[16:19], s56 offen offset:3072 nt lds
s_mov_b32 s24, s50
s_mov_b32 s25, s51
s_mov_b32 s50, 256
s_mov_b32 s51, 0x20000
s_add_u32 s44, s24, 100663296
s_addc_u32 s45, s25, 0
s_mov_b32 s46, 32768
s_mov_b32 s47, 0x20000
s_mul_i32 s26, s22, 3670016
s_mul_i32 s28, s27, 1835008
s_add_u32 s26, s26, s28
s_add_u32 s26, s26, 0
s_add_u32 s4, s24, s26
s_addc_u32 s5, s25, 0
s_mov_b32 s6, 1835008
s_mov_b32 s7, 0x20000
s_mul_i32 s26, s27, 12845056
s_add_u32 s8, s8, s26
s_addc_u32 s9, s9, 0
s_mov_b32 s10, 12845056
s_mov_b32 s11, 0x20000
s_add_u32 s12, s24, 16777216
s_addc_u32 s13, s25, 0
s_mov_b32 s14, 14680064
s_mov_b32 s15, 0x20000
s_lshl_b32 s59, s33, 3
s_lshl_b32 s26, s21, 1
s_add_u32 s59, s59, s26
s_mul_i32 s59, s59, 32768
s_mul_i32 s26, s34, 8192
s_add_u32 s59, s59, s26
s_add_u32 s60, s59, 32768
v_lshrrev_b32 v4, 3, v0
s_mov_b32 s26, 28672
v_mul_lo_u32 v4, v4, s26
v_and_b32 v5, 7, v0
v_lshl_add_u32 v244, v5, 4, v4
v_add_u32 v245, 228352, v244
v_add_u32 v246, 456704, v244
v_add_u32 v247, 685056, v244
v_lshrrev_b32 v4, 2, v3
s_movk_i32 s26, 4128
v_mul_lo_u32 v4, v4, s26
v_lshl_add_u32 v4, v2, 7, v4
v_and_b32 v5, 3, v0
v_lshl_add_u32 v160, v5, 3, v4
v_add_u32 v161, 66048, v160
s_mul_i32 s52, s21, 4128
s_add_u32 s53, s52, 66048
s_add_u32 s54, s52, s53
s_mul_i32 s34, s21, 7168
s_lshl_b32 s26, s23, 8
s_add_u32 s34, s34, s26
s_add_u32 s35, s34, 128
s_mov_b32 s26, 7168
v_mul_lo_u32 v4, v0, s26
v_lshrrev_b32 v5, 5, v0
v_lshl_add_u32 v163, v5, 28, v4
s_bfe_u32 s26, s2, 0x20001
s_lshl_b32 s26, s26, 3
s_lshr_b32 s30, 0x15110901, s26
s_lshr_b32 s31, 0x19110d05, s26
s_lshl_b32 s26, s20, 2
s_add_u32 s26, s26, s21
s_cmp_lt_u32 s26, 56
s_cselect_b32 s30, s30, s31
s_cselect_b32 s31, 0, 56
s_and_b32 s30, s30, 0xff
s_sub_u32 s26, s26, s31
s_lshl_b32 s30, s30, 8
s_mul_i32 s31, s26, 229376
s_add_u32 s55, s31, s30
s_mul_i32 s31, s26, 21504
s_add_u32 s3, s31, s30
s_cmp_lt_u32 s26, 43
s_cselect_b32 s3, s3, 0x70000000
v_lshrrev_b32 v4, 1, v0
s_mov_b32 s26, 7168
v_mul_lo_u32 v4, v4, s26
v_and_b32 v5, 1, v0
v_lshl_add_u32 v162, v5, 7, v4
s_lshl_b32 s26, s21, 2
s_add_u32 s26, s26, s22
s_mul_i32 s26, s26, 229376
s_lshl_b32 s30, s23, 8
s_add_u32 s98, s26, s30
s_buffer_load_dwordx2 s[100:101], s[8:11], s3 offset:188
s_buffer_load_dwordx2 s[100:101], s[8:11], s3 offset:7356
s_buffer_load_dwordx2 s[100:101], s[8:11], s3 offset:14524
s_add_u32 s3, s3, 917504
s_buffer_load_dwordx2 s[100:101], s[8:11], s3 offset:188
s_buffer_load_dwordx2 s[100:101], s[8:11], s3 offset:7356
s_buffer_load_dwordx2 s[100:101], s[8:11], s3 offset:14524
s_add_u32 s3, s3, 917504
v_and_b32 v254, 7, v0
v_lshlrev_b32 v254, 2, v254
v_lshrrev_b32 v4, 3, v0
v_add_u32 v5, 1, v4
v_lshrrev_b32 v5, 3, v5
v_add3_u32 v4, v4, v5, 4
v_and_b32 v5, 7, v0
v_lshlrev_b32 v5, 4, v5
v_lshl_add_u32 v252, v4, 7, v5
v_add_u32 v253, 4096, v252
v_mov_b32 v248, 0
v_mov_b32 v249, 1
v_lshlrev_b32 v250, 24, v0
s_mov_b32 s96, 262144
s_lshl_b32 s26, s27, 2
s_add_u32 s26, s26, s21
s_mul_i32 s28, s26, 4096
v_add_u32 v164, s28, v252
s_xor_b32 s26, s26, 4
s_mul_i32 s28, s26, 4096
v_add_u32 v165, s28, v252
v_xor_b32 v4, v2, v3
v_lshlrev_b32 v5, 8, v3
v_add_u32 v5, s58, v5
v_xor_b32 v6, 0, v4
v_lshl_add_u32 v32, v6, 4, v5
v_xor_b32 v6, 4, v4
v_lshl_add_u32 v33, v6, 4, v5
v_xor_b32 v6, 8, v4
v_lshl_add_u32 v34, v6, 4, v5
v_xor_b32 v6, 12, v4
v_lshl_add_u32 v35, v6, 4, v5
v_lshrrev_b32 v4, 2, v3
v_cmp_eq_u32 vcc, v4, v2
v_and_b32 v5, 1, v0
v_lshlrev_b32 v5, 4, v5
v_mov_b32 v6, 0x3f80
v_lshlrev_b32 v6, v5, v6
v_cndmask_b32 v6, 0, v6, vcc
v_and_b32 v5, 2, v0
v_cmp_eq_u32 vcc, 0, v5
v_mov_b32 v168, 0
v_mov_b32 v169, 0
v_cndmask_b32 v170, 0, v6, vcc
v_sub_u32 v171, v6, v170
v_mov_b32 v172, 0
v_mov_b32 v173, 0
v_min_u32 v4, 27, v0
v_mul_u32_u24 v5, 37, v4
v_lshrrev_b32 v5, 8, v5
v_mul_u32_u24 v6, 7, v5
v_sub_u32 v4, v4, v6
v_lshlrev_b32 v4, 12, v4
v_lshl_add_u32 v13, v5, 8, v4
s_add_u32 m0, s58, 8192
s_add_u32 s56, s56, 229376
buffer_load_dwordx4 v8, s[16:19], s56 offen offset:0 nt lds
buffer_load_dwordx4 v9, s[16:19], s56 offen offset:1024 nt lds
buffer_load_dwordx4 v10, s[16:19], s56 offen offset:2048 nt lds
buffer_load_dwordx4 v11, s[16:19], s56 offen offset:3072 nt lds
s_add_u32 m0, s58, 12288
s_add_u32 s56, s56, 229376
buffer_load_dwordx4 v8, s[16:19], s56 offen offset:0 nt lds
buffer_load_dwordx4 v9, s[16:19], s56 offen offset:1024 nt lds
buffer_load_dwordx4 v10, s[16:19], s56 offen offset:2048 nt lds
buffer_load_dwordx4 v11, s[16:19], s56 offen offset:3072 nt lds
s_and_b32 s26, s22, 1
s_mul_i32 s26, s26, 917504
s_add_u32 s34, s34, s26
s_add_u32 s35, s35, s26
s_lshl_b32 s26, s26, 1
s_sub_u32 s20, 917504, s26
s_add_u32 s63, s26, 917504
s_waitcnt vmcnt(12)
v_lshlrev_b32 v40, 16, v16
v_and_b32 v41, 0xffff0000, v16
v_lshlrev_b32 v42, 16, v17
v_and_b32 v43, 0xffff0000, v17
v_lshlrev_b32 v44, 16, v18
v_and_b32 v45, 0xffff0000, v18
v_lshlrev_b32 v46, 16, v19
v_and_b32 v47, 0xffff0000, v19
v_mul_f32 v44, -v44, v40
v_mul_f32 v45, -v45, v41
v_mul_f32 v46, -v46, v42
v_mul_f32 v47, -v47, v43
v_lshlrev_b32 v48, 16, v20
v_and_b32 v49, 0xffff0000, v20
v_lshlrev_b32 v50, 16, v21
v_and_b32 v51, 0xffff0000, v21
v_lshlrev_b32 v52, 16, v22
v_and_b32 v53, 0xffff0000, v22
v_lshlrev_b32 v54, 16, v23
v_and_b32 v55, 0xffff0000, v23
v_mul_f32 v52, -v52, v48
v_mul_f32 v53, -v53, v49
v_mul_f32 v54, -v54, v50
v_mul_f32 v55, -v55, v51
v_lshlrev_b32 v56, 16, v24
v_and_b32 v57, 0xffff0000, v24
v_lshlrev_b32 v58, 16, v25
v_and_b32 v59, 0xffff0000, v25
v_lshlrev_b32 v60, 16, v26
v_and_b32 v61, 0xffff0000, v26
v_lshlrev_b32 v62, 16, v27
v_and_b32 v63, 0xffff0000, v27
v_mul_f32 v60, -v60, v56
v_mul_f32 v61, -v61, v57
v_mul_f32 v62, -v62, v58
v_mul_f32 v63, -v63, v59
v_lshlrev_b32 v64, 16, v28
v_and_b32 v65, 0xffff0000, v28
v_lshlrev_b32 v66, 16, v29
v_and_b32 v67, 0xffff0000, v29
v_lshlrev_b32 v68, 16, v30
v_and_b32 v69, 0xffff0000, v30
v_lshlrev_b32 v70, 16, v31
v_and_b32 v71, 0xffff0000, v31
v_mul_f32 v68, -v68, v64
v_mul_f32 v69, -v69, v65
v_mul_f32 v70, -v70, v66
v_mul_f32 v71, -v71, v67
ds_read_b128 v[72:75], v32 offset:0
ds_read_b128 v[76:79], v33 offset:0
ds_read_b128 v[80:83], v34 offset:0
ds_read_b128 v[84:87], v35 offset:0
s_waitcnt lgkmcnt(3)
v_cvt_f32_i32 v72, v72
v_cvt_f32_i32 v73, v73
v_cvt_f32_i32 v74, v74
v_cvt_f32_i32 v75, v75
v_fma_f32 v72, v72, v40, v44
v_fma_f32 v73, v73, v41, v45
v_fma_f32 v74, v74, v42, v46
v_fma_f32 v75, v75, v43, v47
v_cvt_pk_bf16_f32 v104, v72, v73
v_cvt_pk_bf16_f32 v105, v74, v75
s_waitcnt lgkmcnt(2)
v_cvt_f32_i32 v76, v76
v_cvt_f32_i32 v77, v77
v_cvt_f32_i32 v78, v78
v_cvt_f32_i32 v79, v79
v_fma_f32 v76, v76, v48, v52
v_fma_f32 v77, v77, v49, v53
v_fma_f32 v78, v78, v50, v54
v_fma_f32 v79, v79, v51, v55
v_cvt_pk_bf16_f32 v106, v76, v77
v_cvt_pk_bf16_f32 v107, v78, v79
buffer_store_dwordx4 v[104:107], v252, s[4:7], s59 offen offset:0 sc1
s_waitcnt lgkmcnt(1)
v_cvt_f32_i32 v80, v80
v_cvt_f32_i32 v81, v81
v_cvt_f32_i32 v82, v82
v_cvt_f32_i32 v83, v83
v_fma_f32 v80, v80, v56, v60
v_fma_f32 v81, v81, v57, v61
v_fma_f32 v82, v82, v58, v62
v_fma_f32 v83, v83, v59, v63
v_cvt_pk_bf16_f32 v108, v80, v81
v_cvt_pk_bf16_f32 v109, v82, v83
s_waitcnt lgkmcnt(0)
v_cvt_f32_i32 v84, v84
v_cvt_f32_i32 v85, v85
v_cvt_f32_i32 v86, v86
v_cvt_f32_i32 v87, v87
v_fma_f32 v84, v84, v64, v68
v_fma_f32 v85, v85, v65, v69
v_fma_f32 v86, v86, v66, v70
v_fma_f32 v87, v87, v67, v71
v_cvt_pk_bf16_f32 v110, v84, v85
v_cvt_pk_bf16_f32 v111, v86, v87
buffer_store_dwordx4 v[108:111], v252, s[4:7], s60 offen offset:0 sc1
s_waitcnt vmcnt(10)
ds_read_b128 v[88:91], v32 offset:4096
ds_read_b128 v[92:95], v33 offset:4096
ds_read_b128 v[96:99], v34 offset:4096
ds_read_b128 v[100:103], v35 offset:4096
s_waitcnt lgkmcnt(3)
v_cvt_f32_i32 v88, v88
v_cvt_f32_i32 v89, v89
v_cvt_f32_i32 v90, v90
v_cvt_f32_i32 v91, v91
v_fma_f32 v88, v88, v40, v44
v_fma_f32 v89, v89, v41, v45
v_fma_f32 v90, v90, v42, v46
v_fma_f32 v91, v91, v43, v47
v_cvt_pk_bf16_f32 v112, v88, v89
v_cvt_pk_bf16_f32 v113, v90, v91
s_waitcnt lgkmcnt(2)
v_cvt_f32_i32 v92, v92
v_cvt_f32_i32 v93, v93
v_cvt_f32_i32 v94, v94
v_cvt_f32_i32 v95, v95
v_fma_f32 v92, v92, v48, v52
v_fma_f32 v93, v93, v49, v53
v_fma_f32 v94, v94, v50, v54
v_fma_f32 v95, v95, v51, v55
v_cvt_pk_bf16_f32 v114, v92, v93
v_cvt_pk_bf16_f32 v115, v94, v95
buffer_store_dwordx4 v[112:115], v252, s[4:7], s59 offen offset:2048 sc1
s_waitcnt lgkmcnt(1)
v_cvt_f32_i32 v96, v96
v_cvt_f32_i32 v97, v97
v_cvt_f32_i32 v98, v98
v_cvt_f32_i32 v99, v99
v_fma_f32 v96, v96, v56, v60
v_fma_f32 v97, v97, v57, v61
v_fma_f32 v98, v98, v58, v62
v_fma_f32 v99, v99, v59, v63
v_cvt_pk_bf16_f32 v116, v96, v97
v_cvt_pk_bf16_f32 v117, v98, v99
s_waitcnt lgkmcnt(0)
v_cvt_f32_i32 v100, v100
v_cvt_f32_i32 v101, v101
v_cvt_f32_i32 v102, v102
v_cvt_f32_i32 v103, v103
v_fma_f32 v100, v100, v64, v68
v_fma_f32 v101, v101, v65, v69
v_fma_f32 v102, v102, v66, v70
v_fma_f32 v103, v103, v67, v71
v_cvt_pk_bf16_f32 v118, v100, v101
v_cvt_pk_bf16_f32 v119, v102, v103
buffer_store_dwordx4 v[116:119], v252, s[4:7], s60 offen offset:2048 sc1
s_waitcnt vmcnt(8)
ds_read_b128 v[72:75], v32 offset:8192
ds_read_b128 v[76:79], v33 offset:8192
ds_read_b128 v[80:83], v34 offset:8192
ds_read_b128 v[84:87], v35 offset:8192
s_waitcnt lgkmcnt(3)
v_cvt_f32_i32 v72, v72
v_cvt_f32_i32 v73, v73
v_cvt_f32_i32 v74, v74
v_cvt_f32_i32 v75, v75
v_fma_f32 v72, v72, v40, v44
v_fma_f32 v73, v73, v41, v45
v_fma_f32 v74, v74, v42, v46
v_fma_f32 v75, v75, v43, v47
v_cvt_pk_bf16_f32 v104, v72, v73
v_cvt_pk_bf16_f32 v105, v74, v75
s_waitcnt lgkmcnt(2)
v_cvt_f32_i32 v76, v76
v_cvt_f32_i32 v77, v77
v_cvt_f32_i32 v78, v78
v_cvt_f32_i32 v79, v79
v_fma_f32 v76, v76, v48, v52
v_fma_f32 v77, v77, v49, v53
v_fma_f32 v78, v78, v50, v54
v_fma_f32 v79, v79, v51, v55
v_cvt_pk_bf16_f32 v106, v76, v77
v_cvt_pk_bf16_f32 v107, v78, v79
buffer_store_dwordx4 v[104:107], v253, s[4:7], s59 offen offset:0 sc1
s_waitcnt lgkmcnt(1)
v_cvt_f32_i32 v80, v80
v_cvt_f32_i32 v81, v81
v_cvt_f32_i32 v82, v82
v_cvt_f32_i32 v83, v83
v_fma_f32 v80, v80, v56, v60
v_fma_f32 v81, v81, v57, v61
v_fma_f32 v82, v82, v58, v62
v_fma_f32 v83, v83, v59, v63
v_cvt_pk_bf16_f32 v108, v80, v81
v_cvt_pk_bf16_f32 v109, v82, v83
s_waitcnt lgkmcnt(0)
v_cvt_f32_i32 v84, v84
v_cvt_f32_i32 v85, v85
v_cvt_f32_i32 v86, v86
v_cvt_f32_i32 v87, v87
v_fma_f32 v84, v84, v64, v68
v_fma_f32 v85, v85, v65, v69
v_fma_f32 v86, v86, v66, v70
v_fma_f32 v87, v87, v67, v71
v_cvt_pk_bf16_f32 v110, v84, v85
v_cvt_pk_bf16_f32 v111, v86, v87
buffer_store_dwordx4 v[108:111], v253, s[4:7], s60 offen offset:0 sc1
s_waitcnt vmcnt(6)
ds_read_b128 v[88:91], v32 offset:12288
ds_read_b128 v[92:95], v33 offset:12288
ds_read_b128 v[96:99], v34 offset:12288
ds_read_b128 v[100:103], v35 offset:12288
buffer_load_dword v251, v248, s[48:51], 0 offen sc1
s_waitcnt lgkmcnt(3)
v_cvt_f32_i32 v88, v88
v_cvt_f32_i32 v89, v89
v_cvt_f32_i32 v90, v90
v_cvt_f32_i32 v91, v91
v_fma_f32 v88, v88, v40, v44
v_fma_f32 v89, v89, v41, v45
v_fma_f32 v90, v90, v42, v46
v_fma_f32 v91, v91, v43, v47
v_cvt_pk_bf16_f32 v112, v88, v89
v_cvt_pk_bf16_f32 v113, v90, v91
s_waitcnt lgkmcnt(2)
v_cvt_f32_i32 v92, v92
v_cvt_f32_i32 v93, v93
v_cvt_f32_i32 v94, v94
v_cvt_f32_i32 v95, v95
v_fma_f32 v92, v92, v48, v52
v_fma_f32 v93, v93, v49, v53
v_fma_f32 v94, v94, v50, v54
v_fma_f32 v95, v95, v51, v55
v_cvt_pk_bf16_f32 v114, v92, v93
v_cvt_pk_bf16_f32 v115, v94, v95
buffer_store_dwordx4 v[112:115], v253, s[4:7], s59 offen offset:2048 sc1
s_waitcnt lgkmcnt(1)
v_cvt_f32_i32 v96, v96
v_cvt_f32_i32 v97, v97
v_cvt_f32_i32 v98, v98
v_cvt_f32_i32 v99, v99
v_fma_f32 v96, v96, v56, v60
v_fma_f32 v97, v97, v57, v61
v_fma_f32 v98, v98, v58, v62
v_fma_f32 v99, v99, v59, v63
v_cvt_pk_bf16_f32 v116, v96, v97
v_cvt_pk_bf16_f32 v117, v98, v99
s_waitcnt lgkmcnt(0)
v_cvt_f32_i32 v100, v100
v_cvt_f32_i32 v101, v101
v_cvt_f32_i32 v102, v102
v_cvt_f32_i32 v103, v103
v_fma_f32 v100, v100, v64, v68
v_fma_f32 v101, v101, v65, v69
v_fma_f32 v102, v102, v66, v70
v_fma_f32 v103, v103, v67, v71
v_cvt_pk_bf16_f32 v118, v100, v101
v_cvt_pk_bf16_f32 v119, v102, v103
buffer_store_dwordx4 v[116:119], v253, s[4:7], s60 offen offset:2048 sc1
s_barrier
s_add_u32 m0, s52, 16512
s_nop 0
buffer_load_dwordx4 v244, s[8:11], s35 offen offset:0  lds
buffer_load_dwordx4 v245, s[8:11], s35 offen offset:1024  lds
buffer_load_dwordx4 v246, s[8:11], s35 offen offset:2048  lds
buffer_load_dwordx4 v247, s[8:11], s35 offen offset:3072  lds
s_add_u32 s35, s35, s20
s_add_u32 m0, s52, 0
s_nop 0
buffer_load_dwordx4 v244, s[8:11], s34 offen offset:0  lds
buffer_load_dwordx4 v245, s[8:11], s34 offen offset:1024  lds
buffer_load_dwordx4 v246, s[8:11], s34 offen offset:2048  lds
buffer_load_dwordx4 v247, s[8:11], s34 offen offset:3072  lds
s_add_u32 s34, s34, s20
s_buffer_load_dwordx2 s[100:101], s[8:11], s3 offset:188
s_buffer_load_dwordx2 s[100:101], s[8:11], s3 offset:7356
s_buffer_load_dwordx2 s[100:101], s[8:11], s3 offset:14524
s_add_u32 s3, s3, 917504
s_buffer_load_dwordx2 s[100:101], s[8:11], s3 offset:188
s_buffer_load_dwordx2 s[100:101], s[8:11], s3 offset:7356
s_buffer_load_dwordx2 s[100:101], s[8:11], s3 offset:14524
s_add_u32 s3, s3, 917504
s_lshl_b32 s26, s27, 2
s_add_u32 s26, s26, s22
s_lshl_b32 s61, s26, 7
s_lshl_b32 s41, s22, 3
s_add_u32 s41, s41, s27
s_add_u32 s41, s41, 32
s_lshl_b32 s41, s41, 7
s_lshl_b32 s99, s2, 7
s_lshl_b32 s28, s26, 2
s_add_u32 s28, s28, s21
s_mul_i32 s29, s28, 262144
s_add_u32 s29, s29, 33554432
s_add_u32 s16, s24, s29
s_addc_u32 s17, s25, 0
s_mov_b32 s18, 262144
s_mov_b32 s19, 0x20000
s_mul_i32 s28, s28, 458752
s_lshl_b32 s29, s23, 8
s_add_u32 s42, s28, s29
s_lshl_b32 s36, s22, 1
s_add_u32 s36, s36, s27
s_mul_i32 s37, s23, 524288
s_mul_i32 s31, s21, 16384
s_add_u32 s38, s37, s31
s_mul_i32 s31, s36, 65536
s_add_u32 s38, s38, s31
s_mul_i32 s31, s21, 4096
s_add_u32 s37, s37, s31
s_lshl_b32 s39, s21, 2
s_add_u32 s39, s39, 96
s_add_u32 s62, s99, s39
s_lshl_b32 s43, s21, 13
s_mov_b32 s30, 1677878304
s_mov_b32 s31, 1107714564
s_lshl_b32 s29, s22, 4
s_lshr_b64 s[30:31], s[30:31], s29
s_and_b32 s30, s30, 0xffff
s_mov_b32 s31, 0x64200000
s_or_b32 s36, s30, s31
s_lshl_b32 s29, s27, 4
s_lshr_b32 s30, 0x11110000, s29
s_or_b32 s36, s36, s30
s_andn2_b32 s39, s99, 3200
s_add_u32 s39, s39, 96
v_and_b32 v4, 3, v0
v_mov_b32 v5, 4
v_bfe_u32 v5, s36, v5, 4
v_lshrrev_b32 v6, 1, v5
v_and_b32 v5, 1, v5
v_lshlrev_b32 v5, 7, v5
v_lshl_add_u32 v5, v6, 10, v5
v_lshl_add_u32 v167, v4, 2, v5
v_bfe_u32 v5, v0, 2, 1
v_lshl_add_u32 v5, v5, 2, 8
v_bfe_u32 v5, s36, v5, 4
v_lshrrev_b32 v6, 1, v5
v_and_b32 v5, 1, v5
v_lshlrev_b32 v5, 7, v5
v_lshl_add_u32 v5, v6, 10, v5
v_lshl_add_u32 v242, v4, 2, v5
v_bfe_u32 v5, v0, 2, 2
v_lshl_add_u32 v5, v5, 2, 16
v_bfe_u32 v5, s36, v5, 4
v_lshrrev_b32 v6, 1, v5
v_and_b32 v5, 1, v5
v_lshlrev_b32 v5, 7, v5
v_lshl_add_u32 v5, v6, 10, v5
v_lshl_add_u32 v166, v4, 2, v5
v_bfe_u32 v5, v0, 2, 2
v_lshlrev_b32 v5, 10, v5
v_lshl_add_u32 v182, v4, 2, v5
s_mov_b32 s26, 28672
v_mul_lo_u32 v4, v2, s26
v_lshl_add_u32 v183, v3, 4, v4
v_lshrrev_b32 v4, 1, v3
v_and_b32 v5, 1, v3
v_lshl_add_u32 v5, v5, 3, v4
v_lshlrev_b32 v5, 4, v5
v_lshl_add_u32 v5, v2, 8, v5
v_lshl_add_u32 v5, v4, 10, v5
v_lshlrev_b32 v6, 4, v0
s_add_u32 s26, s43, 66048
v_add_u32 v6, s26, v6
s_lshl_b32 s43, s21, 11
v_xor_b32 v174, 0, v252
v_xor_b32 v232, 0, v6
v_xor_b32 v216, 0, v5
v_add_u32 v224, 66048, v216
v_xor_b32 v175, 16, v252
v_xor_b32 v233, 16, v6
v_xor_b32 v217, 16, v5
v_add_u32 v225, 66048, v217
v_xor_b32 v176, 32, v252
v_xor_b32 v234, 32, v6
v_xor_b32 v218, 32, v5
v_add_u32 v226, 66048, v218
v_xor_b32 v177, 48, v252
v_xor_b32 v235, 48, v6
v_xor_b32 v219, 48, v5
v_add_u32 v227, 66048, v219
v_xor_b32 v178, 64, v252
v_xor_b32 v236, 64, v6
v_xor_b32 v220, 64, v5
v_add_u32 v228, 66048, v220
v_xor_b32 v179, 80, v252
v_xor_b32 v237, 80, v6
v_xor_b32 v221, 80, v5
v_add_u32 v229, 66048, v221
v_xor_b32 v180, 96, v252
v_xor_b32 v238, 96, v6
v_xor_b32 v222, 96, v5
v_add_u32 v230, 66048, v222
v_xor_b32 v181, 112, v252
v_xor_b32 v239, 112, v6
v_xor_b32 v223, 112, v5
v_add_u32 v231, 66048, v223
v_add_u32 v241, 1024, v252
s_waitcnt vmcnt(8)
s_barrier
s_cmp_lg_u32 s21, 0
s_cbranch_scc1 standalone__weight_only_int_quip__prompt_kernel_h1_pub
v_cmp_eq_u32 vcc, 0, v251
s_cbranch_vccnz standalone__weight_only_int_quip__prompt_kernel_init_spin
standalone__weight_only_int_quip__prompt_kernel_init_ok:
buffer_store_dword v249, v250, s[44:47], s99 offen sc1
standalone__weight_only_int_quip__prompt_kernel_h1_pub:
s_add_u32 m0, s52, 49536
s_nop 0
buffer_load_dwordx4 v244, s[8:11], s35 offen offset:0  lds
buffer_load_dwordx4 v245, s[8:11], s35 offen offset:1024  lds
buffer_load_dwordx4 v246, s[8:11], s35 offen offset:2048  lds
buffer_load_dwordx4 v247, s[8:11], s35 offen offset:3072  lds
s_add_u32 s35, s35, s63
s_add_u32 m0, s52, 33024
s_nop 0
buffer_load_dwordx4 v244, s[8:11], s34 offen offset:0  lds
buffer_load_dwordx4 v245, s[8:11], s34 offen offset:1024  lds
buffer_load_dwordx4 v246, s[8:11], s34 offen offset:2048  lds
buffer_load_dwordx4 v247, s[8:11], s34 offen offset:3072  lds
s_add_u32 s34, s34, s63
s_buffer_load_dwordx2 s[100:101], s[8:11], s3 offset:188
s_buffer_load_dwordx2 s[100:101], s[8:11], s3 offset:7356
s_buffer_load_dwordx2 s[100:101], s[8:11], s3 offset:14524
s_add_u32 s3, s3, 917504
s_add_u32 s56, s24, 50331648
s_addc_u32 s57, s25, 0
s_mov_b32 s58, 14680064
s_mov_b32 s59, 0x20000
s_sub_u32 s26, s2, 32
s_lshl_b32 s30, s26, 2
s_add_u32 s30, s30, s21
s_xor_b32 s31, s30, 4
s_mul_i32 s97, s30, 16384
s_mul_i32 s98, s31, 16384
s_sub_u32 s99, s62, 80
s_xor_b32 s55, s99, 128
s_mov_b32 s32, 0
s_mov_b32 s33, 1441792
s_mov_b32 s60, 4
s_and_b32 s26, s22, 1
s_mul_i32 s32, s26, 131072
s_xor_b32 s33, s33, s32
s_lshl_b32 s26, s32, 1
s_sub_u32 s30, 32768, s26
s_add_u32 s31, s26, 32768
s_mov_b32 s60, 3
s_and_b32 s26, s23, 0
s_mul_i32 s51, s26, 32768
s_xor_b32 s49, s32, s51
s_xor_b32 s50, s33, s51
s_lshr_b32 s26, s22, 1
s_lshl_b32 s23, s26, 7
s_mul_i32 s28, s26, 16512
s_sub_u32 s29, 16512, s28
s_cmp_lg_u32 s21, 0
s_cbranch_scc1 standalone__weight_only_int_quip__prompt_kernel_h1_ok
v_mov_b32 v162, v13
v_cmp_gt_u32 vcc, 4, v0
s_nop 1
v_cndmask_b32 v13, 0, v13, vcc
standalone__weight_only_int_quip__prompt_kernel_h1_spin:
buffer_load_dword v251, v13, s[44:47], s41 offen sc1
s_waitcnt vmcnt(0)
s_sub_u32 s96, s96, 1
s_cmp_lt_i32 s96, 1
s_cbranch_scc1 standalone__weight_only_int_quip__prompt_kernel_h1_ok
v_cmp_eq_u32 vcc, 0, v251
s_cbranch_vccnz standalone__weight_only_int_quip__prompt_kernel_h1_spin
standalone__weight_only_int_quip__prompt_kernel_h1_ok:
s_waitcnt vmcnt(8)
s_barrier
buffer_load_dwordx4 a[0:3], v164, s[4:7], s32 offen offset:0 sc1
buffer_load_dwordx4 a[4:7], v164, s[4:7], s32 offen offset:2048 sc1
buffer_load_dwordx4 a[8:11], v165, s[4:7], s32 offen offset:0 sc1
buffer_load_dwordx4 a[12:15], v165, s[4:7], s32 offen offset:2048 sc1
s_add_u32 s32, s32, 32768
buffer_load_dwordx4 a[16:19], v164, s[4:7], s32 offen offset:0 sc1
buffer_load_dwordx4 a[20:23], v164, s[4:7], s32 offen offset:2048 sc1
buffer_load_dwordx4 a[24:27], v165, s[4:7], s32 offen offset:0 sc1
buffer_load_dwordx4 a[28:31], v165, s[4:7], s32 offen offset:2048 sc1
s_add_u32 s32, s32, 32768
ds_read_b64_tr_b16 v[128:129], v160 offset:0
ds_read_b64_tr_b16 v[130:131], v160 offset:512
ds_read_b64_tr_b16 v[132:133], v160 offset:32
ds_read_b64_tr_b16 v[134:135], v160 offset:544
ds_read_b64_tr_b16 v[136:137], v160 offset:64
ds_read_b64_tr_b16 v[138:139], v160 offset:576
ds_read_b64_tr_b16 v[140:141], v160 offset:96
ds_read_b64_tr_b16 v[142:143], v160 offset:608
ds_read_b64_tr_b16 v[144:145], v160 offset:16512
ds_read_b64_tr_b16 v[146:147], v160 offset:17024
ds_read_b64_tr_b16 v[148:149], v160 offset:16544
ds_read_b64_tr_b16 v[150:151], v160 offset:17056
s_waitcnt vmcnt(7) lgkmcnt(10)
v_mfma_f32_16x16x32_bf16 v[0:3], a[0:3], v[128:131], 0
s_waitcnt vmcnt(6)
ds_read_b64_tr_b16 v[152:153], v160 offset:16576
v_mfma_f32_16x16x32_bf16 v[32:35], a[4:7], v[128:131], 0
s_waitcnt vmcnt(5)
ds_read_b64_tr_b16 v[154:155], v160 offset:17088
v_mfma_f32_16x16x32_bf16 v[64:67], a[8:11], v[128:131], 0
s_waitcnt vmcnt(4)
buffer_load_dwordx4 a[32:35], v164, s[4:7], s32 offen offset:0 sc1
v_mfma_f32_16x16x32_bf16 v[96:99], a[12:15], v[128:131], 0
s_waitcnt lgkmcnt(10)
v_mfma_f32_16x16x32_bf16 v[4:7], a[0:3], v[132:135], 0
ds_read_b64_tr_b16 v[156:157], v160 offset:16608
v_mfma_f32_16x16x32_bf16 v[36:39], a[4:7], v[132:135], 0
ds_read_b64_tr_b16 v[158:159], v160 offset:17120
v_mfma_f32_16x16x32_bf16 v[68:71], a[8:11], v[132:135], 0
buffer_load_dwordx4 a[36:39], v164, s[4:7], s32 offen offset:2048 sc1
v_mfma_f32_16x16x32_bf16 v[100:103], a[12:15], v[132:135], 0
s_waitcnt lgkmcnt(10)
s_buffer_load_dwordx2 s[100:101], s[8:11], s3 offset:188
v_mfma_f32_16x16x32_bf16 v[8:11], a[0:3], v[136:139], 0
ds_read_b64_tr_b16 v[128:129], v160 offset:1024
v_mfma_f32_16x16x32_bf16 v[40:43], a[4:7], v[136:139], 0
ds_read_b64_tr_b16 v[130:131], v160 offset:1536
v_mfma_f32_16x16x32_bf16 v[72:75], a[8:11], v[136:139], 0
buffer_load_dwordx4 a[40:43], v165, s[4:7], s32 offen offset:0 sc1
v_mfma_f32_16x16x32_bf16 v[104:107], a[12:15], v[136:139], 0
s_waitcnt lgkmcnt(10)
v_mfma_f32_16x16x32_bf16 v[12:15], a[0:3], v[140:143], 0
ds_read_b64_tr_b16 v[132:133], v160 offset:1056
v_mfma_f32_16x16x32_bf16 v[44:47], a[4:7], v[140:143], 0
ds_read_b64_tr_b16 v[134:135], v160 offset:1568
v_mfma_f32_16x16x32_bf16 v[76:79], a[8:11], v[140:143], 0
buffer_load_dwordx4 a[44:47], v165, s[4:7], s32 offen offset:2048 sc1
v_mfma_f32_16x16x32_bf16 v[108:111], a[12:15], v[140:143], 0
s_waitcnt lgkmcnt(10)
s_add_u32 s32, s32, 32768
v_mfma_f32_16x16x32_bf16 v[16:19], a[0:3], v[144:147], 0
ds_read_b64_tr_b16 v[136:137], v160 offset:1088
v_mfma_f32_16x16x32_bf16 v[48:51], a[4:7], v[144:147], 0
ds_read_b64_tr_b16 v[138:139], v160 offset:1600
v_mfma_f32_16x16x32_bf16 v[80:83], a[8:11], v[144:147], 0
buffer_load_dwordx4 a[48:51], v164, s[4:7], s32 offen offset:0 sc1
v_mfma_f32_16x16x32_bf16 v[112:115], a[12:15], v[144:147], 0
s_waitcnt lgkmcnt(10)
v_mfma_f32_16x16x32_bf16 v[20:23], a[0:3], v[148:151], 0
ds_read_b64_tr_b16 v[140:141], v160 offset:1120
v_mfma_f32_16x16x32_bf16 v[52:55], a[4:7], v[148:151], 0
ds_read_b64_tr_b16 v[142:143], v160 offset:1632
v_mfma_f32_16x16x32_bf16 v[84:87], a[8:11], v[148:151], 0
buffer_load_dwordx4 a[52:55], v164, s[4:7], s32 offen offset:2048 sc1
v_mfma_f32_16x16x32_bf16 v[116:119], a[12:15], v[148:151], 0
s_waitcnt lgkmcnt(10)
v_mfma_f32_16x16x32_bf16 v[24:27], a[0:3], v[152:155], 0
ds_read_b64_tr_b16 v[144:145], v160 offset:17536
v_mfma_f32_16x16x32_bf16 v[56:59], a[4:7], v[152:155], 0
ds_read_b64_tr_b16 v[146:147], v160 offset:18048
v_mfma_f32_16x16x32_bf16 v[88:91], a[8:11], v[152:155], 0
buffer_load_dwordx4 a[56:59], v165, s[4:7], s32 offen offset:0 sc1
v_mfma_f32_16x16x32_bf16 v[120:123], a[12:15], v[152:155], 0
s_waitcnt lgkmcnt(10)
v_mfma_f32_16x16x32_bf16 v[28:31], a[0:3], v[156:159], 0
ds_read_b64_tr_b16 v[148:149], v160 offset:17568
v_mfma_f32_16x16x32_bf16 v[60:63], a[4:7], v[156:159], 0
ds_read_b64_tr_b16 v[150:151], v160 offset:18080
v_mfma_f32_16x16x32_bf16 v[92:95], a[8:11], v[156:159], 0
buffer_load_dwordx4 a[60:63], v165, s[4:7], s32 offen offset:2048 sc1
v_mfma_f32_16x16x32_bf16 v[124:127], a[12:15], v[156:159], 0
s_waitcnt vmcnt(11) lgkmcnt(10)
s_add_u32 s32, s32, s30
v_mfma_f32_16x16x32_bf16 v[0:3], a[16:19], v[128:131], v[0:3]
s_waitcnt vmcnt(10)
ds_read_b64_tr_b16 v[152:153], v160 offset:17600
v_mfma_f32_16x16x32_bf16 v[32:35], a[20:23], v[128:131], v[32:35]
s_waitcnt vmcnt(9)
ds_read_b64_tr_b16 v[154:155], v160 offset:18112
v_mfma_f32_16x16x32_bf16 v[64:67], a[24:27], v[128:131], v[64:67]
s_waitcnt vmcnt(8)
buffer_load_dwordx4 a[64:67], v164, s[4:7], s32 offen offset:0 sc1
v_mfma_f32_16x16x32_bf16 v[96:99], a[28:31], v[128:131], v[96:99]
s_waitcnt lgkmcnt(10)
v_mfma_f32_16x16x32_bf16 v[4:7], a[16:19], v[132:135], v[4:7]
ds_read_b64_tr_b16 v[156:157], v160 offset:17632
v_mfma_f32_16x16x32_bf16 v[36:39], a[20:23], v[132:135], v[36:39]
ds_read_b64_tr_b16 v[158:159], v160 offset:18144
v_mfma_f32_16x16x32_bf16 v[68:71], a[24:27], v[132:135], v[68:71]
buffer_load_dwordx4 a[68:71], v164, s[4:7], s32 offen offset:2048 sc1
v_mfma_f32_16x16x32_bf16 v[100:103], a[28:31], v[132:135], v[100:103]
s_waitcnt lgkmcnt(10)
v_mfma_f32_16x16x32_bf16 v[8:11], a[16:19], v[136:139], v[8:11]
ds_read_b64_tr_b16 v[128:129], v160 offset:2048
v_mfma_f32_16x16x32_bf16 v[40:43], a[20:23], v[136:139], v[40:43]
ds_read_b64_tr_b16 v[130:131], v160 offset:2560
v_mfma_f32_16x16x32_bf16 v[72:75], a[24:27], v[136:139], v[72:75]
buffer_load_dwordx4 a[72:75], v165, s[4:7], s32 offen offset:0 sc1
v_mfma_f32_16x16x32_bf16 v[104:107], a[28:31], v[136:139], v[104:107]
s_waitcnt lgkmcnt(10)
v_mfma_f32_16x16x32_bf16 v[12:15], a[16:19], v[140:143], v[12:15]
ds_read_b64_tr_b16 v[132:133], v160 offset:2080
v_mfma_f32_16x16x32_bf16 v[44:47], a[20:23], v[140:143], v[44:47]
ds_read_b64_tr_b16 v[134:135], v160 offset:2592
v_mfma_f32_16x16x32_bf16 v[76:79], a[24:27], v[140:143], v[76:79]
buffer_load_dwordx4 a[76:79], v165, s[4:7], s32 offen offset:2048 sc1
v_mfma_f32_16x16x32_bf16 v[108:111], a[28:31], v[140:143], v[108:111]
s_waitcnt lgkmcnt(10)
s_add_u32 s32, s32, 32768
s_buffer_load_dwordx2 s[100:101], s[8:11], s3 offset:7356
v_mfma_f32_16x16x32_bf16 v[16:19], a[16:19], v[144:147], v[16:19]
ds_read_b64_tr_b16 v[136:137], v160 offset:2112
v_mfma_f32_16x16x32_bf16 v[48:51], a[20:23], v[144:147], v[48:51]
ds_read_b64_tr_b16 v[138:139], v160 offset:2624
v_mfma_f32_16x16x32_bf16 v[80:83], a[24:27], v[144:147], v[80:83]
buffer_load_dwordx4 a[80:83], v164, s[4:7], s32 offen offset:0 sc1
v_mfma_f32_16x16x32_bf16 v[112:115], a[28:31], v[144:147], v[112:115]
s_waitcnt lgkmcnt(10)
v_mfma_f32_16x16x32_bf16 v[20:23], a[16:19], v[148:151], v[20:23]
ds_read_b64_tr_b16 v[140:141], v160 offset:2144
v_mfma_f32_16x16x32_bf16 v[52:55], a[20:23], v[148:151], v[52:55]
ds_read_b64_tr_b16 v[142:143], v160 offset:2656
v_mfma_f32_16x16x32_bf16 v[84:87], a[24:27], v[148:151], v[84:87]
buffer_load_dwordx4 a[84:87], v164, s[4:7], s32 offen offset:2048 sc1
v_mfma_f32_16x16x32_bf16 v[116:119], a[28:31], v[148:151], v[116:119]
s_waitcnt lgkmcnt(10)
v_mfma_f32_16x16x32_bf16 v[24:27], a[16:19], v[152:155], v[24:27]
ds_read_b64_tr_b16 v[144:145], v160 offset:18560
v_mfma_f32_16x16x32_bf16 v[56:59], a[20:23], v[152:155], v[56:59]
ds_read_b64_tr_b16 v[146:147], v160 offset:19072
s_cmp_lg_u32 s21, 0
s_cbranch_scc1 standalone__weight_only_int_quip__prompt_kernel_nop1b
buffer_load_dword v251, v162, s[44:47], s41 offen sc1
standalone__weight_only_int_quip__prompt_kernel_nop1b:
v_mfma_f32_16x16x32_bf16 v[88:91], a[24:27], v[152:155], v[88:91]
buffer_load_dwordx4 a[88:91], v165, s[4:7], s32 offen offset:0 sc1
v_mfma_f32_16x16x32_bf16 v[120:123], a[28:31], v[152:155], v[120:123]
s_waitcnt lgkmcnt(10)
v_mfma_f32_16x16x32_bf16 v[28:31], a[16:19], v[156:159], v[28:31]
ds_read_b64_tr_b16 v[148:149], v160 offset:18592
v_mfma_f32_16x16x32_bf16 v[60:63], a[20:23], v[156:159], v[60:63]
ds_read_b64_tr_b16 v[150:151], v160 offset:19104
v_mfma_f32_16x16x32_bf16 v[92:95], a[24:27], v[156:159], v[92:95]
buffer_load_dwordx4 a[92:95], v165, s[4:7], s32 offen offset:2048 sc1
v_mfma_f32_16x16x32_bf16 v[124:127], a[28:31], v[156:159], v[124:127]
s_waitcnt vmcnt(15) lgkmcnt(10)
s_add_u32 s32, s32, 32768
v_mfma_f32_16x16x32_bf16 v[0:3], a[32:35], v[128:131], v[0:3]
s_waitcnt vmcnt(14)
ds_read_b64_tr_b16 v[152:153], v160 offset:18624
v_mfma_f32_16x16x32_bf16 v[32:35], a[36:39], v[128:131], v[32:35]
s_waitcnt vmcnt(13)
ds_read_b64_tr_b16 v[154:155], v160 offset:19136
v_mfma_f32_16x16x32_bf16 v[64:67], a[40:43], v[128:131], v[64:67]
s_waitcnt vmcnt(12)
buffer_load_dwordx4 a[96:99], v164, s[4:7], s32 offen offset:0 sc1
v_mfma_f32_16x16x32_bf16 v[96:99], a[44:47], v[128:131], v[96:99]
s_waitcnt lgkmcnt(10)
v_mfma_f32_16x16x32_bf16 v[4:7], a[32:35], v[132:135], v[4:7]
ds_read_b64_tr_b16 v[156:157], v160 offset:18656
v_mfma_f32_16x16x32_bf16 v[36:39], a[36:39], v[132:135], v[36:39]
ds_read_b64_tr_b16 v[158:159], v160 offset:19168
v_mfma_f32_16x16x32_bf16 v[68:71], a[40:43], v[132:135], v[68:71]
buffer_load_dwordx4 a[100:103], v164, s[4:7], s32 offen offset:2048 sc1
v_mfma_f32_16x16x32_bf16 v[100:103], a[44:47], v[132:135], v[100:103]
s_waitcnt lgkmcnt(10)
v_mfma_f32_16x16x32_bf16 v[8:11], a[32:35], v[136:139], v[8:11]
ds_read_b64_tr_b16 v[128:129], v160 offset:3072
v_mfma_f32_16x16x32_bf16 v[40:43], a[36:39], v[136:139], v[40:43]
ds_read_b64_tr_b16 v[130:131], v160 offset:3584
v_mfma_f32_16x16x32_bf16 v[72:75], a[40:43], v[136:139], v[72:75]
buffer_load_dwordx4 a[104:107], v165, s[4:7], s32 offen offset:0 sc1
v_mfma_f32_16x16x32_bf16 v[104:107], a[44:47], v[136:139], v[104:107]
s_waitcnt lgkmcnt(10)
v_mfma_f32_16x16x32_bf16 v[12:15], a[32:35], v[140:143], v[12:15]
ds_read_b64_tr_b16 v[132:133], v160 offset:3104
v_mfma_f32_16x16x32_bf16 v[44:47], a[36:39], v[140:143], v[44:47]
ds_read_b64_tr_b16 v[134:135], v160 offset:3616
v_mfma_f32_16x16x32_bf16 v[76:79], a[40:43], v[140:143], v[76:79]
buffer_load_dwordx4 a[108:111], v165, s[4:7], s32 offen offset:2048 sc1
v_mfma_f32_16x16x32_bf16 v[108:111], a[44:47], v[140:143], v[108:111]
s_waitcnt lgkmcnt(10)
s_add_u32 s32, s32, 32768
v_mfma_f32_16x16x32_bf16 v[16:19], a[32:35], v[144:147], v[16:19]
ds_read_b64_tr_b16 v[136:137], v160 offset:3136
v_mfma_f32_16x16x32_bf16 v[48:51], a[36:39], v[144:147], v[48:51]
ds_read_b64_tr_b16 v[138:139], v160 offset:3648
v_mfma_f32_16x16x32_bf16 v[80:83], a[40:43], v[144:147], v[80:83]
buffer_load_dwordx4 a[112:115], v164, s[4:7], s32 offen offset:0 sc1
v_mfma_f32_16x16x32_bf16 v[112:115], a[44:47], v[144:147], v[112:115]
s_waitcnt lgkmcnt(10)
v_mfma_f32_16x16x32_bf16 v[20:23], a[32:35], v[148:151], v[20:23]
ds_read_b64_tr_b16 v[140:141], v160 offset:3168
v_mfma_f32_16x16x32_bf16 v[52:55], a[36:39], v[148:151], v[52:55]
ds_read_b64_tr_b16 v[142:143], v160 offset:3680
v_mfma_f32_16x16x32_bf16 v[84:87], a[40:43], v[148:151], v[84:87]
buffer_load_dwordx4 a[116:119], v164, s[4:7], s32 offen offset:2048 sc1
v_mfma_f32_16x16x32_bf16 v[116:119], a[44:47], v[148:151], v[116:119]
s_waitcnt lgkmcnt(10)
s_buffer_load_dwordx2 s[100:101], s[8:11], s3 offset:14524
s_add_u32 s3, s3, 917504
v_mfma_f32_16x16x32_bf16 v[24:27], a[32:35], v[152:155], v[24:27]
ds_read_b64_tr_b16 v[144:145], v160 offset:19584
v_mfma_f32_16x16x32_bf16 v[56:59], a[36:39], v[152:155], v[56:59]
ds_read_b64_tr_b16 v[146:147], v160 offset:20096
v_mfma_f32_16x16x32_bf16 v[88:91], a[40:43], v[152:155], v[88:91]
buffer_load_dwordx4 a[120:123], v165, s[4:7], s32 offen offset:0 sc1
v_mfma_f32_16x16x32_bf16 v[120:123], a[44:47], v[152:155], v[120:123]
s_waitcnt lgkmcnt(10)
v_mfma_f32_16x16x32_bf16 v[28:31], a[32:35], v[156:159], v[28:31]
ds_read_b64_tr_b16 v[148:149], v160 offset:19616
v_mfma_f32_16x16x32_bf16 v[60:63], a[36:39], v[156:159], v[60:63]
ds_read_b64_tr_b16 v[150:151], v160 offset:20128
v_mfma_f32_16x16x32_bf16 v[92:95], a[40:43], v[156:159], v[92:95]
buffer_load_dwordx4 a[124:127], v165, s[4:7], s32 offen offset:2048 sc1
v_mfma_f32_16x16x32_bf16 v[124:127], a[44:47], v[156:159], v[124:127]
s_waitcnt vmcnt(19) lgkmcnt(10)
s_add_u32 s32, s32, s31
v_mfma_f32_16x16x32_bf16 v[0:3], a[48:51], v[128:131], v[0:3]
s_waitcnt vmcnt(18)
ds_read_b64_tr_b16 v[152:153], v160 offset:19648
v_mfma_f32_16x16x32_bf16 v[32:35], a[52:55], v[128:131], v[32:35]
s_waitcnt vmcnt(17)
ds_read_b64_tr_b16 v[154:155], v160 offset:20160
v_mfma_f32_16x16x32_bf16 v[64:67], a[56:59], v[128:131], v[64:67]
s_waitcnt vmcnt(16)
v_mfma_f32_16x16x32_bf16 v[96:99], a[60:63], v[128:131], v[96:99]
s_waitcnt lgkmcnt(10)
v_mfma_f32_16x16x32_bf16 v[4:7], a[48:51], v[132:135], v[4:7]
ds_read_b64_tr_b16 v[156:157], v160 offset:19680
v_mfma_f32_16x16x32_bf16 v[36:39], a[52:55], v[132:135], v[36:39]
ds_read_b64_tr_b16 v[158:159], v160 offset:20192
s_cmp_lg_u32 s21, 0
s_cbranch_scc1 standalone__weight_only_int_quip__prompt_kernel_h1b_ok
s_waitcnt vmcnt(9)
v_cmp_eq_u32 vcc, 0, v251
s_cbranch_vccnz standalone__weight_only_int_quip__prompt_kernel_h1b_spin
standalone__weight_only_int_quip__prompt_kernel_h1b_ok:
v_mfma_f32_16x16x32_bf16 v[68:71], a[56:59], v[132:135], v[68:71]
v_mfma_f32_16x16x32_bf16 v[100:103], a[60:63], v[132:135], v[100:103]
s_waitcnt vmcnt(32) lgkmcnt(10)
s_barrier
v_mfma_f32_16x16x32_bf16 v[8:11], a[48:51], v[136:139], v[8:11]
ds_read_b64_tr_b16 v[128:129], v160 offset:33024
v_mfma_f32_16x16x32_bf16 v[40:43], a[52:55], v[136:139], v[40:43]
s_add_u32 m0, s53, 16512
ds_read_b64_tr_b16 v[130:131], v160 offset:33536
v_mfma_f32_16x16x32_bf16 v[72:75], a[56:59], v[136:139], v[72:75]
buffer_load_dwordx4 v244, s[8:11], s35 offen offset:0  lds
v_mfma_f32_16x16x32_bf16 v[104:107], a[60:63], v[136:139], v[104:107]
s_waitcnt lgkmcnt(10)
v_mfma_f32_16x16x32_bf16 v[12:15], a[48:51], v[140:143], v[12:15]
ds_read_b64_tr_b16 v[132:133], v160 offset:33056
v_mfma_f32_16x16x32_bf16 v[44:47], a[52:55], v[140:143], v[44:47]
ds_read_b64_tr_b16 v[134:135], v160 offset:33568
v_mfma_f32_16x16x32_bf16 v[76:79], a[56:59], v[140:143], v[76:79]
buffer_load_dwordx4 v245, s[8:11], s35 offen offset:1024  lds
v_mfma_f32_16x16x32_bf16 v[108:111], a[60:63], v[140:143], v[108:111]
s_waitcnt lgkmcnt(10)
v_mfma_f32_16x16x32_bf16 v[16:19], a[48:51], v[144:147], v[16:19]
ds_read_b64_tr_b16 v[136:137], v160 offset:33088
v_mfma_f32_16x16x32_bf16 v[48:51], a[52:55], v[144:147], v[48:51]
ds_read_b64_tr_b16 v[138:139], v160 offset:33600
v_mfma_f32_16x16x32_bf16 v[80:83], a[56:59], v[144:147], v[80:83]
buffer_load_dwordx4 v246, s[8:11], s35 offen offset:2048  lds
v_mfma_f32_16x16x32_bf16 v[112:115], a[60:63], v[144:147], v[112:115]
s_waitcnt lgkmcnt(10)
v_mfma_f32_16x16x32_bf16 v[20:23], a[48:51], v[148:151], v[20:23]
ds_read_b64_tr_b16 v[140:141], v160 offset:33120
v_mfma_f32_16x16x32_bf16 v[52:55], a[52:55], v[148:151], v[52:55]
ds_read_b64_tr_b16 v[142:143], v160 offset:33632
v_mfma_f32_16x16x32_bf16 v[84:87], a[56:59], v[148:151], v[84:87]
buffer_load_dwordx4 v247, s[8:11], s35 offen offset:3072  lds
v_mfma_f32_16x16x32_bf16 v[116:119], a[60:63], v[148:151], v[116:119]
s_waitcnt lgkmcnt(10)
s_add_u32 s35, s35, 1835008
v_mfma_f32_16x16x32_bf16 v[24:27], a[48:51], v[152:155], v[24:27]
ds_read_b64_tr_b16 v[144:145], v160 offset:49536
v_mfma_f32_16x16x32_bf16 v[56:59], a[52:55], v[152:155], v[56:59]
s_add_u32 m0, s53, 0
ds_read_b64_tr_b16 v[146:147], v160 offset:50048
v_mfma_f32_16x16x32_bf16 v[88:91], a[56:59], v[152:155], v[88:91]
buffer_load_dwordx4 v244, s[8:11], s34 offen offset:0  lds
v_mfma_f32_16x16x32_bf16 v[120:123], a[60:63], v[152:155], v[120:123]
s_waitcnt lgkmcnt(10)
v_mfma_f32_16x16x32_bf16 v[28:31], a[48:51], v[156:159], v[28:31]
ds_read_b64_tr_b16 v[148:149], v160 offset:49568
v_mfma_f32_16x16x32_bf16 v[60:63], a[52:55], v[156:159], v[60:63]
ds_read_b64_tr_b16 v[150:151], v160 offset:50080
v_mfma_f32_16x16x32_bf16 v[92:95], a[56:59], v[156:159], v[92:95]
buffer_load_dwordx4 v245, s[8:11], s34 offen offset:1024  lds
v_mfma_f32_16x16x32_bf16 v[124:127], a[60:63], v[156:159], v[124:127]
s_waitcnt vmcnt(21) lgkmcnt(10)
v_mfma_f32_16x16x32_bf16 v[0:3], a[64:67], v[128:131], v[0:3]
s_waitcnt vmcnt(20)
ds_read_b64_tr_b16 v[152:153], v160 offset:49600
v_mfma_f32_16x16x32_bf16 v[32:35], a[68:71], v[128:131], v[32:35]
s_waitcnt vmcnt(19)
ds_read_b64_tr_b16 v[154:155], v160 offset:50112
v_mfma_f32_16x16x32_bf16 v[64:67], a[72:75], v[128:131], v[64:67]
s_waitcnt vmcnt(18)
buffer_load_dwordx4 v246, s[8:11], s34 offen offset:2048  lds
v_mfma_f32_16x16x32_bf16 v[96:99], a[76:79], v[128:131], v[96:99]
s_waitcnt lgkmcnt(10)
v_mfma_f32_16x16x32_bf16 v[4:7], a[64:67], v[132:135], v[4:7]
ds_read_b64_tr_b16 v[156:157], v160 offset:49632
v_mfma_f32_16x16x32_bf16 v[36:39], a[68:71], v[132:135], v[36:39]
ds_read_b64_tr_b16 v[158:159], v160 offset:50144
v_mfma_f32_16x16x32_bf16 v[68:71], a[72:75], v[132:135], v[68:71]
buffer_load_dwordx4 v247, s[8:11], s34 offen offset:3072  lds
v_mfma_f32_16x16x32_bf16 v[100:103], a[76:79], v[132:135], v[100:103]
s_waitcnt lgkmcnt(10)
s_add_u32 s34, s34, 1835008
v_mfma_f32_16x16x32_bf16 v[8:11], a[64:67], v[136:139], v[8:11]
ds_read_b64_tr_b16 v[128:129], v160 offset:34048
v_mfma_f32_16x16x32_bf16 v[40:43], a[68:71], v[136:139], v[40:43]
ds_read_b64_tr_b16 v[130:131], v160 offset:34560
v_mfma_f32_16x16x32_bf16 v[72:75], a[72:75], v[136:139], v[72:75]
v_mfma_f32_16x16x32_bf16 v[104:107], a[76:79], v[136:139], v[104:107]
s_waitcnt lgkmcnt(10)
v_mfma_f32_16x16x32_bf16 v[12:15], a[64:67], v[140:143], v[12:15]
ds_read_b64_tr_b16 v[132:133], v160 offset:34080
v_mfma_f32_16x16x32_bf16 v[44:47], a[68:71], v[140:143], v[44:47]
ds_read_b64_tr_b16 v[134:135], v160 offset:34592
v_mfma_f32_16x16x32_bf16 v[76:79], a[72:75], v[140:143], v[76:79]
v_mfma_f32_16x16x32_bf16 v[108:111], a[76:79], v[140:143], v[108:111]
s_waitcnt lgkmcnt(10)
v_mfma_f32_16x16x32_bf16 v[16:19], a[64:67], v[144:147], v[16:19]
ds_read_b64_tr_b16 v[136:137], v160 offset:34112
v_mfma_f32_16x16x32_bf16 v[48:51], a[68:71], v[144:147], v[48:51]
ds_read_b64_tr_b16 v[138:139], v160 offset:34624
v_mfma_f32_16x16x32_bf16 v[80:83], a[72:75], v[144:147], v[80:83]
v_mfma_f32_16x16x32_bf16 v[112:115], a[76:79], v[144:147], v[112:115]
s_waitcnt lgkmcnt(10)
v_mfma_f32_16x16x32_bf16 v[20:23], a[64:67], v[148:151], v[20:23]
ds_read_b64_tr_b16 v[140:141], v160 offset:34144
v_mfma_f32_16x16x32_bf16 v[52:55], a[68:71], v[148:151], v[52:55]
ds_read_b64_tr_b16 v[142:143], v160 offset:34656
v_mfma_f32_16x16x32_bf16 v[84:87], a[72:75], v[148:151], v[84:87]
v_mfma_f32_16x16x32_bf16 v[116:119], a[76:79], v[148:151], v[116:119]
s_waitcnt lgkmcnt(10)
v_mfma_f32_16x16x32_bf16 v[24:27], a[64:67], v[152:155], v[24:27]
ds_read_b64_tr_b16 v[144:145], v160 offset:50560
v_mfma_f32_16x16x32_bf16 v[56:59], a[68:71], v[152:155], v[56:59]
ds_read_b64_tr_b16 v[146:147], v160 offset:51072
v_mfma_f32_16x16x32_bf16 v[88:91], a[72:75], v[152:155], v[88:91]
v_mfma_f32_16x16x32_bf16 v[120:123], a[76:79], v[152:155], v[120:123]
s_waitcnt lgkmcnt(10)
v_mfma_f32_16x16x32_bf16 v[28:31], a[64:67], v[156:159], v[28:31]
ds_read_b64_tr_b16 v[148:149], v160 offset:50592
v_mfma_f32_16x16x32_bf16 v[60:63], a[68:71], v[156:159], v[60:63]
ds_read_b64_tr_b16 v[150:151], v160 offset:51104
v_mfma_f32_16x16x32_bf16 v[92:95], a[72:75], v[156:159], v[92:95]
v_mfma_f32_16x16x32_bf16 v[124:127], a[76:79], v[156:159], v[124:127]
s_waitcnt vmcnt(19) lgkmcnt(10)
v_mfma_f32_16x16x32_bf16 v[0:3], a[80:83], v[128:131], v[0:3]
s_waitcnt vmcnt(18)
ds_read_b64_tr_b16 v[152:153], v160 offset:50624
v_mfma_f32_16x16x32_bf16 v[32:35], a[84:87], v[128:131], v[32:35]
s_waitcnt vmcnt(17)
ds_read_b64_tr_b16 v[154:155], v160 offset:51136
v_mfma_f32_16x16x32_bf16 v[64:67], a[88:91], v[128:131], v[64:67]
s_waitcnt vmcnt(16)
v_mfma_f32_16x16x32_bf16 v[96:99], a[92:95], v[128:131], v[96:99]
s_waitcnt lgkmcnt(10)
v_mfma_f32_16x16x32_bf16 v[4:7], a[80:83], v[132:135], v[4:7]
ds_read_b64_tr_b16 v[156:157], v160 offset:50656
v_mfma_f32_16x16x32_bf16 v[36:39], a[84:87], v[132:135], v[36:39]
ds_read_b64_tr_b16 v[158:159], v160 offset:51168
v_mfma_f32_16x16x32_bf16 v[68:71], a[88:91], v[132:135], v[68:71]
v_mfma_f32_16x16x32_bf16 v[100:103], a[92:95], v[132:135], v[100:103]
s_waitcnt lgkmcnt(10)
v_mfma_f32_16x16x32_bf16 v[8:11], a[80:83], v[136:139], v[8:11]
ds_read_b64_tr_b16 v[128:129], v160 offset:35072
v_mfma_f32_16x16x32_bf16 v[40:43], a[84:87], v[136:139], v[40:43]
ds_read_b64_tr_b16 v[130:131], v160 offset:35584
v_mfma_f32_16x16x32_bf16 v[72:75], a[88:91], v[136:139], v[72:75]
buffer_load_dwordx4 a[0:3], v164, s[4:7], s32 offen offset:0 sc1
v_mfma_f32_16x16x32_bf16 v[104:107], a[92:95], v[136:139], v[104:107]
s_waitcnt lgkmcnt(10)
v_mfma_f32_16x16x32_bf16 v[12:15], a[80:83], v[140:143], v[12:15]
ds_read_b64_tr_b16 v[132:133], v160 offset:35104
v_mfma_f32_16x16x32_bf16 v[44:47], a[84:87], v[140:143], v[44:47]
ds_read_b64_tr_b16 v[134:135], v160 offset:35616
v_mfma_f32_16x16x32_bf16 v[76:79], a[88:91], v[140:143], v[76:79]
buffer_load_dwordx4 a[4:7], v164, s[4:7], s32 offen offset:2048 sc1
v_mfma_f32_16x16x32_bf16 v[108:111], a[92:95], v[140:143], v[108:111]
s_waitcnt lgkmcnt(10)
v_mfma_f32_16x16x32_bf16 v[16:19], a[80:83], v[144:147], v[16:19]
ds_read_b64_tr_b16 v[136:137], v160 offset:35136
v_mfma_f32_16x16x32_bf16 v[48:51], a[84:87], v[144:147], v[48:51]
ds_read_b64_tr_b16 v[138:139], v160 offset:35648
v_mfma_f32_16x16x32_bf16 v[80:83], a[88:91], v[144:147], v[80:83]
buffer_load_dwordx4 a[8:11], v165, s[4:7], s32 offen offset:0 sc1
v_mfma_f32_16x16x32_bf16 v[112:115], a[92:95], v[144:147], v[112:115]
s_waitcnt lgkmcnt(10)
v_mfma_f32_16x16x32_bf16 v[20:23], a[80:83], v[148:151], v[20:23]
ds_read_b64_tr_b16 v[140:141], v160 offset:35168
v_mfma_f32_16x16x32_bf16 v[52:55], a[84:87], v[148:151], v[52:55]
ds_read_b64_tr_b16 v[142:143], v160 offset:35680
v_mfma_f32_16x16x32_bf16 v[84:87], a[88:91], v[148:151], v[84:87]
buffer_load_dwordx4 a[12:15], v165, s[4:7], s32 offen offset:2048 sc1
v_mfma_f32_16x16x32_bf16 v[116:119], a[92:95], v[148:151], v[116:119]
s_waitcnt lgkmcnt(10)
s_add_u32 s32, s32, 32768
v_mfma_f32_16x16x32_bf16 v[24:27], a[80:83], v[152:155], v[24:27]
ds_read_b64_tr_b16 v[144:145], v160 offset:51584
v_mfma_f32_16x16x32_bf16 v[56:59], a[84:87], v[152:155], v[56:59]
ds_read_b64_tr_b16 v[146:147], v160 offset:52096
v_mfma_f32_16x16x32_bf16 v[88:91], a[88:91], v[152:155], v[88:91]
buffer_load_dwordx4 a[16:19], v164, s[4:7], s32 offen offset:0 sc1
v_mfma_f32_16x16x32_bf16 v[120:123], a[92:95], v[152:155], v[120:123]
s_waitcnt lgkmcnt(10)
v_mfma_f32_16x16x32_bf16 v[28:31], a[80:83], v[156:159], v[28:31]
ds_read_b64_tr_b16 v[148:149], v160 offset:51616
v_mfma_f32_16x16x32_bf16 v[60:63], a[84:87], v[156:159], v[60:63]
ds_read_b64_tr_b16 v[150:151], v160 offset:52128
v_mfma_f32_16x16x32_bf16 v[92:95], a[88:91], v[156:159], v[92:95]
buffer_load_dwordx4 a[20:23], v164, s[4:7], s32 offen offset:2048 sc1
v_mfma_f32_16x16x32_bf16 v[124:127], a[92:95], v[156:159], v[124:127]
s_waitcnt vmcnt(21) lgkmcnt(10)
v_mfma_f32_16x16x32_bf16 v[0:3], a[96:99], v[128:131], v[0:3]
s_waitcnt vmcnt(20)
ds_read_b64_tr_b16 v[152:153], v160 offset:51648
v_mfma_f32_16x16x32_bf16 v[32:35], a[100:103], v[128:131], v[32:35]
s_waitcnt vmcnt(19)
ds_read_b64_tr_b16 v[154:155], v160 offset:52160
v_mfma_f32_16x16x32_bf16 v[64:67], a[104:107], v[128:131], v[64:67]
s_waitcnt vmcnt(18)
buffer_load_dwordx4 a[24:27], v165, s[4:7], s32 offen offset:0 sc1
v_mfma_f32_16x16x32_bf16 v[96:99], a[108:111], v[128:131], v[96:99]
s_waitcnt lgkmcnt(10)
v_mfma_f32_16x16x32_bf16 v[4:7], a[96:99], v[132:135], v[4:7]
ds_read_b64_tr_b16 v[156:157], v160 offset:51680
v_mfma_f32_16x16x32_bf16 v[36:39], a[100:103], v[132:135], v[36:39]
ds_read_b64_tr_b16 v[158:159], v160 offset:52192
v_mfma_f32_16x16x32_bf16 v[68:71], a[104:107], v[132:135], v[68:71]
buffer_load_dwordx4 a[28:31], v165, s[4:7], s32 offen offset:2048 sc1
v_mfma_f32_16x16x32_bf16 v[100:103], a[108:111], v[132:135], v[100:103]
s_waitcnt lgkmcnt(10)
s_add_u32 s32, s32, 32768
v_mfma_f32_16x16x32_bf16 v[8:11], a[96:99], v[136:139], v[8:11]
ds_read_b64_tr_b16 v[128:129], v160 offset:36096
v_mfma_f32_16x16x32_bf16 v[40:43], a[100:103], v[136:139], v[40:43]
ds_read_b64_tr_b16 v[130:131], v160 offset:36608
v_mfma_f32_16x16x32_bf16 v[72:75], a[104:107], v[136:139], v[72:75]
buffer_load_dwordx4 a[32:35], v164, s[4:7], s32 offen offset:0 sc1
v_mfma_f32_16x16x32_bf16 v[104:107], a[108:111], v[136:139], v[104:107]
s_waitcnt lgkmcnt(10)
v_mfma_f32_16x16x32_bf16 v[12:15], a[96:99], v[140:143], v[12:15]
ds_read_b64_tr_b16 v[132:133], v160 offset:36128
v_mfma_f32_16x16x32_bf16 v[44:47], a[100:103], v[140:143], v[44:47]
ds_read_b64_tr_b16 v[134:135], v160 offset:36640
v_mfma_f32_16x16x32_bf16 v[76:79], a[104:107], v[140:143], v[76:79]
buffer_load_dwordx4 a[36:39], v164, s[4:7], s32 offen offset:2048 sc1
v_mfma_f32_16x16x32_bf16 v[108:111], a[108:111], v[140:143], v[108:111]
s_waitcnt lgkmcnt(10)
v_mfma_f32_16x16x32_bf16 v[16:19], a[96:99], v[144:147], v[16:19]
ds_read_b64_tr_b16 v[136:137], v160 offset:36160
v_mfma_f32_16x16x32_bf16 v[48:51], a[100:103], v[144:147], v[48:51]
ds_read_b64_tr_b16 v[138:139], v160 offset:36672
v_mfma_f32_16x16x32_bf16 v[80:83], a[104:107], v[144:147], v[80:83]
buffer_load_dwordx4 a[40:43], v165, s[4:7], s32 offen offset:0 sc1
v_mfma_f32_16x16x32_bf16 v[112:115], a[108:111], v[144:147], v[112:115]
s_waitcnt lgkmcnt(10)
v_mfma_f32_16x16x32_bf16 v[20:23], a[96:99], v[148:151], v[20:23]
ds_read_b64_tr_b16 v[140:141], v160 offset:36192
v_mfma_f32_16x16x32_bf16 v[52:55], a[100:103], v[148:151], v[52:55]
ds_read_b64_tr_b16 v[142:143], v160 offset:36704
v_mfma_f32_16x16x32_bf16 v[84:87], a[104:107], v[148:151], v[84:87]
buffer_load_dwordx4 a[44:47], v165, s[4:7], s32 offen offset:2048 sc1
v_mfma_f32_16x16x32_bf16 v[116:119], a[108:111], v[148:151], v[116:119]
s_waitcnt lgkmcnt(10)
s_add_u32 s32, s32, 32768
v_mfma_f32_16x16x32_bf16 v[24:27], a[96:99], v[152:155], v[24:27]
ds_read_b64_tr_b16 v[144:145], v160 offset:52608
v_mfma_f32_16x16x32_bf16 v[56:59], a[100:103], v[152:155], v[56:59]
ds_read_b64_tr_b16 v[146:147], v160 offset:53120
v_mfma_f32_16x16x32_bf16 v[88:91], a[104:107], v[152:155], v[88:91]
buffer_load_dwordx4 a[48:51], v164, s[4:7], s32 offen offset:0 sc1
v_mfma_f32_16x16x32_bf16 v[120:123], a[108:111], v[152:155], v[120:123]
s_waitcnt lgkmcnt(10)
v_mfma_f32_16x16x32_bf16 v[28:31], a[96:99], v[156:159], v[28:31]
ds_read_b64_tr_b16 v[148:149], v160 offset:52640
v_mfma_f32_16x16x32_bf16 v[60:63], a[100:103], v[156:159], v[60:63]
ds_read_b64_tr_b16 v[150:151], v160 offset:53152
v_mfma_f32_16x16x32_bf16 v[92:95], a[104:107], v[156:159], v[92:95]
buffer_load_dwordx4 a[52:55], v164, s[4:7], s32 offen offset:2048 sc1
v_mfma_f32_16x16x32_bf16 v[124:127], a[108:111], v[156:159], v[124:127]
s_waitcnt vmcnt(25) lgkmcnt(10)
v_mfma_f32_16x16x32_bf16 v[0:3], a[112:115], v[128:131], v[0:3]
s_waitcnt vmcnt(24)
ds_read_b64_tr_b16 v[152:153], v160 offset:52672
v_mfma_f32_16x16x32_bf16 v[32:35], a[116:119], v[128:131], v[32:35]
s_waitcnt vmcnt(23)
ds_read_b64_tr_b16 v[154:155], v160 offset:53184
v_mfma_f32_16x16x32_bf16 v[64:67], a[120:123], v[128:131], v[64:67]
s_waitcnt vmcnt(22)
buffer_load_dwordx4 a[56:59], v165, s[4:7], s32 offen offset:0 sc1
v_mfma_f32_16x16x32_bf16 v[96:99], a[124:127], v[128:131], v[96:99]
s_waitcnt lgkmcnt(10)
v_mfma_f32_16x16x32_bf16 v[4:7], a[112:115], v[132:135], v[4:7]
ds_read_b64_tr_b16 v[156:157], v160 offset:52704
v_mfma_f32_16x16x32_bf16 v[36:39], a[116:119], v[132:135], v[36:39]
ds_read_b64_tr_b16 v[158:159], v160 offset:53216
v_mfma_f32_16x16x32_bf16 v[68:71], a[120:123], v[132:135], v[68:71]
buffer_load_dwordx4 a[60:63], v165, s[4:7], s32 offen offset:2048 sc1
v_mfma_f32_16x16x32_bf16 v[100:103], a[124:127], v[132:135], v[100:103]
s_waitcnt vmcnt(16) lgkmcnt(10)
s_add_u32 s32, s32, s30
s_barrier
v_mfma_f32_16x16x32_bf16 v[8:11], a[112:115], v[136:139], v[8:11]
ds_read_b64_tr_b16 v[128:129], v161 offset:0
v_mfma_f32_16x16x32_bf16 v[40:43], a[116:119], v[136:139], v[40:43]
s_add_u32 m0, s52, 16512
ds_read_b64_tr_b16 v[130:131], v161 offset:512
v_mfma_f32_16x16x32_bf16 v[72:75], a[120:123], v[136:139], v[72:75]
buffer_load_dwordx4 v244, s[8:11], s35 offen offset:0  lds
v_mfma_f32_16x16x32_bf16 v[104:107], a[124:127], v[136:139], v[104:107]
s_waitcnt lgkmcnt(10)
v_mfma_f32_16x16x32_bf16 v[12:15], a[112:115], v[140:143], v[12:15]
ds_read_b64_tr_b16 v[132:133], v161 offset:32
v_mfma_f32_16x16x32_bf16 v[44:47], a[116:119], v[140:143], v[44:47]
ds_read_b64_tr_b16 v[134:135], v161 offset:544
v_mfma_f32_16x16x32_bf16 v[76:79], a[120:123], v[140:143], v[76:79]
buffer_load_dwordx4 v245, s[8:11], s35 offen offset:1024  lds
v_mfma_f32_16x16x32_bf16 v[108:111], a[124:127], v[140:143], v[108:111]
s_waitcnt lgkmcnt(10)
v_mfma_f32_16x16x32_bf16 v[16:19], a[112:115], v[144:147], v[16:19]
ds_read_b64_tr_b16 v[136:137], v161 offset:64
v_mfma_f32_16x16x32_bf16 v[48:51], a[116:119], v[144:147], v[48:51]
ds_read_b64_tr_b16 v[138:139], v161 offset:576
v_mfma_f32_16x16x32_bf16 v[80:83], a[120:123], v[144:147], v[80:83]
buffer_load_dwordx4 v246, s[8:11], s35 offen offset:2048  lds
v_mfma_f32_16x16x32_bf16 v[112:115], a[124:127], v[144:147], v[112:115]
s_waitcnt lgkmcnt(10)
v_mfma_f32_16x16x32_bf16 v[20:23], a[112:115], v[148:151], v[20:23]
ds_read_b64_tr_b16 v[140:141], v161 offset:96
v_mfma_f32_16x16x32_bf16 v[52:55], a[116:119], v[148:151], v[52:55]
ds_read_b64_tr_b16 v[142:143], v161 offset:608
v_mfma_f32_16x16x32_bf16 v[84:87], a[120:123], v[148:151], v[84:87]
buffer_load_dwordx4 v247, s[8:11], s35 offen offset:3072  lds
v_mfma_f32_16x16x32_bf16 v[116:119], a[124:127], v[148:151], v[116:119]
s_waitcnt lgkmcnt(10)
s_sub_u32 s35, s35, s63
v_mfma_f32_16x16x32_bf16 v[24:27], a[112:115], v[152:155], v[24:27]
ds_read_b64_tr_b16 v[144:145], v161 offset:16512
v_mfma_f32_16x16x32_bf16 v[56:59], a[116:119], v[152:155], v[56:59]
s_add_u32 m0, s52, 0
ds_read_b64_tr_b16 v[146:147], v161 offset:17024
v_mfma_f32_16x16x32_bf16 v[88:91], a[120:123], v[152:155], v[88:91]
buffer_load_dwordx4 v244, s[8:11], s34 offen offset:0  lds
v_mfma_f32_16x16x32_bf16 v[120:123], a[124:127], v[152:155], v[120:123]
s_waitcnt lgkmcnt(10)
v_mfma_f32_16x16x32_bf16 v[28:31], a[112:115], v[156:159], v[28:31]
ds_read_b64_tr_b16 v[148:149], v161 offset:16544
v_mfma_f32_16x16x32_bf16 v[60:63], a[116:119], v[156:159], v[60:63]
ds_read_b64_tr_b16 v[150:151], v161 offset:17056
v_mfma_f32_16x16x32_bf16 v[92:95], a[120:123], v[156:159], v[92:95]
buffer_load_dwordx4 v245, s[8:11], s34 offen offset:1024  lds
v_mfma_f32_16x16x32_bf16 v[124:127], a[124:127], v[156:159], v[124:127]
s_waitcnt vmcnt(21) lgkmcnt(10)
v_mfma_f32_16x16x32_bf16 v[0:3], a[0:3], v[128:131], v[0:3]
s_waitcnt vmcnt(20)
ds_read_b64_tr_b16 v[152:153], v161 offset:16576
v_mfma_f32_16x16x32_bf16 v[32:35], a[4:7], v[128:131], v[32:35]
s_waitcnt vmcnt(19)
ds_read_b64_tr_b16 v[154:155], v161 offset:17088
v_mfma_f32_16x16x32_bf16 v[64:67], a[8:11], v[128:131], v[64:67]
s_waitcnt vmcnt(18)
buffer_load_dwordx4 v246, s[8:11], s34 offen offset:2048  lds
v_mfma_f32_16x16x32_bf16 v[96:99], a[12:15], v[128:131], v[96:99]
s_waitcnt lgkmcnt(10)
v_mfma_f32_16x16x32_bf16 v[4:7], a[0:3], v[132:135], v[4:7]
ds_read_b64_tr_b16 v[156:157], v161 offset:16608
v_mfma_f32_16x16x32_bf16 v[36:39], a[4:7], v[132:135], v[36:39]
ds_read_b64_tr_b16 v[158:159], v161 offset:17120
v_mfma_f32_16x16x32_bf16 v[68:71], a[8:11], v[132:135], v[68:71]
buffer_load_dwordx4 v247, s[8:11], s34 offen offset:3072  lds
v_mfma_f32_16x16x32_bf16 v[100:103], a[12:15], v[132:135], v[100:103]
s_waitcnt lgkmcnt(10)
s_sub_u32 s34, s34, s63
v_mfma_f32_16x16x32_bf16 v[8:11], a[0:3], v[136:139], v[8:11]
ds_read_b64_tr_b16 v[128:129], v161 offset:1024
v_mfma_f32_16x16x32_bf16 v[40:43], a[4:7], v[136:139], v[40:43]
ds_read_b64_tr_b16 v[130:131], v161 offset:1536
v_mfma_f32_16x16x32_bf16 v[72:75], a[8:11], v[136:139], v[72:75]
v_mfma_f32_16x16x32_bf16 v[104:107], a[12:15], v[136:139], v[104:107]
s_waitcnt lgkmcnt(10)
v_mfma_f32_16x16x32_bf16 v[12:15], a[0:3], v[140:143], v[12:15]
ds_read_b64_tr_b16 v[132:133], v161 offset:1056
v_mfma_f32_16x16x32_bf16 v[44:47], a[4:7], v[140:143], v[44:47]
ds_read_b64_tr_b16 v[134:135], v161 offset:1568
v_mfma_f32_16x16x32_bf16 v[76:79], a[8:11], v[140:143], v[76:79]
v_mfma_f32_16x16x32_bf16 v[108:111], a[12:15], v[140:143], v[108:111]
s_waitcnt lgkmcnt(10)
v_mfma_f32_16x16x32_bf16 v[16:19], a[0:3], v[144:147], v[16:19]
ds_read_b64_tr_b16 v[136:137], v161 offset:1088
v_mfma_f32_16x16x32_bf16 v[48:51], a[4:7], v[144:147], v[48:51]
ds_read_b64_tr_b16 v[138:139], v161 offset:1600
v_mfma_f32_16x16x32_bf16 v[80:83], a[8:11], v[144:147], v[80:83]
v_mfma_f32_16x16x32_bf16 v[112:115], a[12:15], v[144:147], v[112:115]
s_waitcnt lgkmcnt(10)
v_mfma_f32_16x16x32_bf16 v[20:23], a[0:3], v[148:151], v[20:23]
ds_read_b64_tr_b16 v[140:141], v161 offset:1120
v_mfma_f32_16x16x32_bf16 v[52:55], a[4:7], v[148:151], v[52:55]
ds_read_b64_tr_b16 v[142:143], v161 offset:1632
v_mfma_f32_16x16x32_bf16 v[84:87], a[8:11], v[148:151], v[84:87]
v_mfma_f32_16x16x32_bf16 v[116:119], a[12:15], v[148:151], v[116:119]
s_waitcnt lgkmcnt(10)
v_mfma_f32_16x16x32_bf16 v[24:27], a[0:3], v[152:155], v[24:27]
ds_read_b64_tr_b16 v[144:145], v161 offset:17536
v_mfma_f32_16x16x32_bf16 v[56:59], a[4:7], v[152:155], v[56:59]
ds_read_b64_tr_b16 v[146:147], v161 offset:18048
v_mfma_f32_16x16x32_bf16 v[88:91], a[8:11], v[152:155], v[88:91]
v_mfma_f32_16x16x32_bf16 v[120:123], a[12:15], v[152:155], v[120:123]
s_waitcnt lgkmcnt(10)
v_mfma_f32_16x16x32_bf16 v[28:31], a[0:3], v[156:159], v[28:31]
ds_read_b64_tr_b16 v[148:149], v161 offset:17568
v_mfma_f32_16x16x32_bf16 v[60:63], a[4:7], v[156:159], v[60:63]
ds_read_b64_tr_b16 v[150:151], v161 offset:18080
v_mfma_f32_16x16x32_bf16 v[92:95], a[8:11], v[156:159], v[92:95]
v_mfma_f32_16x16x32_bf16 v[124:127], a[12:15], v[156:159], v[124:127]
s_waitcnt vmcnt(19) lgkmcnt(10)
v_mfma_f32_16x16x32_bf16 v[0:3], a[16:19], v[128:131], v[0:3]
s_waitcnt vmcnt(18)
ds_read_b64_tr_b16 v[152:153], v161 offset:17600
v_mfma_f32_16x16x32_bf16 v[32:35], a[20:23], v[128:131], v[32:35]
s_waitcnt vmcnt(17)
s_add_u32 m0, s53, 49536
ds_read_b64_tr_b16 v[154:155], v161 offset:18112
v_mfma_f32_16x16x32_bf16 v[64:67], a[24:27], v[128:131], v[64:67]
s_waitcnt vmcnt(16)
buffer_load_dwordx4 v244, s[8:11], s35 offen offset:0  lds
v_mfma_f32_16x16x32_bf16 v[96:99], a[28:31], v[128:131], v[96:99]
s_waitcnt lgkmcnt(10)
v_mfma_f32_16x16x32_bf16 v[4:7], a[16:19], v[132:135], v[4:7]
ds_read_b64_tr_b16 v[156:157], v161 offset:17632
v_mfma_f32_16x16x32_bf16 v[36:39], a[20:23], v[132:135], v[36:39]
ds_read_b64_tr_b16 v[158:159], v161 offset:18144
v_mfma_f32_16x16x32_bf16 v[68:71], a[24:27], v[132:135], v[68:71]
buffer_load_dwordx4 v245, s[8:11], s35 offen offset:1024  lds
v_mfma_f32_16x16x32_bf16 v[100:103], a[28:31], v[132:135], v[100:103]
s_waitcnt lgkmcnt(10)
v_mfma_f32_16x16x32_bf16 v[8:11], a[16:19], v[136:139], v[8:11]
ds_read_b64_tr_b16 v[128:129], v161 offset:2048
v_mfma_f32_16x16x32_bf16 v[40:43], a[20:23], v[136:139], v[40:43]
ds_read_b64_tr_b16 v[130:131], v161 offset:2560
v_mfma_f32_16x16x32_bf16 v[72:75], a[24:27], v[136:139], v[72:75]
buffer_load_dwordx4 v246, s[8:11], s35 offen offset:2048  lds
v_mfma_f32_16x16x32_bf16 v[104:107], a[28:31], v[136:139], v[104:107]
s_waitcnt lgkmcnt(10)
v_mfma_f32_16x16x32_bf16 v[12:15], a[16:19], v[140:143], v[12:15]
ds_read_b64_tr_b16 v[132:133], v161 offset:2080
v_mfma_f32_16x16x32_bf16 v[44:47], a[20:23], v[140:143], v[44:47]
ds_read_b64_tr_b16 v[134:135], v161 offset:2592
v_mfma_f32_16x16x32_bf16 v[76:79], a[24:27], v[140:143], v[76:79]
buffer_load_dwordx4 v247, s[8:11], s35 offen offset:3072  lds
v_mfma_f32_16x16x32_bf16 v[108:111], a[28:31], v[140:143], v[108:111]
s_waitcnt lgkmcnt(10)
s_add_u32 s35, s35, 1835008
v_mfma_f32_16x16x32_bf16 v[16:19], a[16:19], v[144:147], v[16:19]
ds_read_b64_tr_b16 v[136:137], v161 offset:2112
v_mfma_f32_16x16x32_bf16 v[48:51], a[20:23], v[144:147], v[48:51]
ds_read_b64_tr_b16 v[138:139], v161 offset:2624
v_mfma_f32_16x16x32_bf16 v[80:83], a[24:27], v[144:147], v[80:83]
buffer_load_dwordx4 a[64:67], v164, s[4:7], s32 offen offset:0 sc1
v_mfma_f32_16x16x32_bf16 v[112:115], a[28:31], v[144:147], v[112:115]
s_waitcnt lgkmcnt(10)
v_mfma_f32_16x16x32_bf16 v[20:23], a[16:19], v[148:151], v[20:23]
ds_read_b64_tr_b16 v[140:141], v161 offset:2144
v_mfma_f32_16x16x32_bf16 v[52:55], a[20:23], v[148:151], v[52:55]
s_add_u32 m0, s53, 33024
ds_read_b64_tr_b16 v[142:143], v161 offset:2656
v_mfma_f32_16x16x32_bf16 v[84:87], a[24:27], v[148:151], v[84:87]
buffer_load_dwordx4 v244, s[8:11], s34 offen offset:0  lds
v_mfma_f32_16x16x32_bf16 v[116:119], a[28:31], v[148:151], v[116:119]
s_waitcnt lgkmcnt(10)
v_mfma_f32_16x16x32_bf16 v[24:27], a[16:19], v[152:155], v[24:27]
ds_read_b64_tr_b16 v[144:145], v161 offset:18560
v_mfma_f32_16x16x32_bf16 v[56:59], a[20:23], v[152:155], v[56:59]
ds_read_b64_tr_b16 v[146:147], v161 offset:19072
v_mfma_f32_16x16x32_bf16 v[88:91], a[24:27], v[152:155], v[88:91]
buffer_load_dwordx4 v245, s[8:11], s34 offen offset:1024  lds
v_mfma_f32_16x16x32_bf16 v[120:123], a[28:31], v[152:155], v[120:123]
s_waitcnt lgkmcnt(10)
v_mfma_f32_16x16x32_bf16 v[28:31], a[16:19], v[156:159], v[28:31]
ds_read_b64_tr_b16 v[148:149], v161 offset:18592
v_mfma_f32_16x16x32_bf16 v[60:63], a[20:23], v[156:159], v[60:63]
ds_read_b64_tr_b16 v[150:151], v161 offset:19104
v_mfma_f32_16x16x32_bf16 v[92:95], a[24:27], v[156:159], v[92:95]
buffer_load_dwordx4 v246, s[8:11], s34 offen offset:2048  lds
v_mfma_f32_16x16x32_bf16 v[124:127], a[28:31], v[156:159], v[124:127]
s_waitcnt vmcnt(23) lgkmcnt(10)
v_mfma_f32_16x16x32_bf16 v[0:3], a[32:35], v[128:131], v[0:3]
s_waitcnt vmcnt(22)
ds_read_b64_tr_b16 v[152:153], v161 offset:18624
v_mfma_f32_16x16x32_bf16 v[32:35], a[36:39], v[128:131], v[32:35]
s_waitcnt vmcnt(21)
ds_read_b64_tr_b16 v[154:155], v161 offset:19136
v_mfma_f32_16x16x32_bf16 v[64:67], a[40:43], v[128:131], v[64:67]
s_waitcnt vmcnt(20)
buffer_load_dwordx4 v247, s[8:11], s34 offen offset:3072  lds
v_mfma_f32_16x16x32_bf16 v[96:99], a[44:47], v[128:131], v[96:99]
s_waitcnt lgkmcnt(10)
s_add_u32 s34, s34, 1835008
v_mfma_f32_16x16x32_bf16 v[4:7], a[32:35], v[132:135], v[4:7]
ds_read_b64_tr_b16 v[156:157], v161 offset:18656
v_mfma_f32_16x16x32_bf16 v[36:39], a[36:39], v[132:135], v[36:39]
ds_read_b64_tr_b16 v[158:159], v161 offset:19168
v_mfma_f32_16x16x32_bf16 v[68:71], a[40:43], v[132:135], v[68:71]
buffer_load_dwordx4 a[68:71], v164, s[4:7], s32 offen offset:2048 sc1
v_mfma_f32_16x16x32_bf16 v[100:103], a[44:47], v[132:135], v[100:103]
s_waitcnt lgkmcnt(10)
v_mfma_f32_16x16x32_bf16 v[8:11], a[32:35], v[136:139], v[8:11]
ds_read_b64_tr_b16 v[128:129], v161 offset:3072
v_mfma_f32_16x16x32_bf16 v[40:43], a[36:39], v[136:139], v[40:43]
ds_read_b64_tr_b16 v[130:131], v161 offset:3584
v_mfma_f32_16x16x32_bf16 v[72:75], a[40:43], v[136:139], v[72:75]
buffer_load_dwordx4 a[72:75], v165, s[4:7], s32 offen offset:0 sc1
v_mfma_f32_16x16x32_bf16 v[104:107], a[44:47], v[136:139], v[104:107]
s_waitcnt lgkmcnt(10)
v_mfma_f32_16x16x32_bf16 v[12:15], a[32:35], v[140:143], v[12:15]
ds_read_b64_tr_b16 v[132:133], v161 offset:3104
v_mfma_f32_16x16x32_bf16 v[44:47], a[36:39], v[140:143], v[44:47]
ds_read_b64_tr_b16 v[134:135], v161 offset:3616
v_mfma_f32_16x16x32_bf16 v[76:79], a[40:43], v[140:143], v[76:79]
v_mfma_f32_16x16x32_bf16 v[108:111], a[44:47], v[140:143], v[108:111]
s_waitcnt lgkmcnt(10)
v_mfma_f32_16x16x32_bf16 v[16:19], a[32:35], v[144:147], v[16:19]
ds_read_b64_tr_b16 v[136:137], v161 offset:3136
v_mfma_f32_16x16x32_bf16 v[48:51], a[36:39], v[144:147], v[48:51]
ds_read_b64_tr_b16 v[138:139], v161 offset:3648
v_mfma_f32_16x16x32_bf16 v[80:83], a[40:43], v[144:147], v[80:83]
buffer_load_dwordx4 a[76:79], v165, s[4:7], s32 offen offset:2048 sc1
v_mfma_f32_16x16x32_bf16 v[112:115], a[44:47], v[144:147], v[112:115]
s_waitcnt lgkmcnt(10)
s_add_u32 s32, s32, 32768
v_mfma_f32_16x16x32_bf16 v[20:23], a[32:35], v[148:151], v[20:23]
ds_read_b64_tr_b16 v[140:141], v161 offset:3168
v_mfma_f32_16x16x32_bf16 v[52:55], a[36:39], v[148:151], v[52:55]
ds_read_b64_tr_b16 v[142:143], v161 offset:3680
v_mfma_f32_16x16x32_bf16 v[84:87], a[40:43], v[148:151], v[84:87]
buffer_load_dwordx4 a[80:83], v164, s[4:7], s32 offen offset:0 sc1
v_mfma_f32_16x16x32_bf16 v[116:119], a[44:47], v[148:151], v[116:119]
s_waitcnt lgkmcnt(10)
v_mfma_f32_16x16x32_bf16 v[24:27], a[32:35], v[152:155], v[24:27]
ds_read_b64_tr_b16 v[144:145], v161 offset:19584
v_mfma_f32_16x16x32_bf16 v[56:59], a[36:39], v[152:155], v[56:59]
ds_read_b64_tr_b16 v[146:147], v161 offset:20096
v_mfma_f32_16x16x32_bf16 v[88:91], a[40:43], v[152:155], v[88:91]
buffer_load_dwordx4 a[84:87], v164, s[4:7], s32 offen offset:2048 sc1
v_mfma_f32_16x16x32_bf16 v[120:123], a[44:47], v[152:155], v[120:123]
s_waitcnt lgkmcnt(10)
v_mfma_f32_16x16x32_bf16 v[28:31], a[32:35], v[156:159], v[28:31]
ds_read_b64_tr_b16 v[148:149], v161 offset:19616
v_mfma_f32_16x16x32_bf16 v[60:63], a[36:39], v[156:159], v[60:63]
ds_read_b64_tr_b16 v[150:151], v161 offset:20128
v_mfma_f32_16x16x32_bf16 v[92:95], a[40:43], v[156:159], v[92:95]
buffer_load_dwordx4 a[88:91], v165, s[4:7], s32 offen offset:0 sc1
v_mfma_f32_16x16x32_bf16 v[124:127], a[44:47], v[156:159], v[124:127]
s_waitcnt vmcnt(26) lgkmcnt(10)
v_mfma_f32_16x16x32_bf16 v[0:3], a[48:51], v[128:131], v[0:3]
s_waitcnt vmcnt(25)
ds_read_b64_tr_b16 v[152:153], v161 offset:19648
v_mfma_f32_16x16x32_bf16 v[32:35], a[52:55], v[128:131], v[32:35]
s_waitcnt vmcnt(24)
ds_read_b64_tr_b16 v[154:155], v161 offset:20160
v_mfma_f32_16x16x32_bf16 v[64:67], a[56:59], v[128:131], v[64:67]
s_waitcnt vmcnt(23)
v_mfma_f32_16x16x32_bf16 v[96:99], a[60:63], v[128:131], v[96:99]
s_waitcnt lgkmcnt(10)
v_mfma_f32_16x16x32_bf16 v[4:7], a[48:51], v[132:135], v[4:7]
ds_read_b64_tr_b16 v[156:157], v161 offset:19680
v_mfma_f32_16x16x32_bf16 v[36:39], a[52:55], v[132:135], v[36:39]
ds_read_b64_tr_b16 v[158:159], v161 offset:20192
v_mfma_f32_16x16x32_bf16 v[68:71], a[56:59], v[132:135], v[68:71]
buffer_load_dwordx4 a[92:95], v165, s[4:7], s32 offen offset:2048 sc1
v_mfma_f32_16x16x32_bf16 v[100:103], a[60:63], v[132:135], v[100:103]
s_waitcnt vmcnt(7) lgkmcnt(10)
s_add_u32 s32, s32, 32768
s_barrier
v_mfma_f32_16x16x32_bf16 v[8:11], a[48:51], v[136:139], v[8:11]
ds_read_b64_tr_b16 v[128:129], v161 offset:33024
v_mfma_f32_16x16x32_bf16 v[40:43], a[52:55], v[136:139], v[40:43]
ds_read_b64_tr_b16 v[130:131], v161 offset:33536
v_mfma_f32_16x16x32_bf16 v[72:75], a[56:59], v[136:139], v[72:75]
buffer_load_dwordx4 a[96:99], v164, s[4:7], s32 offen offset:0 sc1
v_mfma_f32_16x16x32_bf16 v[104:107], a[60:63], v[136:139], v[104:107]
s_waitcnt lgkmcnt(10)
v_mfma_f32_16x16x32_bf16 v[12:15], a[48:51], v[140:143], v[12:15]
ds_read_b64_tr_b16 v[132:133], v161 offset:33056
v_mfma_f32_16x16x32_bf16 v[44:47], a[52:55], v[140:143], v[44:47]
ds_read_b64_tr_b16 v[134:135], v161 offset:33568
v_mfma_f32_16x16x32_bf16 v[76:79], a[56:59], v[140:143], v[76:79]
buffer_load_dwordx4 a[100:103], v164, s[4:7], s32 offen offset:2048 sc1
v_mfma_f32_16x16x32_bf16 v[108:111], a[60:63], v[140:143], v[108:111]
s_waitcnt lgkmcnt(10)
v_mfma_f32_16x16x32_bf16 v[16:19], a[48:51], v[144:147], v[16:19]
ds_read_b64_tr_b16 v[136:137], v161 offset:33088
v_mfma_f32_16x16x32_bf16 v[48:51], a[52:55], v[144:147], v[48:51]
s_add_u32 m0, s52, 49536
ds_read_b64_tr_b16 v[138:139], v161 offset:33600
v_mfma_f32_16x16x32_bf16 v[80:83], a[56:59], v[144:147], v[80:83]
buffer_load_dwordx4 v244, s[8:11], s35 offen offset:0  lds
v_mfma_f32_16x16x32_bf16 v[112:115], a[60:63], v[144:147], v[112:115]
s_waitcnt lgkmcnt(10)
v_mfma_f32_16x16x32_bf16 v[20:23], a[48:51], v[148:151], v[20:23]
ds_read_b64_tr_b16 v[140:141], v161 offset:33120
v_mfma_f32_16x16x32_bf16 v[52:55], a[52:55], v[148:151], v[52:55]
ds_read_b64_tr_b16 v[142:143], v161 offset:33632
v_mfma_f32_16x16x32_bf16 v[84:87], a[56:59], v[148:151], v[84:87]
buffer_load_dwordx4 a[104:107], v165, s[4:7], s32 offen offset:0 sc1
v_mfma_f32_16x16x32_bf16 v[116:119], a[60:63], v[148:151], v[116:119]
s_waitcnt lgkmcnt(10)
v_mfma_f32_16x16x32_bf16 v[24:27], a[48:51], v[152:155], v[24:27]
ds_read_b64_tr_b16 v[144:145], v161 offset:49536
v_mfma_f32_16x16x32_bf16 v[56:59], a[52:55], v[152:155], v[56:59]
ds_read_b64_tr_b16 v[146:147], v161 offset:50048
v_mfma_f32_16x16x32_bf16 v[88:91], a[56:59], v[152:155], v[88:91]
buffer_load_dwordx4 a[108:111], v165, s[4:7], s32 offen offset:2048 sc1
v_mfma_f32_16x16x32_bf16 v[120:123], a[60:63], v[152:155], v[120:123]
s_waitcnt lgkmcnt(10)
s_add_u32 s32, s32, 32768
v_mfma_f32_16x16x32_bf16 v[28:31], a[48:51], v[156:159], v[28:31]
ds_read_b64_tr_b16 v[148:149], v161 offset:49568
v_mfma_f32_16x16x32_bf16 v[60:63], a[52:55], v[156:159], v[60:63]
ds_read_b64_tr_b16 v[150:151], v161 offset:50080
v_mfma_f32_16x16x32_bf16 v[92:95], a[56:59], v[156:159], v[92:95]
buffer_load_dwordx4 a[112:115], v164, s[4:7], s32 offen offset:0 sc1
v_mfma_f32_16x16x32_bf16 v[124:127], a[60:63], v[156:159], v[124:127]
s_waitcnt lgkmcnt(10)
v_mfma_f32_16x16x32_bf16 v[0:3], a[64:67], v[128:131], v[0:3]
s_waitcnt vmcnt(12)
ds_read_b64_tr_b16 v[152:153], v161 offset:49600
v_mfma_f32_16x16x32_bf16 v[32:35], a[68:71], v[128:131], v[32:35]
s_waitcnt vmcnt(11)
ds_read_b64_tr_b16 v[154:155], v161 offset:50112
v_mfma_f32_16x16x32_bf16 v[64:67], a[72:75], v[128:131], v[64:67]
s_waitcnt vmcnt(10)
buffer_load_dwordx4 v245, s[8:11], s35 offen offset:1024  lds
v_mfma_f32_16x16x32_bf16 v[96:99], a[76:79], v[128:131], v[96:99]
s_waitcnt lgkmcnt(10)
v_mfma_f32_16x16x32_bf16 v[4:7], a[64:67], v[132:135], v[4:7]
ds_read_b64_tr_b16 v[156:157], v161 offset:49632
v_mfma_f32_16x16x32_bf16 v[36:39], a[68:71], v[132:135], v[36:39]
ds_read_b64_tr_b16 v[158:159], v161 offset:50144
v_mfma_f32_16x16x32_bf16 v[68:71], a[72:75], v[132:135], v[68:71]
buffer_load_dwordx4 a[116:119], v164, s[4:7], s32 offen offset:2048 sc1
v_mfma_f32_16x16x32_bf16 v[100:103], a[76:79], v[132:135], v[100:103]
s_waitcnt lgkmcnt(10)
v_mfma_f32_16x16x32_bf16 v[8:11], a[64:67], v[136:139], v[8:11]
ds_read_b64_tr_b16 v[128:129], v161 offset:34048
v_mfma_f32_16x16x32_bf16 v[40:43], a[68:71], v[136:139], v[40:43]
ds_read_b64_tr_b16 v[130:131], v161 offset:34560
v_mfma_f32_16x16x32_bf16 v[72:75], a[72:75], v[136:139], v[72:75]
buffer_load_dwordx4 a[120:123], v165, s[4:7], s32 offen offset:0 sc1
v_mfma_f32_16x16x32_bf16 v[104:107], a[76:79], v[136:139], v[104:107]
s_waitcnt lgkmcnt(10)
v_mfma_f32_16x16x32_bf16 v[12:15], a[64:67], v[140:143], v[12:15]
ds_read_b64_tr_b16 v[132:133], v161 offset:34080
v_mfma_f32_16x16x32_bf16 v[44:47], a[68:71], v[140:143], v[44:47]
ds_read_b64_tr_b16 v[134:135], v161 offset:34592
v_mfma_f32_16x16x32_bf16 v[76:79], a[72:75], v[140:143], v[76:79]
buffer_load_dwordx4 a[124:127], v165, s[4:7], s32 offen offset:2048 sc1
v_mfma_f32_16x16x32_bf16 v[108:111], a[76:79], v[140:143], v[108:111]
s_waitcnt lgkmcnt(10)
s_add_u32 s32, s32, s31
v_mfma_f32_16x16x32_bf16 v[16:19], a[64:67], v[144:147], v[16:19]
ds_read_b64_tr_b16 v[136:137], v161 offset:34112
v_mfma_f32_16x16x32_bf16 v[48:51], a[68:71], v[144:147], v[48:51]
ds_read_b64_tr_b16 v[138:139], v161 offset:34624
v_mfma_f32_16x16x32_bf16 v[80:83], a[72:75], v[144:147], v[80:83]
buffer_load_dwordx4 v246, s[8:11], s35 offen offset:2048  lds
v_mfma_f32_16x16x32_bf16 v[112:115], a[76:79], v[144:147], v[112:115]
s_waitcnt lgkmcnt(10)
v_mfma_f32_16x16x32_bf16 v[20:23], a[64:67], v[148:151], v[20:23]
ds_read_b64_tr_b16 v[140:141], v161 offset:34144
v_mfma_f32_16x16x32_bf16 v[52:55], a[68:71], v[148:151], v[52:55]
ds_read_b64_tr_b16 v[142:143], v161 offset:34656
v_mfma_f32_16x16x32_bf16 v[84:87], a[72:75], v[148:151], v[84:87]
buffer_load_dwordx4 a[0:3], v164, s[4:7], s32 offen offset:0 sc1
v_mfma_f32_16x16x32_bf16 v[116:119], a[76:79], v[148:151], v[116:119]
s_waitcnt lgkmcnt(10)
v_mfma_f32_16x16x32_bf16 v[24:27], a[64:67], v[152:155], v[24:27]
ds_read_b64_tr_b16 v[144:145], v161 offset:50560
v_mfma_f32_16x16x32_bf16 v[56:59], a[68:71], v[152:155], v[56:59]
ds_read_b64_tr_b16 v[146:147], v161 offset:51072
v_mfma_f32_16x16x32_bf16 v[88:91], a[72:75], v[152:155], v[88:91]
buffer_load_dwordx4 a[4:7], v164, s[4:7], s32 offen offset:2048 sc1
v_mfma_f32_16x16x32_bf16 v[120:123], a[76:79], v[152:155], v[120:123]
s_waitcnt lgkmcnt(10)
v_mfma_f32_16x16x32_bf16 v[28:31], a[64:67], v[156:159], v[28:31]
ds_read_b64_tr_b16 v[148:149], v161 offset:50592
v_mfma_f32_16x16x32_bf16 v[60:63], a[68:71], v[156:159], v[60:63]
ds_read_b64_tr_b16 v[150:151], v161 offset:51104
v_mfma_f32_16x16x32_bf16 v[92:95], a[72:75], v[156:159], v[92:95]
buffer_load_dwordx4 a[8:11], v165, s[4:7], s32 offen offset:0 sc1
v_mfma_f32_16x16x32_bf16 v[124:127], a[76:79], v[156:159], v[124:127]
s_waitcnt vmcnt(17) lgkmcnt(10)
v_mfma_f32_16x16x32_bf16 v[0:3], a[80:83], v[128:131], v[0:3]
s_waitcnt vmcnt(16)
ds_read_b64_tr_b16 v[152:153], v161 offset:50624
v_mfma_f32_16x16x32_bf16 v[32:35], a[84:87], v[128:131], v[32:35]
s_waitcnt vmcnt(15)
ds_read_b64_tr_b16 v[154:155], v161 offset:51136
v_mfma_f32_16x16x32_bf16 v[64:67], a[88:91], v[128:131], v[64:67]
s_waitcnt vmcnt(14)
buffer_load_dwordx4 v247, s[8:11], s35 offen offset:3072  lds
v_mfma_f32_16x16x32_bf16 v[96:99], a[92:95], v[128:131], v[96:99]
s_waitcnt lgkmcnt(10)
s_add_u32 s35, s35, s63
v_mfma_f32_16x16x32_bf16 v[4:7], a[80:83], v[132:135], v[4:7]
ds_read_b64_tr_b16 v[156:157], v161 offset:50656
v_mfma_f32_16x16x32_bf16 v[36:39], a[84:87], v[132:135], v[36:39]
ds_read_b64_tr_b16 v[158:159], v161 offset:51168
v_mfma_f32_16x16x32_bf16 v[68:71], a[88:91], v[132:135], v[68:71]
buffer_load_dwordx4 a[12:15], v165, s[4:7], s32 offen offset:2048 sc1
v_mfma_f32_16x16x32_bf16 v[100:103], a[92:95], v[132:135], v[100:103]
s_waitcnt lgkmcnt(10)
s_add_u32 s32, s32, 32768
v_mfma_f32_16x16x32_bf16 v[8:11], a[80:83], v[136:139], v[8:11]
ds_read_b64_tr_b16 v[128:129], v161 offset:35072
v_mfma_f32_16x16x32_bf16 v[40:43], a[84:87], v[136:139], v[40:43]
ds_read_b64_tr_b16 v[130:131], v161 offset:35584
v_mfma_f32_16x16x32_bf16 v[72:75], a[88:91], v[136:139], v[72:75]
buffer_load_dwordx4 a[16:19], v164, s[4:7], s32 offen offset:0 sc1
v_mfma_f32_16x16x32_bf16 v[104:107], a[92:95], v[136:139], v[104:107]
s_waitcnt lgkmcnt(10)
v_mfma_f32_16x16x32_bf16 v[12:15], a[80:83], v[140:143], v[12:15]
ds_read_b64_tr_b16 v[132:133], v161 offset:35104
v_mfma_f32_16x16x32_bf16 v[44:47], a[84:87], v[140:143], v[44:47]
ds_read_b64_tr_b16 v[134:135], v161 offset:35616
v_mfma_f32_16x16x32_bf16 v[76:79], a[88:91], v[140:143], v[76:79]
buffer_load_dwordx4 a[20:23], v164, s[4:7], s32 offen offset:2048 sc1
v_mfma_f32_16x16x32_bf16 v[108:111], a[92:95], v[140:143], v[108:111]
s_waitcnt lgkmcnt(10)
v_mfma_f32_16x16x32_bf16 v[16:19], a[80:83], v[144:147], v[16:19]
ds_read_b64_tr_b16 v[136:137], v161 offset:35136
v_mfma_f32_16x16x32_bf16 v[48:51], a[84:87], v[144:147], v[48:51]
s_add_u32 m0, s52, 33024
ds_read_b64_tr_b16 v[138:139], v161 offset:35648
v_mfma_f32_16x16x32_bf16 v[80:83], a[88:91], v[144:147], v[80:83]
buffer_load_dwordx4 v244, s[8:11], s34 offen offset:0  lds
v_mfma_f32_16x16x32_bf16 v[112:115], a[92:95], v[144:147], v[112:115]
s_waitcnt lgkmcnt(10)
v_mfma_f32_16x16x32_bf16 v[20:23], a[80:83], v[148:151], v[20:23]
ds_read_b64_tr_b16 v[140:141], v161 offset:35168
v_mfma_f32_16x16x32_bf16 v[52:55], a[84:87], v[148:151], v[52:55]
ds_read_b64_tr_b16 v[142:143], v161 offset:35680
v_mfma_f32_16x16x32_bf16 v[84:87], a[88:91], v[148:151], v[84:87]
buffer_load_dwordx4 a[24:27], v165, s[4:7], s32 offen offset:0 sc1
v_mfma_f32_16x16x32_bf16 v[116:119], a[92:95], v[148:151], v[116:119]
s_waitcnt lgkmcnt(10)
v_mfma_f32_16x16x32_bf16 v[24:27], a[80:83], v[152:155], v[24:27]
ds_read_b64_tr_b16 v[144:145], v161 offset:51584
v_mfma_f32_16x16x32_bf16 v[56:59], a[84:87], v[152:155], v[56:59]
ds_read_b64_tr_b16 v[146:147], v161 offset:52096
v_mfma_f32_16x16x32_bf16 v[88:91], a[88:91], v[152:155], v[88:91]
buffer_load_dwordx4 a[28:31], v165, s[4:7], s32 offen offset:2048 sc1
v_mfma_f32_16x16x32_bf16 v[120:123], a[92:95], v[152:155], v[120:123]
s_waitcnt lgkmcnt(10)
s_add_u32 s32, s32, 32768
v_mfma_f32_16x16x32_bf16 v[28:31], a[80:83], v[156:159], v[28:31]
ds_read_b64_tr_b16 v[148:149], v161 offset:51616
v_mfma_f32_16x16x32_bf16 v[60:63], a[84:87], v[156:159], v[60:63]
ds_read_b64_tr_b16 v[150:151], v161 offset:52128
v_mfma_f32_16x16x32_bf16 v[92:95], a[88:91], v[156:159], v[92:95]
buffer_load_dwordx4 a[32:35], v164, s[4:7], s32 offen offset:0 sc1
v_mfma_f32_16x16x32_bf16 v[124:127], a[92:95], v[156:159], v[124:127]
s_waitcnt vmcnt(21) lgkmcnt(10)
v_mfma_f32_16x16x32_bf16 v[0:3], a[96:99], v[128:131], v[0:3]
s_waitcnt vmcnt(20)
ds_read_b64_tr_b16 v[152:153], v161 offset:51648
v_mfma_f32_16x16x32_bf16 v[32:35], a[100:103], v[128:131], v[32:35]
s_waitcnt vmcnt(18)
ds_read_b64_tr_b16 v[154:155], v161 offset:52160
v_mfma_f32_16x16x32_bf16 v[64:67], a[104:107], v[128:131], v[64:67]
s_waitcnt vmcnt(17)
buffer_load_dwordx4 v245, s[8:11], s34 offen offset:1024  lds
v_mfma_f32_16x16x32_bf16 v[96:99], a[108:111], v[128:131], v[96:99]
s_waitcnt lgkmcnt(10)
v_mfma_f32_16x16x32_bf16 v[4:7], a[96:99], v[132:135], v[4:7]
ds_read_b64_tr_b16 v[156:157], v161 offset:51680
v_mfma_f32_16x16x32_bf16 v[36:39], a[100:103], v[132:135], v[36:39]
ds_read_b64_tr_b16 v[158:159], v161 offset:52192
v_mfma_f32_16x16x32_bf16 v[68:71], a[104:107], v[132:135], v[68:71]
buffer_load_dwordx4 a[36:39], v164, s[4:7], s32 offen offset:2048 sc1
v_mfma_f32_16x16x32_bf16 v[100:103], a[108:111], v[132:135], v[100:103]
s_waitcnt lgkmcnt(10)
v_mfma_f32_16x16x32_bf16 v[8:11], a[96:99], v[136:139], v[8:11]
ds_read_b64_tr_b16 v[128:129], v161 offset:36096
v_mfma_f32_16x16x32_bf16 v[40:43], a[100:103], v[136:139], v[40:43]
ds_read_b64_tr_b16 v[130:131], v161 offset:36608
v_mfma_f32_16x16x32_bf16 v[72:75], a[104:107], v[136:139], v[72:75]
buffer_load_dwordx4 a[40:43], v165, s[4:7], s32 offen offset:0 sc1
v_mfma_f32_16x16x32_bf16 v[104:107], a[108:111], v[136:139], v[104:107]
s_waitcnt lgkmcnt(10)
v_mfma_f32_16x16x32_bf16 v[12:15], a[96:99], v[140:143], v[12:15]
ds_read_b64_tr_b16 v[132:133], v161 offset:36128
v_mfma_f32_16x16x32_bf16 v[44:47], a[100:103], v[140:143], v[44:47]
ds_read_b64_tr_b16 v[134:135], v161 offset:36640
v_mfma_f32_16x16x32_bf16 v[76:79], a[104:107], v[140:143], v[76:79]
buffer_load_dwordx4 a[44:47], v165, s[4:7], s32 offen offset:2048 sc1
v_mfma_f32_16x16x32_bf16 v[108:111], a[108:111], v[140:143], v[108:111]
s_waitcnt lgkmcnt(10)
s_add_u32 s32, s32, 32768
v_mfma_f32_16x16x32_bf16 v[16:19], a[96:99], v[144:147], v[16:19]
ds_read_b64_tr_b16 v[136:137], v161 offset:36160
v_mfma_f32_16x16x32_bf16 v[48:51], a[100:103], v[144:147], v[48:51]
ds_read_b64_tr_b16 v[138:139], v161 offset:36672
v_mfma_f32_16x16x32_bf16 v[80:83], a[104:107], v[144:147], v[80:83]
buffer_load_dwordx4 v246, s[8:11], s34 offen offset:2048  lds
v_mfma_f32_16x16x32_bf16 v[112:115], a[108:111], v[144:147], v[112:115]
s_waitcnt lgkmcnt(10)
v_mfma_f32_16x16x32_bf16 v[20:23], a[96:99], v[148:151], v[20:23]
ds_read_b64_tr_b16 v[140:141], v161 offset:36192
v_mfma_f32_16x16x32_bf16 v[52:55], a[100:103], v[148:151], v[52:55]
ds_read_b64_tr_b16 v[142:143], v161 offset:36704
v_mfma_f32_16x16x32_bf16 v[84:87], a[104:107], v[148:151], v[84:87]
buffer_load_dwordx4 a[48:51], v164, s[4:7], s32 offen offset:0 sc1
v_mfma_f32_16x16x32_bf16 v[116:119], a[108:111], v[148:151], v[116:119]
s_waitcnt lgkmcnt(10)
v_mfma_f32_16x16x32_bf16 v[24:27], a[96:99], v[152:155], v[24:27]
ds_read_b64_tr_b16 v[144:145], v161 offset:52608
v_mfma_f32_16x16x32_bf16 v[56:59], a[100:103], v[152:155], v[56:59]
ds_read_b64_tr_b16 v[146:147], v161 offset:53120
v_mfma_f32_16x16x32_bf16 v[88:91], a[104:107], v[152:155], v[88:91]
buffer_load_dwordx4 a[52:55], v164, s[4:7], s32 offen offset:2048 sc1
v_mfma_f32_16x16x32_bf16 v[120:123], a[108:111], v[152:155], v[120:123]
s_waitcnt lgkmcnt(10)
v_mfma_f32_16x16x32_bf16 v[28:31], a[96:99], v[156:159], v[28:31]
ds_read_b64_tr_b16 v[148:149], v161 offset:52640
v_mfma_f32_16x16x32_bf16 v[60:63], a[100:103], v[156:159], v[60:63]
ds_read_b64_tr_b16 v[150:151], v161 offset:53152
v_mfma_f32_16x16x32_bf16 v[92:95], a[104:107], v[156:159], v[92:95]
buffer_load_dwordx4 a[56:59], v165, s[4:7], s32 offen offset:0 sc1
v_mfma_f32_16x16x32_bf16 v[124:127], a[108:111], v[156:159], v[124:127]
s_waitcnt vmcnt(24) lgkmcnt(10)
v_mfma_f32_16x16x32_bf16 v[0:3], a[112:115], v[128:131], v[0:3]
s_waitcnt vmcnt(22)
ds_read_b64_tr_b16 v[152:153], v161 offset:52672
v_mfma_f32_16x16x32_bf16 v[32:35], a[116:119], v[128:131], v[32:35]
s_waitcnt vmcnt(21)
ds_read_b64_tr_b16 v[154:155], v161 offset:53184
v_mfma_f32_16x16x32_bf16 v[64:67], a[120:123], v[128:131], v[64:67]
s_waitcnt vmcnt(20)
buffer_load_dwordx4 v247, s[8:11], s34 offen offset:3072  lds
v_mfma_f32_16x16x32_bf16 v[96:99], a[124:127], v[128:131], v[96:99]
s_waitcnt lgkmcnt(10)
s_add_u32 s34, s34, s63
v_mfma_f32_16x16x32_bf16 v[4:7], a[112:115], v[132:135], v[4:7]
ds_read_b64_tr_b16 v[156:157], v161 offset:52704
v_mfma_f32_16x16x32_bf16 v[36:39], a[116:119], v[132:135], v[36:39]
ds_read_b64_tr_b16 v[158:159], v161 offset:53216
v_mfma_f32_16x16x32_bf16 v[68:71], a[120:123], v[132:135], v[68:71]
buffer_load_dwordx4 a[60:63], v165, s[4:7], s32 offen offset:2048 sc1
v_mfma_f32_16x16x32_bf16 v[100:103], a[124:127], v[132:135], v[100:103]
s_waitcnt lgkmcnt(10)
s_add_u32 s32, s32, s30
s_barrier
v_mfma_f32_16x16x32_bf16 v[8:11], a[112:115], v[136:139], v[8:11]
s_xor_b32 s34, s34, s23
ds_read_b64_tr_b16 v[128:129], v160 offset:0
v_mfma_f32_16x16x32_bf16 v[40:43], a[116:119], v[136:139], v[40:43]
s_xor_b32 s35, s35, s23
s_add_u32 m0, s53, s29
ds_read_b64_tr_b16 v[130:131], v160 offset:512
v_mfma_f32_16x16x32_bf16 v[72:75], a[120:123], v[136:139], v[72:75]
buffer_load_dwordx4 v244, s[8:11], s35 offen offset:0  lds
v_mfma_f32_16x16x32_bf16 v[104:107], a[124:127], v[136:139], v[104:107]
s_waitcnt lgkmcnt(10)
v_mfma_f32_16x16x32_bf16 v[12:15], a[112:115], v[140:143], v[12:15]
ds_read_b64_tr_b16 v[132:133], v160 offset:32
v_mfma_f32_16x16x32_bf16 v[44:47], a[116:119], v[140:143], v[44:47]
ds_read_b64_tr_b16 v[134:135], v160 offset:544
v_mfma_f32_16x16x32_bf16 v[76:79], a[120:123], v[140:143], v[76:79]
buffer_load_dwordx4 v245, s[8:11], s35 offen offset:1024  lds
v_mfma_f32_16x16x32_bf16 v[108:111], a[124:127], v[140:143], v[108:111]
s_waitcnt lgkmcnt(10)
v_mfma_f32_16x16x32_bf16 v[16:19], a[112:115], v[144:147], v[16:19]
ds_read_b64_tr_b16 v[136:137], v160 offset:64
v_mfma_f32_16x16x32_bf16 v[48:51], a[116:119], v[144:147], v[48:51]
ds_read_b64_tr_b16 v[138:139], v160 offset:576
v_mfma_f32_16x16x32_bf16 v[80:83], a[120:123], v[144:147], v[80:83]
buffer_load_dwordx4 v246, s[8:11], s35 offen offset:2048  lds
v_mfma_f32_16x16x32_bf16 v[112:115], a[124:127], v[144:147], v[112:115]
s_waitcnt lgkmcnt(10)
v_mfma_f32_16x16x32_bf16 v[20:23], a[112:115], v[148:151], v[20:23]
ds_read_b64_tr_b16 v[140:141], v160 offset:96
v_mfma_f32_16x16x32_bf16 v[52:55], a[116:119], v[148:151], v[52:55]
ds_read_b64_tr_b16 v[142:143], v160 offset:608
v_mfma_f32_16x16x32_bf16 v[84:87], a[120:123], v[148:151], v[84:87]
buffer_load_dwordx4 v247, s[8:11], s35 offen offset:3072  lds
v_mfma_f32_16x16x32_bf16 v[116:119], a[124:127], v[148:151], v[116:119]
s_waitcnt lgkmcnt(10)
s_add_u32 s35, s35, s20
v_mfma_f32_16x16x32_bf16 v[24:27], a[112:115], v[152:155], v[24:27]
ds_read_b64_tr_b16 v[144:145], v160 offset:16512
v_mfma_f32_16x16x32_bf16 v[56:59], a[116:119], v[152:155], v[56:59]
ds_read_b64_tr_b16 v[146:147], v160 offset:17024
v_mfma_f32_16x16x32_bf16 v[88:91], a[120:123], v[152:155], v[88:91]
v_mfma_f32_16x16x32_bf16 v[120:123], a[124:127], v[152:155], v[120:123]
s_waitcnt lgkmcnt(10)
v_mfma_f32_16x16x32_bf16 v[28:31], a[112:115], v[156:159], v[28:31]
ds_read_b64_tr_b16 v[148:149], v160 offset:16544
v_mfma_f32_16x16x32_bf16 v[60:63], a[116:119], v[156:159], v[60:63]
ds_read_b64_tr_b16 v[150:151], v160 offset:17056
v_mfma_f32_16x16x32_bf16 v[92:95], a[120:123], v[156:159], v[92:95]
v_mfma_f32_16x16x32_bf16 v[124:127], a[124:127], v[156:159], v[124:127]
s_branch standalone__weight_only_int_quip__prompt_kernel_loop1
.p2align 7
.fill 0, 4, 0xbf800000
standalone__weight_only_int_quip__prompt_kernel_loop1:
s_waitcnt vmcnt(24) lgkmcnt(10)
v_mfma_f32_16x16x32_bf16 v[0:3], a[0:3], v[128:131], v[0:3]
s_waitcnt vmcnt(23)
ds_read_b64_tr_b16 v[152:153], v160 offset:16576
v_mfma_f32_16x16x32_bf16 v[32:35], a[4:7], v[128:131], v[32:35]
s_waitcnt vmcnt(22)
ds_read_b64_tr_b16 v[154:155], v160 offset:17088
v_mfma_f32_16x16x32_bf16 v[64:67], a[8:11], v[128:131], v[64:67]
s_waitcnt vmcnt(20)
v_mfma_f32_16x16x32_bf16 v[96:99], a[12:15], v[128:131], v[96:99]
s_waitcnt lgkmcnt(10)
v_mfma_f32_16x16x32_bf16 v[4:7], a[0:3], v[132:135], v[4:7]
ds_read_b64_tr_b16 v[156:157], v160 offset:16608
v_mfma_f32_16x16x32_bf16 v[36:39], a[4:7], v[132:135], v[36:39]
ds_read_b64_tr_b16 v[158:159], v160 offset:17120
v_mfma_f32_16x16x32_bf16 v[68:71], a[8:11], v[132:135], v[68:71]
v_mfma_f32_16x16x32_bf16 v[100:103], a[12:15], v[132:135], v[100:103]
s_waitcnt lgkmcnt(10)
v_mfma_f32_16x16x32_bf16 v[8:11], a[0:3], v[136:139], v[8:11]
ds_read_b64_tr_b16 v[128:129], v160 offset:1024
v_mfma_f32_16x16x32_bf16 v[40:43], a[4:7], v[136:139], v[40:43]
ds_read_b64_tr_b16 v[130:131], v160 offset:1536
v_mfma_f32_16x16x32_bf16 v[72:75], a[8:11], v[136:139], v[72:75]
v_mfma_f32_16x16x32_bf16 v[104:107], a[12:15], v[136:139], v[104:107]
s_waitcnt lgkmcnt(10)
v_mfma_f32_16x16x32_bf16 v[12:15], a[0:3], v[140:143], v[12:15]
ds_read_b64_tr_b16 v[132:133], v160 offset:1056
v_mfma_f32_16x16x32_bf16 v[44:47], a[4:7], v[140:143], v[44:47]
ds_read_b64_tr_b16 v[134:135], v160 offset:1568
v_mfma_f32_16x16x32_bf16 v[76:79], a[8:11], v[140:143], v[76:79]
v_mfma_f32_16x16x32_bf16 v[108:111], a[12:15], v[140:143], v[108:111]
s_waitcnt lgkmcnt(10)
v_mfma_f32_16x16x32_bf16 v[16:19], a[0:3], v[144:147], v[16:19]
ds_read_b64_tr_b16 v[136:137], v160 offset:1088
v_mfma_f32_16x16x32_bf16 v[48:51], a[4:7], v[144:147], v[48:51]
ds_read_b64_tr_b16 v[138:139], v160 offset:1600
v_mfma_f32_16x16x32_bf16 v[80:83], a[8:11], v[144:147], v[80:83]
v_mfma_f32_16x16x32_bf16 v[112:115], a[12:15], v[144:147], v[112:115]
s_waitcnt lgkmcnt(10)
v_mfma_f32_16x16x32_bf16 v[20:23], a[0:3], v[148:151], v[20:23]
ds_read_b64_tr_b16 v[140:141], v160 offset:1120
v_mfma_f32_16x16x32_bf16 v[52:55], a[4:7], v[148:151], v[52:55]
ds_read_b64_tr_b16 v[142:143], v160 offset:1632
v_mfma_f32_16x16x32_bf16 v[84:87], a[8:11], v[148:151], v[84:87]
v_mfma_f32_16x16x32_bf16 v[116:119], a[12:15], v[148:151], v[116:119]
s_waitcnt lgkmcnt(10)
v_mfma_f32_16x16x32_bf16 v[24:27], a[0:3], v[152:155], v[24:27]
ds_read_b64_tr_b16 v[144:145], v160 offset:17536
v_mfma_f32_16x16x32_bf16 v[56:59], a[4:7], v[152:155], v[56:59]
ds_read_b64_tr_b16 v[146:147], v160 offset:18048
v_mfma_f32_16x16x32_bf16 v[88:91], a[8:11], v[152:155], v[88:91]
buffer_load_dwordx4 a[64:67], v164, s[4:7], s32 offen offset:0 sc1
v_mfma_f32_16x16x32_bf16 v[120:123], a[12:15], v[152:155], v[120:123]
s_waitcnt lgkmcnt(10)
v_mfma_f32_16x16x32_bf16 v[28:31], a[0:3], v[156:159], v[28:31]
ds_read_b64_tr_b16 v[148:149], v160 offset:17568
v_mfma_f32_16x16x32_bf16 v[60:63], a[4:7], v[156:159], v[60:63]
ds_read_b64_tr_b16 v[150:151], v160 offset:18080
v_mfma_f32_16x16x32_bf16 v[92:95], a[8:11], v[156:159], v[92:95]
buffer_load_dwordx4 a[68:71], v164, s[4:7], s32 offen offset:2048 sc1
v_mfma_f32_16x16x32_bf16 v[124:127], a[12:15], v[156:159], v[124:127]
s_waitcnt vmcnt(21) lgkmcnt(10)
v_mfma_f32_16x16x32_bf16 v[0:3], a[16:19], v[128:131], v[0:3]
s_waitcnt vmcnt(20)
ds_read_b64_tr_b16 v[152:153], v160 offset:17600
v_mfma_f32_16x16x32_bf16 v[32:35], a[20:23], v[128:131], v[32:35]
s_waitcnt vmcnt(18)
ds_read_b64_tr_b16 v[154:155], v160 offset:18112
v_mfma_f32_16x16x32_bf16 v[64:67], a[24:27], v[128:131], v[64:67]
s_waitcnt vmcnt(17)
buffer_load_dwordx4 a[72:75], v165, s[4:7], s32 offen offset:0 sc1
v_mfma_f32_16x16x32_bf16 v[96:99], a[28:31], v[128:131], v[96:99]
s_waitcnt lgkmcnt(10)
v_mfma_f32_16x16x32_bf16 v[4:7], a[16:19], v[132:135], v[4:7]
ds_read_b64_tr_b16 v[156:157], v160 offset:17632
v_mfma_f32_16x16x32_bf16 v[36:39], a[20:23], v[132:135], v[36:39]
s_add_u32 m0, s53, s28
ds_read_b64_tr_b16 v[158:159], v160 offset:18144
v_mfma_f32_16x16x32_bf16 v[68:71], a[24:27], v[132:135], v[68:71]
buffer_load_dwordx4 v244, s[8:11], s34 offen offset:0  lds
v_mfma_f32_16x16x32_bf16 v[100:103], a[28:31], v[132:135], v[100:103]
s_waitcnt lgkmcnt(10)
v_mfma_f32_16x16x32_bf16 v[8:11], a[16:19], v[136:139], v[8:11]
ds_read_b64_tr_b16 v[128:129], v160 offset:2048
v_mfma_f32_16x16x32_bf16 v[40:43], a[20:23], v[136:139], v[40:43]
ds_read_b64_tr_b16 v[130:131], v160 offset:2560
v_mfma_f32_16x16x32_bf16 v[72:75], a[24:27], v[136:139], v[72:75]
buffer_load_dwordx4 a[76:79], v165, s[4:7], s32 offen offset:2048 sc1
v_mfma_f32_16x16x32_bf16 v[104:107], a[28:31], v[136:139], v[104:107]
s_waitcnt lgkmcnt(10)
s_add_u32 s32, s32, 32768
v_mfma_f32_16x16x32_bf16 v[12:15], a[16:19], v[140:143], v[12:15]
ds_read_b64_tr_b16 v[132:133], v160 offset:2080
v_mfma_f32_16x16x32_bf16 v[44:47], a[20:23], v[140:143], v[44:47]
ds_read_b64_tr_b16 v[134:135], v160 offset:2592
v_mfma_f32_16x16x32_bf16 v[76:79], a[24:27], v[140:143], v[76:79]
buffer_load_dwordx4 a[80:83], v164, s[4:7], s32 offen offset:0 sc1
v_mfma_f32_16x16x32_bf16 v[108:111], a[28:31], v[140:143], v[108:111]
s_waitcnt lgkmcnt(10)
v_mfma_f32_16x16x32_bf16 v[16:19], a[16:19], v[144:147], v[16:19]
ds_read_b64_tr_b16 v[136:137], v160 offset:2112
v_mfma_f32_16x16x32_bf16 v[48:51], a[20:23], v[144:147], v[48:51]
ds_read_b64_tr_b16 v[138:139], v160 offset:2624
v_mfma_f32_16x16x32_bf16 v[80:83], a[24:27], v[144:147], v[80:83]
buffer_load_dwordx4 a[84:87], v164, s[4:7], s32 offen offset:2048 sc1
v_mfma_f32_16x16x32_bf16 v[112:115], a[28:31], v[144:147], v[112:115]
s_waitcnt lgkmcnt(10)
v_mfma_f32_16x16x32_bf16 v[20:23], a[16:19], v[148:151], v[20:23]
ds_read_b64_tr_b16 v[140:141], v160 offset:2144
v_mfma_f32_16x16x32_bf16 v[52:55], a[20:23], v[148:151], v[52:55]
ds_read_b64_tr_b16 v[142:143], v160 offset:2656
v_mfma_f32_16x16x32_bf16 v[84:87], a[24:27], v[148:151], v[84:87]
buffer_load_dwordx4 v245, s[8:11], s34 offen offset:1024  lds
v_mfma_f32_16x16x32_bf16 v[116:119], a[28:31], v[148:151], v[116:119]
s_waitcnt lgkmcnt(10)
v_mfma_f32_16x16x32_bf16 v[24:27], a[16:19], v[152:155], v[24:27]
ds_read_b64_tr_b16 v[144:145], v160 offset:18560
v_mfma_f32_16x16x32_bf16 v[56:59], a[20:23], v[152:155], v[56:59]
ds_read_b64_tr_b16 v[146:147], v160 offset:19072
v_mfma_f32_16x16x32_bf16 v[88:91], a[24:27], v[152:155], v[88:91]
buffer_load_dwordx4 a[88:91], v165, s[4:7], s32 offen offset:0 sc1
v_mfma_f32_16x16x32_bf16 v[120:123], a[28:31], v[152:155], v[120:123]
s_waitcnt lgkmcnt(10)
v_mfma_f32_16x16x32_bf16 v[28:31], a[16:19], v[156:159], v[28:31]
ds_read_b64_tr_b16 v[148:149], v160 offset:18592
v_mfma_f32_16x16x32_bf16 v[60:63], a[20:23], v[156:159], v[60:63]
ds_read_b64_tr_b16 v[150:151], v160 offset:19104
v_mfma_f32_16x16x32_bf16 v[92:95], a[24:27], v[156:159], v[92:95]
buffer_load_dwordx4 a[92:95], v165, s[4:7], s32 offen offset:2048 sc1
v_mfma_f32_16x16x32_bf16 v[124:127], a[28:31], v[156:159], v[124:127]
s_waitcnt vmcnt(24) lgkmcnt(10)
s_add_u32 s32, s32, 32768
v_mfma_f32_16x16x32_bf16 v[0:3], a[32:35], v[128:131], v[0:3]
s_waitcnt vmcnt(22)
ds_read_b64_tr_b16 v[152:153], v160 offset:18624
v_mfma_f32_16x16x32_bf16 v[32:35], a[36:39], v[128:131], v[32:35]
s_waitcnt vmcnt(21)
ds_read_b64_tr_b16 v[154:155], v160 offset:19136
v_mfma_f32_16x16x32_bf16 v[64:67], a[40:43], v[128:131], v[64:67]
s_waitcnt vmcnt(20)
buffer_load_dwordx4 a[96:99], v164, s[4:7], s32 offen offset:0 sc1
v_mfma_f32_16x16x32_bf16 v[96:99], a[44:47], v[128:131], v[96:99]
s_waitcnt lgkmcnt(10)
v_mfma_f32_16x16x32_bf16 v[4:7], a[32:35], v[132:135], v[4:7]
ds_read_b64_tr_b16 v[156:157], v160 offset:18656
v_mfma_f32_16x16x32_bf16 v[36:39], a[36:39], v[132:135], v[36:39]
ds_read_b64_tr_b16 v[158:159], v160 offset:19168
v_mfma_f32_16x16x32_bf16 v[68:71], a[40:43], v[132:135], v[68:71]
buffer_load_dwordx4 v246, s[8:11], s34 offen offset:2048  lds
v_mfma_f32_16x16x32_bf16 v[100:103], a[44:47], v[132:135], v[100:103]
s_waitcnt lgkmcnt(10)
v_mfma_f32_16x16x32_bf16 v[8:11], a[32:35], v[136:139], v[8:11]
ds_read_b64_tr_b16 v[128:129], v160 offset:3072
v_mfma_f32_16x16x32_bf16 v[40:43], a[36:39], v[136:139], v[40:43]
ds_read_b64_tr_b16 v[130:131], v160 offset:3584
v_mfma_f32_16x16x32_bf16 v[72:75], a[40:43], v[136:139], v[72:75]
buffer_load_dwordx4 a[100:103], v164, s[4:7], s32 offen offset:2048 sc1
v_mfma_f32_16x16x32_bf16 v[104:107], a[44:47], v[136:139], v[104:107]
s_waitcnt lgkmcnt(10)
v_mfma_f32_16x16x32_bf16 v[12:15], a[32:35], v[140:143], v[12:15]
ds_read_b64_tr_b16 v[132:133], v160 offset:3104
v_mfma_f32_16x16x32_bf16 v[44:47], a[36:39], v[140:143], v[44:47]
ds_read_b64_tr_b16 v[134:135], v160 offset:3616
v_mfma_f32_16x16x32_bf16 v[76:79], a[40:43], v[140:143], v[76:79]
buffer_load_dwordx4 a[104:107], v165, s[4:7], s32 offen offset:0 sc1
v_mfma_f32_16x16x32_bf16 v[108:111], a[44:47], v[140:143], v[108:111]
s_waitcnt lgkmcnt(10)
v_mfma_f32_16x16x32_bf16 v[16:19], a[32:35], v[144:147], v[16:19]
ds_read_b64_tr_b16 v[136:137], v160 offset:3136
v_mfma_f32_16x16x32_bf16 v[48:51], a[36:39], v[144:147], v[48:51]
ds_read_b64_tr_b16 v[138:139], v160 offset:3648
v_mfma_f32_16x16x32_bf16 v[80:83], a[40:43], v[144:147], v[80:83]
buffer_load_dwordx4 a[108:111], v165, s[4:7], s32 offen offset:2048 sc1
v_mfma_f32_16x16x32_bf16 v[112:115], a[44:47], v[144:147], v[112:115]
s_waitcnt lgkmcnt(10)
s_add_u32 s32, s32, 32768
v_mfma_f32_16x16x32_bf16 v[20:23], a[32:35], v[148:151], v[20:23]
ds_read_b64_tr_b16 v[140:141], v160 offset:3168
v_mfma_f32_16x16x32_bf16 v[52:55], a[36:39], v[148:151], v[52:55]
ds_read_b64_tr_b16 v[142:143], v160 offset:3680
v_mfma_f32_16x16x32_bf16 v[84:87], a[40:43], v[148:151], v[84:87]
buffer_load_dwordx4 v247, s[8:11], s34 offen offset:3072  lds
v_mfma_f32_16x16x32_bf16 v[116:119], a[44:47], v[148:151], v[116:119]
s_waitcnt lgkmcnt(10)
s_add_u32 s34, s34, s20
v_mfma_f32_16x16x32_bf16 v[24:27], a[32:35], v[152:155], v[24:27]
ds_read_b64_tr_b16 v[144:145], v160 offset:19584
v_mfma_f32_16x16x32_bf16 v[56:59], a[36:39], v[152:155], v[56:59]
ds_read_b64_tr_b16 v[146:147], v160 offset:20096
v_mfma_f32_16x16x32_bf16 v[88:91], a[40:43], v[152:155], v[88:91]
buffer_load_dwordx4 a[112:115], v164, s[4:7], s32 offen offset:0 sc1
v_mfma_f32_16x16x32_bf16 v[120:123], a[44:47], v[152:155], v[120:123]
s_waitcnt lgkmcnt(10)
v_mfma_f32_16x16x32_bf16 v[28:31], a[32:35], v[156:159], v[28:31]
ds_read_b64_tr_b16 v[148:149], v160 offset:19616
v_mfma_f32_16x16x32_bf16 v[60:63], a[36:39], v[156:159], v[60:63]
ds_read_b64_tr_b16 v[150:151], v160 offset:20128
v_mfma_f32_16x16x32_bf16 v[92:95], a[40:43], v[156:159], v[92:95]
buffer_load_dwordx4 a[116:119], v164, s[4:7], s32 offen offset:2048 sc1
v_mfma_f32_16x16x32_bf16 v[124:127], a[44:47], v[156:159], v[124:127]
s_waitcnt vmcnt(26) lgkmcnt(10)
v_mfma_f32_16x16x32_bf16 v[0:3], a[48:51], v[128:131], v[0:3]
s_waitcnt vmcnt(25)
ds_read_b64_tr_b16 v[152:153], v160 offset:19648
v_mfma_f32_16x16x32_bf16 v[32:35], a[52:55], v[128:131], v[32:35]
s_waitcnt vmcnt(24)
ds_read_b64_tr_b16 v[154:155], v160 offset:20160
v_mfma_f32_16x16x32_bf16 v[64:67], a[56:59], v[128:131], v[64:67]
s_waitcnt vmcnt(22)
buffer_load_dwordx4 a[120:123], v165, s[4:7], s32 offen offset:0 sc1
v_mfma_f32_16x16x32_bf16 v[96:99], a[60:63], v[128:131], v[96:99]
s_waitcnt lgkmcnt(10)
v_mfma_f32_16x16x32_bf16 v[4:7], a[48:51], v[132:135], v[4:7]
ds_read_b64_tr_b16 v[156:157], v160 offset:19680
v_mfma_f32_16x16x32_bf16 v[36:39], a[52:55], v[132:135], v[36:39]
ds_read_b64_tr_b16 v[158:159], v160 offset:20192
v_mfma_f32_16x16x32_bf16 v[68:71], a[56:59], v[132:135], v[68:71]
buffer_load_dwordx4 a[124:127], v165, s[4:7], s32 offen offset:2048 sc1
v_mfma_f32_16x16x32_bf16 v[100:103], a[60:63], v[132:135], v[100:103]
s_waitcnt lgkmcnt(10)
s_add_u32 s32, s32, s31
s_barrier
v_mfma_f32_16x16x32_bf16 v[8:11], a[48:51], v[136:139], v[8:11]
ds_read_b64_tr_b16 v[128:129], v160 offset:33024
v_mfma_f32_16x16x32_bf16 v[40:43], a[52:55], v[136:139], v[40:43]
ds_read_b64_tr_b16 v[130:131], v160 offset:33536
v_mfma_f32_16x16x32_bf16 v[72:75], a[56:59], v[136:139], v[72:75]
buffer_load_dwordx4 a[0:3], v164, s[4:7], s32 offen offset:0 sc1
v_mfma_f32_16x16x32_bf16 v[104:107], a[60:63], v[136:139], v[104:107]
s_waitcnt lgkmcnt(10)
v_mfma_f32_16x16x32_bf16 v[12:15], a[48:51], v[140:143], v[12:15]
ds_read_b64_tr_b16 v[132:133], v160 offset:33056
v_mfma_f32_16x16x32_bf16 v[44:47], a[52:55], v[140:143], v[44:47]
s_add_u32 m0, s53, s29
s_add_u32 m0, m0, 33024
ds_read_b64_tr_b16 v[134:135], v160 offset:33568
v_mfma_f32_16x16x32_bf16 v[76:79], a[56:59], v[140:143], v[76:79]
buffer_load_dwordx4 v244, s[8:11], s35 offen offset:0  lds
v_mfma_f32_16x16x32_bf16 v[108:111], a[60:63], v[140:143], v[108:111]
s_waitcnt lgkmcnt(10)
v_mfma_f32_16x16x32_bf16 v[16:19], a[48:51], v[144:147], v[16:19]
ds_read_b64_tr_b16 v[136:137], v160 offset:33088
v_mfma_f32_16x16x32_bf16 v[48:51], a[52:55], v[144:147], v[48:51]
ds_read_b64_tr_b16 v[138:139], v160 offset:33600
v_mfma_f32_16x16x32_bf16 v[80:83], a[56:59], v[144:147], v[80:83]
buffer_load_dwordx4 a[4:7], v164, s[4:7], s32 offen offset:2048 sc1
v_mfma_f32_16x16x32_bf16 v[112:115], a[60:63], v[144:147], v[112:115]
s_waitcnt lgkmcnt(10)
v_mfma_f32_16x16x32_bf16 v[20:23], a[48:51], v[148:151], v[20:23]
ds_read_b64_tr_b16 v[140:141], v160 offset:33120
v_mfma_f32_16x16x32_bf16 v[52:55], a[52:55], v[148:151], v[52:55]
ds_read_b64_tr_b16 v[142:143], v160 offset:33632
v_mfma_f32_16x16x32_bf16 v[84:87], a[56:59], v[148:151], v[84:87]
v_mfma_f32_16x16x32_bf16 v[116:119], a[60:63], v[148:151], v[116:119]
s_waitcnt lgkmcnt(10)
v_mfma_f32_16x16x32_bf16 v[24:27], a[48:51], v[152:155], v[24:27]
ds_read_b64_tr_b16 v[144:145], v160 offset:49536
v_mfma_f32_16x16x32_bf16 v[56:59], a[52:55], v[152:155], v[56:59]
ds_read_b64_tr_b16 v[146:147], v160 offset:50048
v_mfma_f32_16x16x32_bf16 v[88:91], a[56:59], v[152:155], v[88:91]
buffer_load_dwordx4 a[8:11], v165, s[4:7], s32 offen offset:0 sc1
v_mfma_f32_16x16x32_bf16 v[120:123], a[60:63], v[152:155], v[120:123]
s_waitcnt lgkmcnt(10)
v_mfma_f32_16x16x32_bf16 v[28:31], a[48:51], v[156:159], v[28:31]
ds_read_b64_tr_b16 v[148:149], v160 offset:49568
v_mfma_f32_16x16x32_bf16 v[60:63], a[52:55], v[156:159], v[60:63]
ds_read_b64_tr_b16 v[150:151], v160 offset:50080
v_mfma_f32_16x16x32_bf16 v[92:95], a[56:59], v[156:159], v[92:95]
buffer_load_dwordx4 v245, s[8:11], s35 offen offset:1024  lds
v_mfma_f32_16x16x32_bf16 v[124:127], a[60:63], v[156:159], v[124:127]
s_waitcnt vmcnt(24) lgkmcnt(10)
v_mfma_f32_16x16x32_bf16 v[0:3], a[64:67], v[128:131], v[0:3]
s_waitcnt vmcnt(23)
ds_read_b64_tr_b16 v[152:153], v160 offset:49600
v_mfma_f32_16x16x32_bf16 v[32:35], a[68:71], v[128:131], v[32:35]
s_waitcnt vmcnt(22)
ds_read_b64_tr_b16 v[154:155], v160 offset:50112
v_mfma_f32_16x16x32_bf16 v[64:67], a[72:75], v[128:131], v[64:67]
s_waitcnt vmcnt(20)
buffer_load_dwordx4 a[12:15], v165, s[4:7], s32 offen offset:2048 sc1
v_mfma_f32_16x16x32_bf16 v[96:99], a[76:79], v[128:131], v[96:99]
s_waitcnt lgkmcnt(10)
s_add_u32 s32, s32, 32768
v_mfma_f32_16x16x32_bf16 v[4:7], a[64:67], v[132:135], v[4:7]
ds_read_b64_tr_b16 v[156:157], v160 offset:49632
v_mfma_f32_16x16x32_bf16 v[36:39], a[68:71], v[132:135], v[36:39]
ds_read_b64_tr_b16 v[158:159], v160 offset:50144
v_mfma_f32_16x16x32_bf16 v[68:71], a[72:75], v[132:135], v[68:71]
v_mfma_f32_16x16x32_bf16 v[100:103], a[76:79], v[132:135], v[100:103]
s_waitcnt lgkmcnt(10)
v_mfma_f32_16x16x32_bf16 v[8:11], a[64:67], v[136:139], v[8:11]
ds_read_b64_tr_b16 v[128:129], v160 offset:34048
v_mfma_f32_16x16x32_bf16 v[40:43], a[68:71], v[136:139], v[40:43]
ds_read_b64_tr_b16 v[130:131], v160 offset:34560
v_mfma_f32_16x16x32_bf16 v[72:75], a[72:75], v[136:139], v[72:75]
buffer_load_dwordx4 a[16:19], v164, s[4:7], s32 offen offset:0 sc1
v_mfma_f32_16x16x32_bf16 v[104:107], a[76:79], v[136:139], v[104:107]
s_waitcnt lgkmcnt(10)
v_mfma_f32_16x16x32_bf16 v[12:15], a[64:67], v[140:143], v[12:15]
ds_read_b64_tr_b16 v[132:133], v160 offset:34080
v_mfma_f32_16x16x32_bf16 v[44:47], a[68:71], v[140:143], v[44:47]
ds_read_b64_tr_b16 v[134:135], v160 offset:34592
v_mfma_f32_16x16x32_bf16 v[76:79], a[72:75], v[140:143], v[76:79]
buffer_load_dwordx4 v246, s[8:11], s35 offen offset:2048  lds
v_mfma_f32_16x16x32_bf16 v[108:111], a[76:79], v[140:143], v[108:111]
s_waitcnt lgkmcnt(10)
v_mfma_f32_16x16x32_bf16 v[16:19], a[64:67], v[144:147], v[16:19]
ds_read_b64_tr_b16 v[136:137], v160 offset:34112
v_mfma_f32_16x16x32_bf16 v[48:51], a[68:71], v[144:147], v[48:51]
ds_read_b64_tr_b16 v[138:139], v160 offset:34624
v_mfma_f32_16x16x32_bf16 v[80:83], a[72:75], v[144:147], v[80:83]
buffer_load_dwordx4 a[20:23], v164, s[4:7], s32 offen offset:2048 sc1
v_mfma_f32_16x16x32_bf16 v[112:115], a[76:79], v[144:147], v[112:115]
s_waitcnt lgkmcnt(10)
v_mfma_f32_16x16x32_bf16 v[20:23], a[64:67], v[148:151], v[20:23]
ds_read_b64_tr_b16 v[140:141], v160 offset:34144
v_mfma_f32_16x16x32_bf16 v[52:55], a[68:71], v[148:151], v[52:55]
ds_read_b64_tr_b16 v[142:143], v160 offset:34656
v_mfma_f32_16x16x32_bf16 v[84:87], a[72:75], v[148:151], v[84:87]
v_mfma_f32_16x16x32_bf16 v[116:119], a[76:79], v[148:151], v[116:119]
s_waitcnt lgkmcnt(10)
v_mfma_f32_16x16x32_bf16 v[24:27], a[64:67], v[152:155], v[24:27]
ds_read_b64_tr_b16 v[144:145], v160 offset:50560
v_mfma_f32_16x16x32_bf16 v[56:59], a[68:71], v[152:155], v[56:59]
ds_read_b64_tr_b16 v[146:147], v160 offset:51072
v_mfma_f32_16x16x32_bf16 v[88:91], a[72:75], v[152:155], v[88:91]
buffer_load_dwordx4 a[24:27], v165, s[4:7], s32 offen offset:0 sc1
v_mfma_f32_16x16x32_bf16 v[120:123], a[76:79], v[152:155], v[120:123]
s_waitcnt lgkmcnt(10)
v_mfma_f32_16x16x32_bf16 v[28:31], a[64:67], v[156:159], v[28:31]
ds_read_b64_tr_b16 v[148:149], v160 offset:50592
v_mfma_f32_16x16x32_bf16 v[60:63], a[68:71], v[156:159], v[60:63]
ds_read_b64_tr_b16 v[150:151], v160 offset:51104
v_mfma_f32_16x16x32_bf16 v[92:95], a[72:75], v[156:159], v[92:95]
buffer_load_dwordx4 v247, s[8:11], s35 offen offset:3072  lds
v_mfma_f32_16x16x32_bf16 v[124:127], a[76:79], v[156:159], v[124:127]
s_waitcnt vmcnt(25) lgkmcnt(10)
s_add_u32 s35, s35, s63
v_mfma_f32_16x16x32_bf16 v[0:3], a[80:83], v[128:131], v[0:3]
s_waitcnt vmcnt(24)
ds_read_b64_tr_b16 v[152:153], v160 offset:50624
v_mfma_f32_16x16x32_bf16 v[32:35], a[84:87], v[128:131], v[32:35]
s_waitcnt vmcnt(22)
ds_read_b64_tr_b16 v[154:155], v160 offset:51136
v_mfma_f32_16x16x32_bf16 v[64:67], a[88:91], v[128:131], v[64:67]
s_waitcnt vmcnt(21)
buffer_load_dwordx4 a[28:31], v165, s[4:7], s32 offen offset:2048 sc1
v_mfma_f32_16x16x32_bf16 v[96:99], a[92:95], v[128:131], v[96:99]
s_waitcnt lgkmcnt(10)
s_add_u32 s32, s32, 32768
v_mfma_f32_16x16x32_bf16 v[4:7], a[80:83], v[132:135], v[4:7]
ds_read_b64_tr_b16 v[156:157], v160 offset:50656
v_mfma_f32_16x16x32_bf16 v[36:39], a[84:87], v[132:135], v[36:39]
ds_read_b64_tr_b16 v[158:159], v160 offset:51168
v_mfma_f32_16x16x32_bf16 v[68:71], a[88:91], v[132:135], v[68:71]
v_mfma_f32_16x16x32_bf16 v[100:103], a[92:95], v[132:135], v[100:103]
s_waitcnt lgkmcnt(10)
v_mfma_f32_16x16x32_bf16 v[8:11], a[80:83], v[136:139], v[8:11]
ds_read_b64_tr_b16 v[128:129], v160 offset:35072
v_mfma_f32_16x16x32_bf16 v[40:43], a[84:87], v[136:139], v[40:43]
ds_read_b64_tr_b16 v[130:131], v160 offset:35584
v_mfma_f32_16x16x32_bf16 v[72:75], a[88:91], v[136:139], v[72:75]
buffer_load_dwordx4 a[32:35], v164, s[4:7], s32 offen offset:0 sc1
v_mfma_f32_16x16x32_bf16 v[104:107], a[92:95], v[136:139], v[104:107]
s_waitcnt lgkmcnt(10)
v_mfma_f32_16x16x32_bf16 v[12:15], a[80:83], v[140:143], v[12:15]
ds_read_b64_tr_b16 v[132:133], v160 offset:35104
v_mfma_f32_16x16x32_bf16 v[44:47], a[84:87], v[140:143], v[44:47]
s_add_u32 m0, s53, s28
s_add_u32 m0, m0, 33024
ds_read_b64_tr_b16 v[134:135], v160 offset:35616
v_mfma_f32_16x16x32_bf16 v[76:79], a[88:91], v[140:143], v[76:79]
buffer_load_dwordx4 v244, s[8:11], s34 offen offset:0  lds
v_mfma_f32_16x16x32_bf16 v[108:111], a[92:95], v[140:143], v[108:111]
s_waitcnt lgkmcnt(10)
v_mfma_f32_16x16x32_bf16 v[16:19], a[80:83], v[144:147], v[16:19]
ds_read_b64_tr_b16 v[136:137], v160 offset:35136
v_mfma_f32_16x16x32_bf16 v[48:51], a[84:87], v[144:147], v[48:51]
ds_read_b64_tr_b16 v[138:139], v160 offset:35648
v_mfma_f32_16x16x32_bf16 v[80:83], a[88:91], v[144:147], v[80:83]
buffer_load_dwordx4 a[36:39], v164, s[4:7], s32 offen offset:2048 sc1
v_mfma_f32_16x16x32_bf16 v[112:115], a[92:95], v[144:147], v[112:115]
s_waitcnt lgkmcnt(10)
v_mfma_f32_16x16x32_bf16 v[20:23], a[80:83], v[148:151], v[20:23]
ds_read_b64_tr_b16 v[140:141], v160 offset:35168
v_mfma_f32_16x16x32_bf16 v[52:55], a[84:87], v[148:151], v[52:55]
ds_read_b64_tr_b16 v[142:143], v160 offset:35680
v_mfma_f32_16x16x32_bf16 v[84:87], a[88:91], v[148:151], v[84:87]
v_mfma_f32_16x16x32_bf16 v[116:119], a[92:95], v[148:151], v[116:119]
s_waitcnt lgkmcnt(10)
v_mfma_f32_16x16x32_bf16 v[24:27], a[80:83], v[152:155], v[24:27]
ds_read_b64_tr_b16 v[144:145], v160 offset:51584
v_mfma_f32_16x16x32_bf16 v[56:59], a[84:87], v[152:155], v[56:59]
ds_read_b64_tr_b16 v[146:147], v160 offset:52096
v_mfma_f32_16x16x32_bf16 v[88:91], a[88:91], v[152:155], v[88:91]
buffer_load_dwordx4 a[40:43], v165, s[4:7], s32 offen offset:0 sc1
v_mfma_f32_16x16x32_bf16 v[120:123], a[92:95], v[152:155], v[120:123]
s_waitcnt lgkmcnt(10)
v_mfma_f32_16x16x32_bf16 v[28:31], a[80:83], v[156:159], v[28:31]
ds_read_b64_tr_b16 v[148:149], v160 offset:51616
v_mfma_f32_16x16x32_bf16 v[60:63], a[84:87], v[156:159], v[60:63]
ds_read_b64_tr_b16 v[150:151], v160 offset:52128
v_mfma_f32_16x16x32_bf16 v[92:95], a[88:91], v[156:159], v[92:95]
buffer_load_dwordx4 v245, s[8:11], s34 offen offset:1024  lds
v_mfma_f32_16x16x32_bf16 v[124:127], a[92:95], v[156:159], v[124:127]
s_waitcnt vmcnt(26) lgkmcnt(10)
v_mfma_f32_16x16x32_bf16 v[0:3], a[96:99], v[128:131], v[0:3]
s_waitcnt vmcnt(24)
ds_read_b64_tr_b16 v[152:153], v160 offset:51648
v_mfma_f32_16x16x32_bf16 v[32:35], a[100:103], v[128:131], v[32:35]
s_waitcnt vmcnt(23)
ds_read_b64_tr_b16 v[154:155], v160 offset:52160
v_mfma_f32_16x16x32_bf16 v[64:67], a[104:107], v[128:131], v[64:67]
s_waitcnt vmcnt(22)
buffer_load_dwordx4 a[44:47], v165, s[4:7], s32 offen offset:2048 sc1
v_mfma_f32_16x16x32_bf16 v[96:99], a[108:111], v[128:131], v[96:99]
s_waitcnt lgkmcnt(10)
s_add_u32 s32, s32, 32768
v_mfma_f32_16x16x32_bf16 v[4:7], a[96:99], v[132:135], v[4:7]
ds_read_b64_tr_b16 v[156:157], v160 offset:51680
v_mfma_f32_16x16x32_bf16 v[36:39], a[100:103], v[132:135], v[36:39]
ds_read_b64_tr_b16 v[158:159], v160 offset:52192
v_mfma_f32_16x16x32_bf16 v[68:71], a[104:107], v[132:135], v[68:71]
v_mfma_f32_16x16x32_bf16 v[100:103], a[108:111], v[132:135], v[100:103]
s_waitcnt lgkmcnt(10)
v_mfma_f32_16x16x32_bf16 v[8:11], a[96:99], v[136:139], v[8:11]
ds_read_b64_tr_b16 v[128:129], v160 offset:36096
v_mfma_f32_16x16x32_bf16 v[40:43], a[100:103], v[136:139], v[40:43]
ds_read_b64_tr_b16 v[130:131], v160 offset:36608
v_mfma_f32_16x16x32_bf16 v[72:75], a[104:107], v[136:139], v[72:75]
buffer_load_dwordx4 a[48:51], v164, s[4:7], s32 offen offset:0 sc1
v_mfma_f32_16x16x32_bf16 v[104:107], a[108:111], v[136:139], v[104:107]
s_waitcnt lgkmcnt(10)
v_mfma_f32_16x16x32_bf16 v[12:15], a[96:99], v[140:143], v[12:15]
ds_read_b64_tr_b16 v[132:133], v160 offset:36128
v_mfma_f32_16x16x32_bf16 v[44:47], a[100:103], v[140:143], v[44:47]
ds_read_b64_tr_b16 v[134:135], v160 offset:36640
v_mfma_f32_16x16x32_bf16 v[76:79], a[104:107], v[140:143], v[76:79]
buffer_load_dwordx4 v246, s[8:11], s34 offen offset:2048  lds
v_mfma_f32_16x16x32_bf16 v[108:111], a[108:111], v[140:143], v[108:111]
s_waitcnt lgkmcnt(10)
v_mfma_f32_16x16x32_bf16 v[16:19], a[96:99], v[144:147], v[16:19]
ds_read_b64_tr_b16 v[136:137], v160 offset:36160
v_mfma_f32_16x16x32_bf16 v[48:51], a[100:103], v[144:147], v[48:51]
ds_read_b64_tr_b16 v[138:139], v160 offset:36672
v_mfma_f32_16x16x32_bf16 v[80:83], a[104:107], v[144:147], v[80:83]
buffer_load_dwordx4 a[52:55], v164, s[4:7], s32 offen offset:2048 sc1
v_mfma_f32_16x16x32_bf16 v[112:115], a[108:111], v[144:147], v[112:115]
s_waitcnt lgkmcnt(10)
v_mfma_f32_16x16x32_bf16 v[20:23], a[96:99], v[148:151], v[20:23]
ds_read_b64_tr_b16 v[140:141], v160 offset:36192
v_mfma_f32_16x16x32_bf16 v[52:55], a[100:103], v[148:151], v[52:55]
ds_read_b64_tr_b16 v[142:143], v160 offset:36704
v_mfma_f32_16x16x32_bf16 v[84:87], a[104:107], v[148:151], v[84:87]
v_mfma_f32_16x16x32_bf16 v[116:119], a[108:111], v[148:151], v[116:119]
s_waitcnt lgkmcnt(10)
v_mfma_f32_16x16x32_bf16 v[24:27], a[96:99], v[152:155], v[24:27]
ds_read_b64_tr_b16 v[144:145], v160 offset:52608
v_mfma_f32_16x16x32_bf16 v[56:59], a[100:103], v[152:155], v[56:59]
ds_read_b64_tr_b16 v[146:147], v160 offset:53120
v_mfma_f32_16x16x32_bf16 v[88:91], a[104:107], v[152:155], v[88:91]
buffer_load_dwordx4 a[56:59], v165, s[4:7], s32 offen offset:0 sc1
v_mfma_f32_16x16x32_bf16 v[120:123], a[108:111], v[152:155], v[120:123]
s_waitcnt lgkmcnt(10)
v_mfma_f32_16x16x32_bf16 v[28:31], a[96:99], v[156:159], v[28:31]
ds_read_b64_tr_b16 v[148:149], v160 offset:52640
v_mfma_f32_16x16x32_bf16 v[60:63], a[100:103], v[156:159], v[60:63]
ds_read_b64_tr_b16 v[150:151], v160 offset:53152
v_mfma_f32_16x16x32_bf16 v[92:95], a[104:107], v[156:159], v[92:95]
buffer_load_dwordx4 v247, s[8:11], s34 offen offset:3072  lds
v_mfma_f32_16x16x32_bf16 v[124:127], a[108:111], v[156:159], v[124:127]
s_waitcnt vmcnt(26) lgkmcnt(10)
s_add_u32 s34, s34, s63
v_mfma_f32_16x16x32_bf16 v[0:3], a[112:115], v[128:131], v[0:3]
s_waitcnt vmcnt(25)
ds_read_b64_tr_b16 v[152:153], v160 offset:52672
v_mfma_f32_16x16x32_bf16 v[32:35], a[116:119], v[128:131], v[32:35]
s_waitcnt vmcnt(24)
ds_read_b64_tr_b16 v[154:155], v160 offset:53184
v_mfma_f32_16x16x32_bf16 v[64:67], a[120:123], v[128:131], v[64:67]
s_waitcnt vmcnt(23)
buffer_load_dwordx4 a[60:63], v165, s[4:7], s32 offen offset:2048 sc1
v_mfma_f32_16x16x32_bf16 v[96:99], a[124:127], v[128:131], v[96:99]
s_waitcnt lgkmcnt(10)
s_add_u32 s32, s32, s30
v_mfma_f32_16x16x32_bf16 v[4:7], a[112:115], v[132:135], v[4:7]
ds_read_b64_tr_b16 v[156:157], v160 offset:52704
v_mfma_f32_16x16x32_bf16 v[36:39], a[116:119], v[132:135], v[36:39]
ds_read_b64_tr_b16 v[158:159], v160 offset:53216
v_mfma_f32_16x16x32_bf16 v[68:71], a[120:123], v[132:135], v[68:71]
v_mfma_f32_16x16x32_bf16 v[100:103], a[124:127], v[132:135], v[100:103]
s_waitcnt lgkmcnt(10)
s_barrier
v_mfma_f32_16x16x32_bf16 v[8:11], a[112:115], v[136:139], v[8:11]
ds_read_b64_tr_b16 v[128:129], v161 offset:0
v_mfma_f32_16x16x32_bf16 v[40:43], a[116:119], v[136:139], v[40:43]
s_add_u32 m0, s52, s29
ds_read_b64_tr_b16 v[130:131], v161 offset:512
v_mfma_f32_16x16x32_bf16 v[72:75], a[120:123], v[136:139], v[72:75]
buffer_load_dwordx4 v244, s[8:11], s35 offen offset:0  lds
v_mfma_f32_16x16x32_bf16 v[104:107], a[124:127], v[136:139], v[104:107]
s_waitcnt lgkmcnt(10)
v_mfma_f32_16x16x32_bf16 v[12:15], a[112:115], v[140:143], v[12:15]
ds_read_b64_tr_b16 v[132:133], v161 offset:32
v_mfma_f32_16x16x32_bf16 v[44:47], a[116:119], v[140:143], v[44:47]
ds_read_b64_tr_b16 v[134:135], v161 offset:544
v_mfma_f32_16x16x32_bf16 v[76:79], a[120:123], v[140:143], v[76:79]
buffer_load_dwordx4 v245, s[8:11], s35 offen offset:1024  lds
v_mfma_f32_16x16x32_bf16 v[108:111], a[124:127], v[140:143], v[108:111]
s_waitcnt lgkmcnt(10)
v_mfma_f32_16x16x32_bf16 v[16:19], a[112:115], v[144:147], v[16:19]
ds_read_b64_tr_b16 v[136:137], v161 offset:64
v_mfma_f32_16x16x32_bf16 v[48:51], a[116:119], v[144:147], v[48:51]
ds_read_b64_tr_b16 v[138:139], v161 offset:576
v_mfma_f32_16x16x32_bf16 v[80:83], a[120:123], v[144:147], v[80:83]
buffer_load_dwordx4 v246, s[8:11], s35 offen offset:2048  lds
v_mfma_f32_16x16x32_bf16 v[112:115], a[124:127], v[144:147], v[112:115]
s_waitcnt lgkmcnt(10)
v_mfma_f32_16x16x32_bf16 v[20:23], a[112:115], v[148:151], v[20:23]
ds_read_b64_tr_b16 v[140:141], v161 offset:96
v_mfma_f32_16x16x32_bf16 v[52:55], a[116:119], v[148:151], v[52:55]
ds_read_b64_tr_b16 v[142:143], v161 offset:608
v_mfma_f32_16x16x32_bf16 v[84:87], a[120:123], v[148:151], v[84:87]
buffer_load_dwordx4 v247, s[8:11], s35 offen offset:3072  lds
v_mfma_f32_16x16x32_bf16 v[116:119], a[124:127], v[148:151], v[116:119]
s_waitcnt lgkmcnt(10)
s_add_u32 s35, s35, s20
v_mfma_f32_16x16x32_bf16 v[24:27], a[112:115], v[152:155], v[24:27]
ds_read_b64_tr_b16 v[144:145], v161 offset:16512
v_mfma_f32_16x16x32_bf16 v[56:59], a[116:119], v[152:155], v[56:59]
ds_read_b64_tr_b16 v[146:147], v161 offset:17024
v_mfma_f32_16x16x32_bf16 v[88:91], a[120:123], v[152:155], v[88:91]
v_mfma_f32_16x16x32_bf16 v[120:123], a[124:127], v[152:155], v[120:123]
s_waitcnt lgkmcnt(10)
v_mfma_f32_16x16x32_bf16 v[28:31], a[112:115], v[156:159], v[28:31]
ds_read_b64_tr_b16 v[148:149], v161 offset:16544
v_mfma_f32_16x16x32_bf16 v[60:63], a[116:119], v[156:159], v[60:63]
ds_read_b64_tr_b16 v[150:151], v161 offset:17056
v_mfma_f32_16x16x32_bf16 v[92:95], a[120:123], v[156:159], v[92:95]
s_sub_u32 s60, s60, 1
s_sub_u32 s52, s54, s52
s_sub_u32 s53, s54, s53
v_mfma_f32_16x16x32_bf16 v[124:127], a[124:127], v[156:159], v[124:127]
v_swap_b32 v160, v161
s_cmp_lg_u32 s60, 0
s_cbranch_scc1 standalone__weight_only_int_quip__prompt_kernel_loop1
s_waitcnt vmcnt(27) lgkmcnt(10)
v_mfma_f32_16x16x32_bf16 v[0:3], a[0:3], v[128:131], v[0:3]
s_waitcnt vmcnt(25)
ds_read_b64_tr_b16 v[152:153], v160 offset:16576
v_mfma_f32_16x16x32_bf16 v[32:35], a[4:7], v[128:131], v[32:35]
s_waitcnt vmcnt(24)
ds_read_b64_tr_b16 v[154:155], v160 offset:17088
v_mfma_f32_16x16x32_bf16 v[64:67], a[8:11], v[128:131], v[64:67]
s_waitcnt vmcnt(22)
v_mfma_f32_16x16x32_bf16 v[96:99], a[12:15], v[128:131], v[96:99]
s_waitcnt lgkmcnt(10)
v_mfma_f32_16x16x32_bf16 v[4:7], a[0:3], v[132:135], v[4:7]
ds_read_b64_tr_b16 v[156:157], v160 offset:16608
v_mfma_f32_16x16x32_bf16 v[36:39], a[4:7], v[132:135], v[36:39]
ds_read_b64_tr_b16 v[158:159], v160 offset:17120
v_mfma_f32_16x16x32_bf16 v[68:71], a[8:11], v[132:135], v[68:71]
v_mfma_f32_16x16x32_bf16 v[100:103], a[12:15], v[132:135], v[100:103]
s_waitcnt lgkmcnt(10)
v_mfma_f32_16x16x32_bf16 v[8:11], a[0:3], v[136:139], v[8:11]
ds_read_b64_tr_b16 v[128:129], v160 offset:1024
v_mfma_f32_16x16x32_bf16 v[40:43], a[4:7], v[136:139], v[40:43]
ds_read_b64_tr_b16 v[130:131], v160 offset:1536
v_mfma_f32_16x16x32_bf16 v[72:75], a[8:11], v[136:139], v[72:75]
v_mfma_f32_16x16x32_bf16 v[104:107], a[12:15], v[136:139], v[104:107]
s_waitcnt lgkmcnt(10)
v_mfma_f32_16x16x32_bf16 v[12:15], a[0:3], v[140:143], v[12:15]
ds_read_b64_tr_b16 v[132:133], v160 offset:1056
v_mfma_f32_16x16x32_bf16 v[44:47], a[4:7], v[140:143], v[44:47]
ds_read_b64_tr_b16 v[134:135], v160 offset:1568
v_mfma_f32_16x16x32_bf16 v[76:79], a[8:11], v[140:143], v[76:79]
v_mfma_f32_16x16x32_bf16 v[108:111], a[12:15], v[140:143], v[108:111]
s_waitcnt lgkmcnt(10)
v_mfma_f32_16x16x32_bf16 v[16:19], a[0:3], v[144:147], v[16:19]
ds_read_b64_tr_b16 v[136:137], v160 offset:1088
v_mfma_f32_16x16x32_bf16 v[48:51], a[4:7], v[144:147], v[48:51]
ds_read_b64_tr_b16 v[138:139], v160 offset:1600
v_mfma_f32_16x16x32_bf16 v[80:83], a[8:11], v[144:147], v[80:83]
v_mfma_f32_16x16x32_bf16 v[112:115], a[12:15], v[144:147], v[112:115]
s_waitcnt lgkmcnt(10)
v_mfma_f32_16x16x32_bf16 v[20:23], a[0:3], v[148:151], v[20:23]
ds_read_b64_tr_b16 v[140:141], v160 offset:1120
v_mfma_f32_16x16x32_bf16 v[52:55], a[4:7], v[148:151], v[52:55]
ds_read_b64_tr_b16 v[142:143], v160 offset:1632
v_mfma_f32_16x16x32_bf16 v[84:87], a[8:11], v[148:151], v[84:87]
v_mfma_f32_16x16x32_bf16 v[116:119], a[12:15], v[148:151], v[116:119]
s_waitcnt lgkmcnt(10)
v_mfma_f32_16x16x32_bf16 v[24:27], a[0:3], v[152:155], v[24:27]
ds_read_b64_tr_b16 v[144:145], v160 offset:17536
v_mfma_f32_16x16x32_bf16 v[56:59], a[4:7], v[152:155], v[56:59]
ds_read_b64_tr_b16 v[146:147], v160 offset:18048
v_mfma_f32_16x16x32_bf16 v[88:91], a[8:11], v[152:155], v[88:91]
buffer_load_dwordx4 a[64:67], v165, s[4:7], s32 offen offset:0 sc1
v_mfma_f32_16x16x32_bf16 v[120:123], a[12:15], v[152:155], v[120:123]
s_waitcnt lgkmcnt(10)
v_mfma_f32_16x16x32_bf16 v[28:31], a[0:3], v[156:159], v[28:31]
ds_read_b64_tr_b16 v[148:149], v160 offset:17568
v_mfma_f32_16x16x32_bf16 v[60:63], a[4:7], v[156:159], v[60:63]
ds_read_b64_tr_b16 v[150:151], v160 offset:18080
v_mfma_f32_16x16x32_bf16 v[92:95], a[8:11], v[156:159], v[92:95]
buffer_load_dwordx4 a[68:71], v165, s[4:7], s32 offen offset:2048 sc1
v_mfma_f32_16x16x32_bf16 v[124:127], a[12:15], v[156:159], v[124:127]
s_waitcnt vmcnt(23) lgkmcnt(10)
s_add_u32 s32, s32, 32768
v_mfma_f32_16x16x32_bf16 v[0:3], a[16:19], v[128:131], v[0:3]
s_waitcnt vmcnt(21)
ds_read_b64_tr_b16 v[152:153], v160 offset:17600
v_mfma_f32_16x16x32_bf16 v[32:35], a[20:23], v[128:131], v[32:35]
s_waitcnt vmcnt(20)
ds_read_b64_tr_b16 v[154:155], v160 offset:18112
v_mfma_f32_16x16x32_bf16 v[64:67], a[24:27], v[128:131], v[64:67]
s_waitcnt vmcnt(18)
buffer_load_dwordx4 a[72:75], v165, s[4:7], s32 offen offset:0 sc1
v_mfma_f32_16x16x32_bf16 v[96:99], a[28:31], v[128:131], v[96:99]
s_waitcnt lgkmcnt(10)
v_mfma_f32_16x16x32_bf16 v[4:7], a[16:19], v[132:135], v[4:7]
ds_read_b64_tr_b16 v[156:157], v160 offset:17632
v_mfma_f32_16x16x32_bf16 v[36:39], a[20:23], v[132:135], v[36:39]
s_add_u32 m0, s53, s28
ds_read_b64_tr_b16 v[158:159], v160 offset:18144
v_mfma_f32_16x16x32_bf16 v[68:71], a[24:27], v[132:135], v[68:71]
buffer_load_dwordx4 v244, s[8:11], s34 offen offset:0  lds
v_mfma_f32_16x16x32_bf16 v[100:103], a[28:31], v[132:135], v[100:103]
s_waitcnt lgkmcnt(10)
v_mfma_f32_16x16x32_bf16 v[8:11], a[16:19], v[136:139], v[8:11]
ds_read_b64_tr_b16 v[128:129], v160 offset:2048
v_mfma_f32_16x16x32_bf16 v[40:43], a[20:23], v[136:139], v[40:43]
ds_read_b64_tr_b16 v[130:131], v160 offset:2560
v_mfma_f32_16x16x32_bf16 v[72:75], a[24:27], v[136:139], v[72:75]
buffer_load_dwordx4 a[76:79], v165, s[4:7], s32 offen offset:2048 sc1
v_mfma_f32_16x16x32_bf16 v[104:107], a[28:31], v[136:139], v[104:107]
s_waitcnt lgkmcnt(10)
s_add_u32 s32, s32, 32768
v_mfma_f32_16x16x32_bf16 v[12:15], a[16:19], v[140:143], v[12:15]
ds_read_b64_tr_b16 v[132:133], v160 offset:2080
v_mfma_f32_16x16x32_bf16 v[44:47], a[20:23], v[140:143], v[44:47]
ds_read_b64_tr_b16 v[134:135], v160 offset:2592
v_mfma_f32_16x16x32_bf16 v[76:79], a[24:27], v[140:143], v[76:79]
buffer_load_dwordx4 a[80:83], v165, s[4:7], s32 offen offset:0 sc1
v_mfma_f32_16x16x32_bf16 v[108:111], a[28:31], v[140:143], v[108:111]
s_waitcnt lgkmcnt(10)
v_mfma_f32_16x16x32_bf16 v[16:19], a[16:19], v[144:147], v[16:19]
ds_read_b64_tr_b16 v[136:137], v160 offset:2112
v_mfma_f32_16x16x32_bf16 v[48:51], a[20:23], v[144:147], v[48:51]
ds_read_b64_tr_b16 v[138:139], v160 offset:2624
v_mfma_f32_16x16x32_bf16 v[80:83], a[24:27], v[144:147], v[80:83]
buffer_load_dwordx4 a[84:87], v165, s[4:7], s32 offen offset:2048 sc1
v_mfma_f32_16x16x32_bf16 v[112:115], a[28:31], v[144:147], v[112:115]
s_waitcnt lgkmcnt(10)
s_add_u32 s32, s32, 32768
v_mfma_f32_16x16x32_bf16 v[20:23], a[16:19], v[148:151], v[20:23]
ds_read_b64_tr_b16 v[140:141], v160 offset:2144
v_mfma_f32_16x16x32_bf16 v[52:55], a[20:23], v[148:151], v[52:55]
ds_read_b64_tr_b16 v[142:143], v160 offset:2656
v_mfma_f32_16x16x32_bf16 v[84:87], a[24:27], v[148:151], v[84:87]
buffer_load_dwordx4 v245, s[8:11], s34 offen offset:1024  lds
v_mfma_f32_16x16x32_bf16 v[116:119], a[28:31], v[148:151], v[116:119]
s_waitcnt lgkmcnt(10)
v_mfma_f32_16x16x32_bf16 v[24:27], a[16:19], v[152:155], v[24:27]
ds_read_b64_tr_b16 v[144:145], v160 offset:18560
v_mfma_f32_16x16x32_bf16 v[56:59], a[20:23], v[152:155], v[56:59]
ds_read_b64_tr_b16 v[146:147], v160 offset:19072
v_mfma_f32_16x16x32_bf16 v[88:91], a[24:27], v[152:155], v[88:91]
buffer_load_dwordx4 a[88:91], v165, s[4:7], s32 offen offset:0 sc1
v_mfma_f32_16x16x32_bf16 v[120:123], a[28:31], v[152:155], v[120:123]
s_waitcnt lgkmcnt(10)
v_mfma_f32_16x16x32_bf16 v[28:31], a[16:19], v[156:159], v[28:31]
ds_read_b64_tr_b16 v[148:149], v160 offset:18592
v_mfma_f32_16x16x32_bf16 v[60:63], a[20:23], v[156:159], v[60:63]
ds_read_b64_tr_b16 v[150:151], v160 offset:19104
v_mfma_f32_16x16x32_bf16 v[92:95], a[24:27], v[156:159], v[92:95]
buffer_load_dwordx4 a[92:95], v165, s[4:7], s32 offen offset:2048 sc1
v_mfma_f32_16x16x32_bf16 v[124:127], a[28:31], v[156:159], v[124:127]
s_waitcnt vmcnt(25) lgkmcnt(10)
s_add_u32 s32, s32, s31
v_mfma_f32_16x16x32_bf16 v[0:3], a[32:35], v[128:131], v[0:3]
s_waitcnt vmcnt(23)
ds_read_b64_tr_b16 v[152:153], v160 offset:18624
v_mfma_f32_16x16x32_bf16 v[32:35], a[36:39], v[128:131], v[32:35]
s_waitcnt vmcnt(22)
ds_read_b64_tr_b16 v[154:155], v160 offset:19136
v_mfma_f32_16x16x32_bf16 v[64:67], a[40:43], v[128:131], v[64:67]
s_waitcnt vmcnt(20)
buffer_load_dwordx4 a[96:99], v165, s[4:7], s32 offen offset:0 sc1
v_mfma_f32_16x16x32_bf16 v[96:99], a[44:47], v[128:131], v[96:99]
s_waitcnt lgkmcnt(10)
v_mfma_f32_16x16x32_bf16 v[4:7], a[32:35], v[132:135], v[4:7]
ds_read_b64_tr_b16 v[156:157], v160 offset:18656
v_mfma_f32_16x16x32_bf16 v[36:39], a[36:39], v[132:135], v[36:39]
ds_read_b64_tr_b16 v[158:159], v160 offset:19168
v_mfma_f32_16x16x32_bf16 v[68:71], a[40:43], v[132:135], v[68:71]
buffer_load_dwordx4 v246, s[8:11], s34 offen offset:2048  lds
v_mfma_f32_16x16x32_bf16 v[100:103], a[44:47], v[132:135], v[100:103]
s_waitcnt lgkmcnt(10)
v_mfma_f32_16x16x32_bf16 v[8:11], a[32:35], v[136:139], v[8:11]
ds_read_b64_tr_b16 v[128:129], v160 offset:3072
v_mfma_f32_16x16x32_bf16 v[40:43], a[36:39], v[136:139], v[40:43]
ds_read_b64_tr_b16 v[130:131], v160 offset:3584
v_mfma_f32_16x16x32_bf16 v[72:75], a[40:43], v[136:139], v[72:75]
buffer_load_dwordx4 a[100:103], v165, s[4:7], s32 offen offset:2048 sc1
v_mfma_f32_16x16x32_bf16 v[104:107], a[44:47], v[136:139], v[104:107]
s_waitcnt lgkmcnt(10)
s_add_u32 s32, s32, 32768
v_mfma_f32_16x16x32_bf16 v[12:15], a[32:35], v[140:143], v[12:15]
ds_read_b64_tr_b16 v[132:133], v160 offset:3104
v_mfma_f32_16x16x32_bf16 v[44:47], a[36:39], v[140:143], v[44:47]
ds_read_b64_tr_b16 v[134:135], v160 offset:3616
v_mfma_f32_16x16x32_bf16 v[76:79], a[40:43], v[140:143], v[76:79]
buffer_load_dwordx4 a[104:107], v165, s[4:7], s32 offen offset:0 sc1
v_mfma_f32_16x16x32_bf16 v[108:111], a[44:47], v[140:143], v[108:111]
s_waitcnt lgkmcnt(10)
v_mfma_f32_16x16x32_bf16 v[16:19], a[32:35], v[144:147], v[16:19]
ds_read_b64_tr_b16 v[136:137], v160 offset:3136
v_mfma_f32_16x16x32_bf16 v[48:51], a[36:39], v[144:147], v[48:51]
ds_read_b64_tr_b16 v[138:139], v160 offset:3648
v_mfma_f32_16x16x32_bf16 v[80:83], a[40:43], v[144:147], v[80:83]
buffer_load_dwordx4 a[108:111], v165, s[4:7], s32 offen offset:2048 sc1
v_mfma_f32_16x16x32_bf16 v[112:115], a[44:47], v[144:147], v[112:115]
s_waitcnt lgkmcnt(10)
s_add_u32 s32, s32, 32768
v_mfma_f32_16x16x32_bf16 v[20:23], a[32:35], v[148:151], v[20:23]
ds_read_b64_tr_b16 v[140:141], v160 offset:3168
v_mfma_f32_16x16x32_bf16 v[52:55], a[36:39], v[148:151], v[52:55]
ds_read_b64_tr_b16 v[142:143], v160 offset:3680
v_mfma_f32_16x16x32_bf16 v[84:87], a[40:43], v[148:151], v[84:87]
buffer_load_dwordx4 v247, s[8:11], s34 offen offset:3072  lds
v_mfma_f32_16x16x32_bf16 v[116:119], a[44:47], v[148:151], v[116:119]
s_waitcnt lgkmcnt(10)
s_add_u32 s34, s34, s20
v_mfma_f32_16x16x32_bf16 v[24:27], a[32:35], v[152:155], v[24:27]
ds_read_b64_tr_b16 v[144:145], v160 offset:19584
v_mfma_f32_16x16x32_bf16 v[56:59], a[36:39], v[152:155], v[56:59]
ds_read_b64_tr_b16 v[146:147], v160 offset:20096
v_mfma_f32_16x16x32_bf16 v[88:91], a[40:43], v[152:155], v[88:91]
buffer_load_dwordx4 a[112:115], v165, s[4:7], s32 offen offset:0 sc1
v_mfma_f32_16x16x32_bf16 v[120:123], a[44:47], v[152:155], v[120:123]
s_waitcnt lgkmcnt(10)
v_mfma_f32_16x16x32_bf16 v[28:31], a[32:35], v[156:159], v[28:31]
ds_read_b64_tr_b16 v[148:149], v160 offset:19616
v_mfma_f32_16x16x32_bf16 v[60:63], a[36:39], v[156:159], v[60:63]
ds_read_b64_tr_b16 v[150:151], v160 offset:20128
v_mfma_f32_16x16x32_bf16 v[92:95], a[40:43], v[156:159], v[92:95]
buffer_load_dwordx4 a[116:119], v165, s[4:7], s32 offen offset:2048 sc1
v_mfma_f32_16x16x32_bf16 v[124:127], a[44:47], v[156:159], v[124:127]
s_waitcnt vmcnt(27) lgkmcnt(10)
s_add_u32 s32, s32, 32768
v_mfma_f32_16x16x32_bf16 v[0:3], a[48:51], v[128:131], v[0:3]
s_waitcnt vmcnt(25)
ds_read_b64_tr_b16 v[152:153], v160 offset:19648
v_mfma_f32_16x16x32_bf16 v[32:35], a[52:55], v[128:131], v[32:35]
s_waitcnt vmcnt(24)
ds_read_b64_tr_b16 v[154:155], v160 offset:20160
v_mfma_f32_16x16x32_bf16 v[64:67], a[56:59], v[128:131], v[64:67]
s_waitcnt vmcnt(22)
buffer_load_dwordx4 a[120:123], v165, s[4:7], s32 offen offset:0 sc1
v_mfma_f32_16x16x32_bf16 v[96:99], a[60:63], v[128:131], v[96:99]
s_waitcnt lgkmcnt(10)
v_mfma_f32_16x16x32_bf16 v[4:7], a[48:51], v[132:135], v[4:7]
ds_read_b64_tr_b16 v[156:157], v160 offset:19680
v_mfma_f32_16x16x32_bf16 v[36:39], a[52:55], v[132:135], v[36:39]
ds_read_b64_tr_b16 v[158:159], v160 offset:20192
v_mfma_f32_16x16x32_bf16 v[68:71], a[56:59], v[132:135], v[68:71]
buffer_load_dwordx4 a[124:127], v165, s[4:7], s32 offen offset:2048 sc1
v_mfma_f32_16x16x32_bf16 v[100:103], a[60:63], v[132:135], v[100:103]
s_waitcnt lgkmcnt(10)
s_add_u32 s32, s32, s30
s_barrier
v_mfma_f32_16x16x32_bf16 v[8:11], a[48:51], v[136:139], v[8:11]
ds_read_b64_tr_b16 v[128:129], v160 offset:33024
v_mfma_f32_16x16x32_bf16 v[40:43], a[52:55], v[136:139], v[40:43]
s_add_u32 m0, s53, s29
s_add_u32 m0, m0, 33024
ds_read_b64_tr_b16 v[130:131], v160 offset:33536
v_mfma_f32_16x16x32_bf16 v[72:75], a[56:59], v[136:139], v[72:75]
buffer_load_dwordx4 v244, s[8:11], s35 offen offset:0  lds
v_mfma_f32_16x16x32_bf16 v[104:107], a[60:63], v[136:139], v[104:107]
s_waitcnt lgkmcnt(10)
v_mfma_f32_16x16x32_bf16 v[12:15], a[48:51], v[140:143], v[12:15]
ds_read_b64_tr_b16 v[132:133], v160 offset:33056
v_mfma_f32_16x16x32_bf16 v[44:47], a[52:55], v[140:143], v[44:47]
ds_read_b64_tr_b16 v[134:135], v160 offset:33568
v_mfma_f32_16x16x32_bf16 v[76:79], a[56:59], v[140:143], v[76:79]
buffer_load_dwordx4 v245, s[8:11], s35 offen offset:1024  lds
v_mfma_f32_16x16x32_bf16 v[108:111], a[60:63], v[140:143], v[108:111]
s_waitcnt lgkmcnt(10)
v_mfma_f32_16x16x32_bf16 v[16:19], a[48:51], v[144:147], v[16:19]
ds_read_b64_tr_b16 v[136:137], v160 offset:33088
v_mfma_f32_16x16x32_bf16 v[48:51], a[52:55], v[144:147], v[48:51]
ds_read_b64_tr_b16 v[138:139], v160 offset:33600
v_mfma_f32_16x16x32_bf16 v[80:83], a[56:59], v[144:147], v[80:83]
buffer_load_dwordx4 v246, s[8:11], s35 offen offset:2048  lds
v_mfma_f32_16x16x32_bf16 v[112:115], a[60:63], v[144:147], v[112:115]
s_waitcnt lgkmcnt(10)
v_mfma_f32_16x16x32_bf16 v[20:23], a[48:51], v[148:151], v[20:23]
ds_read_b64_tr_b16 v[140:141], v160 offset:33120
v_mfma_f32_16x16x32_bf16 v[52:55], a[52:55], v[148:151], v[52:55]
ds_read_b64_tr_b16 v[142:143], v160 offset:33632
v_mfma_f32_16x16x32_bf16 v[84:87], a[56:59], v[148:151], v[84:87]
buffer_load_dwordx4 v247, s[8:11], s35 offen offset:3072  lds
v_mfma_f32_16x16x32_bf16 v[116:119], a[60:63], v[148:151], v[116:119]
s_waitcnt lgkmcnt(10)
s_add_u32 s35, s35, s63
v_mfma_f32_16x16x32_bf16 v[24:27], a[48:51], v[152:155], v[24:27]
ds_read_b64_tr_b16 v[144:145], v160 offset:34048
v_mfma_f32_16x16x32_bf16 v[56:59], a[52:55], v[152:155], v[56:59]
s_add_u32 m0, s53, s28
s_add_u32 m0, m0, 33024
ds_read_b64_tr_b16 v[146:147], v160 offset:34560
v_mfma_f32_16x16x32_bf16 v[88:91], a[56:59], v[152:155], v[88:91]
buffer_load_dwordx4 v244, s[8:11], s34 offen offset:0  lds
v_mfma_f32_16x16x32_bf16 v[120:123], a[60:63], v[152:155], v[120:123]
s_waitcnt lgkmcnt(10)
v_mfma_f32_16x16x32_bf16 v[28:31], a[48:51], v[156:159], v[28:31]
ds_read_b64_tr_b16 v[148:149], v160 offset:34080
v_mfma_f32_16x16x32_bf16 v[60:63], a[52:55], v[156:159], v[60:63]
ds_read_b64_tr_b16 v[150:151], v160 offset:34592
v_mfma_f32_16x16x32_bf16 v[92:95], a[56:59], v[156:159], v[92:95]
buffer_load_dwordx4 v245, s[8:11], s34 offen offset:1024  lds
v_mfma_f32_16x16x32_bf16 v[124:127], a[60:63], v[156:159], v[124:127]
s_waitcnt vmcnt(25) lgkmcnt(10)
v_mfma_f32_16x16x32_bf16 v[64:67], a[64:67], v[128:131], v[64:67]
s_waitcnt vmcnt(24)
v_mfma_f32_16x16x32_bf16 v[96:99], a[68:71], v[128:131], v[96:99]
s_waitcnt lgkmcnt(8)
ds_read_b64_tr_b16 v[152:153], v160 offset:34112
ds_read_b64_tr_b16 v[154:155], v160 offset:34624
v_mfma_f32_16x16x32_bf16 v[68:71], a[64:67], v[132:135], v[68:71]
buffer_load_dwordx4 v246, s[8:11], s34 offen offset:2048  lds
v_mfma_f32_16x16x32_bf16 v[100:103], a[68:71], v[132:135], v[100:103]
s_waitcnt lgkmcnt(8)
ds_read_b64_tr_b16 v[156:157], v160 offset:34144
ds_read_b64_tr_b16 v[158:159], v160 offset:34656
v_mfma_f32_16x16x32_bf16 v[72:75], a[64:67], v[136:139], v[72:75]
v_mfma_f32_16x16x32_bf16 v[104:107], a[68:71], v[136:139], v[104:107]
s_waitcnt lgkmcnt(8)
ds_read_b64_tr_b16 v[128:129], v160 offset:35072
ds_read_b64_tr_b16 v[130:131], v160 offset:35584
v_mfma_f32_16x16x32_bf16 v[76:79], a[64:67], v[140:143], v[76:79]
buffer_load_dwordx4 v247, s[8:11], s34 offen offset:3072  lds
v_mfma_f32_16x16x32_bf16 v[108:111], a[68:71], v[140:143], v[108:111]
s_waitcnt vmcnt(25) lgkmcnt(8)
ds_read_b64_tr_b16 v[132:133], v160 offset:35104
ds_read_b64_tr_b16 v[134:135], v160 offset:35616
v_mfma_f32_16x16x32_bf16 v[64:67], a[72:75], v[144:147], v[64:67]
s_waitcnt vmcnt(23)
s_add_u32 s34, s34, s63
v_mfma_f32_16x16x32_bf16 v[96:99], a[76:79], v[144:147], v[96:99]
s_waitcnt lgkmcnt(8)
ds_read_b64_tr_b16 v[136:137], v160 offset:35136
ds_read_b64_tr_b16 v[138:139], v160 offset:35648
v_mfma_f32_16x16x32_bf16 v[68:71], a[72:75], v[148:151], v[68:71]
buffer_load_dwordx4 a[0:3], v165, s[4:7], s32 offen offset:0 sc1
v_mfma_f32_16x16x32_bf16 v[100:103], a[76:79], v[148:151], v[100:103]
s_waitcnt lgkmcnt(8)
ds_read_b64_tr_b16 v[140:141], v160 offset:35168
ds_read_b64_tr_b16 v[142:143], v160 offset:35680
v_mfma_f32_16x16x32_bf16 v[72:75], a[72:75], v[152:155], v[72:75]
v_mfma_f32_16x16x32_bf16 v[104:107], a[76:79], v[152:155], v[104:107]
s_waitcnt lgkmcnt(8)
ds_read_b64_tr_b16 v[144:145], v160 offset:36096
ds_read_b64_tr_b16 v[146:147], v160 offset:36608
v_mfma_f32_16x16x32_bf16 v[76:79], a[72:75], v[156:159], v[76:79]
buffer_load_dwordx4 a[4:7], v165, s[4:7], s32 offen offset:2048 sc1
v_mfma_f32_16x16x32_bf16 v[108:111], a[76:79], v[156:159], v[108:111]
s_waitcnt vmcnt(24) lgkmcnt(8)
ds_read_b64_tr_b16 v[148:149], v160 offset:36128
ds_read_b64_tr_b16 v[150:151], v160 offset:36640
v_mfma_f32_16x16x32_bf16 v[64:67], a[80:83], v[128:131], v[64:67]
s_waitcnt vmcnt(23)
s_add_u32 s32, s32, 32768
v_mfma_f32_16x16x32_bf16 v[96:99], a[84:87], v[128:131], v[96:99]
s_waitcnt lgkmcnt(8)
ds_read_b64_tr_b16 v[152:153], v160 offset:36160
ds_read_b64_tr_b16 v[154:155], v160 offset:36672
v_mfma_f32_16x16x32_bf16 v[68:71], a[80:83], v[132:135], v[68:71]
buffer_load_dwordx4 a[8:11], v165, s[4:7], s32 offen offset:0 sc1
v_mfma_f32_16x16x32_bf16 v[100:103], a[84:87], v[132:135], v[100:103]
s_waitcnt lgkmcnt(8)
ds_read_b64_tr_b16 v[156:157], v160 offset:36192
ds_read_b64_tr_b16 v[158:159], v160 offset:36704
v_mfma_f32_16x16x32_bf16 v[72:75], a[80:83], v[136:139], v[72:75]
s_waitcnt vmcnt(15)
s_barrier
v_mfma_f32_16x16x32_bf16 v[104:107], a[84:87], v[136:139], v[104:107]
s_waitcnt lgkmcnt(8)
ds_read_b64_tr_b16 v[128:129], v161 offset:0
ds_read_b64_tr_b16 v[130:131], v161 offset:512
v_mfma_f32_16x16x32_bf16 v[76:79], a[80:83], v[140:143], v[76:79]
buffer_load_dwordx4 a[12:15], v165, s[4:7], s32 offen offset:2048 sc1
v_mfma_f32_16x16x32_bf16 v[108:111], a[84:87], v[140:143], v[108:111]
s_waitcnt lgkmcnt(8)
ds_read_b64_tr_b16 v[132:133], v161 offset:32
ds_read_b64_tr_b16 v[134:135], v161 offset:544
v_mfma_f32_16x16x32_bf16 v[64:67], a[88:91], v[144:147], v[64:67]
s_add_u32 s32, s32, 32768
v_mfma_f32_16x16x32_bf16 v[96:99], a[92:95], v[144:147], v[96:99]
s_waitcnt lgkmcnt(8)
ds_read_b64_tr_b16 v[136:137], v161 offset:64
ds_read_b64_tr_b16 v[138:139], v161 offset:576
v_mfma_f32_16x16x32_bf16 v[68:71], a[88:91], v[148:151], v[68:71]
buffer_load_dwordx4 a[16:19], v165, s[4:7], s32 offen offset:0 sc1
v_mfma_f32_16x16x32_bf16 v[100:103], a[92:95], v[148:151], v[100:103]
s_waitcnt lgkmcnt(8)
ds_read_b64_tr_b16 v[140:141], v161 offset:96
ds_read_b64_tr_b16 v[142:143], v161 offset:608
v_mfma_f32_16x16x32_bf16 v[72:75], a[88:91], v[152:155], v[72:75]
v_mfma_f32_16x16x32_bf16 v[104:107], a[92:95], v[152:155], v[104:107]
s_waitcnt lgkmcnt(8)
ds_read_b64_tr_b16 v[144:145], v161 offset:1024
ds_read_b64_tr_b16 v[146:147], v161 offset:1536
v_mfma_f32_16x16x32_bf16 v[76:79], a[88:91], v[156:159], v[76:79]
buffer_load_dwordx4 a[20:23], v165, s[4:7], s32 offen offset:2048 sc1
v_mfma_f32_16x16x32_bf16 v[108:111], a[92:95], v[156:159], v[108:111]
s_waitcnt lgkmcnt(8)
ds_read_b64_tr_b16 v[148:149], v161 offset:1056
ds_read_b64_tr_b16 v[150:151], v161 offset:1568
v_mfma_f32_16x16x32_bf16 v[64:67], a[96:99], v[128:131], v[64:67]
s_add_u32 s32, s32, 32768
v_mfma_f32_16x16x32_bf16 v[96:99], a[100:103], v[128:131], v[96:99]
s_waitcnt lgkmcnt(8)
ds_read_b64_tr_b16 v[152:153], v161 offset:1088
ds_read_b64_tr_b16 v[154:155], v161 offset:1600
v_mfma_f32_16x16x32_bf16 v[68:71], a[96:99], v[132:135], v[68:71]
buffer_load_dwordx4 a[24:27], v165, s[4:7], s32 offen offset:0 sc1
v_mfma_f32_16x16x32_bf16 v[100:103], a[100:103], v[132:135], v[100:103]
s_waitcnt lgkmcnt(8)
ds_read_b64_tr_b16 v[156:157], v161 offset:1120
ds_read_b64_tr_b16 v[158:159], v161 offset:1632
v_mfma_f32_16x16x32_bf16 v[72:75], a[96:99], v[136:139], v[72:75]
v_mfma_f32_16x16x32_bf16 v[104:107], a[100:103], v[136:139], v[104:107]
s_waitcnt lgkmcnt(8)
ds_read_b64_tr_b16 v[128:129], v161 offset:2048
ds_read_b64_tr_b16 v[130:131], v161 offset:2560
v_mfma_f32_16x16x32_bf16 v[76:79], a[96:99], v[140:143], v[76:79]
buffer_load_dwordx4 a[28:31], v165, s[4:7], s32 offen offset:2048 sc1
v_mfma_f32_16x16x32_bf16 v[108:111], a[100:103], v[140:143], v[108:111]
s_waitcnt lgkmcnt(8)
ds_read_b64_tr_b16 v[132:133], v161 offset:2080
ds_read_b64_tr_b16 v[134:135], v161 offset:2592
v_mfma_f32_16x16x32_bf16 v[64:67], a[104:107], v[144:147], v[64:67]
s_add_u32 s32, s32, s31
v_mfma_f32_16x16x32_bf16 v[96:99], a[108:111], v[144:147], v[96:99]
s_waitcnt lgkmcnt(8)
ds_read_b64_tr_b16 v[136:137], v161 offset:2112
ds_read_b64_tr_b16 v[138:139], v161 offset:2624
v_mfma_f32_16x16x32_bf16 v[68:71], a[104:107], v[148:151], v[68:71]
buffer_load_dwordx4 a[128:131], v164, s[4:7], s33 offen offset:0 sc1
v_mfma_f32_16x16x32_bf16 v[100:103], a[108:111], v[148:151], v[100:103]
s_waitcnt lgkmcnt(8)
ds_read_b64_tr_b16 v[140:141], v161 offset:2144
ds_read_b64_tr_b16 v[142:143], v161 offset:2656
v_mfma_f32_16x16x32_bf16 v[72:75], a[104:107], v[152:155], v[72:75]
v_mfma_f32_16x16x32_bf16 v[104:107], a[108:111], v[152:155], v[104:107]
s_waitcnt lgkmcnt(8)
ds_read_b64_tr_b16 v[144:145], v161 offset:3072
ds_read_b64_tr_b16 v[146:147], v161 offset:3584
v_mfma_f32_16x16x32_bf16 v[76:79], a[104:107], v[156:159], v[76:79]
buffer_load_dwordx4 a[132:135], v164, s[4:7], s33 offen offset:2048 sc1
v_mfma_f32_16x16x32_bf16 v[108:111], a[108:111], v[156:159], v[108:111]
s_waitcnt vmcnt(21) lgkmcnt(8)
ds_read_b64_tr_b16 v[148:149], v161 offset:3104
ds_read_b64_tr_b16 v[150:151], v161 offset:3616
v_mfma_f32_16x16x32_bf16 v[64:67], a[112:115], v[128:131], v[64:67]
s_waitcnt vmcnt(20)
s_add_u32 s33, s33, 32768
v_mfma_f32_16x16x32_bf16 v[96:99], a[116:119], v[128:131], v[96:99]
s_waitcnt lgkmcnt(8)
ds_read_b64_tr_b16 v[152:153], v161 offset:3136
ds_read_b64_tr_b16 v[154:155], v161 offset:3648
v_mfma_f32_16x16x32_bf16 v[68:71], a[112:115], v[132:135], v[68:71]
buffer_load_dwordx4 a[136:139], v164, s[4:7], s33 offen offset:0 sc1
v_mfma_f32_16x16x32_bf16 v[100:103], a[116:119], v[132:135], v[100:103]
s_waitcnt lgkmcnt(8)
ds_read_b64_tr_b16 v[156:157], v161 offset:3168
ds_read_b64_tr_b16 v[158:159], v161 offset:3680
v_mfma_f32_16x16x32_bf16 v[72:75], a[112:115], v[136:139], v[72:75]
s_waitcnt vmcnt(11)
s_barrier
v_mfma_f32_16x16x32_bf16 v[104:107], a[116:119], v[136:139], v[104:107]
s_waitcnt lgkmcnt(8)
ds_read_b64_tr_b16 v[128:129], v161 offset:33024
ds_read_b64_tr_b16 v[130:131], v161 offset:33536
v_mfma_f32_16x16x32_bf16 v[76:79], a[112:115], v[140:143], v[76:79]
buffer_load_dwordx4 a[140:143], v164, s[4:7], s33 offen offset:2048 sc1
v_mfma_f32_16x16x32_bf16 v[108:111], a[116:119], v[140:143], v[108:111]
s_waitcnt lgkmcnt(8)
ds_read_b64_tr_b16 v[132:133], v161 offset:33056
ds_read_b64_tr_b16 v[134:135], v161 offset:33568
v_mfma_f32_16x16x32_bf16 v[64:67], a[120:123], v[144:147], v[64:67]
s_add_u32 s33, s33, 32768
v_mfma_f32_16x16x32_bf16 v[96:99], a[124:127], v[144:147], v[96:99]
s_waitcnt lgkmcnt(8)
ds_read_b64_tr_b16 v[136:137], v161 offset:33088
ds_read_b64_tr_b16 v[138:139], v161 offset:33600
v_mfma_f32_16x16x32_bf16 v[68:71], a[120:123], v[148:151], v[68:71]
buffer_load_dwordx4 a[144:147], v164, s[4:7], s33 offen offset:0 sc1
v_mfma_f32_16x16x32_bf16 v[100:103], a[124:127], v[148:151], v[100:103]
s_waitcnt lgkmcnt(8)
ds_read_b64_tr_b16 v[140:141], v161 offset:33120
ds_read_b64_tr_b16 v[142:143], v161 offset:33632
v_mfma_f32_16x16x32_bf16 v[72:75], a[120:123], v[152:155], v[72:75]
v_mfma_f32_16x16x32_bf16 v[104:107], a[124:127], v[152:155], v[104:107]
s_waitcnt lgkmcnt(8)
ds_read_b64_tr_b16 v[144:145], v161 offset:34048
ds_read_b64_tr_b16 v[146:147], v161 offset:34560
v_mfma_f32_16x16x32_bf16 v[76:79], a[120:123], v[156:159], v[76:79]
buffer_load_dwordx4 a[148:151], v164, s[4:7], s33 offen offset:2048 sc1
v_mfma_f32_16x16x32_bf16 v[108:111], a[124:127], v[156:159], v[108:111]
s_waitcnt vmcnt(13) lgkmcnt(8)
ds_read_b64_tr_b16 v[148:149], v161 offset:34080
ds_read_b64_tr_b16 v[150:151], v161 offset:34592
v_mfma_f32_16x16x32_bf16 v[64:67], a[0:3], v[128:131], v[64:67]
s_waitcnt vmcnt(12)
s_add_u32 s33, s33, 32768
v_mfma_f32_16x16x32_bf16 v[96:99], a[4:7], v[128:131], v[96:99]
s_waitcnt lgkmcnt(8)
ds_read_b64_tr_b16 v[152:153], v161 offset:34112
ds_read_b64_tr_b16 v[154:155], v161 offset:34624
v_mfma_f32_16x16x32_bf16 v[68:71], a[0:3], v[132:135], v[68:71]
buffer_load_dwordx4 a[152:155], v164, s[4:7], s33 offen offset:0 sc1
v_mfma_f32_16x16x32_bf16 v[100:103], a[4:7], v[132:135], v[100:103]
s_waitcnt lgkmcnt(8)
ds_read_b64_tr_b16 v[156:157], v161 offset:34144
ds_read_b64_tr_b16 v[158:159], v161 offset:34656
v_mfma_f32_16x16x32_bf16 v[72:75], a[0:3], v[136:139], v[72:75]
v_mfma_f32_16x16x32_bf16 v[104:107], a[4:7], v[136:139], v[104:107]
s_waitcnt lgkmcnt(8)
ds_read_b64_tr_b16 v[128:129], v161 offset:35072
ds_read_b64_tr_b16 v[130:131], v161 offset:35584
v_mfma_f32_16x16x32_bf16 v[76:79], a[0:3], v[140:143], v[76:79]
buffer_load_dwordx4 a[156:159], v164, s[4:7], s33 offen offset:2048 sc1
v_mfma_f32_16x16x32_bf16 v[108:111], a[4:7], v[140:143], v[108:111]
s_waitcnt vmcnt(13) lgkmcnt(8)
ds_read_b64_tr_b16 v[132:133], v161 offset:35104
ds_read_b64_tr_b16 v[134:135], v161 offset:35616
v_mfma_f32_16x16x32_bf16 v[64:67], a[8:11], v[144:147], v[64:67]
s_waitcnt vmcnt(12)
s_add_u32 s33, s33, s31
v_mfma_f32_16x16x32_bf16 v[96:99], a[12:15], v[144:147], v[96:99]
s_waitcnt lgkmcnt(8)
ds_read_b64_tr_b16 v[136:137], v161 offset:35136
ds_read_b64_tr_b16 v[138:139], v161 offset:35648
v_mfma_f32_16x16x32_bf16 v[68:71], a[8:11], v[148:151], v[68:71]
buffer_load_dwordx4 a[160:163], v164, s[4:7], s33 offen offset:0 sc1
v_mfma_f32_16x16x32_bf16 v[100:103], a[12:15], v[148:151], v[100:103]
s_waitcnt lgkmcnt(8)
ds_read_b64_tr_b16 v[140:141], v161 offset:35168
ds_read_b64_tr_b16 v[142:143], v161 offset:35680
v_mfma_f32_16x16x32_bf16 v[72:75], a[8:11], v[152:155], v[72:75]
v_mfma_f32_16x16x32_bf16 v[104:107], a[12:15], v[152:155], v[104:107]
s_waitcnt lgkmcnt(8)
ds_read_b64_tr_b16 v[144:145], v161 offset:36096
ds_read_b64_tr_b16 v[146:147], v161 offset:36608
v_mfma_f32_16x16x32_bf16 v[76:79], a[8:11], v[156:159], v[76:79]
buffer_load_dwordx4 a[164:167], v164, s[4:7], s33 offen offset:2048 sc1
v_mfma_f32_16x16x32_bf16 v[108:111], a[12:15], v[156:159], v[108:111]
s_waitcnt vmcnt(13) lgkmcnt(8)
ds_read_b64_tr_b16 v[148:149], v161 offset:36128
ds_read_b64_tr_b16 v[150:151], v161 offset:36640
v_mfma_f32_16x16x32_bf16 v[64:67], a[16:19], v[128:131], v[64:67]
s_waitcnt vmcnt(12)
s_add_u32 s33, s33, 32768
v_mfma_f32_16x16x32_bf16 v[96:99], a[20:23], v[128:131], v[96:99]
s_waitcnt lgkmcnt(8)
ds_read_b64_tr_b16 v[152:153], v161 offset:36160
ds_read_b64_tr_b16 v[154:155], v161 offset:36672
v_mfma_f32_16x16x32_bf16 v[68:71], a[16:19], v[132:135], v[68:71]
buffer_load_dwordx4 a[168:171], v164, s[4:7], s33 offen offset:0 sc1
v_mfma_f32_16x16x32_bf16 v[100:103], a[20:23], v[132:135], v[100:103]
s_waitcnt lgkmcnt(8)
ds_read_b64_tr_b16 v[156:157], v161 offset:36192
ds_read_b64_tr_b16 v[158:159], v161 offset:36704
v_mfma_f32_16x16x32_bf16 v[72:75], a[16:19], v[136:139], v[72:75]
v_mfma_f32_16x16x32_bf16 v[104:107], a[20:23], v[136:139], v[104:107]
s_waitcnt lgkmcnt(8)
ds_read_b64_tr_b16 v[128:129], v160 offset:49536
ds_read_b64_tr_b16 v[130:131], v160 offset:50048
v_mfma_f32_16x16x32_bf16 v[76:79], a[16:19], v[140:143], v[76:79]
buffer_load_dwordx4 a[172:175], v164, s[4:7], s33 offen offset:2048 sc1
v_mfma_f32_16x16x32_bf16 v[108:111], a[20:23], v[140:143], v[108:111]
s_waitcnt vmcnt(13) lgkmcnt(8)
ds_read_b64_tr_b16 v[132:133], v160 offset:49568
ds_read_b64_tr_b16 v[134:135], v160 offset:50080
v_mfma_f32_16x16x32_bf16 v[64:67], a[24:27], v[144:147], v[64:67]
s_waitcnt vmcnt(12)
s_add_u32 s33, s33, 32768
v_mfma_f32_16x16x32_bf16 v[96:99], a[28:31], v[144:147], v[96:99]
s_waitcnt lgkmcnt(8)
ds_read_b64_tr_b16 v[136:137], v160 offset:49600
ds_read_b64_tr_b16 v[138:139], v160 offset:50112
v_mfma_f32_16x16x32_bf16 v[68:71], a[24:27], v[148:151], v[68:71]
buffer_load_dwordx4 a[176:179], v164, s[4:7], s33 offen offset:0 sc1
v_mfma_f32_16x16x32_bf16 v[100:103], a[28:31], v[148:151], v[100:103]
s_waitcnt lgkmcnt(8)
ds_read_b64_tr_b16 v[140:141], v160 offset:49632
ds_read_b64_tr_b16 v[142:143], v160 offset:50144
v_mfma_f32_16x16x32_bf16 v[72:75], a[24:27], v[152:155], v[72:75]
v_cvt_pk_bf16_f32 v184, v64, v65
v_cvt_pk_bf16_f32 v185, v66, v67
v_mfma_f32_16x16x32_bf16 v[104:107], a[28:31], v[152:155], v[104:107]
s_waitcnt lgkmcnt(8)
ds_read_b64_tr_b16 v[144:145], v160 offset:50560
ds_read_b64_tr_b16 v[146:147], v160 offset:51072
v_mfma_f32_16x16x32_bf16 v[76:79], a[24:27], v[156:159], v[76:79]
v_cvt_pk_bf16_f32 v186, v96, v97
buffer_load_dwordx4 a[180:183], v164, s[4:7], s33 offen offset:2048 sc1
v_mfma_f32_16x16x32_bf16 v[108:111], a[28:31], v[156:159], v[108:111]
s_waitcnt lgkmcnt(8)
ds_read_b64_tr_b16 v[148:149], v160 offset:50592
ds_read_b64_tr_b16 v[150:151], v160 offset:51104
v_mfma_f32_16x16x32_bf16 v[80:83], a[64:67], v[128:131], v[80:83]
s_add_u32 s33, s33, 32768
v_cvt_pk_bf16_f32 v187, v98, v99
v_mfma_f32_16x16x32_bf16 v[112:115], a[68:71], v[128:131], v[112:115]
s_waitcnt lgkmcnt(8)
ds_read_b64_tr_b16 v[152:153], v160 offset:50624
ds_read_b64_tr_b16 v[154:155], v160 offset:51136
v_mfma_f32_16x16x32_bf16 v[84:87], a[64:67], v[132:135], v[84:87]
buffer_store_dwordx4 v[184:187], v252, s[56:59], s97 offen offset:0 sc1
v_mfma_f32_16x16x32_bf16 v[116:119], a[68:71], v[132:135], v[116:119]
s_waitcnt lgkmcnt(8)
ds_read_b64_tr_b16 v[156:157], v160 offset:50656
ds_read_b64_tr_b16 v[158:159], v160 offset:51168
v_mfma_f32_16x16x32_bf16 v[88:91], a[64:67], v[136:139], v[88:91]
v_cvt_pk_bf16_f32 v188, v68, v69
v_mfma_f32_16x16x32_bf16 v[120:123], a[68:71], v[136:139], v[120:123]
s_waitcnt lgkmcnt(8)
ds_read_b64_tr_b16 v[128:129], v160 offset:51584
ds_read_b64_tr_b16 v[130:131], v160 offset:52096
v_mfma_f32_16x16x32_bf16 v[92:95], a[64:67], v[140:143], v[92:95]
v_cvt_pk_bf16_f32 v189, v70, v71
v_cvt_pk_bf16_f32 v190, v100, v101
v_mfma_f32_16x16x32_bf16 v[124:127], a[68:71], v[140:143], v[124:127]
s_waitcnt lgkmcnt(8)
ds_read_b64_tr_b16 v[132:133], v160 offset:51616
ds_read_b64_tr_b16 v[134:135], v160 offset:52128
v_mfma_f32_16x16x32_bf16 v[80:83], a[72:75], v[144:147], v[80:83]
v_cvt_pk_bf16_f32 v191, v102, v103
v_mfma_f32_16x16x32_bf16 v[112:115], a[76:79], v[144:147], v[112:115]
s_waitcnt lgkmcnt(8)
ds_read_b64_tr_b16 v[136:137], v160 offset:51648
ds_read_b64_tr_b16 v[138:139], v160 offset:52160
v_mfma_f32_16x16x32_bf16 v[84:87], a[72:75], v[148:151], v[84:87]
buffer_store_dwordx4 v[188:191], v252, s[56:59], s97 offen offset:2048 sc1
v_mfma_f32_16x16x32_bf16 v[116:119], a[76:79], v[148:151], v[116:119]
s_waitcnt lgkmcnt(8)
ds_read_b64_tr_b16 v[140:141], v160 offset:51680
ds_read_b64_tr_b16 v[142:143], v160 offset:52192
v_mfma_f32_16x16x32_bf16 v[88:91], a[72:75], v[152:155], v[88:91]
s_add_u32 s97, s97, 4096
v_cvt_pk_bf16_f32 v192, v72, v73
v_mfma_f32_16x16x32_bf16 v[120:123], a[76:79], v[152:155], v[120:123]
s_waitcnt lgkmcnt(8)
ds_read_b64_tr_b16 v[144:145], v160 offset:52608
ds_read_b64_tr_b16 v[146:147], v160 offset:53120
v_mfma_f32_16x16x32_bf16 v[92:95], a[72:75], v[156:159], v[92:95]
v_cvt_pk_bf16_f32 v193, v74, v75
v_cvt_pk_bf16_f32 v194, v104, v105
v_mfma_f32_16x16x32_bf16 v[124:127], a[76:79], v[156:159], v[124:127]
s_waitcnt lgkmcnt(8)
ds_read_b64_tr_b16 v[148:149], v160 offset:52640
ds_read_b64_tr_b16 v[150:151], v160 offset:53152
v_mfma_f32_16x16x32_bf16 v[80:83], a[80:83], v[128:131], v[80:83]
v_cvt_pk_bf16_f32 v195, v106, v107
v_mfma_f32_16x16x32_bf16 v[112:115], a[84:87], v[128:131], v[112:115]
s_waitcnt lgkmcnt(8)
ds_read_b64_tr_b16 v[152:153], v160 offset:52672
ds_read_b64_tr_b16 v[154:155], v160 offset:53184
v_mfma_f32_16x16x32_bf16 v[84:87], a[80:83], v[132:135], v[84:87]
buffer_store_dwordx4 v[192:195], v252, s[56:59], s97 offen offset:0 sc1
v_mfma_f32_16x16x32_bf16 v[116:119], a[84:87], v[132:135], v[116:119]
s_waitcnt lgkmcnt(8)
ds_read_b64_tr_b16 v[156:157], v160 offset:52704
ds_read_b64_tr_b16 v[158:159], v160 offset:53216
v_mfma_f32_16x16x32_bf16 v[88:91], a[80:83], v[136:139], v[88:91]
v_cvt_pk_bf16_f32 v196, v76, v77
v_mfma_f32_16x16x32_bf16 v[120:123], a[84:87], v[136:139], v[120:123]
s_waitcnt lgkmcnt(8)
ds_read_b64_tr_b16 v[128:129], v161 offset:16512
ds_read_b64_tr_b16 v[130:131], v161 offset:17024
v_mfma_f32_16x16x32_bf16 v[92:95], a[80:83], v[140:143], v[92:95]
v_cvt_pk_bf16_f32 v197, v78, v79
v_cvt_pk_bf16_f32 v198, v108, v109
v_mfma_f32_16x16x32_bf16 v[124:127], a[84:87], v[140:143], v[124:127]
s_waitcnt lgkmcnt(8)
ds_read_b64_tr_b16 v[132:133], v161 offset:16544
ds_read_b64_tr_b16 v[134:135], v161 offset:17056
v_mfma_f32_16x16x32_bf16 v[80:83], a[88:91], v[144:147], v[80:83]
v_cvt_pk_bf16_f32 v199, v110, v111
v_mfma_f32_16x16x32_bf16 v[112:115], a[92:95], v[144:147], v[112:115]
s_waitcnt lgkmcnt(8)
ds_read_b64_tr_b16 v[136:137], v161 offset:16576
ds_read_b64_tr_b16 v[138:139], v161 offset:17088
v_mfma_f32_16x16x32_bf16 v[84:87], a[88:91], v[148:151], v[84:87]
buffer_store_dwordx4 v[196:199], v252, s[56:59], s97 offen offset:2048 sc1
v_mfma_f32_16x16x32_bf16 v[116:119], a[92:95], v[148:151], v[116:119]
s_waitcnt lgkmcnt(8)
ds_read_b64_tr_b16 v[140:141], v161 offset:16608
ds_read_b64_tr_b16 v[142:143], v161 offset:17120
v_mfma_f32_16x16x32_bf16 v[88:91], a[88:91], v[152:155], v[88:91]
s_add_u32 s97, s97, 4096
v_mfma_f32_16x16x32_bf16 v[120:123], a[92:95], v[152:155], v[120:123]
s_waitcnt lgkmcnt(8)
ds_read_b64_tr_b16 v[144:145], v161 offset:17536
ds_read_b64_tr_b16 v[146:147], v161 offset:18048
v_mfma_f32_16x16x32_bf16 v[92:95], a[88:91], v[156:159], v[92:95]
v_mfma_f32_16x16x32_bf16 v[124:127], a[92:95], v[156:159], v[124:127]
s_waitcnt lgkmcnt(8)
ds_read_b64_tr_b16 v[148:149], v161 offset:17568
ds_read_b64_tr_b16 v[150:151], v161 offset:18080
v_mfma_f32_16x16x32_bf16 v[80:83], a[96:99], v[128:131], v[80:83]
v_mfma_f32_16x16x32_bf16 v[112:115], a[100:103], v[128:131], v[112:115]
s_waitcnt lgkmcnt(8)
ds_read_b64_tr_b16 v[152:153], v161 offset:17600
ds_read_b64_tr_b16 v[154:155], v161 offset:18112
v_mfma_f32_16x16x32_bf16 v[84:87], a[96:99], v[132:135], v[84:87]
buffer_load_dwordx4 a[184:187], v164, s[4:7], s33 offen offset:0 sc1
v_mfma_f32_16x16x32_bf16 v[116:119], a[100:103], v[132:135], v[116:119]
s_waitcnt lgkmcnt(8)
ds_read_b64_tr_b16 v[156:157], v161 offset:17632
ds_read_b64_tr_b16 v[158:159], v161 offset:18144
v_mfma_f32_16x16x32_bf16 v[88:91], a[96:99], v[136:139], v[88:91]
v_mfma_f32_16x16x32_bf16 v[120:123], a[100:103], v[136:139], v[120:123]
s_waitcnt lgkmcnt(8)
ds_read_b64_tr_b16 v[128:129], v161 offset:18560
ds_read_b64_tr_b16 v[130:131], v161 offset:19072
v_mfma_f32_16x16x32_bf16 v[92:95], a[96:99], v[140:143], v[92:95]
buffer_load_dwordx4 a[188:191], v164, s[4:7], s33 offen offset:2048 sc1
v_mfma_f32_16x16x32_bf16 v[124:127], a[100:103], v[140:143], v[124:127]
s_waitcnt lgkmcnt(8)
ds_read_b64_tr_b16 v[132:133], v161 offset:18592
ds_read_b64_tr_b16 v[134:135], v161 offset:19104
v_mfma_f32_16x16x32_bf16 v[80:83], a[104:107], v[144:147], v[80:83]
s_add_u32 s33, s33, s30
v_mfma_f32_16x16x32_bf16 v[112:115], a[108:111], v[144:147], v[112:115]
s_waitcnt lgkmcnt(8)
ds_read_b64_tr_b16 v[136:137], v161 offset:18624
ds_read_b64_tr_b16 v[138:139], v161 offset:19136
v_mfma_f32_16x16x32_bf16 v[84:87], a[104:107], v[148:151], v[84:87]
buffer_load_dwordx4 a[192:195], v164, s[4:7], s33 offen offset:0 sc1
v_mfma_f32_16x16x32_bf16 v[116:119], a[108:111], v[148:151], v[116:119]
s_waitcnt lgkmcnt(8)
ds_read_b64_tr_b16 v[140:141], v161 offset:18656
ds_read_b64_tr_b16 v[142:143], v161 offset:19168
v_mfma_f32_16x16x32_bf16 v[88:91], a[104:107], v[152:155], v[88:91]
v_mfma_f32_16x16x32_bf16 v[120:123], a[108:111], v[152:155], v[120:123]
s_waitcnt lgkmcnt(8)
ds_read_b64_tr_b16 v[144:145], v161 offset:19584
ds_read_b64_tr_b16 v[146:147], v161 offset:20096
v_mfma_f32_16x16x32_bf16 v[92:95], a[104:107], v[156:159], v[92:95]
buffer_load_dwordx4 a[196:199], v164, s[4:7], s33 offen offset:2048 sc1
v_mfma_f32_16x16x32_bf16 v[124:127], a[108:111], v[156:159], v[124:127]
s_waitcnt lgkmcnt(8)
ds_read_b64_tr_b16 v[148:149], v161 offset:19616
ds_read_b64_tr_b16 v[150:151], v161 offset:20128
v_mfma_f32_16x16x32_bf16 v[80:83], a[112:115], v[128:131], v[80:83]
s_add_u32 s33, s33, 32768
v_mfma_f32_16x16x32_bf16 v[112:115], a[116:119], v[128:131], v[112:115]
s_waitcnt lgkmcnt(8)
ds_read_b64_tr_b16 v[152:153], v161 offset:19648
ds_read_b64_tr_b16 v[154:155], v161 offset:20160
v_mfma_f32_16x16x32_bf16 v[84:87], a[112:115], v[132:135], v[84:87]
buffer_load_dwordx4 a[200:203], v164, s[4:7], s33 offen offset:0 sc1
v_mfma_f32_16x16x32_bf16 v[116:119], a[116:119], v[132:135], v[116:119]
s_waitcnt lgkmcnt(8)
ds_read_b64_tr_b16 v[156:157], v161 offset:19680
ds_read_b64_tr_b16 v[158:159], v161 offset:20192
v_mfma_f32_16x16x32_bf16 v[88:91], a[112:115], v[136:139], v[88:91]
v_mfma_f32_16x16x32_bf16 v[120:123], a[116:119], v[136:139], v[120:123]
s_waitcnt lgkmcnt(8)
ds_read_b64_tr_b16 v[128:129], v161 offset:49536
ds_read_b64_tr_b16 v[130:131], v161 offset:50048
v_mfma_f32_16x16x32_bf16 v[92:95], a[112:115], v[140:143], v[92:95]
buffer_load_dwordx4 a[204:207], v164, s[4:7], s33 offen offset:2048 sc1
v_mfma_f32_16x16x32_bf16 v[124:127], a[116:119], v[140:143], v[124:127]
s_waitcnt lgkmcnt(8)
ds_read_b64_tr_b16 v[132:133], v161 offset:49568
ds_read_b64_tr_b16 v[134:135], v161 offset:50080
v_mfma_f32_16x16x32_bf16 v[80:83], a[120:123], v[144:147], v[80:83]
s_add_u32 s33, s33, 32768
v_mfma_f32_16x16x32_bf16 v[112:115], a[124:127], v[144:147], v[112:115]
s_waitcnt lgkmcnt(8)
ds_read_b64_tr_b16 v[136:137], v161 offset:49600
ds_read_b64_tr_b16 v[138:139], v161 offset:50112
v_mfma_f32_16x16x32_bf16 v[84:87], a[120:123], v[148:151], v[84:87]
buffer_load_dwordx4 a[208:211], v164, s[4:7], s33 offen offset:0 sc1
v_mfma_f32_16x16x32_bf16 v[116:119], a[124:127], v[148:151], v[116:119]
s_waitcnt lgkmcnt(8)
ds_read_b64_tr_b16 v[140:141], v161 offset:49632
ds_read_b64_tr_b16 v[142:143], v161 offset:50144
v_mfma_f32_16x16x32_bf16 v[88:91], a[120:123], v[152:155], v[88:91]
v_mfma_f32_16x16x32_bf16 v[120:123], a[124:127], v[152:155], v[120:123]
s_waitcnt lgkmcnt(8)
ds_read_b64_tr_b16 v[144:145], v161 offset:50560
ds_read_b64_tr_b16 v[146:147], v161 offset:51072
v_mfma_f32_16x16x32_bf16 v[92:95], a[120:123], v[156:159], v[92:95]
buffer_load_dwordx4 a[212:215], v164, s[4:7], s33 offen offset:2048 sc1
v_mfma_f32_16x16x32_bf16 v[124:127], a[124:127], v[156:159], v[124:127]
s_waitcnt lgkmcnt(8)
ds_read_b64_tr_b16 v[148:149], v161 offset:50592
ds_read_b64_tr_b16 v[150:151], v161 offset:51104
v_mfma_f32_16x16x32_bf16 v[80:83], a[0:3], v[128:131], v[80:83]
s_add_u32 s33, s33, 32768
v_mfma_f32_16x16x32_bf16 v[112:115], a[4:7], v[128:131], v[112:115]
s_waitcnt lgkmcnt(8)
ds_read_b64_tr_b16 v[152:153], v161 offset:50624
ds_read_b64_tr_b16 v[154:155], v161 offset:51136
v_mfma_f32_16x16x32_bf16 v[84:87], a[0:3], v[132:135], v[84:87]
buffer_load_dwordx4 a[216:219], v164, s[4:7], s33 offen offset:0 sc1
v_mfma_f32_16x16x32_bf16 v[116:119], a[4:7], v[132:135], v[116:119]
s_waitcnt lgkmcnt(8)
ds_read_b64_tr_b16 v[156:157], v161 offset:50656
ds_read_b64_tr_b16 v[158:159], v161 offset:51168
v_mfma_f32_16x16x32_bf16 v[88:91], a[0:3], v[136:139], v[88:91]
v_mfma_f32_16x16x32_bf16 v[120:123], a[4:7], v[136:139], v[120:123]
s_waitcnt lgkmcnt(8)
ds_read_b64_tr_b16 v[128:129], v161 offset:51584
ds_read_b64_tr_b16 v[130:131], v161 offset:52096
v_mfma_f32_16x16x32_bf16 v[92:95], a[0:3], v[140:143], v[92:95]
buffer_load_dword v255, v182, s[44:47], s61 offen sc1
v_mfma_f32_16x16x32_bf16 v[124:127], a[4:7], v[140:143], v[124:127]
s_waitcnt lgkmcnt(8)
ds_read_b64_tr_b16 v[132:133], v161 offset:51616
ds_read_b64_tr_b16 v[134:135], v161 offset:52128
v_mfma_f32_16x16x32_bf16 v[80:83], a[8:11], v[144:147], v[80:83]
v_mfma_f32_16x16x32_bf16 v[112:115], a[12:15], v[144:147], v[112:115]
s_waitcnt lgkmcnt(8)
ds_read_b64_tr_b16 v[136:137], v161 offset:51648
ds_read_b64_tr_b16 v[138:139], v161 offset:52160
v_mfma_f32_16x16x32_bf16 v[84:87], a[8:11], v[148:151], v[84:87]
s_waitcnt vmcnt(10)
buffer_store_dword v249, v250, s[44:47], s99 offen offset:0 sc1
v_mfma_f32_16x16x32_bf16 v[116:119], a[12:15], v[148:151], v[116:119]
s_waitcnt lgkmcnt(8)
ds_read_b64_tr_b16 v[140:141], v161 offset:51680
ds_read_b64_tr_b16 v[142:143], v161 offset:52192
v_mfma_f32_16x16x32_bf16 v[88:91], a[8:11], v[152:155], v[88:91]
v_mfma_f32_16x16x32_bf16 v[120:123], a[12:15], v[152:155], v[120:123]
s_waitcnt lgkmcnt(8)
ds_read_b64_tr_b16 v[144:145], v161 offset:52608
ds_read_b64_tr_b16 v[146:147], v161 offset:53120
v_mfma_f32_16x16x32_bf16 v[92:95], a[8:11], v[156:159], v[92:95]
buffer_load_dwordx4 a[220:223], v164, s[4:7], s33 offen offset:2048 sc1
v_mfma_f32_16x16x32_bf16 v[124:127], a[12:15], v[156:159], v[124:127]
s_waitcnt lgkmcnt(8)
ds_read_b64_tr_b16 v[148:149], v161 offset:52640
ds_read_b64_tr_b16 v[150:151], v161 offset:53152
v_mfma_f32_16x16x32_bf16 v[80:83], a[16:19], v[128:131], v[80:83]
s_add_u32 s33, s33, s31
v_mfma_f32_16x16x32_bf16 v[112:115], a[20:23], v[128:131], v[112:115]
s_waitcnt lgkmcnt(8)
ds_read_b64_tr_b16 v[152:153], v161 offset:52672
ds_read_b64_tr_b16 v[154:155], v161 offset:53184
v_mfma_f32_16x16x32_bf16 v[84:87], a[16:19], v[132:135], v[84:87]
v_mfma_f32_16x16x32_bf16 v[116:119], a[20:23], v[132:135], v[116:119]
s_waitcnt lgkmcnt(8)
ds_read_b64_tr_b16 v[156:157], v161 offset:52704
ds_read_b64_tr_b16 v[158:159], v161 offset:53216
v_mfma_f32_16x16x32_bf16 v[88:91], a[16:19], v[136:139], v[88:91]
v_mfma_f32_16x16x32_bf16 v[120:123], a[20:23], v[136:139], v[120:123]
s_waitcnt lgkmcnt(8)
ds_read_b64_tr_b16 v[128:129], v160 offset:33024
ds_read_b64_tr_b16 v[130:131], v160 offset:33536
v_mfma_f32_16x16x32_bf16 v[92:95], a[16:19], v[140:143], v[92:95]
v_mfma_f32_16x16x32_bf16 v[124:127], a[20:23], v[140:143], v[124:127]
s_waitcnt lgkmcnt(8)
ds_read_b64_tr_b16 v[132:133], v160 offset:33056
ds_read_b64_tr_b16 v[134:135], v160 offset:33568
v_mfma_f32_16x16x32_bf16 v[80:83], a[24:27], v[144:147], v[80:83]
v_mfma_f32_16x16x32_bf16 v[112:115], a[28:31], v[144:147], v[112:115]
s_waitcnt lgkmcnt(8)
ds_read_b64_tr_b16 v[136:137], v160 offset:33088
ds_read_b64_tr_b16 v[138:139], v160 offset:33600
v_mfma_f32_16x16x32_bf16 v[84:87], a[24:27], v[148:151], v[84:87]
v_mfma_f32_16x16x32_bf16 v[116:119], a[28:31], v[148:151], v[116:119]
s_waitcnt lgkmcnt(8)
ds_read_b64_tr_b16 v[140:141], v160 offset:33120
ds_read_b64_tr_b16 v[142:143], v160 offset:33632
v_mfma_f32_16x16x32_bf16 v[88:91], a[24:27], v[152:155], v[88:91]
v_cvt_pk_bf16_f32 v200, v80, v81
v_mfma_f32_16x16x32_bf16 v[120:123], a[28:31], v[152:155], v[120:123]
s_waitcnt lgkmcnt(8)
ds_read_b64_tr_b16 v[144:145], v160 offset:34048
ds_read_b64_tr_b16 v[146:147], v160 offset:34560
v_mfma_f32_16x16x32_bf16 v[92:95], a[24:27], v[156:159], v[92:95]
v_cvt_pk_bf16_f32 v201, v82, v83
v_cvt_pk_bf16_f32 v202, v112, v113
v_mfma_f32_16x16x32_bf16 v[124:127], a[28:31], v[156:159], v[124:127]
s_waitcnt lgkmcnt(8)
ds_read_b64_tr_b16 v[148:149], v160 offset:34080
ds_read_b64_tr_b16 v[150:151], v160 offset:34592
v_mfma_f32_16x16x32_bf16 v[0:3], a[128:131], v[128:131], v[0:3]
v_cvt_pk_bf16_f32 v203, v114, v115
v_mfma_f32_16x16x32_bf16 v[32:35], a[132:135], v[128:131], v[32:35]
s_waitcnt lgkmcnt(8)
ds_read_b64_tr_b16 v[152:153], v160 offset:34112
ds_read_b64_tr_b16 v[154:155], v160 offset:34624
v_mfma_f32_16x16x32_bf16 v[4:7], a[128:131], v[132:135], v[4:7]
buffer_store_dwordx4 v[200:203], v252, s[56:59], s97 offen offset:0 sc1
v_mfma_f32_16x16x32_bf16 v[36:39], a[132:135], v[132:135], v[36:39]
s_waitcnt lgkmcnt(8)
ds_read_b64_tr_b16 v[156:157], v160 offset:34144
ds_read_b64_tr_b16 v[158:159], v160 offset:34656
v_mfma_f32_16x16x32_bf16 v[8:11], a[128:131], v[136:139], v[8:11]
v_cvt_pk_bf16_f32 v204, v84, v85
v_mfma_f32_16x16x32_bf16 v[40:43], a[132:135], v[136:139], v[40:43]
s_waitcnt lgkmcnt(8)
ds_read_b64_tr_b16 v[128:129], v160 offset:35072
ds_read_b64_tr_b16 v[130:131], v160 offset:35584
v_mfma_f32_16x16x32_bf16 v[12:15], a[128:131], v[140:143], v[12:15]
v_cvt_pk_bf16_f32 v205, v86, v87
v_cvt_pk_bf16_f32 v206, v116, v117
v_mfma_f32_16x16x32_bf16 v[44:47], a[132:135], v[140:143], v[44:47]
s_waitcnt lgkmcnt(8)
ds_read_b64_tr_b16 v[132:133], v160 offset:35104
ds_read_b64_tr_b16 v[134:135], v160 offset:35616
v_mfma_f32_16x16x32_bf16 v[0:3], a[136:139], v[144:147], v[0:3]
v_cvt_pk_bf16_f32 v207, v118, v119
v_mfma_f32_16x16x32_bf16 v[32:35], a[140:143], v[144:147], v[32:35]
s_waitcnt lgkmcnt(8)
ds_read_b64_tr_b16 v[136:137], v160 offset:35136
ds_read_b64_tr_b16 v[138:139], v160 offset:35648
v_mfma_f32_16x16x32_bf16 v[4:7], a[136:139], v[148:151], v[4:7]
buffer_store_dwordx4 v[204:207], v252, s[56:59], s97 offen offset:2048 sc1
v_mfma_f32_16x16x32_bf16 v[36:39], a[140:143], v[148:151], v[36:39]
s_waitcnt lgkmcnt(8)
ds_read_b64_tr_b16 v[140:141], v160 offset:35168
ds_read_b64_tr_b16 v[142:143], v160 offset:35680
v_mfma_f32_16x16x32_bf16 v[8:11], a[136:139], v[152:155], v[8:11]
s_add_u32 s97, s97, 4096
v_cvt_pk_bf16_f32 v208, v88, v89
v_mfma_f32_16x16x32_bf16 v[40:43], a[140:143], v[152:155], v[40:43]
s_waitcnt lgkmcnt(8)
ds_read_b64_tr_b16 v[144:145], v160 offset:36096
ds_read_b64_tr_b16 v[146:147], v160 offset:36608
v_mfma_f32_16x16x32_bf16 v[12:15], a[136:139], v[156:159], v[12:15]
v_cvt_pk_bf16_f32 v209, v90, v91
v_cvt_pk_bf16_f32 v210, v120, v121
v_mfma_f32_16x16x32_bf16 v[44:47], a[140:143], v[156:159], v[44:47]
s_waitcnt lgkmcnt(8)
ds_read_b64_tr_b16 v[148:149], v160 offset:36128
ds_read_b64_tr_b16 v[150:151], v160 offset:36640
v_mfma_f32_16x16x32_bf16 v[0:3], a[144:147], v[128:131], v[0:3]
v_cvt_pk_bf16_f32 v211, v122, v123
v_mfma_f32_16x16x32_bf16 v[32:35], a[148:151], v[128:131], v[32:35]
s_waitcnt lgkmcnt(8)
ds_read_b64_tr_b16 v[152:153], v160 offset:36160
ds_read_b64_tr_b16 v[154:155], v160 offset:36672
v_mfma_f32_16x16x32_bf16 v[4:7], a[144:147], v[132:135], v[4:7]
buffer_store_dwordx4 v[208:211], v252, s[56:59], s97 offen offset:0 sc1
v_mfma_f32_16x16x32_bf16 v[36:39], a[148:151], v[132:135], v[36:39]
s_waitcnt lgkmcnt(8)
ds_read_b64_tr_b16 v[156:157], v160 offset:36192
ds_read_b64_tr_b16 v[158:159], v160 offset:36704
v_mfma_f32_16x16x32_bf16 v[8:11], a[144:147], v[136:139], v[8:11]
v_cvt_pk_bf16_f32 v212, v92, v93
v_mfma_f32_16x16x32_bf16 v[40:43], a[148:151], v[136:139], v[40:43]
s_waitcnt lgkmcnt(8)
ds_read_b64_tr_b16 v[128:129], v161 offset:0
ds_read_b64_tr_b16 v[130:131], v161 offset:512
v_mfma_f32_16x16x32_bf16 v[12:15], a[144:147], v[140:143], v[12:15]
v_cvt_pk_bf16_f32 v213, v94, v95
v_cvt_pk_bf16_f32 v214, v124, v125
v_mfma_f32_16x16x32_bf16 v[44:47], a[148:151], v[140:143], v[44:47]
s_waitcnt lgkmcnt(8)
ds_read_b64_tr_b16 v[132:133], v161 offset:32
ds_read_b64_tr_b16 v[134:135], v161 offset:544
v_mfma_f32_16x16x32_bf16 v[0:3], a[152:155], v[144:147], v[0:3]
v_cvt_pk_bf16_f32 v215, v126, v127
v_mfma_f32_16x16x32_bf16 v[32:35], a[156:159], v[144:147], v[32:35]
s_waitcnt lgkmcnt(8)
ds_read_b64_tr_b16 v[136:137], v161 offset:64
ds_read_b64_tr_b16 v[138:139], v161 offset:576
v_mfma_f32_16x16x32_bf16 v[4:7], a[152:155], v[148:151], v[4:7]
buffer_store_dwordx4 v[212:215], v252, s[56:59], s97 offen offset:2048 sc1
v_mfma_f32_16x16x32_bf16 v[36:39], a[156:159], v[148:151], v[36:39]
s_waitcnt lgkmcnt(8)
ds_read_b64_tr_b16 v[140:141], v161 offset:96
ds_read_b64_tr_b16 v[142:143], v161 offset:608
v_mfma_f32_16x16x32_bf16 v[8:11], a[152:155], v[152:155], v[8:11]
s_add_u32 s97, s97, 4096
v_mfma_f32_16x16x32_bf16 v[40:43], a[156:159], v[152:155], v[40:43]
s_waitcnt lgkmcnt(8)
ds_read_b64_tr_b16 v[144:145], v161 offset:1024
ds_read_b64_tr_b16 v[146:147], v161 offset:1536
v_mfma_f32_16x16x32_bf16 v[12:15], a[152:155], v[156:159], v[12:15]
v_mfma_f32_16x16x32_bf16 v[44:47], a[156:159], v[156:159], v[44:47]
s_waitcnt lgkmcnt(8)
ds_read_b64_tr_b16 v[148:149], v161 offset:1056
ds_read_b64_tr_b16 v[150:151], v161 offset:1568
v_mfma_f32_16x16x32_bf16 v[0:3], a[160:163], v[128:131], v[0:3]
v_mfma_f32_16x16x32_bf16 v[32:35], a[164:167], v[128:131], v[32:35]
s_waitcnt lgkmcnt(8)
ds_read_b64_tr_b16 v[152:153], v161 offset:1088
ds_read_b64_tr_b16 v[154:155], v161 offset:1600
v_mfma_f32_16x16x32_bf16 v[4:7], a[160:163], v[132:135], v[4:7]
s_waitcnt vmcnt(6)
v_cmp_eq_u32 vcc, 0, v255
s_cbranch_vccnz standalone__weight_only_int_quip__prompt_kernel_h4a_spin
standalone__weight_only_int_quip__prompt_kernel_h4a_ok:
v_mfma_f32_16x16x32_bf16 v[36:39], a[164:167], v[132:135], v[36:39]
s_waitcnt lgkmcnt(8)
ds_read_b64_tr_b16 v[156:157], v161 offset:1120
ds_read_b64_tr_b16 v[158:159], v161 offset:1632
v_mfma_f32_16x16x32_bf16 v[8:11], a[160:163], v[136:139], v[8:11]
v_mfma_f32_16x16x32_bf16 v[40:43], a[164:167], v[136:139], v[40:43]
s_waitcnt lgkmcnt(8)
ds_read_b64_tr_b16 v[128:129], v161 offset:2048
ds_read_b64_tr_b16 v[130:131], v161 offset:2560
v_mfma_f32_16x16x32_bf16 v[12:15], a[160:163], v[140:143], v[12:15]
buffer_load_dword v251, v248, s[44:47], s55 offen offset:0 sc1
v_mfma_f32_16x16x32_bf16 v[44:47], a[164:167], v[140:143], v[44:47]
s_waitcnt vmcnt(24) lgkmcnt(8)
ds_read_b64_tr_b16 v[132:133], v161 offset:2080
ds_read_b64_tr_b16 v[134:135], v161 offset:2592
v_mfma_f32_16x16x32_bf16 v[0:3], a[168:171], v[144:147], v[0:3]
s_waitcnt vmcnt(23)
s_bfe_u32 s26, s36, 262144
s_mul_i32 s40, s26, 32768
v_mfma_f32_16x16x32_bf16 v[32:35], a[172:175], v[144:147], v[32:35]
s_waitcnt lgkmcnt(8)
ds_read_b64_tr_b16 v[136:137], v161 offset:2112
ds_read_b64_tr_b16 v[138:139], v161 offset:2624
v_mfma_f32_16x16x32_bf16 v[4:7], a[168:171], v[148:151], v[4:7]
buffer_load_dwordx4 a[0:3], v252, s[16:19], s40 offen offset:0 sc1
v_mfma_f32_16x16x32_bf16 v[36:39], a[172:175], v[148:151], v[36:39]
s_waitcnt lgkmcnt(8)
ds_read_b64_tr_b16 v[140:141], v161 offset:2144
ds_read_b64_tr_b16 v[142:143], v161 offset:2656
v_mfma_f32_16x16x32_bf16 v[8:11], a[168:171], v[152:155], v[8:11]
v_mfma_f32_16x16x32_bf16 v[40:43], a[172:175], v[152:155], v[40:43]
s_waitcnt lgkmcnt(8)
ds_read_b64_tr_b16 v[144:145], v161 offset:3072
ds_read_b64_tr_b16 v[146:147], v161 offset:3584
v_mfma_f32_16x16x32_bf16 v[12:15], a[168:171], v[156:159], v[12:15]
buffer_load_dwordx4 a[4:7], v252, s[16:19], s40 offen offset:2048 sc1
v_mfma_f32_16x16x32_bf16 v[44:47], a[172:175], v[156:159], v[44:47]
s_waitcnt vmcnt(24) lgkmcnt(8)
ds_read_b64_tr_b16 v[148:149], v161 offset:3104
ds_read_b64_tr_b16 v[150:151], v161 offset:3616
v_mfma_f32_16x16x32_bf16 v[0:3], a[176:179], v[128:131], v[0:3]
s_waitcnt vmcnt(23)
v_mfma_f32_16x16x32_bf16 v[32:35], a[180:183], v[128:131], v[32:35]
s_waitcnt lgkmcnt(8)
ds_read_b64_tr_b16 v[152:153], v161 offset:3136
ds_read_b64_tr_b16 v[154:155], v161 offset:3648
v_mfma_f32_16x16x32_bf16 v[4:7], a[176:179], v[132:135], v[4:7]
buffer_load_dwordx4 a[8:11], v253, s[16:19], s40 offen offset:0 sc1
v_mfma_f32_16x16x32_bf16 v[36:39], a[180:183], v[132:135], v[36:39]
s_waitcnt lgkmcnt(8)
ds_read_b64_tr_b16 v[156:157], v161 offset:3168
ds_read_b64_tr_b16 v[158:159], v161 offset:3680
v_mfma_f32_16x16x32_bf16 v[8:11], a[176:179], v[136:139], v[8:11]
v_mfma_f32_16x16x32_bf16 v[40:43], a[180:183], v[136:139], v[40:43]
s_waitcnt lgkmcnt(8)
ds_read_b64_tr_b16 v[128:129], v161 offset:33024
ds_read_b64_tr_b16 v[130:131], v161 offset:33536
v_mfma_f32_16x16x32_bf16 v[12:15], a[176:179], v[140:143], v[12:15]
buffer_load_dwordx4 a[12:15], v253, s[16:19], s40 offen offset:2048 sc1
v_mfma_f32_16x16x32_bf16 v[44:47], a[180:183], v[140:143], v[44:47]
s_waitcnt vmcnt(20) lgkmcnt(8)
ds_read_b64_tr_b16 v[132:133], v161 offset:33056
ds_read_b64_tr_b16 v[134:135], v161 offset:33568
v_mfma_f32_16x16x32_bf16 v[0:3], a[184:187], v[144:147], v[0:3]
s_waitcnt vmcnt(19)
s_add_u32 s40, s40, 8192
v_mfma_f32_16x16x32_bf16 v[32:35], a[188:191], v[144:147], v[32:35]
s_waitcnt lgkmcnt(8)
ds_read_b64_tr_b16 v[136:137], v161 offset:33088
ds_read_b64_tr_b16 v[138:139], v161 offset:33600
v_mfma_f32_16x16x32_bf16 v[4:7], a[184:187], v[148:151], v[4:7]
buffer_load_dwordx4 a[16:19], v252, s[16:19], s40 offen offset:0 sc1
v_mfma_f32_16x16x32_bf16 v[36:39], a[188:191], v[148:151], v[36:39]
s_waitcnt lgkmcnt(8)
ds_read_b64_tr_b16 v[140:141], v161 offset:33120
ds_read_b64_tr_b16 v[142:143], v161 offset:33632
v_mfma_f32_16x16x32_bf16 v[8:11], a[184:187], v[152:155], v[8:11]
v_mfma_f32_16x16x32_bf16 v[40:43], a[188:191], v[152:155], v[40:43]
s_waitcnt lgkmcnt(8)
ds_read_b64_tr_b16 v[144:145], v161 offset:34048
ds_read_b64_tr_b16 v[146:147], v161 offset:34560
v_mfma_f32_16x16x32_bf16 v[12:15], a[184:187], v[156:159], v[12:15]
buffer_load_dwordx4 a[20:23], v252, s[16:19], s40 offen offset:2048 sc1
v_mfma_f32_16x16x32_bf16 v[44:47], a[188:191], v[156:159], v[44:47]
s_waitcnt vmcnt(20) lgkmcnt(8)
ds_read_b64_tr_b16 v[148:149], v161 offset:34080
ds_read_b64_tr_b16 v[150:151], v161 offset:34592
v_mfma_f32_16x16x32_bf16 v[0:3], a[192:195], v[128:131], v[0:3]
s_waitcnt vmcnt(19)
v_mfma_f32_16x16x32_bf16 v[32:35], a[196:199], v[128:131], v[32:35]
s_waitcnt lgkmcnt(8)
ds_read_b64_tr_b16 v[152:153], v161 offset:34112
ds_read_b64_tr_b16 v[154:155], v161 offset:34624
v_mfma_f32_16x16x32_bf16 v[4:7], a[192:195], v[132:135], v[4:7]
buffer_load_dwordx4 a[24:27], v253, s[16:19], s40 offen offset:0 sc1
v_mfma_f32_16x16x32_bf16 v[36:39], a[196:199], v[132:135], v[36:39]
s_waitcnt lgkmcnt(8)
ds_read_b64_tr_b16 v[156:157], v161 offset:34144
ds_read_b64_tr_b16 v[158:159], v161 offset:34656
v_mfma_f32_16x16x32_bf16 v[8:11], a[192:195], v[136:139], v[8:11]
v_mfma_f32_16x16x32_bf16 v[40:43], a[196:199], v[136:139], v[40:43]
s_waitcnt lgkmcnt(8)
ds_read_b64_tr_b16 v[128:129], v161 offset:35072
ds_read_b64_tr_b16 v[130:131], v161 offset:35584
v_mfma_f32_16x16x32_bf16 v[12:15], a[192:195], v[140:143], v[12:15]
buffer_load_dwordx4 a[28:31], v253, s[16:19], s40 offen offset:2048 sc1
v_mfma_f32_16x16x32_bf16 v[44:47], a[196:199], v[140:143], v[44:47]
s_waitcnt vmcnt(20) lgkmcnt(8)
ds_read_b64_tr_b16 v[132:133], v161 offset:35104
ds_read_b64_tr_b16 v[134:135], v161 offset:35616
v_mfma_f32_16x16x32_bf16 v[0:3], a[200:203], v[144:147], v[0:3]
s_waitcnt vmcnt(19)
v_mfma_f32_16x16x32_bf16 v[32:35], a[204:207], v[144:147], v[32:35]
s_waitcnt lgkmcnt(8)
ds_read_b64_tr_b16 v[136:137], v161 offset:35136
ds_read_b64_tr_b16 v[138:139], v161 offset:35648
v_mfma_f32_16x16x32_bf16 v[4:7], a[200:203], v[148:151], v[4:7]
s_waitcnt vmcnt(9)
buffer_store_dword v249, v250, s[44:47], s99 offen offset:16 sc1
v_mfma_f32_16x16x32_bf16 v[36:39], a[204:207], v[148:151], v[36:39]
s_waitcnt lgkmcnt(8)
ds_read_b64_tr_b16 v[140:141], v161 offset:35168
ds_read_b64_tr_b16 v[142:143], v161 offset:35680
v_mfma_f32_16x16x32_bf16 v[8:11], a[200:203], v[152:155], v[8:11]
v_mfma_f32_16x16x32_bf16 v[40:43], a[204:207], v[152:155], v[40:43]
s_waitcnt vmcnt(9)
ds_read_b64_tr_b16 v[144:145], v161 offset:36096
ds_read_b64_tr_b16 v[146:147], v161 offset:36608
v_cmp_eq_u32 vcc, 0, v251
s_cbranch_vccnz standalone__weight_only_int_quip__prompt_kernel_h20_spin
standalone__weight_only_int_quip__prompt_kernel_h20_ok:
s_waitcnt lgkmcnt(10)
v_mfma_f32_16x16x32_bf16 v[12:15], a[200:203], v[156:159], v[12:15]
buffer_load_dwordx4 v[64:67], v252, s[56:59], s98 offen offset:0 sc1
v_mfma_f32_16x16x32_bf16 v[44:47], a[204:207], v[156:159], v[44:47]
s_waitcnt vmcnt(20) lgkmcnt(8)
ds_read_b64_tr_b16 v[148:149], v161 offset:36128
ds_read_b64_tr_b16 v[150:151], v161 offset:36640
v_mfma_f32_16x16x32_bf16 v[0:3], a[208:211], v[128:131], v[0:3]
s_waitcnt vmcnt(19)
buffer_load_dwordx4 v[68:71], v252, s[56:59], s98 offen offset:2048 sc1
v_mfma_f32_16x16x32_bf16 v[32:35], a[212:215], v[128:131], v[32:35]
s_waitcnt lgkmcnt(8)
s_add_u32 s98, s98, 4096
ds_read_b64_tr_b16 v[152:153], v161 offset:36160
ds_read_b64_tr_b16 v[154:155], v161 offset:36672
v_mfma_f32_16x16x32_bf16 v[4:7], a[208:211], v[132:135], v[4:7]
buffer_load_dwordx4 v[72:75], v252, s[56:59], s98 offen offset:0 sc1
v_mfma_f32_16x16x32_bf16 v[36:39], a[212:215], v[132:135], v[36:39]
s_waitcnt lgkmcnt(8)
ds_read_b64_tr_b16 v[156:157], v161 offset:36192
ds_read_b64_tr_b16 v[158:159], v161 offset:36704
v_mfma_f32_16x16x32_bf16 v[8:11], a[208:211], v[136:139], v[8:11]
buffer_load_dwordx4 v[76:79], v252, s[56:59], s98 offen offset:2048 sc1
v_mfma_f32_16x16x32_bf16 v[40:43], a[212:215], v[136:139], v[40:43]
s_waitcnt lgkmcnt(8)
s_add_u32 s98, s98, 4096
ds_read_b64_tr_b16 v[128:129], v160 offset:49536
ds_read_b64_tr_b16 v[130:131], v160 offset:50048
v_mfma_f32_16x16x32_bf16 v[12:15], a[208:211], v[140:143], v[12:15]
s_add_u32 s40, s40, 8192
buffer_load_dwordx4 a[32:35], v252, s[16:19], s40 offen offset:0 sc1
v_mfma_f32_16x16x32_bf16 v[44:47], a[212:215], v[140:143], v[44:47]
s_waitcnt vmcnt(22) lgkmcnt(8)
ds_read_b64_tr_b16 v[132:133], v160 offset:49568
ds_read_b64_tr_b16 v[134:135], v160 offset:50080
v_mfma_f32_16x16x32_bf16 v[0:3], a[216:219], v[144:147], v[0:3]
s_waitcnt vmcnt(19)
v_mfma_f32_16x16x32_bf16 v[32:35], a[220:223], v[144:147], v[32:35]
s_waitcnt lgkmcnt(8)
ds_read_b64_tr_b16 v[136:137], v160 offset:49600
ds_read_b64_tr_b16 v[138:139], v160 offset:50112
v_mfma_f32_16x16x32_bf16 v[4:7], a[216:219], v[148:151], v[4:7]
buffer_load_dwordx4 a[36:39], v252, s[16:19], s40 offen offset:2048 sc1
v_mfma_f32_16x16x32_bf16 v[36:39], a[220:223], v[148:151], v[36:39]
s_waitcnt lgkmcnt(8)
ds_read_b64_tr_b16 v[140:141], v160 offset:49632
ds_read_b64_tr_b16 v[142:143], v160 offset:50144
v_mfma_f32_16x16x32_bf16 v[8:11], a[216:219], v[152:155], v[8:11]
v_mfma_f32_16x16x32_bf16 v[40:43], a[220:223], v[152:155], v[40:43]
s_waitcnt lgkmcnt(8)
ds_read_b64_tr_b16 v[144:145], v160 offset:50560
ds_read_b64_tr_b16 v[146:147], v160 offset:51072
v_mfma_f32_16x16x32_bf16 v[12:15], a[216:219], v[156:159], v[12:15]
buffer_load_dwordx4 a[40:43], v253, s[16:19], s40 offen offset:0 sc1
v_mfma_f32_16x16x32_bf16 v[44:47], a[220:223], v[156:159], v[44:47]
s_waitcnt lgkmcnt(8)
ds_read_b64_tr_b16 v[148:149], v160 offset:50592
ds_read_b64_tr_b16 v[150:151], v160 offset:51104
v_mfma_f32_16x16x32_bf16 v[16:19], a[128:131], v[128:131], v[16:19]
v_mfma_f32_16x16x32_bf16 v[48:51], a[132:135], v[128:131], v[48:51]
s_waitcnt lgkmcnt(8)
ds_read_b64_tr_b16 v[152:153], v160 offset:50624
ds_read_b64_tr_b16 v[154:155], v160 offset:51136
v_mfma_f32_16x16x32_bf16 v[20:23], a[128:131], v[132:135], v[20:23]
buffer_load_dwordx4 a[44:47], v253, s[16:19], s40 offen offset:2048 sc1
v_mfma_f32_16x16x32_bf16 v[52:55], a[132:135], v[132:135], v[52:55]
s_waitcnt lgkmcnt(8)
ds_read_b64_tr_b16 v[156:157], v160 offset:50656
ds_read_b64_tr_b16 v[158:159], v160 offset:51168
v_mfma_f32_16x16x32_bf16 v[24:27], a[128:131], v[136:139], v[24:27]
v_mfma_f32_16x16x32_bf16 v[56:59], a[132:135], v[136:139], v[56:59]
s_waitcnt lgkmcnt(8)
ds_read_b64_tr_b16 v[128:129], v160 offset:51584
ds_read_b64_tr_b16 v[130:131], v160 offset:52096
v_mfma_f32_16x16x32_bf16 v[28:31], a[128:131], v[140:143], v[28:31]
buffer_load_dword v251, v248, s[44:47], s55 offen offset:16 sc1
v_mfma_f32_16x16x32_bf16 v[60:63], a[132:135], v[140:143], v[60:63]
s_waitcnt lgkmcnt(8)
ds_read_b64_tr_b16 v[132:133], v160 offset:51616
ds_read_b64_tr_b16 v[134:135], v160 offset:52128
v_mfma_f32_16x16x32_bf16 v[16:19], a[136:139], v[144:147], v[16:19]
s_add_u32 s40, s40, 8192
v_mfma_f32_16x16x32_bf16 v[48:51], a[140:143], v[144:147], v[48:51]
s_waitcnt lgkmcnt(8)
ds_read_b64_tr_b16 v[136:137], v160 offset:51648
ds_read_b64_tr_b16 v[138:139], v160 offset:52160
v_mfma_f32_16x16x32_bf16 v[20:23], a[136:139], v[148:151], v[20:23]
buffer_load_dwordx4 a[48:51], v252, s[16:19], s40 offen offset:0 sc1
v_mfma_f32_16x16x32_bf16 v[52:55], a[140:143], v[148:151], v[52:55]
s_waitcnt lgkmcnt(8)
ds_read_b64_tr_b16 v[140:141], v160 offset:51680
ds_read_b64_tr_b16 v[142:143], v160 offset:52192
v_mfma_f32_16x16x32_bf16 v[24:27], a[136:139], v[152:155], v[24:27]
v_mfma_f32_16x16x32_bf16 v[56:59], a[140:143], v[152:155], v[56:59]
s_waitcnt lgkmcnt(8)
ds_read_b64_tr_b16 v[144:145], v160 offset:52608
ds_read_b64_tr_b16 v[146:147], v160 offset:53120
v_mfma_f32_16x16x32_bf16 v[28:31], a[136:139], v[156:159], v[28:31]
buffer_load_dwordx4 a[52:55], v252, s[16:19], s40 offen offset:2048 sc1
v_mfma_f32_16x16x32_bf16 v[60:63], a[140:143], v[156:159], v[60:63]
s_waitcnt lgkmcnt(8)
ds_read_b64_tr_b16 v[148:149], v160 offset:52640
ds_read_b64_tr_b16 v[150:151], v160 offset:53152
v_mfma_f32_16x16x32_bf16 v[16:19], a[144:147], v[128:131], v[16:19]
v_mfma_f32_16x16x32_bf16 v[48:51], a[148:151], v[128:131], v[48:51]
s_waitcnt lgkmcnt(8)
ds_read_b64_tr_b16 v[152:153], v160 offset:52672
ds_read_b64_tr_b16 v[154:155], v160 offset:53184
v_mfma_f32_16x16x32_bf16 v[20:23], a[144:147], v[132:135], v[20:23]
buffer_load_dwordx4 a[56:59], v253, s[16:19], s40 offen offset:0 sc1
v_mfma_f32_16x16x32_bf16 v[52:55], a[148:151], v[132:135], v[52:55]
s_waitcnt lgkmcnt(8)
ds_read_b64_tr_b16 v[156:157], v160 offset:52704
ds_read_b64_tr_b16 v[158:159], v160 offset:53216
v_mfma_f32_16x16x32_bf16 v[24:27], a[144:147], v[136:139], v[24:27]
v_mfma_f32_16x16x32_bf16 v[56:59], a[148:151], v[136:139], v[56:59]
s_waitcnt lgkmcnt(8)
ds_read_b64_tr_b16 v[128:129], v161 offset:16512
ds_read_b64_tr_b16 v[130:131], v161 offset:17024
v_mfma_f32_16x16x32_bf16 v[28:31], a[144:147], v[140:143], v[28:31]
buffer_load_dwordx4 a[60:63], v253, s[16:19], s40 offen offset:2048 sc1
v_mfma_f32_16x16x32_bf16 v[60:63], a[148:151], v[140:143], v[60:63]
s_waitcnt lgkmcnt(8)
ds_read_b64_tr_b16 v[132:133], v161 offset:16544
ds_read_b64_tr_b16 v[134:135], v161 offset:17056
v_mfma_f32_16x16x32_bf16 v[16:19], a[152:155], v[144:147], v[16:19]
s_bfe_u32 s26, s36, 262148
s_mul_i32 s40, s26, 32768
v_mfma_f32_16x16x32_bf16 v[48:51], a[156:159], v[144:147], v[48:51]
s_waitcnt lgkmcnt(8)
ds_read_b64_tr_b16 v[136:137], v161 offset:16576
ds_read_b64_tr_b16 v[138:139], v161 offset:17088
v_mfma_f32_16x16x32_bf16 v[20:23], a[152:155], v[148:151], v[20:23]
buffer_load_dwordx4 a[64:67], v252, s[16:19], s40 offen offset:0 sc1
v_mfma_f32_16x16x32_bf16 v[52:55], a[156:159], v[148:151], v[52:55]
s_waitcnt lgkmcnt(8)
ds_read_b64_tr_b16 v[140:141], v161 offset:16608
ds_read_b64_tr_b16 v[142:143], v161 offset:17120
v_mfma_f32_16x16x32_bf16 v[24:27], a[152:155], v[152:155], v[24:27]
v_mfma_f32_16x16x32_bf16 v[56:59], a[156:159], v[152:155], v[56:59]
s_waitcnt lgkmcnt(8)
ds_read_b64_tr_b16 v[144:145], v161 offset:17536
ds_read_b64_tr_b16 v[146:147], v161 offset:18048
v_mfma_f32_16x16x32_bf16 v[28:31], a[152:155], v[156:159], v[28:31]
buffer_load_dwordx4 a[68:71], v252, s[16:19], s40 offen offset:2048 sc1
v_mfma_f32_16x16x32_bf16 v[60:63], a[156:159], v[156:159], v[60:63]
s_waitcnt lgkmcnt(8)
ds_read_b64_tr_b16 v[148:149], v161 offset:17568
ds_read_b64_tr_b16 v[150:151], v161 offset:18080
v_mfma_f32_16x16x32_bf16 v[16:19], a[160:163], v[128:131], v[16:19]
v_mfma_f32_16x16x32_bf16 v[48:51], a[164:167], v[128:131], v[48:51]
s_waitcnt lgkmcnt(8)
ds_read_b64_tr_b16 v[152:153], v161 offset:17600
ds_read_b64_tr_b16 v[154:155], v161 offset:18112
v_mfma_f32_16x16x32_bf16 v[20:23], a[160:163], v[132:135], v[20:23]
buffer_load_dwordx4 a[72:75], v253, s[16:19], s40 offen offset:0 sc1
v_mfma_f32_16x16x32_bf16 v[52:55], a[164:167], v[132:135], v[52:55]
s_waitcnt lgkmcnt(8)
ds_read_b64_tr_b16 v[156:157], v161 offset:17632
ds_read_b64_tr_b16 v[158:159], v161 offset:18144
v_mfma_f32_16x16x32_bf16 v[24:27], a[160:163], v[136:139], v[24:27]
v_mfma_f32_16x16x32_bf16 v[56:59], a[164:167], v[136:139], v[56:59]
s_waitcnt lgkmcnt(8)
ds_read_b64_tr_b16 v[128:129], v161 offset:18560
ds_read_b64_tr_b16 v[130:131], v161 offset:19072
v_mfma_f32_16x16x32_bf16 v[28:31], a[160:163], v[140:143], v[28:31]
buffer_load_dwordx4 a[76:79], v253, s[16:19], s40 offen offset:2048 sc1
v_mfma_f32_16x16x32_bf16 v[60:63], a[164:167], v[140:143], v[60:63]
s_waitcnt lgkmcnt(8)
ds_read_b64_tr_b16 v[132:133], v161 offset:18592
ds_read_b64_tr_b16 v[134:135], v161 offset:19104
v_mfma_f32_16x16x32_bf16 v[16:19], a[168:171], v[144:147], v[16:19]
v_mfma_f32_16x16x32_bf16 v[48:51], a[172:175], v[144:147], v[48:51]
s_waitcnt lgkmcnt(8)
ds_read_b64_tr_b16 v[136:137], v161 offset:18624
ds_read_b64_tr_b16 v[138:139], v161 offset:19136
v_mfma_f32_16x16x32_bf16 v[20:23], a[168:171], v[148:151], v[20:23]
v_mfma_f32_16x16x32_bf16 v[52:55], a[172:175], v[148:151], v[52:55]
s_waitcnt lgkmcnt(8)
ds_read_b64_tr_b16 v[140:141], v161 offset:18656
ds_read_b64_tr_b16 v[142:143], v161 offset:19168
v_mfma_f32_16x16x32_bf16 v[24:27], a[168:171], v[152:155], v[24:27]
v_mfma_f32_16x16x32_bf16 v[56:59], a[172:175], v[152:155], v[56:59]
s_waitcnt vmcnt(16)
ds_read_b64_tr_b16 v[144:145], v161 offset:19584
ds_read_b64_tr_b16 v[146:147], v161 offset:20096
v_mfma_f32_16x16x32_bf16 v[0:3], v[170:173], v[64:67], v[0:3]
v_mfma_f32_16x16x32_bf16 v[32:35], v[168:171], v[64:67], v[32:35]
s_waitcnt lgkmcnt(10)
v_mfma_f32_16x16x32_bf16 v[28:31], a[168:171], v[156:159], v[28:31]
v_mfma_f32_16x16x32_bf16 v[60:63], a[172:175], v[156:159], v[60:63]
s_waitcnt vmcnt(15)
ds_read_b64_tr_b16 v[148:149], v161 offset:19616
ds_read_b64_tr_b16 v[150:151], v161 offset:20128
v_mfma_f32_16x16x32_bf16 v[4:7], v[170:173], v[68:71], v[4:7]
v_mfma_f32_16x16x32_bf16 v[36:39], v[168:171], v[68:71], v[36:39]
s_waitcnt lgkmcnt(10)
v_mfma_f32_16x16x32_bf16 v[16:19], a[176:179], v[128:131], v[16:19]
v_mfma_f32_16x16x32_bf16 v[48:51], a[180:183], v[128:131], v[48:51]
s_waitcnt vmcnt(14)
ds_read_b64_tr_b16 v[152:153], v161 offset:19648
ds_read_b64_tr_b16 v[154:155], v161 offset:20160
v_mfma_f32_16x16x32_bf16 v[8:11], v[170:173], v[72:75], v[8:11]
v_mfma_f32_16x16x32_bf16 v[40:43], v[168:171], v[72:75], v[40:43]
s_waitcnt vmcnt(8)
v_cmp_eq_u32 vcc, 0, v251
s_cbranch_vccnz standalone__weight_only_int_quip__prompt_kernel_h21_spin
standalone__weight_only_int_quip__prompt_kernel_h21_ok:
s_waitcnt lgkmcnt(10)
v_mfma_f32_16x16x32_bf16 v[20:23], a[176:179], v[132:135], v[20:23]
buffer_load_dwordx4 v[80:83], v252, s[56:59], s98 offen offset:0 sc1
v_mfma_f32_16x16x32_bf16 v[52:55], a[180:183], v[132:135], v[52:55]
s_waitcnt vmcnt(14)
ds_read_b64_tr_b16 v[156:157], v161 offset:19680
ds_read_b64_tr_b16 v[158:159], v161 offset:20192
v_mfma_f32_16x16x32_bf16 v[12:15], v[170:173], v[76:79], v[12:15]
v_mfma_f32_16x16x32_bf16 v[44:47], v[168:171], v[76:79], v[44:47]
s_waitcnt lgkmcnt(10)
v_cvt_pk_bf16_f32 v184, v0, v1
v_mfma_f32_16x16x32_bf16 v[24:27], a[176:179], v[136:139], v[24:27]
buffer_load_dwordx4 v[84:87], v252, s[56:59], s98 offen offset:2048 sc1
v_mfma_f32_16x16x32_bf16 v[56:59], a[180:183], v[136:139], v[56:59]
s_waitcnt lgkmcnt(8)
s_add_u32 s98, s98, 4096
ds_read_b64_tr_b16 v[128:129], v161 offset:49536
ds_read_b64_tr_b16 v[130:131], v161 offset:50048
v_cvt_pk_bf16_f32 v185, v2, v3
v_mfma_f32_16x16x32_bf16 v[28:31], a[176:179], v[140:143], v[28:31]
v_cvt_pk_bf16_f32 v186, v32, v33
buffer_load_dwordx4 v[88:91], v252, s[56:59], s98 offen offset:0 sc1
v_mfma_f32_16x16x32_bf16 v[60:63], a[180:183], v[140:143], v[60:63]
s_waitcnt lgkmcnt(8)
ds_read_b64_tr_b16 v[132:133], v161 offset:49568
ds_read_b64_tr_b16 v[134:135], v161 offset:50080
v_cvt_pk_bf16_f32 v187, v34, v35
v_mfma_f32_16x16x32_bf16 v[16:19], a[184:187], v[144:147], v[16:19]
v_cvt_pk_bf16_f32 v188, v4, v5
buffer_load_dwordx4 v[92:95], v252, s[56:59], s98 offen offset:2048 sc1
v_mfma_f32_16x16x32_bf16 v[48:51], a[188:191], v[144:147], v[48:51]
s_waitcnt lgkmcnt(8)
s_add_u32 s98, s98, 4096
ds_read_b64_tr_b16 v[136:137], v161 offset:49600
ds_read_b64_tr_b16 v[138:139], v161 offset:50112
v_cvt_pk_bf16_f32 v189, v6, v7
v_mfma_f32_16x16x32_bf16 v[20:23], a[184:187], v[148:151], v[20:23]
buffer_store_dwordx4 v[184:187], v174, s[12:15], s38 offen offset:0 sc1
v_cvt_pk_bf16_f32 v190, v36, v37
v_mfma_f32_16x16x32_bf16 v[52:55], a[188:191], v[148:151], v[52:55]
s_waitcnt lgkmcnt(8)
ds_read_b64_tr_b16 v[140:141], v161 offset:49632
ds_read_b64_tr_b16 v[142:143], v161 offset:50144
v_cvt_pk_bf16_f32 v191, v38, v39
v_mfma_f32_16x16x32_bf16 v[24:27], a[184:187], v[152:155], v[24:27]
ds_write_b128 v232, v[184:187] offset:0
v_cvt_pk_bf16_f32 v192, v8, v9
v_mfma_f32_16x16x32_bf16 v[56:59], a[188:191], v[152:155], v[56:59]
s_waitcnt lgkmcnt(9)
ds_read_b64_tr_b16 v[144:145], v161 offset:50560
ds_read_b64_tr_b16 v[146:147], v161 offset:51072
v_cvt_pk_bf16_f32 v193, v10, v11
v_mfma_f32_16x16x32_bf16 v[28:31], a[184:187], v[156:159], v[28:31]
buffer_store_dwordx4 v[188:191], v175, s[12:15], s38 offen offset:2048 sc1
s_add_u32 s38, s38, 4096
v_cvt_pk_bf16_f32 v194, v40, v41
v_mfma_f32_16x16x32_bf16 v[60:63], a[188:191], v[156:159], v[60:63]
s_waitcnt lgkmcnt(9)
ds_read_b64_tr_b16 v[148:149], v161 offset:50592
ds_read_b64_tr_b16 v[150:151], v161 offset:51104
v_cvt_pk_bf16_f32 v195, v42, v43
v_mfma_f32_16x16x32_bf16 v[16:19], a[192:195], v[128:131], v[16:19]
ds_write_b128 v233, v[188:191] offset:1024
v_cvt_pk_bf16_f32 v196, v12, v13
v_mfma_f32_16x16x32_bf16 v[48:51], a[196:199], v[128:131], v[48:51]
s_waitcnt lgkmcnt(10)
ds_read_b64_tr_b16 v[152:153], v161 offset:50624
ds_read_b64_tr_b16 v[154:155], v161 offset:51136
v_cvt_pk_bf16_f32 v197, v14, v15
v_mfma_f32_16x16x32_bf16 v[20:23], a[192:195], v[132:135], v[20:23]
buffer_store_dwordx4 v[192:195], v176, s[12:15], s38 offen offset:0 sc1
v_cvt_pk_bf16_f32 v198, v44, v45
v_mfma_f32_16x16x32_bf16 v[52:55], a[196:199], v[132:135], v[52:55]
s_waitcnt lgkmcnt(10)
ds_read_b64_tr_b16 v[156:157], v161 offset:50656
ds_read_b64_tr_b16 v[158:159], v161 offset:51168
v_mfma_f32_16x16x32_bf16 v[24:27], a[192:195], v[136:139], v[24:27]
ds_write_b128 v234, v[192:195] offset:2048
v_cvt_pk_bf16_f32 v199, v46, v47
v_mfma_f32_16x16x32_bf16 v[56:59], a[196:199], v[136:139], v[56:59]
s_waitcnt lgkmcnt(11)
ds_read_b64_tr_b16 v[128:129], v161 offset:51584
ds_read_b64_tr_b16 v[130:131], v161 offset:52096
v_mfma_f32_16x16x32_bf16 v[28:31], a[192:195], v[140:143], v[28:31]
buffer_store_dwordx4 v[196:199], v177, s[12:15], s38 offen offset:2048 sc1
v_mfma_f32_16x16x32_bf16 v[60:63], a[196:199], v[140:143], v[60:63]
s_waitcnt lgkmcnt(10)
ds_read_b64_tr_b16 v[132:133], v161 offset:51616
ds_read_b64_tr_b16 v[134:135], v161 offset:52128
v_mfma_f32_16x16x32_bf16 v[16:19], a[200:203], v[144:147], v[16:19]
s_add_u32 s38, s38, 4096
ds_write_b128 v235, v[196:199] offset:3072
v_mfma_f32_16x16x32_bf16 v[48:51], a[204:207], v[144:147], v[48:51]
s_waitcnt lgkmcnt(11)
ds_read_b64_tr_b16 v[136:137], v161 offset:51648
ds_read_b64_tr_b16 v[138:139], v161 offset:52160
v_mfma_f32_16x16x32_bf16 v[20:23], a[200:203], v[148:151], v[20:23]
v_mfma_f32_16x16x32_bf16 v[52:55], a[204:207], v[148:151], v[52:55]
s_waitcnt lgkmcnt(10)
ds_read_b64_tr_b16 v[140:141], v161 offset:51680
ds_read_b64_tr_b16 v[142:143], v161 offset:52192
v_mfma_f32_16x16x32_bf16 v[24:27], a[200:203], v[152:155], v[24:27]
v_mfma_f32_16x16x32_bf16 v[56:59], a[204:207], v[152:155], v[56:59]
s_waitcnt lgkmcnt(10)
ds_read_b64_tr_b16 v[144:145], v161 offset:52608
ds_read_b64_tr_b16 v[146:147], v161 offset:53120
v_mfma_f32_16x16x32_bf16 v[28:31], a[200:203], v[156:159], v[28:31]
v_mfma_f32_16x16x32_bf16 v[60:63], a[204:207], v[156:159], v[60:63]
s_waitcnt lgkmcnt(9)
ds_read_b64_tr_b16 v[148:149], v161 offset:52640
ds_read_b64_tr_b16 v[150:151], v161 offset:53152
v_mfma_f32_16x16x32_bf16 v[16:19], a[208:211], v[128:131], v[16:19]
v_mfma_f32_16x16x32_bf16 v[48:51], a[212:215], v[128:131], v[48:51]
s_waitcnt lgkmcnt(9)
ds_read_b64_tr_b16 v[152:153], v161 offset:52672
ds_read_b64_tr_b16 v[154:155], v161 offset:53184
v_mfma_f32_16x16x32_bf16 v[20:23], a[208:211], v[132:135], v[20:23]
v_mfma_f32_16x16x32_bf16 v[52:55], a[212:215], v[132:135], v[52:55]
s_waitcnt lgkmcnt(8)
ds_read_b64_tr_b16 v[156:157], v161 offset:52704
ds_read_b64_tr_b16 v[158:159], v161 offset:53216
v_mfma_f32_16x16x32_bf16 v[24:27], a[208:211], v[136:139], v[24:27]
v_mfma_f32_16x16x32_bf16 v[56:59], a[212:215], v[136:139], v[56:59]
s_waitcnt lgkmcnt(8)
v_mfma_f32_16x16x32_bf16 v[28:31], a[208:211], v[140:143], v[28:31]
v_mfma_f32_16x16x32_bf16 v[60:63], a[212:215], v[140:143], v[60:63]
s_waitcnt lgkmcnt(6)
v_mfma_f32_16x16x32_bf16 v[16:19], a[216:219], v[144:147], v[16:19]
v_mfma_f32_16x16x32_bf16 v[48:51], a[220:223], v[144:147], v[48:51]
s_waitcnt lgkmcnt(4)
v_mfma_f32_16x16x32_bf16 v[20:23], a[216:219], v[148:151], v[20:23]
v_mfma_f32_16x16x32_bf16 v[52:55], a[220:223], v[148:151], v[52:55]
s_waitcnt lgkmcnt(2)
v_mfma_f32_16x16x32_bf16 v[24:27], a[216:219], v[152:155], v[24:27]
v_mfma_f32_16x16x32_bf16 v[56:59], a[220:223], v[152:155], v[56:59]
s_waitcnt lgkmcnt(0)
v_mfma_f32_16x16x32_bf16 v[28:31], a[216:219], v[156:159], v[28:31]
v_mfma_f32_16x16x32_bf16 v[60:63], a[220:223], v[156:159], v[60:63]
s_load_dwordx2 s[8:9], s[0:1], 48
s_waitcnt vmcnt(7)
v_mfma_f32_16x16x32_bf16 v[16:19], v[170:173], v[80:83], v[16:19]
v_mfma_f32_16x16x32_bf16 v[48:51], v[168:171], v[80:83], v[48:51]
s_waitcnt vmcnt(6)
v_mfma_f32_16x16x32_bf16 v[20:23], v[170:173], v[84:87], v[20:23]
v_mfma_f32_16x16x32_bf16 v[52:55], v[168:171], v[84:87], v[52:55]
s_waitcnt vmcnt(5)
v_mfma_f32_16x16x32_bf16 v[24:27], v[170:173], v[88:91], v[24:27]
v_mfma_f32_16x16x32_bf16 v[56:59], v[168:171], v[88:91], v[56:59]
s_nop 3
s_waitcnt vmcnt(4)
v_cvt_pk_bf16_f32 v200, v16, v17
v_cvt_pk_bf16_f32 v201, v18, v19
v_cvt_pk_bf16_f32 v202, v48, v49
v_cvt_pk_bf16_f32 v203, v50, v51
buffer_store_dwordx4 v[200:203], v178, s[12:15], s38 offen offset:0 sc1
ds_write_b128 v236, v[200:203] offset:4096
v_mfma_f32_16x16x32_bf16 v[28:31], v[170:173], v[92:95], v[28:31]
v_mfma_f32_16x16x32_bf16 v[60:63], v[168:171], v[92:95], v[60:63]
v_cvt_pk_bf16_f32 v204, v20, v21
v_cvt_pk_bf16_f32 v205, v22, v23
v_cvt_pk_bf16_f32 v206, v52, v53
v_cvt_pk_bf16_f32 v207, v54, v55
buffer_store_dwordx4 v[204:207], v179, s[12:15], s38 offen offset:2048 sc1
s_add_u32 s38, s38, 4096
ds_write_b128 v237, v[204:207] offset:5120
s_nop 2
v_cvt_pk_bf16_f32 v208, v24, v25
v_cvt_pk_bf16_f32 v209, v26, v27
v_cvt_pk_bf16_f32 v210, v56, v57
v_cvt_pk_bf16_f32 v211, v58, v59
buffer_store_dwordx4 v[208:211], v180, s[12:15], s38 offen offset:0 sc1
ds_write_b128 v238, v[208:211] offset:6144
s_nop 1
v_cvt_pk_bf16_f32 v212, v28, v29
v_cvt_pk_bf16_f32 v213, v30, v31
v_cvt_pk_bf16_f32 v214, v60, v61
v_cvt_pk_bf16_f32 v215, v62, v63
buffer_store_dwordx4 v[212:215], v181, s[12:15], s38 offen offset:2048 sc1
s_add_u32 s38, s38, 4096
ds_write_b128 v239, v[212:215] offset:7168
s_waitcnt lgkmcnt(0)
s_mov_b32 s10, 14680064
s_mov_b32 s11, 0x20000
s_barrier
ds_read_b128 v[128:131], v224 offset:0
ds_read_b128 v[132:135], v225 offset:0
ds_read_b128 v[136:139], v226 offset:0
s_waitcnt lgkmcnt(2)
v_mfma_f32_16x16x32_bf16 v[0:3], a[0:3], v[128:131], 0
ds_read_b128 v[140:143], v227 offset:0
v_mfma_f32_16x16x32_bf16 v[32:35], a[4:7], v[128:131], 0
s_add_u32 s40, s40, 8192
v_mfma_f32_16x16x32_bf16 v[64:67], a[8:11], v[128:131], 0
buffer_load_dwordx4 a[80:83], v252, s[16:19], s40 offen offset:0 sc1
v_mfma_f32_16x16x32_bf16 v[96:99], a[12:15], v[128:131], 0
s_waitcnt lgkmcnt(2)
v_mfma_f32_16x16x32_bf16 v[4:7], a[0:3], v[132:135], 0
ds_read_b128 v[144:147], v228 offset:0
v_mfma_f32_16x16x32_bf16 v[36:39], a[4:7], v[132:135], 0
v_mfma_f32_16x16x32_bf16 v[68:71], a[8:11], v[132:135], 0
buffer_load_dwordx4 a[84:87], v252, s[16:19], s40 offen offset:2048 sc1
v_mfma_f32_16x16x32_bf16 v[100:103], a[12:15], v[132:135], 0
s_waitcnt lgkmcnt(2)
v_mfma_f32_16x16x32_bf16 v[8:11], a[0:3], v[136:139], 0
ds_read_b128 v[148:151], v229 offset:0
v_mfma_f32_16x16x32_bf16 v[40:43], a[4:7], v[136:139], 0
v_mfma_f32_16x16x32_bf16 v[72:75], a[8:11], v[136:139], 0
buffer_load_dwordx4 a[88:91], v253, s[16:19], s40 offen offset:0 sc1
v_mfma_f32_16x16x32_bf16 v[104:107], a[12:15], v[136:139], 0
s_waitcnt lgkmcnt(2)
v_mfma_f32_16x16x32_bf16 v[12:15], a[0:3], v[140:143], 0
ds_read_b128 v[152:155], v230 offset:0
v_mfma_f32_16x16x32_bf16 v[44:47], a[4:7], v[140:143], 0
v_mfma_f32_16x16x32_bf16 v[76:79], a[8:11], v[140:143], 0
buffer_load_dwordx4 a[92:95], v253, s[16:19], s40 offen offset:2048 sc1
v_mfma_f32_16x16x32_bf16 v[108:111], a[12:15], v[140:143], 0
s_waitcnt lgkmcnt(2)
v_mfma_f32_16x16x32_bf16 v[16:19], a[0:3], v[144:147], 0
ds_read_b128 v[156:159], v231 offset:0
v_mfma_f32_16x16x32_bf16 v[48:51], a[4:7], v[144:147], 0
s_add_u32 s40, s40, 8192
v_mfma_f32_16x16x32_bf16 v[80:83], a[8:11], v[144:147], 0
buffer_load_dwordx4 a[96:99], v252, s[16:19], s40 offen offset:0 sc1
v_mfma_f32_16x16x32_bf16 v[112:115], a[12:15], v[144:147], 0
s_waitcnt lgkmcnt(2)
v_mfma_f32_16x16x32_bf16 v[20:23], a[0:3], v[148:151], 0
ds_read_b128 v[128:131], v224 offset:8192
v_mfma_f32_16x16x32_bf16 v[52:55], a[4:7], v[148:151], 0
v_mfma_f32_16x16x32_bf16 v[84:87], a[8:11], v[148:151], 0
buffer_load_dwordx4 a[100:103], v252, s[16:19], s40 offen offset:2048 sc1
v_mfma_f32_16x16x32_bf16 v[116:119], a[12:15], v[148:151], 0
s_waitcnt lgkmcnt(2)
v_mfma_f32_16x16x32_bf16 v[24:27], a[0:3], v[152:155], 0
ds_read_b128 v[132:135], v225 offset:8192
v_mfma_f32_16x16x32_bf16 v[56:59], a[4:7], v[152:155], 0
v_mfma_f32_16x16x32_bf16 v[88:91], a[8:11], v[152:155], 0
buffer_load_dwordx4 a[104:107], v253, s[16:19], s40 offen offset:0 sc1
v_mfma_f32_16x16x32_bf16 v[120:123], a[12:15], v[152:155], 0
s_waitcnt lgkmcnt(2)
v_mfma_f32_16x16x32_bf16 v[28:31], a[0:3], v[156:159], 0
ds_read_b128 v[136:139], v226 offset:8192
v_mfma_f32_16x16x32_bf16 v[60:63], a[4:7], v[156:159], 0
v_mfma_f32_16x16x32_bf16 v[92:95], a[8:11], v[156:159], 0
buffer_load_dwordx4 a[108:111], v253, s[16:19], s40 offen offset:2048 sc1
v_mfma_f32_16x16x32_bf16 v[124:127], a[12:15], v[156:159], 0
s_waitcnt lgkmcnt(2)
v_mfma_f32_16x16x32_bf16 v[0:3], a[16:19], v[128:131], v[0:3]
ds_read_b128 v[140:143], v227 offset:8192
v_mfma_f32_16x16x32_bf16 v[32:35], a[20:23], v[128:131], v[32:35]
v_mfma_f32_16x16x32_bf16 v[64:67], a[24:27], v[128:131], v[64:67]
s_waitcnt vmcnt(8)
buffer_store_dword v249, v250, s[44:47], s62 offen sc1
v_mfma_f32_16x16x32_bf16 v[96:99], a[28:31], v[128:131], v[96:99]
s_waitcnt lgkmcnt(2)
v_mfma_f32_16x16x32_bf16 v[4:7], a[16:19], v[132:135], v[4:7]
ds_read_b128 v[144:147], v228 offset:8192
v_mfma_f32_16x16x32_bf16 v[36:39], a[20:23], v[132:135], v[36:39]
v_mfma_f32_16x16x32_bf16 v[68:71], a[24:27], v[132:135], v[68:71]
v_mfma_f32_16x16x32_bf16 v[100:103], a[28:31], v[132:135], v[100:103]
s_waitcnt lgkmcnt(2)
v_mfma_f32_16x16x32_bf16 v[8:11], a[16:19], v[136:139], v[8:11]
ds_read_b128 v[148:151], v229 offset:8192
v_mfma_f32_16x16x32_bf16 v[40:43], a[20:23], v[136:139], v[40:43]
v_mfma_f32_16x16x32_bf16 v[72:75], a[24:27], v[136:139], v[72:75]
v_mfma_f32_16x16x32_bf16 v[104:107], a[28:31], v[136:139], v[104:107]
s_waitcnt lgkmcnt(2)
v_mfma_f32_16x16x32_bf16 v[12:15], a[16:19], v[140:143], v[12:15]
ds_read_b128 v[152:155], v230 offset:8192
v_mfma_f32_16x16x32_bf16 v[44:47], a[20:23], v[140:143], v[44:47]
v_mfma_f32_16x16x32_bf16 v[76:79], a[24:27], v[140:143], v[76:79]
v_mfma_f32_16x16x32_bf16 v[108:111], a[28:31], v[140:143], v[108:111]
s_waitcnt lgkmcnt(2)
v_mfma_f32_16x16x32_bf16 v[16:19], a[16:19], v[144:147], v[16:19]
ds_read_b128 v[156:159], v231 offset:8192
v_mfma_f32_16x16x32_bf16 v[48:51], a[20:23], v[144:147], v[48:51]
v_mfma_f32_16x16x32_bf16 v[80:83], a[24:27], v[144:147], v[80:83]
v_mfma_f32_16x16x32_bf16 v[112:115], a[28:31], v[144:147], v[112:115]
s_waitcnt lgkmcnt(2)
v_mfma_f32_16x16x32_bf16 v[20:23], a[16:19], v[148:151], v[20:23]
ds_read_b128 v[128:131], v224 offset:16384
v_mfma_f32_16x16x32_bf16 v[52:55], a[20:23], v[148:151], v[52:55]
v_mfma_f32_16x16x32_bf16 v[84:87], a[24:27], v[148:151], v[84:87]
v_mfma_f32_16x16x32_bf16 v[116:119], a[28:31], v[148:151], v[116:119]
s_waitcnt lgkmcnt(2)
v_mfma_f32_16x16x32_bf16 v[24:27], a[16:19], v[152:155], v[24:27]
ds_read_b128 v[132:135], v225 offset:16384
v_mfma_f32_16x16x32_bf16 v[56:59], a[20:23], v[152:155], v[56:59]
v_mfma_f32_16x16x32_bf16 v[88:91], a[24:27], v[152:155], v[88:91]
v_mfma_f32_16x16x32_bf16 v[120:123], a[28:31], v[152:155], v[120:123]
s_waitcnt lgkmcnt(2)
v_mfma_f32_16x16x32_bf16 v[28:31], a[16:19], v[156:159], v[28:31]
ds_read_b128 v[136:139], v226 offset:16384
v_mfma_f32_16x16x32_bf16 v[60:63], a[20:23], v[156:159], v[60:63]
v_mfma_f32_16x16x32_bf16 v[92:95], a[24:27], v[156:159], v[92:95]
v_mfma_f32_16x16x32_bf16 v[124:127], a[28:31], v[156:159], v[124:127]
s_waitcnt lgkmcnt(2)
v_mfma_f32_16x16x32_bf16 v[0:3], a[32:35], v[128:131], v[0:3]
ds_read_b128 v[140:143], v227 offset:16384
v_mfma_f32_16x16x32_bf16 v[32:35], a[36:39], v[128:131], v[32:35]
v_mfma_f32_16x16x32_bf16 v[64:67], a[40:43], v[128:131], v[64:67]
v_mfma_f32_16x16x32_bf16 v[96:99], a[44:47], v[128:131], v[96:99]
s_waitcnt lgkmcnt(2)
v_mfma_f32_16x16x32_bf16 v[4:7], a[32:35], v[132:135], v[4:7]
ds_read_b128 v[144:147], v228 offset:16384
v_mfma_f32_16x16x32_bf16 v[36:39], a[36:39], v[132:135], v[36:39]
v_mfma_f32_16x16x32_bf16 v[68:71], a[40:43], v[132:135], v[68:71]
v_mfma_f32_16x16x32_bf16 v[100:103], a[44:47], v[132:135], v[100:103]
s_waitcnt lgkmcnt(2)
v_mfma_f32_16x16x32_bf16 v[8:11], a[32:35], v[136:139], v[8:11]
ds_read_b128 v[148:151], v229 offset:16384
v_mfma_f32_16x16x32_bf16 v[40:43], a[36:39], v[136:139], v[40:43]
v_mfma_f32_16x16x32_bf16 v[72:75], a[40:43], v[136:139], v[72:75]
buffer_load_dword v251, v167, s[44:47], s39 offen sc1
v_mfma_f32_16x16x32_bf16 v[104:107], a[44:47], v[136:139], v[104:107]
s_waitcnt lgkmcnt(2)
v_mfma_f32_16x16x32_bf16 v[12:15], a[32:35], v[140:143], v[12:15]
ds_read_b128 v[152:155], v230 offset:16384
v_mfma_f32_16x16x32_bf16 v[44:47], a[36:39], v[140:143], v[44:47]
v_mfma_f32_16x16x32_bf16 v[76:79], a[40:43], v[140:143], v[76:79]
v_mfma_f32_16x16x32_bf16 v[108:111], a[44:47], v[140:143], v[108:111]
s_waitcnt lgkmcnt(2)
v_mfma_f32_16x16x32_bf16 v[16:19], a[32:35], v[144:147], v[16:19]
ds_read_b128 v[156:159], v231 offset:16384
v_mfma_f32_16x16x32_bf16 v[48:51], a[36:39], v[144:147], v[48:51]
v_mfma_f32_16x16x32_bf16 v[80:83], a[40:43], v[144:147], v[80:83]
v_mfma_f32_16x16x32_bf16 v[112:115], a[44:47], v[144:147], v[112:115]
s_waitcnt lgkmcnt(2)
v_mfma_f32_16x16x32_bf16 v[20:23], a[32:35], v[148:151], v[20:23]
ds_read_b128 v[128:131], v224 offset:24576
v_mfma_f32_16x16x32_bf16 v[52:55], a[36:39], v[148:151], v[52:55]
v_mfma_f32_16x16x32_bf16 v[84:87], a[40:43], v[148:151], v[84:87]
v_mfma_f32_16x16x32_bf16 v[116:119], a[44:47], v[148:151], v[116:119]
s_waitcnt lgkmcnt(2)
v_mfma_f32_16x16x32_bf16 v[24:27], a[32:35], v[152:155], v[24:27]
ds_read_b128 v[132:135], v225 offset:24576
v_mfma_f32_16x16x32_bf16 v[56:59], a[36:39], v[152:155], v[56:59]
v_mfma_f32_16x16x32_bf16 v[88:91], a[40:43], v[152:155], v[88:91]
v_mfma_f32_16x16x32_bf16 v[120:123], a[44:47], v[152:155], v[120:123]
s_waitcnt lgkmcnt(2)
v_mfma_f32_16x16x32_bf16 v[28:31], a[32:35], v[156:159], v[28:31]
s_waitcnt vmcnt(0)
ds_read_b128 v[136:139], v226 offset:24576
v_cmp_eq_u32 vcc, 0, v251
s_cbranch_vccnz standalone__weight_only_int_quip__prompt_kernel_h3a_spin
standalone__weight_only_int_quip__prompt_kernel_h3a_ok:
v_mfma_f32_16x16x32_bf16 v[60:63], a[36:39], v[156:159], v[60:63]
s_bfe_u32 s26, s36, 262148
s_mul_i32 s26, s26, 65536
s_add_u32 s41, s37, s26
s_add_u32 m0, s43, 99072
v_mfma_f32_16x16x32_bf16 v[92:95], a[40:43], v[156:159], v[92:95]
buffer_load_dwordx4 v252, s[12:15], s41 offen offset:0 sc1 lds
v_mfma_f32_16x16x32_bf16 v[124:127], a[44:47], v[156:159], v[124:127]
s_waitcnt vmcnt(30) lgkmcnt(2)
buffer_load_dwordx4 v241, s[12:15], s41 offen offset:1024 sc1 lds
v_mfma_f32_16x16x32_bf16 v[0:3], a[48:51], v[128:131], v[0:3]
s_waitcnt vmcnt(30)
ds_read_b128 v[140:143], v227 offset:24576
v_mfma_f32_16x16x32_bf16 v[32:35], a[52:55], v[128:131], v[32:35]
s_waitcnt vmcnt(29)
s_add_u32 s41, s41, 16384
s_add_u32 m0, s43, 107264
v_mfma_f32_16x16x32_bf16 v[64:67], a[56:59], v[128:131], v[64:67]
s_waitcnt vmcnt(28)
buffer_load_dwordx4 v252, s[12:15], s41 offen offset:0 sc1 lds
v_mfma_f32_16x16x32_bf16 v[96:99], a[60:63], v[128:131], v[96:99]
s_waitcnt lgkmcnt(2)
buffer_load_dwordx4 v241, s[12:15], s41 offen offset:1024 sc1 lds
v_mfma_f32_16x16x32_bf16 v[4:7], a[48:51], v[132:135], v[4:7]
ds_read_b128 v[144:147], v228 offset:24576
v_mfma_f32_16x16x32_bf16 v[36:39], a[52:55], v[132:135], v[36:39]
s_add_u32 s41, s41, 16384
s_add_u32 m0, s43, 115456
v_mfma_f32_16x16x32_bf16 v[68:71], a[56:59], v[132:135], v[68:71]
buffer_load_dwordx4 v252, s[12:15], s41 offen offset:0 sc1 lds
v_mfma_f32_16x16x32_bf16 v[100:103], a[60:63], v[132:135], v[100:103]
s_waitcnt lgkmcnt(2)
v_mfma_f32_16x16x32_bf16 v[8:11], a[48:51], v[136:139], v[8:11]
ds_read_b128 v[148:151], v229 offset:24576
v_mfma_f32_16x16x32_bf16 v[40:43], a[52:55], v[136:139], v[40:43]
v_mfma_f32_16x16x32_bf16 v[72:75], a[56:59], v[136:139], v[72:75]
buffer_load_dwordx4 v241, s[12:15], s41 offen offset:1024 sc1 lds
v_mfma_f32_16x16x32_bf16 v[104:107], a[60:63], v[136:139], v[104:107]
s_waitcnt lgkmcnt(2)
v_mfma_f32_16x16x32_bf16 v[12:15], a[48:51], v[140:143], v[12:15]
ds_read_b128 v[152:155], v230 offset:24576
v_mfma_f32_16x16x32_bf16 v[44:47], a[52:55], v[140:143], v[44:47]
s_add_u32 s41, s41, 16384
s_add_u32 m0, s43, 123648
v_mfma_f32_16x16x32_bf16 v[76:79], a[56:59], v[140:143], v[76:79]
buffer_load_dwordx4 v252, s[12:15], s41 offen offset:0 sc1 lds
v_mfma_f32_16x16x32_bf16 v[108:111], a[60:63], v[140:143], v[108:111]
s_waitcnt lgkmcnt(2)
v_mfma_f32_16x16x32_bf16 v[16:19], a[48:51], v[144:147], v[16:19]
ds_read_b128 v[156:159], v231 offset:24576
v_mfma_f32_16x16x32_bf16 v[48:51], a[52:55], v[144:147], v[48:51]
v_mfma_f32_16x16x32_bf16 v[80:83], a[56:59], v[144:147], v[80:83]
buffer_load_dwordx4 v241, s[12:15], s41 offen offset:1024 sc1 lds
v_mfma_f32_16x16x32_bf16 v[112:115], a[60:63], v[144:147], v[112:115]
s_waitcnt vmcnt(6) lgkmcnt(2)
s_barrier
v_mfma_f32_16x16x32_bf16 v[20:23], a[48:51], v[148:151], v[20:23]
ds_read_b128 v[128:131], v224 offset:33024
v_mfma_f32_16x16x32_bf16 v[52:55], a[52:55], v[148:151], v[52:55]
v_mfma_f32_16x16x32_bf16 v[84:87], a[56:59], v[148:151], v[84:87]
v_mfma_f32_16x16x32_bf16 v[116:119], a[60:63], v[148:151], v[116:119]
s_waitcnt lgkmcnt(2)
v_mfma_f32_16x16x32_bf16 v[24:27], a[48:51], v[152:155], v[24:27]
ds_read_b128 v[132:135], v225 offset:33024
v_mfma_f32_16x16x32_bf16 v[56:59], a[52:55], v[152:155], v[56:59]
s_add_u32 s40, s40, 8192
v_mfma_f32_16x16x32_bf16 v[88:91], a[56:59], v[152:155], v[88:91]
buffer_load_dwordx4 a[112:115], v252, s[16:19], s40 offen offset:0 sc1
v_mfma_f32_16x16x32_bf16 v[120:123], a[60:63], v[152:155], v[120:123]
s_waitcnt lgkmcnt(2)
v_mfma_f32_16x16x32_bf16 v[28:31], a[48:51], v[156:159], v[28:31]
ds_read_b128 v[136:139], v226 offset:33024
v_mfma_f32_16x16x32_bf16 v[60:63], a[52:55], v[156:159], v[60:63]
v_mfma_f32_16x16x32_bf16 v[92:95], a[56:59], v[156:159], v[92:95]
buffer_load_dwordx4 a[116:119], v252, s[16:19], s40 offen offset:2048 sc1
v_mfma_f32_16x16x32_bf16 v[124:127], a[60:63], v[156:159], v[124:127]
s_waitcnt lgkmcnt(2)
v_mfma_f32_16x16x32_bf16 v[0:3], a[64:67], v[128:131], v[0:3]
ds_read_b128 v[140:143], v227 offset:33024
v_mfma_f32_16x16x32_bf16 v[32:35], a[68:71], v[128:131], v[32:35]
v_mfma_f32_16x16x32_bf16 v[64:67], a[72:75], v[128:131], v[64:67]
buffer_load_dwordx4 a[120:123], v253, s[16:19], s40 offen offset:0 sc1
v_mfma_f32_16x16x32_bf16 v[96:99], a[76:79], v[128:131], v[96:99]
s_waitcnt lgkmcnt(2)
v_mfma_f32_16x16x32_bf16 v[4:7], a[64:67], v[132:135], v[4:7]
ds_read_b128 v[144:147], v228 offset:33024
v_mfma_f32_16x16x32_bf16 v[36:39], a[68:71], v[132:135], v[36:39]
v_mfma_f32_16x16x32_bf16 v[68:71], a[72:75], v[132:135], v[68:71]
buffer_load_dwordx4 a[124:127], v253, s[16:19], s40 offen offset:2048 sc1
v_mfma_f32_16x16x32_bf16 v[100:103], a[76:79], v[132:135], v[100:103]
s_waitcnt lgkmcnt(2)
v_mfma_f32_16x16x32_bf16 v[8:11], a[64:67], v[136:139], v[8:11]
ds_read_b128 v[148:151], v229 offset:33024
v_mfma_f32_16x16x32_bf16 v[40:43], a[68:71], v[136:139], v[40:43]
v_mfma_f32_16x16x32_bf16 v[72:75], a[72:75], v[136:139], v[72:75]
buffer_load_dword v251, v242, s[44:47], s39 offen sc1
v_mfma_f32_16x16x32_bf16 v[104:107], a[76:79], v[136:139], v[104:107]
s_waitcnt lgkmcnt(2)
v_mfma_f32_16x16x32_bf16 v[12:15], a[64:67], v[140:143], v[12:15]
ds_read_b128 v[152:155], v230 offset:33024
v_mfma_f32_16x16x32_bf16 v[44:47], a[68:71], v[140:143], v[44:47]
v_mfma_f32_16x16x32_bf16 v[76:79], a[72:75], v[140:143], v[76:79]
v_mfma_f32_16x16x32_bf16 v[108:111], a[76:79], v[140:143], v[108:111]
s_waitcnt lgkmcnt(2)
v_mfma_f32_16x16x32_bf16 v[16:19], a[64:67], v[144:147], v[16:19]
ds_read_b128 v[156:159], v231 offset:33024
v_mfma_f32_16x16x32_bf16 v[48:51], a[68:71], v[144:147], v[48:51]
s_bfe_u32 s26, s36, 262152
s_mul_i32 s40, s26, 32768
v_mfma_f32_16x16x32_bf16 v[80:83], a[72:75], v[144:147], v[80:83]
buffer_load_dwordx4 a[128:131], v252, s[16:19], s40 offen offset:0 sc1
v_mfma_f32_16x16x32_bf16 v[112:115], a[76:79], v[144:147], v[112:115]
s_waitcnt vmcnt(10) lgkmcnt(2)
s_barrier
v_mfma_f32_16x16x32_bf16 v[20:23], a[64:67], v[148:151], v[20:23]
ds_read_b128 v[128:131], v224 offset:41216
v_mfma_f32_16x16x32_bf16 v[52:55], a[68:71], v[148:151], v[52:55]
v_mfma_f32_16x16x32_bf16 v[84:87], a[72:75], v[148:151], v[84:87]
buffer_load_dwordx4 a[132:135], v252, s[16:19], s40 offen offset:2048 sc1
v_mfma_f32_16x16x32_bf16 v[116:119], a[76:79], v[148:151], v[116:119]
s_waitcnt lgkmcnt(2)
v_mfma_f32_16x16x32_bf16 v[24:27], a[64:67], v[152:155], v[24:27]
ds_read_b128 v[132:135], v225 offset:41216
v_mfma_f32_16x16x32_bf16 v[56:59], a[68:71], v[152:155], v[56:59]
v_mfma_f32_16x16x32_bf16 v[88:91], a[72:75], v[152:155], v[88:91]
buffer_load_dwordx4 a[136:139], v253, s[16:19], s40 offen offset:0 sc1
v_mfma_f32_16x16x32_bf16 v[120:123], a[76:79], v[152:155], v[120:123]
s_waitcnt lgkmcnt(2)
v_mfma_f32_16x16x32_bf16 v[28:31], a[64:67], v[156:159], v[28:31]
ds_read_b128 v[136:139], v226 offset:41216
v_mfma_f32_16x16x32_bf16 v[60:63], a[68:71], v[156:159], v[60:63]
v_mfma_f32_16x16x32_bf16 v[92:95], a[72:75], v[156:159], v[92:95]
buffer_load_dwordx4 a[140:143], v253, s[16:19], s40 offen offset:2048 sc1
v_mfma_f32_16x16x32_bf16 v[124:127], a[76:79], v[156:159], v[124:127]
s_waitcnt lgkmcnt(2)
v_mfma_f32_16x16x32_bf16 v[0:3], a[80:83], v[128:131], v[0:3]
ds_read_b128 v[140:143], v227 offset:41216
v_mfma_f32_16x16x32_bf16 v[32:35], a[84:87], v[128:131], v[32:35]
s_add_u32 s40, s40, 8192
v_mfma_f32_16x16x32_bf16 v[64:67], a[88:91], v[128:131], v[64:67]
buffer_load_dwordx4 a[144:147], v252, s[16:19], s40 offen offset:0 sc1
v_mfma_f32_16x16x32_bf16 v[96:99], a[92:95], v[128:131], v[96:99]
s_waitcnt lgkmcnt(2)
v_mfma_f32_16x16x32_bf16 v[4:7], a[80:83], v[132:135], v[4:7]
s_waitcnt vmcnt(5)
ds_read_b128 v[144:147], v228 offset:41216
v_cmp_eq_u32 vcc, 0, v251
s_cbranch_vccnz standalone__weight_only_int_quip__prompt_kernel_h3m_spin
standalone__weight_only_int_quip__prompt_kernel_h3m_ok:
v_mfma_f32_16x16x32_bf16 v[36:39], a[84:87], v[132:135], v[36:39]
v_mfma_f32_16x16x32_bf16 v[68:71], a[88:91], v[132:135], v[68:71]
v_mfma_f32_16x16x32_bf16 v[100:103], a[92:95], v[132:135], v[100:103]
s_waitcnt lgkmcnt(2)
v_mfma_f32_16x16x32_bf16 v[8:11], a[80:83], v[136:139], v[8:11]
s_bfe_u32 s26, s36, 262152
ds_read_b128 v[148:151], v229 offset:41216
v_mfma_f32_16x16x32_bf16 v[40:43], a[84:87], v[136:139], v[40:43]
s_mul_i32 s26, s26, 65536
s_add_u32 s41, s37, s26
s_add_u32 m0, s43, 0
v_mfma_f32_16x16x32_bf16 v[72:75], a[88:91], v[136:139], v[72:75]
buffer_load_dwordx4 v252, s[12:15], s41 offen offset:0 sc1 lds
v_mfma_f32_16x16x32_bf16 v[104:107], a[92:95], v[136:139], v[104:107]
s_waitcnt lgkmcnt(2)
v_mfma_f32_16x16x32_bf16 v[12:15], a[80:83], v[140:143], v[12:15]
ds_read_b128 v[152:155], v230 offset:41216
v_mfma_f32_16x16x32_bf16 v[44:47], a[84:87], v[140:143], v[44:47]
v_mfma_f32_16x16x32_bf16 v[76:79], a[88:91], v[140:143], v[76:79]
buffer_load_dwordx4 v241, s[12:15], s41 offen offset:1024 sc1 lds
v_mfma_f32_16x16x32_bf16 v[108:111], a[92:95], v[140:143], v[108:111]
s_waitcnt lgkmcnt(2)
v_mfma_f32_16x16x32_bf16 v[16:19], a[80:83], v[144:147], v[16:19]
ds_read_b128 v[156:159], v231 offset:41216
v_mfma_f32_16x16x32_bf16 v[48:51], a[84:87], v[144:147], v[48:51]
s_add_u32 s41, s41, 16384
s_add_u32 m0, s43, 8192
v_mfma_f32_16x16x32_bf16 v[80:83], a[88:91], v[144:147], v[80:83]
buffer_load_dwordx4 v252, s[12:15], s41 offen offset:0 sc1 lds
v_mfma_f32_16x16x32_bf16 v[112:115], a[92:95], v[144:147], v[112:115]
s_waitcnt vmcnt(13) lgkmcnt(2)
s_barrier
v_mfma_f32_16x16x32_bf16 v[20:23], a[80:83], v[148:151], v[20:23]
ds_read_b128 v[128:131], v224 offset:49408
v_mfma_f32_16x16x32_bf16 v[52:55], a[84:87], v[148:151], v[52:55]
v_mfma_f32_16x16x32_bf16 v[84:87], a[88:91], v[148:151], v[84:87]
buffer_load_dwordx4 v241, s[12:15], s41 offen offset:1024 sc1 lds
v_mfma_f32_16x16x32_bf16 v[116:119], a[92:95], v[148:151], v[116:119]
s_waitcnt lgkmcnt(2)
v_mfma_f32_16x16x32_bf16 v[24:27], a[80:83], v[152:155], v[24:27]
ds_read_b128 v[132:135], v225 offset:49408
v_mfma_f32_16x16x32_bf16 v[56:59], a[84:87], v[152:155], v[56:59]
s_add_u32 s41, s41, 16384
s_add_u32 m0, s43, 16384
v_mfma_f32_16x16x32_bf16 v[88:91], a[88:91], v[152:155], v[88:91]
buffer_load_dwordx4 v252, s[12:15], s41 offen offset:0 sc1 lds
v_mfma_f32_16x16x32_bf16 v[120:123], a[92:95], v[152:155], v[120:123]
s_waitcnt lgkmcnt(2)
v_mfma_f32_16x16x32_bf16 v[28:31], a[80:83], v[156:159], v[28:31]
ds_read_b128 v[136:139], v226 offset:49408
v_mfma_f32_16x16x32_bf16 v[60:63], a[84:87], v[156:159], v[60:63]
v_mfma_f32_16x16x32_bf16 v[92:95], a[88:91], v[156:159], v[92:95]
v_mfma_f32_16x16x32_bf16 v[124:127], a[92:95], v[156:159], v[124:127]
s_waitcnt lgkmcnt(2)
v_mfma_f32_16x16x32_bf16 v[0:3], a[96:99], v[128:131], v[0:3]
ds_read_b128 v[140:143], v227 offset:49408
v_mfma_f32_16x16x32_bf16 v[32:35], a[100:103], v[128:131], v[32:35]
v_mfma_f32_16x16x32_bf16 v[64:67], a[104:107], v[128:131], v[64:67]
buffer_load_dwordx4 v241, s[12:15], s41 offen offset:1024 sc1 lds
v_mfma_f32_16x16x32_bf16 v[96:99], a[108:111], v[128:131], v[96:99]
s_waitcnt lgkmcnt(2)
v_mfma_f32_16x16x32_bf16 v[4:7], a[96:99], v[132:135], v[4:7]
ds_read_b128 v[144:147], v228 offset:49408
v_mfma_f32_16x16x32_bf16 v[36:39], a[100:103], v[132:135], v[36:39]
s_add_u32 s41, s41, 16384
s_add_u32 m0, s43, 24576
v_mfma_f32_16x16x32_bf16 v[68:71], a[104:107], v[132:135], v[68:71]
buffer_load_dwordx4 v252, s[12:15], s41 offen offset:0 sc1 lds
v_mfma_f32_16x16x32_bf16 v[100:103], a[108:111], v[132:135], v[100:103]
s_waitcnt lgkmcnt(2)
v_mfma_f32_16x16x32_bf16 v[8:11], a[96:99], v[136:139], v[8:11]
ds_read_b128 v[148:151], v229 offset:49408
v_mfma_f32_16x16x32_bf16 v[40:43], a[100:103], v[136:139], v[40:43]
v_mfma_f32_16x16x32_bf16 v[72:75], a[104:107], v[136:139], v[72:75]
buffer_load_dwordx4 v241, s[12:15], s41 offen offset:1024 sc1 lds
v_mfma_f32_16x16x32_bf16 v[104:107], a[108:111], v[136:139], v[104:107]
s_waitcnt lgkmcnt(2)
v_mfma_f32_16x16x32_bf16 v[12:15], a[96:99], v[140:143], v[12:15]
ds_read_b128 v[152:155], v230 offset:49408
v_mfma_f32_16x16x32_bf16 v[44:47], a[100:103], v[140:143], v[44:47]
v_mfma_f32_16x16x32_bf16 v[76:79], a[104:107], v[140:143], v[76:79]
buffer_load_dwordx4 a[148:151], v252, s[16:19], s40 offen offset:2048 sc1
v_mfma_f32_16x16x32_bf16 v[108:111], a[108:111], v[140:143], v[108:111]
s_waitcnt lgkmcnt(2)
v_mfma_f32_16x16x32_bf16 v[16:19], a[96:99], v[144:147], v[16:19]
ds_read_b128 v[156:159], v231 offset:49408
v_mfma_f32_16x16x32_bf16 v[48:51], a[100:103], v[144:147], v[48:51]
v_mfma_f32_16x16x32_bf16 v[80:83], a[104:107], v[144:147], v[80:83]
buffer_load_dwordx4 a[152:155], v253, s[16:19], s40 offen offset:0 sc1
v_mfma_f32_16x16x32_bf16 v[112:115], a[108:111], v[144:147], v[112:115]
s_waitcnt lgkmcnt(2)
v_mfma_f32_16x16x32_bf16 v[20:23], a[96:99], v[148:151], v[20:23]
ds_read_b128 v[128:131], v224 offset:57600
v_mfma_f32_16x16x32_bf16 v[52:55], a[100:103], v[148:151], v[52:55]
v_mfma_f32_16x16x32_bf16 v[84:87], a[104:107], v[148:151], v[84:87]
v_mfma_f32_16x16x32_bf16 v[116:119], a[108:111], v[148:151], v[116:119]
s_waitcnt lgkmcnt(2)
v_mfma_f32_16x16x32_bf16 v[24:27], a[96:99], v[152:155], v[24:27]
ds_read_b128 v[132:135], v225 offset:57600
v_mfma_f32_16x16x32_bf16 v[56:59], a[100:103], v[152:155], v[56:59]
v_mfma_f32_16x16x32_bf16 v[88:91], a[104:107], v[152:155], v[88:91]
buffer_load_dwordx4 a[156:159], v253, s[16:19], s40 offen offset:2048 sc1
v_mfma_f32_16x16x32_bf16 v[120:123], a[108:111], v[152:155], v[120:123]
s_waitcnt lgkmcnt(2)
v_mfma_f32_16x16x32_bf16 v[28:31], a[96:99], v[156:159], v[28:31]
ds_read_b128 v[136:139], v226 offset:57600
v_mfma_f32_16x16x32_bf16 v[60:63], a[100:103], v[156:159], v[60:63]
s_add_u32 s40, s40, 8192
v_mfma_f32_16x16x32_bf16 v[92:95], a[104:107], v[156:159], v[92:95]
buffer_load_dwordx4 a[160:163], v252, s[16:19], s40 offen offset:0 sc1
v_mfma_f32_16x16x32_bf16 v[124:127], a[108:111], v[156:159], v[124:127]
s_waitcnt vmcnt(21) lgkmcnt(2)
v_mfma_f32_16x16x32_bf16 v[0:3], a[112:115], v[128:131], v[0:3]
s_waitcnt vmcnt(20)
ds_read_b128 v[140:143], v227 offset:57600
v_mfma_f32_16x16x32_bf16 v[32:35], a[116:119], v[128:131], v[32:35]
s_waitcnt vmcnt(19)
v_mfma_f32_16x16x32_bf16 v[64:67], a[120:123], v[128:131], v[64:67]
s_waitcnt vmcnt(18)
buffer_load_dwordx4 a[164:167], v252, s[16:19], s40 offen offset:2048 sc1
v_mfma_f32_16x16x32_bf16 v[96:99], a[124:127], v[128:131], v[96:99]
s_waitcnt lgkmcnt(2)
v_mfma_f32_16x16x32_bf16 v[4:7], a[112:115], v[132:135], v[4:7]
ds_read_b128 v[144:147], v228 offset:57600
v_mfma_f32_16x16x32_bf16 v[36:39], a[116:119], v[132:135], v[36:39]
v_mfma_f32_16x16x32_bf16 v[68:71], a[120:123], v[132:135], v[68:71]
buffer_load_dwordx4 a[168:171], v253, s[16:19], s40 offen offset:0 sc1
v_mfma_f32_16x16x32_bf16 v[100:103], a[124:127], v[132:135], v[100:103]
s_waitcnt lgkmcnt(2)
v_mfma_f32_16x16x32_bf16 v[8:11], a[112:115], v[136:139], v[8:11]
ds_read_b128 v[148:151], v229 offset:57600
v_mfma_f32_16x16x32_bf16 v[40:43], a[116:119], v[136:139], v[40:43]
v_mfma_f32_16x16x32_bf16 v[72:75], a[120:123], v[136:139], v[72:75]
buffer_load_dwordx4 a[172:175], v253, s[16:19], s40 offen offset:2048 sc1
v_mfma_f32_16x16x32_bf16 v[104:107], a[124:127], v[136:139], v[104:107]
s_waitcnt lgkmcnt(2)
v_mfma_f32_16x16x32_bf16 v[12:15], a[112:115], v[140:143], v[12:15]
ds_read_b128 v[152:155], v230 offset:57600
v_mfma_f32_16x16x32_bf16 v[44:47], a[116:119], v[140:143], v[44:47]
v_mfma_f32_16x16x32_bf16 v[76:79], a[120:123], v[140:143], v[76:79]
v_mfma_f32_16x16x32_bf16 v[108:111], a[124:127], v[140:143], v[108:111]
s_waitcnt lgkmcnt(2)
v_mfma_f32_16x16x32_bf16 v[16:19], a[112:115], v[144:147], v[16:19]
ds_read_b128 v[156:159], v231 offset:57600
v_mfma_f32_16x16x32_bf16 v[48:51], a[116:119], v[144:147], v[48:51]
s_add_u32 s40, s40, 8192
v_mfma_f32_16x16x32_bf16 v[80:83], a[120:123], v[144:147], v[80:83]
buffer_load_dwordx4 a[176:179], v252, s[16:19], s40 offen offset:0 sc1
v_mfma_f32_16x16x32_bf16 v[112:115], a[124:127], v[144:147], v[112:115]
s_waitcnt vmcnt(8) lgkmcnt(2)
s_barrier
v_mfma_f32_16x16x32_bf16 v[20:23], a[112:115], v[148:151], v[20:23]
ds_read_b128 v[128:131], v216 offset:0
v_mfma_f32_16x16x32_bf16 v[52:55], a[116:119], v[148:151], v[52:55]
v_mfma_f32_16x16x32_bf16 v[84:87], a[120:123], v[148:151], v[84:87]
buffer_load_dwordx4 a[180:183], v252, s[16:19], s40 offen offset:2048 sc1
v_mfma_f32_16x16x32_bf16 v[116:119], a[124:127], v[148:151], v[116:119]
s_waitcnt lgkmcnt(2)
v_mfma_f32_16x16x32_bf16 v[24:27], a[112:115], v[152:155], v[24:27]
ds_read_b128 v[132:135], v217 offset:0
v_mfma_f32_16x16x32_bf16 v[56:59], a[116:119], v[152:155], v[56:59]
v_mfma_f32_16x16x32_bf16 v[88:91], a[120:123], v[152:155], v[88:91]
buffer_load_dwordx4 a[184:187], v253, s[16:19], s40 offen offset:0 sc1
v_mfma_f32_16x16x32_bf16 v[120:123], a[124:127], v[152:155], v[120:123]
s_waitcnt lgkmcnt(2)
v_mfma_f32_16x16x32_bf16 v[28:31], a[112:115], v[156:159], v[28:31]
ds_read_b128 v[136:139], v218 offset:0
v_mfma_f32_16x16x32_bf16 v[60:63], a[116:119], v[156:159], v[60:63]
v_mfma_f32_16x16x32_bf16 v[92:95], a[120:123], v[156:159], v[92:95]
buffer_load_dwordx4 a[188:191], v253, s[16:19], s40 offen offset:2048 sc1
v_mfma_f32_16x16x32_bf16 v[124:127], a[124:127], v[156:159], v[124:127]
s_waitcnt lgkmcnt(2)
v_mfma_f32_16x16x32_bf16 v[0:3], a[128:131], v[128:131], v[0:3]
s_bfe_u32 s26, s36, 262156
ds_read_b128 v[140:143], v219 offset:0
v_mfma_f32_16x16x32_bf16 v[32:35], a[132:135], v[128:131], v[32:35]
s_mul_i32 s26, s26, 65536
s_add_u32 s41, s37, s26
s_add_u32 m0, s43, 33024
v_mfma_f32_16x16x32_bf16 v[64:67], a[136:139], v[128:131], v[64:67]
buffer_load_dwordx4 v252, s[12:15], s41 offen offset:0 sc1 lds
v_mfma_f32_16x16x32_bf16 v[96:99], a[140:143], v[128:131], v[96:99]
s_waitcnt lgkmcnt(2)
v_mfma_f32_16x16x32_bf16 v[4:7], a[128:131], v[132:135], v[4:7]
ds_read_b128 v[144:147], v220 offset:0
v_mfma_f32_16x16x32_bf16 v[36:39], a[132:135], v[132:135], v[36:39]
v_mfma_f32_16x16x32_bf16 v[68:71], a[136:139], v[132:135], v[68:71]
v_mfma_f32_16x16x32_bf16 v[100:103], a[140:143], v[132:135], v[100:103]
s_waitcnt lgkmcnt(2)
v_mfma_f32_16x16x32_bf16 v[8:11], a[128:131], v[136:139], v[8:11]
ds_read_b128 v[148:151], v221 offset:0
v_mfma_f32_16x16x32_bf16 v[40:43], a[132:135], v[136:139], v[40:43]
v_mfma_f32_16x16x32_bf16 v[72:75], a[136:139], v[136:139], v[72:75]
buffer_load_dwordx4 v241, s[12:15], s41 offen offset:1024 sc1 lds
v_mfma_f32_16x16x32_bf16 v[104:107], a[140:143], v[136:139], v[104:107]
s_waitcnt lgkmcnt(2)
v_mfma_f32_16x16x32_bf16 v[12:15], a[128:131], v[140:143], v[12:15]
ds_read_b128 v[152:155], v222 offset:0
v_mfma_f32_16x16x32_bf16 v[44:47], a[132:135], v[140:143], v[44:47]
s_add_u32 s41, s41, 16384
s_add_u32 m0, s43, 41216
v_mfma_f32_16x16x32_bf16 v[76:79], a[136:139], v[140:143], v[76:79]
buffer_load_dwordx4 v252, s[12:15], s41 offen offset:0 sc1 lds
v_mfma_f32_16x16x32_bf16 v[108:111], a[140:143], v[140:143], v[108:111]
s_waitcnt lgkmcnt(2)
v_mfma_f32_16x16x32_bf16 v[16:19], a[128:131], v[144:147], v[16:19]
ds_read_b128 v[156:159], v223 offset:0
v_mfma_f32_16x16x32_bf16 v[48:51], a[132:135], v[144:147], v[48:51]
v_mfma_f32_16x16x32_bf16 v[80:83], a[136:139], v[144:147], v[80:83]
buffer_load_dwordx4 v241, s[12:15], s41 offen offset:1024 sc1 lds
v_mfma_f32_16x16x32_bf16 v[112:115], a[140:143], v[144:147], v[112:115]
s_waitcnt lgkmcnt(2)
v_mfma_f32_16x16x32_bf16 v[20:23], a[128:131], v[148:151], v[20:23]
ds_read_b128 v[128:131], v216 offset:8192
v_mfma_f32_16x16x32_bf16 v[52:55], a[132:135], v[148:151], v[52:55]
s_add_u32 s41, s41, 16384
s_add_u32 m0, s43, 49408
v_mfma_f32_16x16x32_bf16 v[84:87], a[136:139], v[148:151], v[84:87]
buffer_load_dwordx4 v252, s[12:15], s41 offen offset:0 sc1 lds
v_mfma_f32_16x16x32_bf16 v[116:119], a[140:143], v[148:151], v[116:119]
s_waitcnt lgkmcnt(2)
v_mfma_f32_16x16x32_bf16 v[24:27], a[128:131], v[152:155], v[24:27]
ds_read_b128 v[132:135], v217 offset:8192
v_mfma_f32_16x16x32_bf16 v[56:59], a[132:135], v[152:155], v[56:59]
v_mfma_f32_16x16x32_bf16 v[88:91], a[136:139], v[152:155], v[88:91]
buffer_load_dwordx4 v241, s[12:15], s41 offen offset:1024 sc1 lds
v_mfma_f32_16x16x32_bf16 v[120:123], a[140:143], v[152:155], v[120:123]
s_waitcnt lgkmcnt(2)
v_mfma_f32_16x16x32_bf16 v[28:31], a[128:131], v[156:159], v[28:31]
ds_read_b128 v[136:139], v218 offset:8192
v_mfma_f32_16x16x32_bf16 v[60:63], a[132:135], v[156:159], v[60:63]
v_mfma_f32_16x16x32_bf16 v[92:95], a[136:139], v[156:159], v[92:95]
v_mfma_f32_16x16x32_bf16 v[124:127], a[140:143], v[156:159], v[124:127]
s_waitcnt lgkmcnt(2)
v_mfma_f32_16x16x32_bf16 v[0:3], a[144:147], v[128:131], v[0:3]
s_waitcnt vmcnt(16)
ds_read_b128 v[140:143], v219 offset:8192
v_mfma_f32_16x16x32_bf16 v[32:35], a[148:151], v[128:131], v[32:35]
s_waitcnt vmcnt(15)
s_add_u32 s41, s41, 16384
s_add_u32 m0, s43, 57600
v_mfma_f32_16x16x32_bf16 v[64:67], a[152:155], v[128:131], v[64:67]
s_waitcnt vmcnt(14)
buffer_load_dwordx4 v252, s[12:15], s41 offen offset:0 sc1 lds
v_mfma_f32_16x16x32_bf16 v[96:99], a[156:159], v[128:131], v[96:99]
s_waitcnt lgkmcnt(2)
v_mfma_f32_16x16x32_bf16 v[4:7], a[144:147], v[132:135], v[4:7]
ds_read_b128 v[144:147], v220 offset:8192
v_mfma_f32_16x16x32_bf16 v[36:39], a[148:151], v[132:135], v[36:39]
v_mfma_f32_16x16x32_bf16 v[68:71], a[152:155], v[132:135], v[68:71]
buffer_load_dwordx4 v241, s[12:15], s41 offen offset:1024 sc1 lds
v_mfma_f32_16x16x32_bf16 v[100:103], a[156:159], v[132:135], v[100:103]
s_waitcnt lgkmcnt(2)
v_mfma_f32_16x16x32_bf16 v[8:11], a[144:147], v[136:139], v[8:11]
ds_read_b128 v[148:151], v221 offset:8192
v_mfma_f32_16x16x32_bf16 v[40:43], a[148:151], v[136:139], v[40:43]
s_bfe_u32 s26, s36, 262156
s_mul_i32 s40, s26, 32768
v_mfma_f32_16x16x32_bf16 v[72:75], a[152:155], v[136:139], v[72:75]
buffer_load_dwordx4 a[192:195], v252, s[16:19], s40 offen offset:0 sc1
v_mfma_f32_16x16x32_bf16 v[104:107], a[156:159], v[136:139], v[104:107]
s_waitcnt lgkmcnt(2)
v_mfma_f32_16x16x32_bf16 v[12:15], a[144:147], v[140:143], v[12:15]
ds_read_b128 v[152:155], v222 offset:8192
v_mfma_f32_16x16x32_bf16 v[44:47], a[148:151], v[140:143], v[44:47]
v_mfma_f32_16x16x32_bf16 v[76:79], a[152:155], v[140:143], v[76:79]
buffer_load_dwordx4 a[196:199], v252, s[16:19], s40 offen offset:2048 sc1
v_mfma_f32_16x16x32_bf16 v[108:111], a[156:159], v[140:143], v[108:111]
s_waitcnt lgkmcnt(2)
v_mfma_f32_16x16x32_bf16 v[16:19], a[144:147], v[144:147], v[16:19]
ds_read_b128 v[156:159], v223 offset:8192
v_mfma_f32_16x16x32_bf16 v[48:51], a[148:151], v[144:147], v[48:51]
v_mfma_f32_16x16x32_bf16 v[80:83], a[152:155], v[144:147], v[80:83]
buffer_load_dwordx4 a[200:203], v253, s[16:19], s40 offen offset:0 sc1
v_mfma_f32_16x16x32_bf16 v[112:115], a[156:159], v[144:147], v[112:115]
s_waitcnt lgkmcnt(2)
v_mfma_f32_16x16x32_bf16 v[20:23], a[144:147], v[148:151], v[20:23]
ds_read_b128 v[128:131], v216 offset:16384
v_mfma_f32_16x16x32_bf16 v[52:55], a[148:151], v[148:151], v[52:55]
v_mfma_f32_16x16x32_bf16 v[84:87], a[152:155], v[148:151], v[84:87]
v_mfma_f32_16x16x32_bf16 v[116:119], a[156:159], v[148:151], v[116:119]
s_waitcnt lgkmcnt(2)
v_mfma_f32_16x16x32_bf16 v[24:27], a[144:147], v[152:155], v[24:27]
ds_read_b128 v[132:135], v217 offset:16384
v_mfma_f32_16x16x32_bf16 v[56:59], a[148:151], v[152:155], v[56:59]
v_mfma_f32_16x16x32_bf16 v[88:91], a[152:155], v[152:155], v[88:91]
buffer_load_dwordx4 a[204:207], v253, s[16:19], s40 offen offset:2048 sc1
v_mfma_f32_16x16x32_bf16 v[120:123], a[156:159], v[152:155], v[120:123]
s_waitcnt lgkmcnt(2)
v_mfma_f32_16x16x32_bf16 v[28:31], a[144:147], v[156:159], v[28:31]
ds_read_b128 v[136:139], v218 offset:16384
v_mfma_f32_16x16x32_bf16 v[60:63], a[148:151], v[156:159], v[60:63]
s_add_u32 s40, s40, 8192
v_mfma_f32_16x16x32_bf16 v[92:95], a[152:155], v[156:159], v[92:95]
buffer_load_dwordx4 a[208:211], v252, s[16:19], s40 offen offset:0 sc1
v_mfma_f32_16x16x32_bf16 v[124:127], a[156:159], v[156:159], v[124:127]
s_waitcnt vmcnt(20) lgkmcnt(2)
v_mfma_f32_16x16x32_bf16 v[0:3], a[160:163], v[128:131], v[0:3]
s_waitcnt vmcnt(19)
ds_read_b128 v[140:143], v219 offset:16384
v_mfma_f32_16x16x32_bf16 v[32:35], a[164:167], v[128:131], v[32:35]
s_waitcnt vmcnt(18)
v_mfma_f32_16x16x32_bf16 v[64:67], a[168:171], v[128:131], v[64:67]
s_waitcnt vmcnt(17)
buffer_load_dwordx4 a[212:215], v252, s[16:19], s40 offen offset:2048 sc1
v_mfma_f32_16x16x32_bf16 v[96:99], a[172:175], v[128:131], v[96:99]
s_waitcnt lgkmcnt(2)
v_mfma_f32_16x16x32_bf16 v[4:7], a[160:163], v[132:135], v[4:7]
ds_read_b128 v[144:147], v220 offset:16384
v_mfma_f32_16x16x32_bf16 v[36:39], a[164:167], v[132:135], v[36:39]
v_mfma_f32_16x16x32_bf16 v[68:71], a[168:171], v[132:135], v[68:71]
buffer_load_dwordx4 a[216:219], v253, s[16:19], s40 offen offset:0 sc1
v_mfma_f32_16x16x32_bf16 v[100:103], a[172:175], v[132:135], v[100:103]
s_waitcnt lgkmcnt(2)
v_mfma_f32_16x16x32_bf16 v[8:11], a[160:163], v[136:139], v[8:11]
ds_read_b128 v[148:151], v221 offset:16384
v_mfma_f32_16x16x32_bf16 v[40:43], a[164:167], v[136:139], v[40:43]
v_mfma_f32_16x16x32_bf16 v[72:75], a[168:171], v[136:139], v[72:75]
buffer_load_dwordx4 a[220:223], v253, s[16:19], s40 offen offset:2048 sc1
v_mfma_f32_16x16x32_bf16 v[104:107], a[172:175], v[136:139], v[104:107]
s_waitcnt lgkmcnt(2)
v_mfma_f32_16x16x32_bf16 v[12:15], a[160:163], v[140:143], v[12:15]
ds_read_b128 v[152:155], v222 offset:16384
v_mfma_f32_16x16x32_bf16 v[44:47], a[164:167], v[140:143], v[44:47]
v_mfma_f32_16x16x32_bf16 v[76:79], a[168:171], v[140:143], v[76:79]
v_mfma_f32_16x16x32_bf16 v[108:111], a[172:175], v[140:143], v[108:111]
s_waitcnt lgkmcnt(2)
v_mfma_f32_16x16x32_bf16 v[16:19], a[160:163], v[144:147], v[16:19]
ds_read_b128 v[156:159], v223 offset:16384
v_mfma_f32_16x16x32_bf16 v[48:51], a[164:167], v[144:147], v[48:51]
v_mfma_f32_16x16x32_bf16 v[80:83], a[168:171], v[144:147], v[80:83]
buffer_load_dword v251, v166, s[44:47], s39 offen sc1
v_mfma_f32_16x16x32_bf16 v[112:115], a[172:175], v[144:147], v[112:115]
s_waitcnt lgkmcnt(2)
v_mfma_f32_16x16x32_bf16 v[20:23], a[160:163], v[148:151], v[20:23]
ds_read_b128 v[128:131], v216 offset:24576
v_mfma_f32_16x16x32_bf16 v[52:55], a[164:167], v[148:151], v[52:55]
v_mfma_f32_16x16x32_bf16 v[84:87], a[168:171], v[148:151], v[84:87]
buffer_load_dword v255, v182, s[44:47], s61 offen offset:16 sc1
v_mfma_f32_16x16x32_bf16 v[116:119], a[172:175], v[148:151], v[116:119]
s_waitcnt lgkmcnt(2)
v_mfma_f32_16x16x32_bf16 v[24:27], a[160:163], v[152:155], v[24:27]
ds_read_b128 v[132:135], v217 offset:24576
v_mfma_f32_16x16x32_bf16 v[56:59], a[164:167], v[152:155], v[56:59]
s_add_u32 s40, s40, 8192
v_mfma_f32_16x16x32_bf16 v[88:91], a[168:171], v[152:155], v[88:91]
buffer_load_dwordx4 a[224:227], v252, s[16:19], s40 offen offset:0 sc1
v_mfma_f32_16x16x32_bf16 v[120:123], a[172:175], v[152:155], v[120:123]
s_waitcnt lgkmcnt(2)
v_mfma_f32_16x16x32_bf16 v[28:31], a[160:163], v[156:159], v[28:31]
ds_read_b128 v[136:139], v218 offset:24576
v_mfma_f32_16x16x32_bf16 v[60:63], a[164:167], v[156:159], v[60:63]
v_mfma_f32_16x16x32_bf16 v[92:95], a[168:171], v[156:159], v[92:95]
buffer_load_dwordx4 a[228:231], v252, s[16:19], s40 offen offset:2048 sc1
v_mfma_f32_16x16x32_bf16 v[124:127], a[172:175], v[156:159], v[124:127]
s_waitcnt vmcnt(23) lgkmcnt(2)
v_mfma_f32_16x16x32_bf16 v[0:3], a[176:179], v[128:131], v[0:3]
s_waitcnt vmcnt(22)
ds_read_b128 v[140:143], v219 offset:24576
v_mfma_f32_16x16x32_bf16 v[32:35], a[180:183], v[128:131], v[32:35]
s_waitcnt vmcnt(21)
v_mfma_f32_16x16x32_bf16 v[64:67], a[184:187], v[128:131], v[64:67]
s_waitcnt vmcnt(20)
buffer_load_dwordx4 a[232:235], v253, s[16:19], s40 offen offset:0 sc1
v_mfma_f32_16x16x32_bf16 v[96:99], a[188:191], v[128:131], v[96:99]
s_waitcnt lgkmcnt(2)
v_mfma_f32_16x16x32_bf16 v[4:7], a[176:179], v[132:135], v[4:7]
ds_read_b128 v[144:147], v220 offset:24576
v_mfma_f32_16x16x32_bf16 v[36:39], a[180:183], v[132:135], v[36:39]
v_mfma_f32_16x16x32_bf16 v[68:71], a[184:187], v[132:135], v[68:71]
v_mfma_f32_16x16x32_bf16 v[100:103], a[188:191], v[132:135], v[100:103]
s_waitcnt lgkmcnt(2)
v_mfma_f32_16x16x32_bf16 v[8:11], a[176:179], v[136:139], v[8:11]
ds_read_b128 v[148:151], v221 offset:24576
v_mfma_f32_16x16x32_bf16 v[40:43], a[180:183], v[136:139], v[40:43]
v_mfma_f32_16x16x32_bf16 v[72:75], a[184:187], v[136:139], v[72:75]
buffer_load_dwordx4 a[236:239], v253, s[16:19], s40 offen offset:2048 sc1
v_mfma_f32_16x16x32_bf16 v[104:107], a[188:191], v[136:139], v[104:107]
s_waitcnt lgkmcnt(2)
v_mfma_f32_16x16x32_bf16 v[12:15], a[176:179], v[140:143], v[12:15]
ds_read_b128 v[152:155], v222 offset:24576
v_mfma_f32_16x16x32_bf16 v[44:47], a[180:183], v[140:143], v[44:47]
s_add_u32 s40, s40, 8192
v_mfma_f32_16x16x32_bf16 v[76:79], a[184:187], v[140:143], v[76:79]
buffer_load_dwordx4 a[240:243], v252, s[16:19], s40 offen offset:0 sc1
v_mfma_f32_16x16x32_bf16 v[108:111], a[188:191], v[140:143], v[108:111]
s_waitcnt lgkmcnt(2)
v_mfma_f32_16x16x32_bf16 v[16:19], a[176:179], v[144:147], v[16:19]
s_waitcnt vmcnt(5)
ds_read_b128 v[156:159], v223 offset:24576
v_cmp_eq_u32 vcc, 0, v251
s_cbranch_vccnz standalone__weight_only_int_quip__prompt_kernel_h3b_spin
standalone__weight_only_int_quip__prompt_kernel_h3b_ok:
v_cmp_eq_u32 vcc, 0, v255
s_cbranch_vccnz standalone__weight_only_int_quip__prompt_kernel_h4b_spin
standalone__weight_only_int_quip__prompt_kernel_h4b_ok:
v_mfma_f32_16x16x32_bf16 v[48:51], a[180:183], v[144:147], v[48:51]
v_mfma_f32_16x16x32_bf16 v[80:83], a[184:187], v[144:147], v[80:83]
buffer_load_dwordx4 a[244:247], v252, s[16:19], s40 offen offset:2048 sc1
v_mfma_f32_16x16x32_bf16 v[112:115], a[188:191], v[144:147], v[112:115]
s_waitcnt vmcnt(16) lgkmcnt(2)
s_barrier
v_mfma_f32_16x16x32_bf16 v[20:23], a[176:179], v[148:151], v[20:23]
ds_read_b128 v[128:131], v216 offset:33024
v_mfma_f32_16x16x32_bf16 v[52:55], a[180:183], v[148:151], v[52:55]
v_mfma_f32_16x16x32_bf16 v[84:87], a[184:187], v[148:151], v[84:87]
buffer_load_dwordx4 a[248:251], v253, s[16:19], s40 offen offset:0 sc1
v_mfma_f32_16x16x32_bf16 v[116:119], a[188:191], v[148:151], v[116:119]
s_waitcnt lgkmcnt(2)
v_mfma_f32_16x16x32_bf16 v[24:27], a[176:179], v[152:155], v[24:27]
ds_read_b128 v[132:135], v217 offset:33024
v_mfma_f32_16x16x32_bf16 v[56:59], a[180:183], v[152:155], v[56:59]
v_mfma_f32_16x16x32_bf16 v[88:91], a[184:187], v[152:155], v[88:91]
buffer_load_dwordx4 a[252:255], v253, s[16:19], s40 offen offset:2048 sc1
v_mfma_f32_16x16x32_bf16 v[120:123], a[188:191], v[152:155], v[120:123]
s_waitcnt lgkmcnt(2)
v_mfma_f32_16x16x32_bf16 v[28:31], a[176:179], v[156:159], v[28:31]
ds_read_b128 v[136:139], v218 offset:33024
v_mfma_f32_16x16x32_bf16 v[60:63], a[180:183], v[156:159], v[60:63]
v_mfma_f32_16x16x32_bf16 v[92:95], a[184:187], v[156:159], v[92:95]
v_mfma_f32_16x16x32_bf16 v[124:127], a[188:191], v[156:159], v[124:127]
s_waitcnt vmcnt(17) lgkmcnt(2)
v_mfma_f32_16x16x32_bf16 v[0:3], a[192:195], v[128:131], v[0:3]
s_waitcnt vmcnt(16)
s_bfe_u32 s26, s36, 262160
ds_read_b128 v[140:143], v219 offset:33024
v_mfma_f32_16x16x32_bf16 v[32:35], a[196:199], v[128:131], v[32:35]
s_waitcnt vmcnt(15)
s_mul_i32 s26, s26, 65536
s_add_u32 s41, s37, s26
s_add_u32 m0, s43, 66048
v_mfma_f32_16x16x32_bf16 v[64:67], a[200:203], v[128:131], v[64:67]
s_waitcnt vmcnt(14)
buffer_load_dwordx4 v252, s[12:15], s41 offen offset:0 sc1 lds
v_mfma_f32_16x16x32_bf16 v[96:99], a[204:207], v[128:131], v[96:99]
s_waitcnt lgkmcnt(2)
v_mfma_f32_16x16x32_bf16 v[4:7], a[192:195], v[132:135], v[4:7]
ds_read_b128 v[144:147], v220 offset:33024
v_mfma_f32_16x16x32_bf16 v[36:39], a[196:199], v[132:135], v[36:39]
v_mfma_f32_16x16x32_bf16 v[68:71], a[200:203], v[132:135], v[68:71]
buffer_load_dwordx4 v241, s[12:15], s41 offen offset:1024 sc1 lds
v_mfma_f32_16x16x32_bf16 v[100:103], a[204:207], v[132:135], v[100:103]
s_waitcnt lgkmcnt(2)
v_mfma_f32_16x16x32_bf16 v[8:11], a[192:195], v[136:139], v[8:11]
ds_read_b128 v[148:151], v221 offset:33024
v_mfma_f32_16x16x32_bf16 v[40:43], a[196:199], v[136:139], v[40:43]
s_add_u32 s41, s41, 16384
s_add_u32 m0, s43, 74240
v_mfma_f32_16x16x32_bf16 v[72:75], a[200:203], v[136:139], v[72:75]
buffer_load_dwordx4 v252, s[12:15], s41 offen offset:0 sc1 lds
v_mfma_f32_16x16x32_bf16 v[104:107], a[204:207], v[136:139], v[104:107]
s_waitcnt lgkmcnt(2)
v_mfma_f32_16x16x32_bf16 v[12:15], a[192:195], v[140:143], v[12:15]
ds_read_b128 v[152:155], v222 offset:33024
v_mfma_f32_16x16x32_bf16 v[44:47], a[196:199], v[140:143], v[44:47]
v_mfma_f32_16x16x32_bf16 v[76:79], a[200:203], v[140:143], v[76:79]
buffer_load_dwordx4 v241, s[12:15], s41 offen offset:1024 sc1 lds
v_mfma_f32_16x16x32_bf16 v[108:111], a[204:207], v[140:143], v[108:111]
s_waitcnt lgkmcnt(2)
v_mfma_f32_16x16x32_bf16 v[16:19], a[192:195], v[144:147], v[16:19]
ds_read_b128 v[156:159], v223 offset:33024
v_mfma_f32_16x16x32_bf16 v[48:51], a[196:199], v[144:147], v[48:51]
s_add_u32 s41, s41, 16384
s_add_u32 m0, s43, 82432
v_mfma_f32_16x16x32_bf16 v[80:83], a[200:203], v[144:147], v[80:83]
buffer_load_dwordx4 v252, s[12:15], s41 offen offset:0 sc1 lds
v_mfma_f32_16x16x32_bf16 v[112:115], a[204:207], v[144:147], v[112:115]
s_waitcnt lgkmcnt(2)
v_mfma_f32_16x16x32_bf16 v[20:23], a[192:195], v[148:151], v[20:23]
ds_read_b128 v[128:131], v216 offset:41216
v_mfma_f32_16x16x32_bf16 v[52:55], a[196:199], v[148:151], v[52:55]
v_mfma_f32_16x16x32_bf16 v[84:87], a[200:203], v[148:151], v[84:87]
v_mfma_f32_16x16x32_bf16 v[116:119], a[204:207], v[148:151], v[116:119]
s_waitcnt lgkmcnt(2)
v_mfma_f32_16x16x32_bf16 v[24:27], a[192:195], v[152:155], v[24:27]
ds_read_b128 v[132:135], v217 offset:41216
v_mfma_f32_16x16x32_bf16 v[56:59], a[196:199], v[152:155], v[56:59]
v_mfma_f32_16x16x32_bf16 v[88:91], a[200:203], v[152:155], v[88:91]
buffer_load_dwordx4 v241, s[12:15], s41 offen offset:1024 sc1 lds
v_mfma_f32_16x16x32_bf16 v[120:123], a[204:207], v[152:155], v[120:123]
s_waitcnt lgkmcnt(2)
v_mfma_f32_16x16x32_bf16 v[28:31], a[192:195], v[156:159], v[28:31]
ds_read_b128 v[136:139], v218 offset:41216
v_mfma_f32_16x16x32_bf16 v[60:63], a[196:199], v[156:159], v[60:63]
s_add_u32 s41, s41, 16384
s_add_u32 m0, s43, 90624
v_mfma_f32_16x16x32_bf16 v[92:95], a[200:203], v[156:159], v[92:95]
buffer_load_dwordx4 v252, s[12:15], s41 offen offset:0 sc1 lds
v_mfma_f32_16x16x32_bf16 v[124:127], a[204:207], v[156:159], v[124:127]
s_waitcnt vmcnt(20) lgkmcnt(2)
v_mfma_f32_16x16x32_bf16 v[0:3], a[208:211], v[128:131], v[0:3]
s_waitcnt vmcnt(19)
ds_read_b128 v[140:143], v219 offset:41216
v_mfma_f32_16x16x32_bf16 v[32:35], a[212:215], v[128:131], v[32:35]
s_waitcnt vmcnt(18)
v_mfma_f32_16x16x32_bf16 v[64:67], a[216:219], v[128:131], v[64:67]
s_waitcnt vmcnt(17)
buffer_load_dwordx4 v241, s[12:15], s41 offen offset:1024 sc1 lds
v_mfma_f32_16x16x32_bf16 v[96:99], a[220:223], v[128:131], v[96:99]
s_waitcnt lgkmcnt(2)
v_mfma_f32_16x16x32_bf16 v[4:7], a[208:211], v[132:135], v[4:7]
ds_read_b128 v[144:147], v220 offset:41216
v_mfma_f32_16x16x32_bf16 v[36:39], a[212:215], v[132:135], v[36:39]
s_bfe_u32 s26, s36, 262160
s_mul_i32 s40, s26, 32768
v_mfma_f32_16x16x32_bf16 v[68:71], a[216:219], v[132:135], v[68:71]
buffer_load_dwordx4 a[0:3], v252, s[16:19], s40 offen offset:0 sc1
v_mfma_f32_16x16x32_bf16 v[100:103], a[220:223], v[132:135], v[100:103]
s_waitcnt lgkmcnt(2)
v_mfma_f32_16x16x32_bf16 v[8:11], a[208:211], v[136:139], v[8:11]
ds_read_b128 v[148:151], v221 offset:41216
v_mfma_f32_16x16x32_bf16 v[40:43], a[212:215], v[136:139], v[40:43]
v_mfma_f32_16x16x32_bf16 v[72:75], a[216:219], v[136:139], v[72:75]
buffer_load_dwordx4 a[4:7], v252, s[16:19], s40 offen offset:2048 sc1
v_mfma_f32_16x16x32_bf16 v[104:107], a[220:223], v[136:139], v[104:107]
s_waitcnt lgkmcnt(2)
v_mfma_f32_16x16x32_bf16 v[12:15], a[208:211], v[140:143], v[12:15]
ds_read_b128 v[152:155], v222 offset:41216
v_mfma_f32_16x16x32_bf16 v[44:47], a[212:215], v[140:143], v[44:47]
v_mfma_f32_16x16x32_bf16 v[76:79], a[216:219], v[140:143], v[76:79]
v_mfma_f32_16x16x32_bf16 v[108:111], a[220:223], v[140:143], v[108:111]
s_waitcnt lgkmcnt(2)
v_mfma_f32_16x16x32_bf16 v[16:19], a[208:211], v[144:147], v[16:19]
ds_read_b128 v[156:159], v223 offset:41216
v_mfma_f32_16x16x32_bf16 v[48:51], a[212:215], v[144:147], v[48:51]
v_mfma_f32_16x16x32_bf16 v[80:83], a[216:219], v[144:147], v[80:83]
buffer_load_dwordx4 a[8:11], v253, s[16:19], s40 offen offset:0 sc1
v_mfma_f32_16x16x32_bf16 v[112:115], a[220:223], v[144:147], v[112:115]
s_waitcnt lgkmcnt(2)
v_mfma_f32_16x16x32_bf16 v[20:23], a[208:211], v[148:151], v[20:23]
ds_read_b128 v[128:131], v216 offset:49408
v_mfma_f32_16x16x32_bf16 v[52:55], a[212:215], v[148:151], v[52:55]
v_mfma_f32_16x16x32_bf16 v[84:87], a[216:219], v[148:151], v[84:87]
buffer_load_dwordx4 a[12:15], v253, s[16:19], s40 offen offset:2048 sc1
v_mfma_f32_16x16x32_bf16 v[116:119], a[220:223], v[148:151], v[116:119]
s_waitcnt lgkmcnt(2)
v_mfma_f32_16x16x32_bf16 v[24:27], a[208:211], v[152:155], v[24:27]
ds_read_b128 v[132:135], v217 offset:49408
v_mfma_f32_16x16x32_bf16 v[56:59], a[212:215], v[152:155], v[56:59]
s_add_u32 s40, s40, 8192
v_mfma_f32_16x16x32_bf16 v[88:91], a[216:219], v[152:155], v[88:91]
buffer_load_dwordx4 a[16:19], v252, s[16:19], s40 offen offset:0 sc1
v_mfma_f32_16x16x32_bf16 v[120:123], a[220:223], v[152:155], v[120:123]
s_waitcnt lgkmcnt(2)
v_mfma_f32_16x16x32_bf16 v[28:31], a[208:211], v[156:159], v[28:31]
ds_read_b128 v[136:139], v218 offset:49408
v_mfma_f32_16x16x32_bf16 v[60:63], a[212:215], v[156:159], v[60:63]
v_mfma_f32_16x16x32_bf16 v[92:95], a[216:219], v[156:159], v[92:95]
buffer_load_dwordx4 a[20:23], v252, s[16:19], s40 offen offset:2048 sc1
v_mfma_f32_16x16x32_bf16 v[124:127], a[220:223], v[156:159], v[124:127]
s_waitcnt vmcnt(21) lgkmcnt(2)
v_mfma_f32_16x16x32_bf16 v[0:3], a[224:227], v[128:131], v[0:3]
s_waitcnt vmcnt(20)
ds_read_b128 v[140:143], v219 offset:49408
v_mfma_f32_16x16x32_bf16 v[32:35], a[228:231], v[128:131], v[32:35]
s_waitcnt vmcnt(19)
v_mfma_f32_16x16x32_bf16 v[64:67], a[232:235], v[128:131], v[64:67]
s_waitcnt vmcnt(18)
buffer_load_dwordx4 a[24:27], v253, s[16:19], s40 offen offset:0 sc1
v_mfma_f32_16x16x32_bf16 v[96:99], a[236:239], v[128:131], v[96:99]
s_waitcnt lgkmcnt(2)
v_mfma_f32_16x16x32_bf16 v[4:7], a[224:227], v[132:135], v[4:7]
ds_read_b128 v[144:147], v220 offset:49408
v_mfma_f32_16x16x32_bf16 v[36:39], a[228:231], v[132:135], v[36:39]
v_mfma_f32_16x16x32_bf16 v[68:71], a[232:235], v[132:135], v[68:71]
v_mfma_f32_16x16x32_bf16 v[100:103], a[236:239], v[132:135], v[100:103]
s_waitcnt lgkmcnt(2)
v_mfma_f32_16x16x32_bf16 v[8:11], a[224:227], v[136:139], v[8:11]
ds_read_b128 v[148:151], v221 offset:49408
v_mfma_f32_16x16x32_bf16 v[40:43], a[228:231], v[136:139], v[40:43]
v_mfma_f32_16x16x32_bf16 v[72:75], a[232:235], v[136:139], v[72:75]
buffer_load_dwordx4 a[28:31], v253, s[16:19], s40 offen offset:2048 sc1
v_mfma_f32_16x16x32_bf16 v[104:107], a[236:239], v[136:139], v[104:107]
s_waitcnt lgkmcnt(2)
v_mfma_f32_16x16x32_bf16 v[12:15], a[224:227], v[140:143], v[12:15]
ds_read_b128 v[152:155], v222 offset:49408
v_mfma_f32_16x16x32_bf16 v[44:47], a[228:231], v[140:143], v[44:47]
s_add_u32 s40, s40, 8192
v_mfma_f32_16x16x32_bf16 v[76:79], a[232:235], v[140:143], v[76:79]
buffer_load_dwordx4 a[32:35], v252, s[16:19], s40 offen offset:0 sc1
v_mfma_f32_16x16x32_bf16 v[108:111], a[236:239], v[140:143], v[108:111]
s_waitcnt lgkmcnt(2)
v_mfma_f32_16x16x32_bf16 v[16:19], a[224:227], v[144:147], v[16:19]
ds_read_b128 v[156:159], v223 offset:49408
v_mfma_f32_16x16x32_bf16 v[48:51], a[228:231], v[144:147], v[48:51]
v_mfma_f32_16x16x32_bf16 v[80:83], a[232:235], v[144:147], v[80:83]
buffer_load_dwordx4 a[36:39], v252, s[16:19], s40 offen offset:2048 sc1
v_mfma_f32_16x16x32_bf16 v[112:115], a[236:239], v[144:147], v[112:115]
s_waitcnt lgkmcnt(2)
v_mfma_f32_16x16x32_bf16 v[20:23], a[224:227], v[148:151], v[20:23]
ds_read_b128 v[128:131], v216 offset:57600
v_mfma_f32_16x16x32_bf16 v[52:55], a[228:231], v[148:151], v[52:55]
v_mfma_f32_16x16x32_bf16 v[84:87], a[232:235], v[148:151], v[84:87]
buffer_load_dwordx4 a[40:43], v253, s[16:19], s40 offen offset:0 sc1
v_mfma_f32_16x16x32_bf16 v[116:119], a[236:239], v[148:151], v[116:119]
s_waitcnt lgkmcnt(2)
v_mfma_f32_16x16x32_bf16 v[24:27], a[224:227], v[152:155], v[24:27]
ds_read_b128 v[132:135], v217 offset:57600
v_mfma_f32_16x16x32_bf16 v[56:59], a[228:231], v[152:155], v[56:59]
v_mfma_f32_16x16x32_bf16 v[88:91], a[232:235], v[152:155], v[88:91]
buffer_load_dwordx4 a[44:47], v253, s[16:19], s40 offen offset:2048 sc1
v_mfma_f32_16x16x32_bf16 v[120:123], a[236:239], v[152:155], v[120:123]
s_waitcnt lgkmcnt(2)
v_mfma_f32_16x16x32_bf16 v[28:31], a[224:227], v[156:159], v[28:31]
ds_read_b128 v[136:139], v218 offset:57600
v_mfma_f32_16x16x32_bf16 v[60:63], a[228:231], v[156:159], v[60:63]
v_mfma_f32_16x16x32_bf16 v[92:95], a[232:235], v[156:159], v[92:95]
v_mfma_f32_16x16x32_bf16 v[124:127], a[236:239], v[156:159], v[124:127]
s_waitcnt vmcnt(23) lgkmcnt(2)
v_mfma_f32_16x16x32_bf16 v[0:3], a[240:243], v[128:131], v[0:3]
s_waitcnt vmcnt(22)
ds_read_b128 v[140:143], v219 offset:57600
v_mfma_f32_16x16x32_bf16 v[32:35], a[244:247], v[128:131], v[32:35]
s_waitcnt vmcnt(21)
s_add_u32 s40, s40, 8192
v_mfma_f32_16x16x32_bf16 v[64:67], a[248:251], v[128:131], v[64:67]
s_waitcnt vmcnt(20)
buffer_load_dwordx4 a[48:51], v252, s[16:19], s40 offen offset:0 sc1
v_mfma_f32_16x16x32_bf16 v[96:99], a[252:255], v[128:131], v[96:99]
s_waitcnt lgkmcnt(2)
v_mfma_f32_16x16x32_bf16 v[4:7], a[240:243], v[132:135], v[4:7]
ds_read_b128 v[144:147], v220 offset:57600
v_mfma_f32_16x16x32_bf16 v[36:39], a[244:247], v[132:135], v[36:39]
v_mfma_f32_16x16x32_bf16 v[68:71], a[248:251], v[132:135], v[68:71]
buffer_load_dwordx4 a[52:55], v252, s[16:19], s40 offen offset:2048 sc1
v_mfma_f32_16x16x32_bf16 v[100:103], a[252:255], v[132:135], v[100:103]
s_waitcnt lgkmcnt(2)
v_mfma_f32_16x16x32_bf16 v[8:11], a[240:243], v[136:139], v[8:11]
ds_read_b128 v[148:151], v221 offset:57600
v_mfma_f32_16x16x32_bf16 v[40:43], a[244:247], v[136:139], v[40:43]
v_mfma_f32_16x16x32_bf16 v[72:75], a[248:251], v[136:139], v[72:75]
buffer_load_dwordx4 a[56:59], v253, s[16:19], s40 offen offset:0 sc1
v_mfma_f32_16x16x32_bf16 v[104:107], a[252:255], v[136:139], v[104:107]
s_waitcnt lgkmcnt(2)
v_mfma_f32_16x16x32_bf16 v[12:15], a[240:243], v[140:143], v[12:15]
ds_read_b128 v[152:155], v222 offset:57600
v_mfma_f32_16x16x32_bf16 v[44:47], a[244:247], v[140:143], v[44:47]
v_mfma_f32_16x16x32_bf16 v[76:79], a[248:251], v[140:143], v[76:79]
buffer_load_dwordx4 a[60:63], v253, s[16:19], s40 offen offset:2048 sc1
v_mfma_f32_16x16x32_bf16 v[108:111], a[252:255], v[140:143], v[108:111]
s_waitcnt lgkmcnt(2)
v_mfma_f32_16x16x32_bf16 v[16:19], a[240:243], v[144:147], v[16:19]
s_bfe_u32 s26, s36, 262164
ds_read_b128 v[156:159], v223 offset:57600
v_mfma_f32_16x16x32_bf16 v[48:51], a[244:247], v[144:147], v[48:51]
s_mul_i32 s26, s26, 65536
s_add_u32 s41, s37, s26
s_add_u32 m0, s43, 99072
v_mfma_f32_16x16x32_bf16 v[80:83], a[248:251], v[144:147], v[80:83]
buffer_load_dwordx4 v252, s[12:15], s41 offen offset:0 sc1 lds
v_mfma_f32_16x16x32_bf16 v[112:115], a[252:255], v[144:147], v[112:115]
s_waitcnt vmcnt(17) lgkmcnt(2)
s_barrier
v_mfma_f32_16x16x32_bf16 v[20:23], a[240:243], v[148:151], v[20:23]
ds_read_b128 v[128:131], v224 offset:0
v_mfma_f32_16x16x32_bf16 v[52:55], a[244:247], v[148:151], v[52:55]
v_mfma_f32_16x16x32_bf16 v[84:87], a[248:251], v[148:151], v[84:87]
v_mfma_f32_16x16x32_bf16 v[116:119], a[252:255], v[148:151], v[116:119]
s_waitcnt lgkmcnt(2)
v_mfma_f32_16x16x32_bf16 v[24:27], a[240:243], v[152:155], v[24:27]
ds_read_b128 v[132:135], v225 offset:0
v_mfma_f32_16x16x32_bf16 v[56:59], a[244:247], v[152:155], v[56:59]
v_mfma_f32_16x16x32_bf16 v[88:91], a[248:251], v[152:155], v[88:91]
buffer_load_dwordx4 v241, s[12:15], s41 offen offset:1024 sc1 lds
v_mfma_f32_16x16x32_bf16 v[120:123], a[252:255], v[152:155], v[120:123]
s_waitcnt lgkmcnt(2)
v_mfma_f32_16x16x32_bf16 v[28:31], a[240:243], v[156:159], v[28:31]
ds_read_b128 v[136:139], v226 offset:0
v_mfma_f32_16x16x32_bf16 v[60:63], a[244:247], v[156:159], v[60:63]
s_add_u32 s41, s41, 16384
s_add_u32 m0, s43, 107264
v_mfma_f32_16x16x32_bf16 v[92:95], a[248:251], v[156:159], v[92:95]
buffer_load_dwordx4 v252, s[12:15], s41 offen offset:0 sc1 lds
v_mfma_f32_16x16x32_bf16 v[124:127], a[252:255], v[156:159], v[124:127]
s_waitcnt vmcnt(18) lgkmcnt(2)
v_mfma_f32_16x16x32_bf16 v[0:3], a[0:3], v[128:131], v[0:3]
s_waitcnt vmcnt(17)
ds_read_b128 v[140:143], v227 offset:0
v_mfma_f32_16x16x32_bf16 v[32:35], a[4:7], v[128:131], v[32:35]
s_waitcnt vmcnt(16)
v_mfma_f32_16x16x32_bf16 v[64:67], a[8:11], v[128:131], v[64:67]
s_waitcnt vmcnt(15)
buffer_load_dwordx4 v241, s[12:15], s41 offen offset:1024 sc1 lds
v_mfma_f32_16x16x32_bf16 v[96:99], a[12:15], v[128:131], v[96:99]
s_waitcnt lgkmcnt(2)
v_mfma_f32_16x16x32_bf16 v[4:7], a[0:3], v[132:135], v[4:7]
ds_read_b128 v[144:147], v228 offset:0
v_mfma_f32_16x16x32_bf16 v[36:39], a[4:7], v[132:135], v[36:39]
s_add_u32 s41, s41, 16384
s_add_u32 m0, s43, 115456
v_mfma_f32_16x16x32_bf16 v[68:71], a[8:11], v[132:135], v[68:71]
buffer_load_dwordx4 v252, s[12:15], s41 offen offset:0 sc1 lds
v_mfma_f32_16x16x32_bf16 v[100:103], a[12:15], v[132:135], v[100:103]
s_waitcnt lgkmcnt(2)
v_mfma_f32_16x16x32_bf16 v[8:11], a[0:3], v[136:139], v[8:11]
ds_read_b128 v[148:151], v229 offset:0
v_mfma_f32_16x16x32_bf16 v[40:43], a[4:7], v[136:139], v[40:43]
v_mfma_f32_16x16x32_bf16 v[72:75], a[8:11], v[136:139], v[72:75]
buffer_load_dwordx4 v241, s[12:15], s41 offen offset:1024 sc1 lds
v_mfma_f32_16x16x32_bf16 v[104:107], a[12:15], v[136:139], v[104:107]
s_waitcnt lgkmcnt(2)
v_mfma_f32_16x16x32_bf16 v[12:15], a[0:3], v[140:143], v[12:15]
ds_read_b128 v[152:155], v230 offset:0
v_mfma_f32_16x16x32_bf16 v[44:47], a[4:7], v[140:143], v[44:47]
v_mfma_f32_16x16x32_bf16 v[76:79], a[8:11], v[140:143], v[76:79]
v_mfma_f32_16x16x32_bf16 v[108:111], a[12:15], v[140:143], v[108:111]
s_waitcnt lgkmcnt(2)
v_mfma_f32_16x16x32_bf16 v[16:19], a[0:3], v[144:147], v[16:19]
ds_read_b128 v[156:159], v231 offset:0
v_mfma_f32_16x16x32_bf16 v[48:51], a[4:7], v[144:147], v[48:51]
s_add_u32 s41, s41, 16384
s_add_u32 m0, s43, 123648
v_mfma_f32_16x16x32_bf16 v[80:83], a[8:11], v[144:147], v[80:83]
buffer_load_dwordx4 v252, s[12:15], s41 offen offset:0 sc1 lds
v_mfma_f32_16x16x32_bf16 v[112:115], a[12:15], v[144:147], v[112:115]
s_waitcnt lgkmcnt(2)
v_mfma_f32_16x16x32_bf16 v[20:23], a[0:3], v[148:151], v[20:23]
ds_read_b128 v[128:131], v224 offset:8192
v_mfma_f32_16x16x32_bf16 v[52:55], a[4:7], v[148:151], v[52:55]
v_mfma_f32_16x16x32_bf16 v[84:87], a[8:11], v[148:151], v[84:87]
buffer_load_dwordx4 v241, s[12:15], s41 offen offset:1024 sc1 lds
v_mfma_f32_16x16x32_bf16 v[116:119], a[12:15], v[148:151], v[116:119]
s_waitcnt lgkmcnt(2)
v_mfma_f32_16x16x32_bf16 v[24:27], a[0:3], v[152:155], v[24:27]
ds_read_b128 v[132:135], v225 offset:8192
v_mfma_f32_16x16x32_bf16 v[56:59], a[4:7], v[152:155], v[56:59]
s_bfe_u32 s26, s36, 262164
s_mul_i32 s40, s26, 32768
v_mfma_f32_16x16x32_bf16 v[88:91], a[8:11], v[152:155], v[88:91]
buffer_load_dwordx4 a[64:67], v252, s[16:19], s40 offen offset:0 sc1
v_mfma_f32_16x16x32_bf16 v[120:123], a[12:15], v[152:155], v[120:123]
s_waitcnt lgkmcnt(2)
v_mfma_f32_16x16x32_bf16 v[28:31], a[0:3], v[156:159], v[28:31]
ds_read_b128 v[136:139], v226 offset:8192
v_mfma_f32_16x16x32_bf16 v[60:63], a[4:7], v[156:159], v[60:63]
v_mfma_f32_16x16x32_bf16 v[92:95], a[8:11], v[156:159], v[92:95]
buffer_load_dwordx4 a[68:71], v252, s[16:19], s40 offen offset:2048 sc1
v_mfma_f32_16x16x32_bf16 v[124:127], a[12:15], v[156:159], v[124:127]
s_waitcnt vmcnt(21) lgkmcnt(2)
v_mfma_f32_16x16x32_bf16 v[0:3], a[16:19], v[128:131], v[0:3]
s_waitcnt vmcnt(20)
ds_read_b128 v[140:143], v227 offset:8192
v_mfma_f32_16x16x32_bf16 v[32:35], a[20:23], v[128:131], v[32:35]
s_waitcnt vmcnt(19)
v_mfma_f32_16x16x32_bf16 v[64:67], a[24:27], v[128:131], v[64:67]
s_waitcnt vmcnt(18)
buffer_load_dwordx4 a[72:75], v253, s[16:19], s40 offen offset:0 sc1
v_mfma_f32_16x16x32_bf16 v[96:99], a[28:31], v[128:131], v[96:99]
s_waitcnt lgkmcnt(2)
v_mfma_f32_16x16x32_bf16 v[4:7], a[16:19], v[132:135], v[4:7]
ds_read_b128 v[144:147], v228 offset:8192
v_mfma_f32_16x16x32_bf16 v[36:39], a[20:23], v[132:135], v[36:39]
v_mfma_f32_16x16x32_bf16 v[68:71], a[24:27], v[132:135], v[68:71]
v_mfma_f32_16x16x32_bf16 v[100:103], a[28:31], v[132:135], v[100:103]
s_waitcnt lgkmcnt(2)
v_mfma_f32_16x16x32_bf16 v[8:11], a[16:19], v[136:139], v[8:11]
ds_read_b128 v[148:151], v229 offset:8192
v_mfma_f32_16x16x32_bf16 v[40:43], a[20:23], v[136:139], v[40:43]
v_mfma_f32_16x16x32_bf16 v[72:75], a[24:27], v[136:139], v[72:75]
buffer_load_dwordx4 a[76:79], v253, s[16:19], s40 offen offset:2048 sc1
v_mfma_f32_16x16x32_bf16 v[104:107], a[28:31], v[136:139], v[104:107]
s_waitcnt lgkmcnt(2)
v_mfma_f32_16x16x32_bf16 v[12:15], a[16:19], v[140:143], v[12:15]
ds_read_b128 v[152:155], v230 offset:8192
v_mfma_f32_16x16x32_bf16 v[44:47], a[20:23], v[140:143], v[44:47]
s_add_u32 s40, s40, 8192
v_mfma_f32_16x16x32_bf16 v[76:79], a[24:27], v[140:143], v[76:79]
buffer_load_dwordx4 a[80:83], v252, s[16:19], s40 offen offset:0 sc1
v_mfma_f32_16x16x32_bf16 v[108:111], a[28:31], v[140:143], v[108:111]
s_waitcnt lgkmcnt(2)
v_mfma_f32_16x16x32_bf16 v[16:19], a[16:19], v[144:147], v[16:19]
ds_read_b128 v[156:159], v231 offset:8192
v_mfma_f32_16x16x32_bf16 v[48:51], a[20:23], v[144:147], v[48:51]
v_mfma_f32_16x16x32_bf16 v[80:83], a[24:27], v[144:147], v[80:83]
buffer_load_dwordx4 a[84:87], v252, s[16:19], s40 offen offset:2048 sc1
v_mfma_f32_16x16x32_bf16 v[112:115], a[28:31], v[144:147], v[112:115]
s_waitcnt lgkmcnt(2)
v_mfma_f32_16x16x32_bf16 v[20:23], a[16:19], v[148:151], v[20:23]
ds_read_b128 v[128:131], v224 offset:16384
v_mfma_f32_16x16x32_bf16 v[52:55], a[20:23], v[148:151], v[52:55]
v_mfma_f32_16x16x32_bf16 v[84:87], a[24:27], v[148:151], v[84:87]
buffer_load_dwordx4 a[88:91], v253, s[16:19], s40 offen offset:0 sc1
v_mfma_f32_16x16x32_bf16 v[116:119], a[28:31], v[148:151], v[116:119]
s_waitcnt lgkmcnt(2)
v_mfma_f32_16x16x32_bf16 v[24:27], a[16:19], v[152:155], v[24:27]
ds_read_b128 v[132:135], v225 offset:16384
v_mfma_f32_16x16x32_bf16 v[56:59], a[20:23], v[152:155], v[56:59]
v_mfma_f32_16x16x32_bf16 v[88:91], a[24:27], v[152:155], v[88:91]
buffer_load_dwordx4 a[92:95], v253, s[16:19], s40 offen offset:2048 sc1
v_mfma_f32_16x16x32_bf16 v[120:123], a[28:31], v[152:155], v[120:123]
s_waitcnt lgkmcnt(2)
v_mfma_f32_16x16x32_bf16 v[28:31], a[16:19], v[156:159], v[28:31]
ds_read_b128 v[136:139], v226 offset:16384
v_mfma_f32_16x16x32_bf16 v[60:63], a[20:23], v[156:159], v[60:63]
v_mfma_f32_16x16x32_bf16 v[92:95], a[24:27], v[156:159], v[92:95]
v_mfma_f32_16x16x32_bf16 v[124:127], a[28:31], v[156:159], v[124:127]
s_waitcnt vmcnt(23) lgkmcnt(2)
v_mfma_f32_16x16x32_bf16 v[0:3], a[32:35], v[128:131], v[0:3]
s_waitcnt vmcnt(22)
ds_read_b128 v[140:143], v227 offset:16384
v_mfma_f32_16x16x32_bf16 v[32:35], a[36:39], v[128:131], v[32:35]
s_waitcnt vmcnt(21)
s_add_u32 s40, s40, 8192
v_mfma_f32_16x16x32_bf16 v[64:67], a[40:43], v[128:131], v[64:67]
s_waitcnt vmcnt(20)
buffer_load_dwordx4 a[96:99], v252, s[16:19], s40 offen offset:0 sc1
v_mfma_f32_16x16x32_bf16 v[96:99], a[44:47], v[128:131], v[96:99]
s_waitcnt lgkmcnt(2)
v_mfma_f32_16x16x32_bf16 v[4:7], a[32:35], v[132:135], v[4:7]
ds_read_b128 v[144:147], v228 offset:16384
v_mfma_f32_16x16x32_bf16 v[36:39], a[36:39], v[132:135], v[36:39]
v_mfma_f32_16x16x32_bf16 v[68:71], a[40:43], v[132:135], v[68:71]
buffer_load_dwordx4 a[100:103], v252, s[16:19], s40 offen offset:2048 sc1
v_mfma_f32_16x16x32_bf16 v[100:103], a[44:47], v[132:135], v[100:103]
s_waitcnt lgkmcnt(2)
v_mfma_f32_16x16x32_bf16 v[8:11], a[32:35], v[136:139], v[8:11]
ds_read_b128 v[148:151], v229 offset:16384
v_mfma_f32_16x16x32_bf16 v[40:43], a[36:39], v[136:139], v[40:43]
s_add_u32 s40, s40, 8192
v_mfma_f32_16x16x32_bf16 v[72:75], a[40:43], v[136:139], v[72:75]
buffer_load_dwordx4 a[112:115], v252, s[16:19], s40 offen offset:0 sc1
v_mfma_f32_16x16x32_bf16 v[104:107], a[44:47], v[136:139], v[104:107]
s_waitcnt lgkmcnt(2)
v_mfma_f32_16x16x32_bf16 v[12:15], a[32:35], v[140:143], v[12:15]
ds_read_b128 v[152:155], v230 offset:16384
v_mfma_f32_16x16x32_bf16 v[44:47], a[36:39], v[140:143], v[44:47]
v_mfma_f32_16x16x32_bf16 v[76:79], a[40:43], v[140:143], v[76:79]
buffer_load_dwordx4 a[116:119], v252, s[16:19], s40 offen offset:2048 sc1
v_mfma_f32_16x16x32_bf16 v[108:111], a[44:47], v[140:143], v[108:111]
s_waitcnt lgkmcnt(2)
v_mfma_f32_16x16x32_bf16 v[16:19], a[32:35], v[144:147], v[16:19]
s_bfe_u32 s26, s36, 262168
ds_read_b128 v[156:159], v231 offset:16384
v_mfma_f32_16x16x32_bf16 v[48:51], a[36:39], v[144:147], v[48:51]
s_mul_i32 s26, s26, 65536
s_add_u32 s41, s37, s26
s_add_u32 m0, s43, 0
v_mfma_f32_16x16x32_bf16 v[80:83], a[40:43], v[144:147], v[80:83]
buffer_load_dwordx4 v252, s[12:15], s41 offen offset:0 sc1 lds
v_mfma_f32_16x16x32_bf16 v[112:115], a[44:47], v[144:147], v[112:115]
s_waitcnt lgkmcnt(2)
v_mfma_f32_16x16x32_bf16 v[20:23], a[32:35], v[148:151], v[20:23]
ds_read_b128 v[128:131], v224 offset:24576
v_mfma_f32_16x16x32_bf16 v[52:55], a[36:39], v[148:151], v[52:55]
v_mfma_f32_16x16x32_bf16 v[84:87], a[40:43], v[148:151], v[84:87]
v_mfma_f32_16x16x32_bf16 v[116:119], a[44:47], v[148:151], v[116:119]
s_waitcnt lgkmcnt(2)
v_mfma_f32_16x16x32_bf16 v[24:27], a[32:35], v[152:155], v[24:27]
ds_read_b128 v[132:135], v225 offset:24576
v_mfma_f32_16x16x32_bf16 v[56:59], a[36:39], v[152:155], v[56:59]
v_mfma_f32_16x16x32_bf16 v[88:91], a[40:43], v[152:155], v[88:91]
buffer_load_dwordx4 v241, s[12:15], s41 offen offset:1024 sc1 lds
v_mfma_f32_16x16x32_bf16 v[120:123], a[44:47], v[152:155], v[120:123]
s_waitcnt lgkmcnt(2)
v_mfma_f32_16x16x32_bf16 v[28:31], a[32:35], v[156:159], v[28:31]
ds_read_b128 v[136:139], v226 offset:24576
v_mfma_f32_16x16x32_bf16 v[60:63], a[36:39], v[156:159], v[60:63]
s_add_u32 s41, s41, 16384
s_add_u32 m0, s43, 8192
v_mfma_f32_16x16x32_bf16 v[92:95], a[40:43], v[156:159], v[92:95]
buffer_load_dwordx4 v252, s[12:15], s41 offen offset:0 sc1 lds
v_mfma_f32_16x16x32_bf16 v[124:127], a[44:47], v[156:159], v[124:127]
s_waitcnt vmcnt(26) lgkmcnt(2)
v_mfma_f32_16x16x32_bf16 v[0:3], a[48:51], v[128:131], v[0:3]
s_waitcnt vmcnt(25)
ds_read_b128 v[140:143], v227 offset:24576
v_mfma_f32_16x16x32_bf16 v[32:35], a[52:55], v[128:131], v[32:35]
s_waitcnt vmcnt(24)
v_mfma_f32_16x16x32_bf16 v[64:67], a[56:59], v[128:131], v[64:67]
s_waitcnt vmcnt(23)
buffer_load_dwordx4 v241, s[12:15], s41 offen offset:1024 sc1 lds
v_mfma_f32_16x16x32_bf16 v[96:99], a[60:63], v[128:131], v[96:99]
s_waitcnt lgkmcnt(2)
v_mfma_f32_16x16x32_bf16 v[4:7], a[48:51], v[132:135], v[4:7]
ds_read_b128 v[144:147], v228 offset:24576
v_mfma_f32_16x16x32_bf16 v[36:39], a[52:55], v[132:135], v[36:39]
s_add_u32 s41, s41, 16384
s_add_u32 m0, s43, 16384
v_mfma_f32_16x16x32_bf16 v[68:71], a[56:59], v[132:135], v[68:71]
buffer_load_dwordx4 v252, s[12:15], s41 offen offset:0 sc1 lds
v_mfma_f32_16x16x32_bf16 v[100:103], a[60:63], v[132:135], v[100:103]
s_waitcnt lgkmcnt(2)
v_mfma_f32_16x16x32_bf16 v[8:11], a[48:51], v[136:139], v[8:11]
ds_read_b128 v[148:151], v229 offset:24576
v_mfma_f32_16x16x32_bf16 v[40:43], a[52:55], v[136:139], v[40:43]
v_mfma_f32_16x16x32_bf16 v[72:75], a[56:59], v[136:139], v[72:75]
buffer_load_dwordx4 v241, s[12:15], s41 offen offset:1024 sc1 lds
v_mfma_f32_16x16x32_bf16 v[104:107], a[60:63], v[136:139], v[104:107]
s_waitcnt lgkmcnt(2)
v_mfma_f32_16x16x32_bf16 v[12:15], a[48:51], v[140:143], v[12:15]
ds_read_b128 v[152:155], v230 offset:24576
v_mfma_f32_16x16x32_bf16 v[44:47], a[52:55], v[140:143], v[44:47]
v_mfma_f32_16x16x32_bf16 v[76:79], a[56:59], v[140:143], v[76:79]
v_mfma_f32_16x16x32_bf16 v[108:111], a[60:63], v[140:143], v[108:111]
s_waitcnt lgkmcnt(2)
v_mfma_f32_16x16x32_bf16 v[16:19], a[48:51], v[144:147], v[16:19]
ds_read_b128 v[156:159], v231 offset:24576
v_mfma_f32_16x16x32_bf16 v[48:51], a[52:55], v[144:147], v[48:51]
s_add_u32 s41, s41, 16384
s_add_u32 m0, s43, 24576
v_mfma_f32_16x16x32_bf16 v[80:83], a[56:59], v[144:147], v[80:83]
buffer_load_dwordx4 v252, s[12:15], s41 offen offset:0 sc1 lds
v_mfma_f32_16x16x32_bf16 v[112:115], a[60:63], v[144:147], v[112:115]
s_waitcnt vmcnt(19) lgkmcnt(2)
s_barrier
v_mfma_f32_16x16x32_bf16 v[20:23], a[48:51], v[148:151], v[20:23]
ds_read_b128 v[128:131], v224 offset:33024
v_mfma_f32_16x16x32_bf16 v[52:55], a[52:55], v[148:151], v[52:55]
v_mfma_f32_16x16x32_bf16 v[84:87], a[56:59], v[148:151], v[84:87]
buffer_load_dwordx4 v241, s[12:15], s41 offen offset:1024 sc1 lds
v_mfma_f32_16x16x32_bf16 v[116:119], a[60:63], v[148:151], v[116:119]
s_waitcnt lgkmcnt(2)
v_mfma_f32_16x16x32_bf16 v[24:27], a[48:51], v[152:155], v[24:27]
ds_read_b128 v[132:135], v225 offset:33024
v_mfma_f32_16x16x32_bf16 v[56:59], a[52:55], v[152:155], v[56:59]
s_bfe_u32 s26, s36, 262168
s_mul_i32 s40, s26, 32768
v_mfma_f32_16x16x32_bf16 v[88:91], a[56:59], v[152:155], v[88:91]
buffer_load_dwordx4 a[128:131], v252, s[16:19], s40 offen offset:0 sc1
v_mfma_f32_16x16x32_bf16 v[120:123], a[60:63], v[152:155], v[120:123]
s_waitcnt lgkmcnt(2)
v_mfma_f32_16x16x32_bf16 v[28:31], a[48:51], v[156:159], v[28:31]
ds_read_b128 v[136:139], v226 offset:33024
v_mfma_f32_16x16x32_bf16 v[60:63], a[52:55], v[156:159], v[60:63]
v_mfma_f32_16x16x32_bf16 v[92:95], a[56:59], v[156:159], v[92:95]
buffer_load_dwordx4 a[132:135], v252, s[16:19], s40 offen offset:2048 sc1
v_mfma_f32_16x16x32_bf16 v[124:127], a[60:63], v[156:159], v[124:127]
s_waitcnt vmcnt(21) lgkmcnt(2)
v_mfma_f32_16x16x32_bf16 v[0:3], a[64:67], v[128:131], v[0:3]
s_waitcnt vmcnt(20)
ds_read_b128 v[140:143], v227 offset:33024
v_mfma_f32_16x16x32_bf16 v[32:35], a[68:71], v[128:131], v[32:35]
s_waitcnt vmcnt(19)
s_add_u32 s40, s40, 8192
v_mfma_f32_16x16x32_bf16 v[64:67], a[72:75], v[128:131], v[64:67]
s_waitcnt vmcnt(18)
buffer_load_dwordx4 a[144:147], v252, s[16:19], s40 offen offset:0 sc1
v_mfma_f32_16x16x32_bf16 v[96:99], a[76:79], v[128:131], v[96:99]
s_waitcnt lgkmcnt(2)
v_mfma_f32_16x16x32_bf16 v[4:7], a[64:67], v[132:135], v[4:7]
ds_read_b128 v[144:147], v228 offset:33024
v_mfma_f32_16x16x32_bf16 v[36:39], a[68:71], v[132:135], v[36:39]
v_mfma_f32_16x16x32_bf16 v[68:71], a[72:75], v[132:135], v[68:71]
v_mfma_f32_16x16x32_bf16 v[100:103], a[76:79], v[132:135], v[100:103]
s_waitcnt lgkmcnt(2)
v_mfma_f32_16x16x32_bf16 v[8:11], a[64:67], v[136:139], v[8:11]
ds_read_b128 v[148:151], v229 offset:33024
v_mfma_f32_16x16x32_bf16 v[40:43], a[68:71], v[136:139], v[40:43]
v_mfma_f32_16x16x32_bf16 v[72:75], a[72:75], v[136:139], v[72:75]
buffer_load_dwordx4 a[148:151], v252, s[16:19], s40 offen offset:2048 sc1
v_mfma_f32_16x16x32_bf16 v[104:107], a[76:79], v[136:139], v[104:107]
s_waitcnt lgkmcnt(2)
v_mfma_f32_16x16x32_bf16 v[12:15], a[64:67], v[140:143], v[12:15]
ds_read_b128 v[152:155], v230 offset:33024
v_mfma_f32_16x16x32_bf16 v[44:47], a[68:71], v[140:143], v[44:47]
s_add_u32 s40, s40, 8192
v_mfma_f32_16x16x32_bf16 v[76:79], a[72:75], v[140:143], v[76:79]
buffer_load_dwordx4 a[160:163], v252, s[16:19], s40 offen offset:0 sc1
v_mfma_f32_16x16x32_bf16 v[108:111], a[76:79], v[140:143], v[108:111]
s_waitcnt lgkmcnt(2)
v_mfma_f32_16x16x32_bf16 v[16:19], a[64:67], v[144:147], v[16:19]
ds_read_b128 v[156:159], v231 offset:33024
v_mfma_f32_16x16x32_bf16 v[48:51], a[68:71], v[144:147], v[48:51]
v_mfma_f32_16x16x32_bf16 v[80:83], a[72:75], v[144:147], v[80:83]
buffer_load_dwordx4 a[164:167], v252, s[16:19], s40 offen offset:2048 sc1
v_mfma_f32_16x16x32_bf16 v[112:115], a[76:79], v[144:147], v[112:115]
s_waitcnt lgkmcnt(2)
v_mfma_f32_16x16x32_bf16 v[20:23], a[64:67], v[148:151], v[20:23]
ds_read_b128 v[128:131], v224 offset:41216
v_mfma_f32_16x16x32_bf16 v[52:55], a[68:71], v[148:151], v[52:55]
s_add_u32 s40, s40, 8192
v_mfma_f32_16x16x32_bf16 v[84:87], a[72:75], v[148:151], v[84:87]
buffer_load_dwordx4 a[176:179], v252, s[16:19], s40 offen offset:0 sc1
v_mfma_f32_16x16x32_bf16 v[116:119], a[76:79], v[148:151], v[116:119]
s_waitcnt lgkmcnt(2)
v_mfma_f32_16x16x32_bf16 v[24:27], a[64:67], v[152:155], v[24:27]
ds_read_b128 v[132:135], v225 offset:41216
v_mfma_f32_16x16x32_bf16 v[56:59], a[68:71], v[152:155], v[56:59]
v_mfma_f32_16x16x32_bf16 v[88:91], a[72:75], v[152:155], v[88:91]
buffer_load_dwordx4 a[180:183], v252, s[16:19], s40 offen offset:2048 sc1
v_mfma_f32_16x16x32_bf16 v[120:123], a[76:79], v[152:155], v[120:123]
s_waitcnt lgkmcnt(2)
v_mfma_f32_16x16x32_bf16 v[28:31], a[64:67], v[156:159], v[28:31]
ds_read_b128 v[136:139], v226 offset:41216
v_mfma_f32_16x16x32_bf16 v[60:63], a[68:71], v[156:159], v[60:63]
v_mfma_f32_16x16x32_bf16 v[92:95], a[72:75], v[156:159], v[92:95]
v_mfma_f32_16x16x32_bf16 v[124:127], a[76:79], v[156:159], v[124:127]
s_waitcnt vmcnt(23) lgkmcnt(2)
v_mfma_f32_16x16x32_bf16 v[0:3], a[80:83], v[128:131], v[0:3]
s_waitcnt vmcnt(22)
s_bfe_u32 s26, s36, 262172
ds_read_b128 v[140:143], v227 offset:41216
v_mfma_f32_16x16x32_bf16 v[32:35], a[84:87], v[128:131], v[32:35]
s_waitcnt vmcnt(21)
s_mul_i32 s26, s26, 65536
s_add_u32 s41, s37, s26
s_add_u32 m0, s43, 33024
v_mfma_f32_16x16x32_bf16 v[64:67], a[88:91], v[128:131], v[64:67]
s_waitcnt vmcnt(20)
buffer_load_dwordx4 v252, s[12:15], s41 offen offset:0 sc1 lds
v_mfma_f32_16x16x32_bf16 v[96:99], a[92:95], v[128:131], v[96:99]
s_waitcnt lgkmcnt(2)
v_mfma_f32_16x16x32_bf16 v[4:7], a[80:83], v[132:135], v[4:7]
ds_read_b128 v[144:147], v228 offset:41216
v_mfma_f32_16x16x32_bf16 v[36:39], a[84:87], v[132:135], v[36:39]
v_mfma_f32_16x16x32_bf16 v[68:71], a[88:91], v[132:135], v[68:71]
buffer_load_dwordx4 v241, s[12:15], s41 offen offset:1024 sc1 lds
v_mfma_f32_16x16x32_bf16 v[100:103], a[92:95], v[132:135], v[100:103]
s_waitcnt lgkmcnt(2)
v_mfma_f32_16x16x32_bf16 v[8:11], a[80:83], v[136:139], v[8:11]
ds_read_b128 v[148:151], v229 offset:41216
v_mfma_f32_16x16x32_bf16 v[40:43], a[84:87], v[136:139], v[40:43]
s_add_u32 s41, s41, 16384
s_add_u32 m0, s43, 41216
v_mfma_f32_16x16x32_bf16 v[72:75], a[88:91], v[136:139], v[72:75]
buffer_load_dwordx4 v252, s[12:15], s41 offen offset:0 sc1 lds
v_mfma_f32_16x16x32_bf16 v[104:107], a[92:95], v[136:139], v[104:107]
s_waitcnt lgkmcnt(2)
v_mfma_f32_16x16x32_bf16 v[12:15], a[80:83], v[140:143], v[12:15]
ds_read_b128 v[152:155], v230 offset:41216
v_mfma_f32_16x16x32_bf16 v[44:47], a[84:87], v[140:143], v[44:47]
v_mfma_f32_16x16x32_bf16 v[76:79], a[88:91], v[140:143], v[76:79]
buffer_load_dwordx4 v241, s[12:15], s41 offen offset:1024 sc1 lds
v_mfma_f32_16x16x32_bf16 v[108:111], a[92:95], v[140:143], v[108:111]
s_waitcnt lgkmcnt(2)
v_mfma_f32_16x16x32_bf16 v[16:19], a[80:83], v[144:147], v[16:19]
ds_read_b128 v[156:159], v231 offset:41216
v_mfma_f32_16x16x32_bf16 v[48:51], a[84:87], v[144:147], v[48:51]
s_add_u32 s41, s41, 16384
s_add_u32 m0, s43, 49408
v_mfma_f32_16x16x32_bf16 v[80:83], a[88:91], v[144:147], v[80:83]
buffer_load_dwordx4 v252, s[12:15], s41 offen offset:0 sc1 lds
v_mfma_f32_16x16x32_bf16 v[112:115], a[92:95], v[144:147], v[112:115]
s_waitcnt lgkmcnt(2)
v_mfma_f32_16x16x32_bf16 v[20:23], a[80:83], v[148:151], v[20:23]
ds_read_b128 v[128:131], v224 offset:49408
v_mfma_f32_16x16x32_bf16 v[52:55], a[84:87], v[148:151], v[52:55]
v_mfma_f32_16x16x32_bf16 v[84:87], a[88:91], v[148:151], v[84:87]
v_mfma_f32_16x16x32_bf16 v[116:119], a[92:95], v[148:151], v[116:119]
s_waitcnt lgkmcnt(2)
v_mfma_f32_16x16x32_bf16 v[24:27], a[80:83], v[152:155], v[24:27]
ds_read_b128 v[132:135], v225 offset:49408
v_mfma_f32_16x16x32_bf16 v[56:59], a[84:87], v[152:155], v[56:59]
ds_read_b128 v[136:139], v226 offset:49408
v_mfma_f32_16x16x32_bf16 v[88:91], a[88:91], v[152:155], v[88:91]
buffer_load_dwordx4 v241, s[12:15], s41 offen offset:1024 sc1 lds
v_mfma_f32_16x16x32_bf16 v[120:123], a[92:95], v[152:155], v[120:123]
s_waitcnt lgkmcnt(3)
v_mfma_f32_16x16x32_bf16 v[28:31], a[80:83], v[156:159], v[28:31]
ds_read_b128 v[140:143], v227 offset:49408
v_mfma_f32_16x16x32_bf16 v[60:63], a[84:87], v[156:159], v[60:63]
s_add_u32 s41, s41, 16384
s_add_u32 m0, s43, 57600
ds_read_b128 v[144:147], v228 offset:49408
v_mfma_f32_16x16x32_bf16 v[92:95], a[88:91], v[156:159], v[92:95]
buffer_load_dwordx4 v252, s[12:15], s41 offen offset:0 sc1 lds
v_mfma_f32_16x16x32_bf16 v[124:127], a[92:95], v[156:159], v[124:127]
s_waitcnt vmcnt(26) lgkmcnt(4)
v_mfma_f32_16x16x32_bf16 v[0:3], a[96:99], v[128:131], v[0:3]
s_waitcnt vmcnt(25)
ds_read_b128 v[148:151], v229 offset:49408
v_mfma_f32_16x16x32_bf16 v[32:35], a[100:103], v[128:131], v[32:35]
s_waitcnt lgkmcnt(4)
buffer_load_dwordx4 v241, s[12:15], s41 offen offset:1024 sc1 lds
v_mfma_f32_16x16x32_bf16 v[4:7], a[96:99], v[132:135], v[4:7]
ds_read_b128 v[152:155], v230 offset:49408
v_mfma_f32_16x16x32_bf16 v[36:39], a[100:103], v[132:135], v[36:39]
s_waitcnt lgkmcnt(4)
v_mfma_f32_16x16x32_bf16 v[8:11], a[96:99], v[136:139], v[8:11]
s_bfe_u32 s26, s36, 262172
s_mul_i32 s40, s26, 32768
ds_read_b128 v[156:159], v231 offset:49408
v_mfma_f32_16x16x32_bf16 v[40:43], a[100:103], v[136:139], v[40:43]
s_waitcnt lgkmcnt(4)
buffer_load_dwordx4 a[192:195], v252, s[16:19], s40 offen offset:0 sc1
v_mfma_f32_16x16x32_bf16 v[12:15], a[96:99], v[140:143], v[12:15]
ds_read_b128 v[128:131], v224 offset:57600
v_mfma_f32_16x16x32_bf16 v[44:47], a[100:103], v[140:143], v[44:47]
s_waitcnt lgkmcnt(4)
v_mfma_f32_16x16x32_bf16 v[16:19], a[96:99], v[144:147], v[16:19]
ds_read_b128 v[132:135], v225 offset:57600
v_mfma_f32_16x16x32_bf16 v[48:51], a[100:103], v[144:147], v[48:51]
s_waitcnt lgkmcnt(4)
buffer_load_dwordx4 a[196:199], v252, s[16:19], s40 offen offset:2048 sc1
v_mfma_f32_16x16x32_bf16 v[20:23], a[96:99], v[148:151], v[20:23]
ds_read_b128 v[136:139], v226 offset:57600
v_mfma_f32_16x16x32_bf16 v[52:55], a[100:103], v[148:151], v[52:55]
s_waitcnt lgkmcnt(4)
v_mfma_f32_16x16x32_bf16 v[24:27], a[96:99], v[152:155], v[24:27]
ds_read_b128 v[140:143], v227 offset:57600
v_mfma_f32_16x16x32_bf16 v[56:59], a[100:103], v[152:155], v[56:59]
s_waitcnt lgkmcnt(4)
v_mfma_f32_16x16x32_bf16 v[28:31], a[96:99], v[156:159], v[28:31]
ds_read_b128 v[144:147], v228 offset:57600
v_mfma_f32_16x16x32_bf16 v[60:63], a[100:103], v[156:159], v[60:63]
s_waitcnt vmcnt(27) lgkmcnt(4)
v_mfma_f32_16x16x32_bf16 v[0:3], a[112:115], v[128:131], v[0:3]
s_waitcnt vmcnt(26)
s_add_u32 s40, s40, 8192
ds_read_b128 v[148:151], v229 offset:57600
v_mfma_f32_16x16x32_bf16 v[32:35], a[116:119], v[128:131], v[32:35]
s_waitcnt lgkmcnt(4)
buffer_load_dwordx4 a[208:211], v252, s[16:19], s40 offen offset:0 sc1
v_mfma_f32_16x16x32_bf16 v[4:7], a[112:115], v[132:135], v[4:7]
ds_read_b128 v[152:155], v230 offset:57600
v_mfma_f32_16x16x32_bf16 v[36:39], a[116:119], v[132:135], v[36:39]
s_waitcnt lgkmcnt(4)
v_mfma_f32_16x16x32_bf16 v[8:11], a[112:115], v[136:139], v[8:11]
ds_read_b128 v[156:159], v231 offset:57600
v_mfma_f32_16x16x32_bf16 v[40:43], a[116:119], v[136:139], v[40:43]
s_waitcnt vmcnt(19) lgkmcnt(4)
s_barrier
buffer_load_dwordx4 a[212:215], v252, s[16:19], s40 offen offset:2048 sc1
v_mfma_f32_16x16x32_bf16 v[12:15], a[112:115], v[140:143], v[12:15]
ds_read_b128 v[128:131], v216 offset:0
v_mfma_f32_16x16x32_bf16 v[44:47], a[116:119], v[140:143], v[44:47]
s_waitcnt lgkmcnt(4)
v_mfma_f32_16x16x32_bf16 v[16:19], a[112:115], v[144:147], v[16:19]
s_add_u32 s40, s40, 8192
ds_read_b128 v[132:135], v217 offset:0
v_mfma_f32_16x16x32_bf16 v[48:51], a[116:119], v[144:147], v[48:51]
s_waitcnt lgkmcnt(4)
buffer_load_dwordx4 a[224:227], v252, s[16:19], s40 offen offset:0 sc1
v_mfma_f32_16x16x32_bf16 v[20:23], a[112:115], v[148:151], v[20:23]
ds_read_b128 v[136:139], v218 offset:0
v_mfma_f32_16x16x32_bf16 v[52:55], a[116:119], v[148:151], v[52:55]
s_waitcnt lgkmcnt(4)
v_mfma_f32_16x16x32_bf16 v[24:27], a[112:115], v[152:155], v[24:27]
ds_read_b128 v[140:143], v219 offset:0
v_mfma_f32_16x16x32_bf16 v[56:59], a[116:119], v[152:155], v[56:59]
s_waitcnt lgkmcnt(4)
buffer_load_dwordx4 a[228:231], v252, s[16:19], s40 offen offset:2048 sc1
v_mfma_f32_16x16x32_bf16 v[28:31], a[112:115], v[156:159], v[28:31]
ds_read_b128 v[144:147], v220 offset:0
v_mfma_f32_16x16x32_bf16 v[60:63], a[116:119], v[156:159], v[60:63]
s_waitcnt vmcnt(21) lgkmcnt(4)
v_mfma_f32_16x16x32_bf16 v[0:3], a[128:131], v[128:131], v[0:3]
s_waitcnt vmcnt(20)
s_add_u32 s40, s40, 8192
ds_read_b128 v[148:151], v221 offset:0
v_mfma_f32_16x16x32_bf16 v[32:35], a[132:135], v[128:131], v[32:35]
s_waitcnt lgkmcnt(4)
buffer_load_dwordx4 a[240:243], v252, s[16:19], s40 offen offset:0 sc1
v_mfma_f32_16x16x32_bf16 v[4:7], a[128:131], v[132:135], v[4:7]
ds_read_b128 v[152:155], v222 offset:0
v_mfma_f32_16x16x32_bf16 v[36:39], a[132:135], v[132:135], v[36:39]
s_waitcnt lgkmcnt(4)
v_mfma_f32_16x16x32_bf16 v[8:11], a[128:131], v[136:139], v[8:11]
ds_read_b128 v[156:159], v223 offset:0
v_mfma_f32_16x16x32_bf16 v[40:43], a[132:135], v[136:139], v[40:43]
s_waitcnt lgkmcnt(4)
v_mfma_f32_16x16x32_bf16 v[12:15], a[128:131], v[140:143], v[12:15]
ds_read_b128 v[128:131], v216 offset:8192
v_mfma_f32_16x16x32_bf16 v[44:47], a[132:135], v[140:143], v[44:47]
s_waitcnt lgkmcnt(4)
v_mfma_f32_16x16x32_bf16 v[16:19], a[128:131], v[144:147], v[16:19]
ds_read_b128 v[132:135], v217 offset:8192
v_mfma_f32_16x16x32_bf16 v[48:51], a[132:135], v[144:147], v[48:51]
s_waitcnt lgkmcnt(4)
buffer_load_dwordx4 a[244:247], v252, s[16:19], s40 offen offset:2048 sc1
v_mfma_f32_16x16x32_bf16 v[20:23], a[128:131], v[148:151], v[20:23]
ds_read_b128 v[136:139], v218 offset:8192
v_mfma_f32_16x16x32_bf16 v[52:55], a[132:135], v[148:151], v[52:55]
s_waitcnt lgkmcnt(4)
v_mfma_f32_16x16x32_bf16 v[24:27], a[128:131], v[152:155], v[24:27]
s_bfe_u32 s26, s36, 262164
s_mul_i32 s40, s26, 32768
ds_read_b128 v[140:143], v219 offset:8192
v_mfma_f32_16x16x32_bf16 v[56:59], a[132:135], v[152:155], v[56:59]
s_waitcnt lgkmcnt(4)
s_add_u32 s40, s40, 16384
buffer_load_dwordx4 a[104:107], v253, s[16:19], s40 offen offset:0 sc1
v_mfma_f32_16x16x32_bf16 v[28:31], a[128:131], v[156:159], v[28:31]
ds_read_b128 v[144:147], v220 offset:8192
v_mfma_f32_16x16x32_bf16 v[60:63], a[132:135], v[156:159], v[60:63]
s_waitcnt vmcnt(22) lgkmcnt(4)
v_mfma_f32_16x16x32_bf16 v[0:3], a[144:147], v[128:131], v[0:3]
s_waitcnt vmcnt(21)
ds_read_b128 v[148:151], v221 offset:8192
v_mfma_f32_16x16x32_bf16 v[32:35], a[148:151], v[128:131], v[32:35]
s_waitcnt lgkmcnt(4)
buffer_load_dwordx4 a[108:111], v253, s[16:19], s40 offen offset:2048 sc1
v_mfma_f32_16x16x32_bf16 v[4:7], a[144:147], v[132:135], v[4:7]
ds_read_b128 v[152:155], v222 offset:8192
v_mfma_f32_16x16x32_bf16 v[36:39], a[148:151], v[132:135], v[36:39]
s_waitcnt lgkmcnt(4)
v_mfma_f32_16x16x32_bf16 v[8:11], a[144:147], v[136:139], v[8:11]
s_add_u32 s40, s40, 8192
ds_read_b128 v[156:159], v223 offset:8192
v_mfma_f32_16x16x32_bf16 v[40:43], a[148:151], v[136:139], v[40:43]
s_waitcnt lgkmcnt(4)
buffer_load_dwordx4 a[120:123], v253, s[16:19], s40 offen offset:0 sc1
v_mfma_f32_16x16x32_bf16 v[12:15], a[144:147], v[140:143], v[12:15]
ds_read_b128 v[128:131], v216 offset:16384
v_mfma_f32_16x16x32_bf16 v[44:47], a[148:151], v[140:143], v[44:47]
s_waitcnt lgkmcnt(4)
v_mfma_f32_16x16x32_bf16 v[16:19], a[144:147], v[144:147], v[16:19]
ds_read_b128 v[132:135], v217 offset:16384
v_mfma_f32_16x16x32_bf16 v[48:51], a[148:151], v[144:147], v[48:51]
s_waitcnt lgkmcnt(4)
buffer_load_dwordx4 a[124:127], v253, s[16:19], s40 offen offset:2048 sc1
v_mfma_f32_16x16x32_bf16 v[20:23], a[144:147], v[148:151], v[20:23]
ds_read_b128 v[136:139], v218 offset:16384
v_mfma_f32_16x16x32_bf16 v[52:55], a[148:151], v[148:151], v[52:55]
s_waitcnt lgkmcnt(4)
v_mfma_f32_16x16x32_bf16 v[24:27], a[144:147], v[152:155], v[24:27]
ds_read_b128 v[140:143], v219 offset:16384
v_mfma_f32_16x16x32_bf16 v[56:59], a[148:151], v[152:155], v[56:59]
s_waitcnt lgkmcnt(4)
v_mfma_f32_16x16x32_bf16 v[28:31], a[144:147], v[156:159], v[28:31]
ds_read_b128 v[144:147], v220 offset:16384
v_mfma_f32_16x16x32_bf16 v[60:63], a[148:151], v[156:159], v[60:63]
s_waitcnt vmcnt(23) lgkmcnt(4)
v_mfma_f32_16x16x32_bf16 v[0:3], a[160:163], v[128:131], v[0:3]
s_waitcnt vmcnt(22)
s_bfe_u32 s26, s36, 262168
ds_read_b128 v[148:151], v221 offset:16384
v_mfma_f32_16x16x32_bf16 v[32:35], a[164:167], v[128:131], v[32:35]
s_waitcnt lgkmcnt(4)
s_mul_i32 s40, s26, 32768
buffer_load_dwordx4 a[136:139], v253, s[16:19], s40 offen offset:0 sc1
v_mfma_f32_16x16x32_bf16 v[4:7], a[160:163], v[132:135], v[4:7]
ds_read_b128 v[152:155], v222 offset:16384
v_mfma_f32_16x16x32_bf16 v[36:39], a[164:167], v[132:135], v[36:39]
s_waitcnt lgkmcnt(4)
v_mfma_f32_16x16x32_bf16 v[8:11], a[160:163], v[136:139], v[8:11]
ds_read_b128 v[156:159], v223 offset:16384
v_mfma_f32_16x16x32_bf16 v[40:43], a[164:167], v[136:139], v[40:43]
s_waitcnt lgkmcnt(4)
buffer_load_dwordx4 a[140:143], v253, s[16:19], s40 offen offset:2048 sc1
v_mfma_f32_16x16x32_bf16 v[12:15], a[160:163], v[140:143], v[12:15]
ds_read_b128 v[128:131], v216 offset:24576
v_mfma_f32_16x16x32_bf16 v[44:47], a[164:167], v[140:143], v[44:47]
s_waitcnt lgkmcnt(4)
v_mfma_f32_16x16x32_bf16 v[16:19], a[160:163], v[144:147], v[16:19]
s_add_u32 s40, s40, 8192
ds_read_b128 v[132:135], v217 offset:24576
v_mfma_f32_16x16x32_bf16 v[48:51], a[164:167], v[144:147], v[48:51]
s_waitcnt lgkmcnt(4)
buffer_load_dwordx4 a[152:155], v253, s[16:19], s40 offen offset:0 sc1
v_mfma_f32_16x16x32_bf16 v[20:23], a[160:163], v[148:151], v[20:23]
ds_read_b128 v[136:139], v218 offset:24576
v_mfma_f32_16x16x32_bf16 v[52:55], a[164:167], v[148:151], v[52:55]
s_waitcnt lgkmcnt(4)
v_mfma_f32_16x16x32_bf16 v[24:27], a[160:163], v[152:155], v[24:27]
ds_read_b128 v[140:143], v219 offset:24576
v_mfma_f32_16x16x32_bf16 v[56:59], a[164:167], v[152:155], v[56:59]
s_waitcnt lgkmcnt(4)
buffer_load_dwordx4 a[156:159], v253, s[16:19], s40 offen offset:2048 sc1
v_mfma_f32_16x16x32_bf16 v[28:31], a[160:163], v[156:159], v[28:31]
ds_read_b128 v[144:147], v220 offset:24576
v_mfma_f32_16x16x32_bf16 v[60:63], a[164:167], v[156:159], v[60:63]
s_waitcnt vmcnt(25) lgkmcnt(4)
v_mfma_f32_16x16x32_bf16 v[0:3], a[176:179], v[128:131], v[0:3]
s_waitcnt vmcnt(24)
s_add_u32 s40, s40, 8192
ds_read_b128 v[148:151], v221 offset:24576
v_mfma_f32_16x16x32_bf16 v[32:35], a[180:183], v[128:131], v[32:35]
s_waitcnt lgkmcnt(4)
buffer_load_dwordx4 a[168:171], v253, s[16:19], s40 offen offset:0 sc1
v_mfma_f32_16x16x32_bf16 v[4:7], a[176:179], v[132:135], v[4:7]
ds_read_b128 v[152:155], v222 offset:24576
v_mfma_f32_16x16x32_bf16 v[36:39], a[180:183], v[132:135], v[36:39]
s_waitcnt lgkmcnt(4)
v_mfma_f32_16x16x32_bf16 v[8:11], a[176:179], v[136:139], v[8:11]
ds_read_b128 v[156:159], v223 offset:24576
v_mfma_f32_16x16x32_bf16 v[40:43], a[180:183], v[136:139], v[40:43]
s_waitcnt vmcnt(17) lgkmcnt(4)
s_barrier
v_mfma_f32_16x16x32_bf16 v[12:15], a[176:179], v[140:143], v[12:15]
ds_read_b128 v[128:131], v216 offset:33024
v_mfma_f32_16x16x32_bf16 v[44:47], a[180:183], v[140:143], v[44:47]
s_waitcnt lgkmcnt(4)
v_mfma_f32_16x16x32_bf16 v[16:19], a[176:179], v[144:147], v[16:19]
ds_read_b128 v[132:135], v217 offset:33024
v_mfma_f32_16x16x32_bf16 v[48:51], a[180:183], v[144:147], v[48:51]
s_waitcnt lgkmcnt(4)
buffer_load_dwordx4 a[172:175], v253, s[16:19], s40 offen offset:2048 sc1
v_mfma_f32_16x16x32_bf16 v[20:23], a[176:179], v[148:151], v[20:23]
ds_read_b128 v[136:139], v218 offset:33024
v_mfma_f32_16x16x32_bf16 v[52:55], a[180:183], v[148:151], v[52:55]
s_waitcnt lgkmcnt(4)
v_mfma_f32_16x16x32_bf16 v[24:27], a[176:179], v[152:155], v[24:27]
s_add_u32 s40, s40, 8192
ds_read_b128 v[140:143], v219 offset:33024
v_mfma_f32_16x16x32_bf16 v[56:59], a[180:183], v[152:155], v[56:59]
s_waitcnt lgkmcnt(4)
buffer_load_dwordx4 a[184:187], v253, s[16:19], s40 offen offset:0 sc1
v_mfma_f32_16x16x32_bf16 v[28:31], a[176:179], v[156:159], v[28:31]
ds_read_b128 v[144:147], v220 offset:33024
v_mfma_f32_16x16x32_bf16 v[60:63], a[180:183], v[156:159], v[60:63]
s_waitcnt vmcnt(18) lgkmcnt(4)
v_mfma_f32_16x16x32_bf16 v[0:3], a[192:195], v[128:131], v[0:3]
s_waitcnt vmcnt(17)
ds_read_b128 v[148:151], v221 offset:33024
v_mfma_f32_16x16x32_bf16 v[32:35], a[196:199], v[128:131], v[32:35]
s_waitcnt lgkmcnt(4)
buffer_load_dwordx4 a[188:191], v253, s[16:19], s40 offen offset:2048 sc1
v_mfma_f32_16x16x32_bf16 v[4:7], a[192:195], v[132:135], v[4:7]
ds_read_b128 v[152:155], v222 offset:33024
v_mfma_f32_16x16x32_bf16 v[36:39], a[196:199], v[132:135], v[36:39]
s_waitcnt lgkmcnt(4)
v_mfma_f32_16x16x32_bf16 v[8:11], a[192:195], v[136:139], v[8:11]
s_bfe_u32 s26, s36, 262172
s_mul_i32 s40, s26, 32768
ds_read_b128 v[156:159], v223 offset:33024
v_mfma_f32_16x16x32_bf16 v[40:43], a[196:199], v[136:139], v[40:43]
s_waitcnt lgkmcnt(4)
buffer_load_dwordx4 a[200:203], v253, s[16:19], s40 offen offset:0 sc1
v_mfma_f32_16x16x32_bf16 v[12:15], a[192:195], v[140:143], v[12:15]
ds_read_b128 v[128:131], v216 offset:41216
v_mfma_f32_16x16x32_bf16 v[44:47], a[196:199], v[140:143], v[44:47]
s_waitcnt lgkmcnt(4)
v_mfma_f32_16x16x32_bf16 v[16:19], a[192:195], v[144:147], v[16:19]
ds_read_b128 v[132:135], v217 offset:41216
v_mfma_f32_16x16x32_bf16 v[48:51], a[196:199], v[144:147], v[48:51]
s_waitcnt lgkmcnt(4)
buffer_load_dwordx4 a[204:207], v253, s[16:19], s40 offen offset:2048 sc1
v_mfma_f32_16x16x32_bf16 v[20:23], a[192:195], v[148:151], v[20:23]
ds_read_b128 v[136:139], v218 offset:41216
v_mfma_f32_16x16x32_bf16 v[52:55], a[196:199], v[148:151], v[52:55]
s_waitcnt lgkmcnt(4)
v_mfma_f32_16x16x32_bf16 v[24:27], a[192:195], v[152:155], v[24:27]
ds_read_b128 v[140:143], v219 offset:41216
v_mfma_f32_16x16x32_bf16 v[56:59], a[196:199], v[152:155], v[56:59]
s_waitcnt lgkmcnt(4)
v_mfma_f32_16x16x32_bf16 v[28:31], a[192:195], v[156:159], v[28:31]
ds_read_b128 v[144:147], v220 offset:41216
v_mfma_f32_16x16x32_bf16 v[60:63], a[196:199], v[156:159], v[60:63]
s_waitcnt vmcnt(19) lgkmcnt(4)
v_mfma_f32_16x16x32_bf16 v[0:3], a[208:211], v[128:131], v[0:3]
s_waitcnt vmcnt(18)
s_add_u32 s40, s40, 8192
ds_read_b128 v[148:151], v221 offset:41216
v_mfma_f32_16x16x32_bf16 v[32:35], a[212:215], v[128:131], v[32:35]
s_waitcnt lgkmcnt(4)
buffer_load_dwordx4 a[216:219], v253, s[16:19], s40 offen offset:0 sc1
v_mfma_f32_16x16x32_bf16 v[4:7], a[208:211], v[132:135], v[4:7]
ds_read_b128 v[152:155], v222 offset:41216
v_mfma_f32_16x16x32_bf16 v[36:39], a[212:215], v[132:135], v[36:39]
s_waitcnt lgkmcnt(4)
v_mfma_f32_16x16x32_bf16 v[8:11], a[208:211], v[136:139], v[8:11]
ds_read_b128 v[156:159], v223 offset:41216
v_mfma_f32_16x16x32_bf16 v[40:43], a[212:215], v[136:139], v[40:43]
s_waitcnt lgkmcnt(4)
buffer_load_dwordx4 a[220:223], v253, s[16:19], s40 offen offset:2048 sc1
v_mfma_f32_16x16x32_bf16 v[12:15], a[208:211], v[140:143], v[12:15]
ds_read_b128 v[128:131], v216 offset:49408
v_mfma_f32_16x16x32_bf16 v[44:47], a[212:215], v[140:143], v[44:47]
s_waitcnt lgkmcnt(4)
v_mfma_f32_16x16x32_bf16 v[16:19], a[208:211], v[144:147], v[16:19]
s_add_u32 s40, s40, 8192
ds_read_b128 v[132:135], v217 offset:49408
v_mfma_f32_16x16x32_bf16 v[48:51], a[212:215], v[144:147], v[48:51]
s_waitcnt lgkmcnt(4)
buffer_load_dwordx4 a[232:235], v253, s[16:19], s40 offen offset:0 sc1
v_mfma_f32_16x16x32_bf16 v[20:23], a[208:211], v[148:151], v[20:23]
ds_read_b128 v[136:139], v218 offset:49408
v_mfma_f32_16x16x32_bf16 v[52:55], a[212:215], v[148:151], v[52:55]
s_waitcnt lgkmcnt(4)
v_mfma_f32_16x16x32_bf16 v[24:27], a[208:211], v[152:155], v[24:27]
ds_read_b128 v[140:143], v219 offset:49408
v_mfma_f32_16x16x32_bf16 v[56:59], a[212:215], v[152:155], v[56:59]
s_waitcnt lgkmcnt(4)
buffer_load_dwordx4 a[236:239], v253, s[16:19], s40 offen offset:2048 sc1
v_mfma_f32_16x16x32_bf16 v[28:31], a[208:211], v[156:159], v[28:31]
ds_read_b128 v[144:147], v220 offset:49408
v_mfma_f32_16x16x32_bf16 v[60:63], a[212:215], v[156:159], v[60:63]
s_waitcnt vmcnt(21) lgkmcnt(4)
v_mfma_f32_16x16x32_bf16 v[0:3], a[224:227], v[128:131], v[0:3]
s_waitcnt vmcnt(20)
s_add_u32 s40, s40, 8192
ds_read_b128 v[148:151], v221 offset:49408
v_mfma_f32_16x16x32_bf16 v[32:35], a[228:231], v[128:131], v[32:35]
s_waitcnt lgkmcnt(4)
buffer_load_dwordx4 a[248:251], v253, s[16:19], s40 offen offset:0 sc1
v_mfma_f32_16x16x32_bf16 v[4:7], a[224:227], v[132:135], v[4:7]
ds_read_b128 v[152:155], v222 offset:49408
v_mfma_f32_16x16x32_bf16 v[36:39], a[228:231], v[132:135], v[36:39]
s_waitcnt lgkmcnt(4)
v_mfma_f32_16x16x32_bf16 v[8:11], a[224:227], v[136:139], v[8:11]
ds_read_b128 v[156:159], v223 offset:49408
v_mfma_f32_16x16x32_bf16 v[40:43], a[228:231], v[136:139], v[40:43]
s_waitcnt lgkmcnt(4)
v_mfma_f32_16x16x32_bf16 v[12:15], a[224:227], v[140:143], v[12:15]
ds_read_b128 v[128:131], v216 offset:57600
v_mfma_f32_16x16x32_bf16 v[44:47], a[228:231], v[140:143], v[44:47]
s_waitcnt lgkmcnt(4)
v_mfma_f32_16x16x32_bf16 v[16:19], a[224:227], v[144:147], v[16:19]
ds_read_b128 v[132:135], v217 offset:57600
v_mfma_f32_16x16x32_bf16 v[48:51], a[228:231], v[144:147], v[48:51]
s_waitcnt lgkmcnt(4)
buffer_load_dwordx4 a[252:255], v253, s[16:19], s40 offen offset:2048 sc1
v_mfma_f32_16x16x32_bf16 v[20:23], a[224:227], v[148:151], v[20:23]
ds_read_b128 v[136:139], v218 offset:57600
v_mfma_f32_16x16x32_bf16 v[52:55], a[228:231], v[148:151], v[52:55]
s_waitcnt lgkmcnt(4)
v_mfma_f32_16x16x32_bf16 v[24:27], a[224:227], v[152:155], v[24:27]
ds_read_b128 v[140:143], v219 offset:57600
v_mfma_f32_16x16x32_bf16 v[56:59], a[228:231], v[152:155], v[56:59]
s_waitcnt lgkmcnt(4)
v_mfma_f32_16x16x32_bf16 v[28:31], a[224:227], v[156:159], v[28:31]
ds_read_b128 v[144:147], v220 offset:57600
v_mfma_f32_16x16x32_bf16 v[60:63], a[228:231], v[156:159], v[60:63]
s_waitcnt vmcnt(21) lgkmcnt(4)
v_mfma_f32_16x16x32_bf16 v[0:3], a[240:243], v[128:131], v[0:3]
s_waitcnt vmcnt(20)
ds_read_b128 v[148:151], v221 offset:57600
v_mfma_f32_16x16x32_bf16 v[32:35], a[244:247], v[128:131], v[32:35]
s_waitcnt lgkmcnt(4)
v_mfma_f32_16x16x32_bf16 v[4:7], a[240:243], v[132:135], v[4:7]
ds_read_b128 v[152:155], v222 offset:57600
v_mfma_f32_16x16x32_bf16 v[36:39], a[244:247], v[132:135], v[36:39]
s_waitcnt lgkmcnt(4)
v_mfma_f32_16x16x32_bf16 v[8:11], a[240:243], v[136:139], v[8:11]
ds_read_b128 v[156:159], v223 offset:57600
v_mfma_f32_16x16x32_bf16 v[40:43], a[244:247], v[136:139], v[40:43]
s_waitcnt lgkmcnt(4)
v_mfma_f32_16x16x32_bf16 v[12:15], a[240:243], v[140:143], v[12:15]
ds_read_b128 v[128:131], v224 offset:49408
v_mfma_f32_16x16x32_bf16 v[44:47], a[244:247], v[140:143], v[44:47]
s_waitcnt lgkmcnt(4)
v_mfma_f32_16x16x32_bf16 v[16:19], a[240:243], v[144:147], v[16:19]
ds_read_b128 v[132:135], v225 offset:49408
v_mfma_f32_16x16x32_bf16 v[48:51], a[244:247], v[144:147], v[48:51]
s_waitcnt lgkmcnt(4)
v_mfma_f32_16x16x32_bf16 v[20:23], a[240:243], v[148:151], v[20:23]
ds_read_b128 v[136:139], v226 offset:49408
v_mfma_f32_16x16x32_bf16 v[52:55], a[244:247], v[148:151], v[52:55]
s_waitcnt lgkmcnt(4)
v_mfma_f32_16x16x32_bf16 v[24:27], a[240:243], v[152:155], v[24:27]
ds_read_b128 v[140:143], v227 offset:49408
v_mfma_f32_16x16x32_bf16 v[56:59], a[244:247], v[152:155], v[56:59]
s_waitcnt lgkmcnt(4)
v_mfma_f32_16x16x32_bf16 v[28:31], a[240:243], v[156:159], v[28:31]
ds_read_b128 v[144:147], v228 offset:49408
v_mfma_f32_16x16x32_bf16 v[60:63], a[244:247], v[156:159], v[60:63]
s_waitcnt vmcnt(19) lgkmcnt(4)
v_mfma_f32_16x16x32_bf16 v[64:67], a[104:107], v[128:131], v[64:67]
s_waitcnt vmcnt(18)
ds_read_b128 v[148:151], v229 offset:49408
v_mfma_f32_16x16x32_bf16 v[96:99], a[108:111], v[128:131], v[96:99]
s_waitcnt lgkmcnt(4)
v_mfma_f32_16x16x32_bf16 v[68:71], a[104:107], v[132:135], v[68:71]
ds_read_b128 v[152:155], v230 offset:49408
v_mfma_f32_16x16x32_bf16 v[100:103], a[108:111], v[132:135], v[100:103]
s_waitcnt lgkmcnt(4)
v_mfma_f32_16x16x32_bf16 v[72:75], a[104:107], v[136:139], v[72:75]
ds_read_b128 v[156:159], v231 offset:49408
v_mfma_f32_16x16x32_bf16 v[104:107], a[108:111], v[136:139], v[104:107]
s_waitcnt lgkmcnt(4)
v_mfma_f32_16x16x32_bf16 v[76:79], a[104:107], v[140:143], v[76:79]
s_add_u32 s27, s42, 0
ds_read_b128 v[128:131], v224 offset:57600
v_cvt_pk_bf16_f32 v184, v0, v4
v_mfma_f32_16x16x32_bf16 v[108:111], a[108:111], v[140:143], v[108:111]
s_waitcnt lgkmcnt(4)
v_cvt_pk_bf16_f32 v185, v8, v12
v_mfma_f32_16x16x32_bf16 v[80:83], a[104:107], v[144:147], v[80:83]
ds_read_b128 v[132:135], v225 offset:57600
v_cvt_pk_bf16_f32 v186, v16, v20
v_mfma_f32_16x16x32_bf16 v[112:115], a[108:111], v[144:147], v[112:115]
s_waitcnt lgkmcnt(4)
v_cvt_pk_bf16_f32 v187, v24, v28
v_mfma_f32_16x16x32_bf16 v[84:87], a[104:107], v[148:151], v[84:87]
ds_read_b128 v[136:139], v226 offset:57600
buffer_store_dwordx4 v[184:187], v183, s[8:11], s27 offen sc1
v_mfma_f32_16x16x32_bf16 v[116:119], a[108:111], v[148:151], v[116:119]
s_waitcnt lgkmcnt(4)
s_add_u32 s27, s42, 7168
v_cvt_pk_bf16_f32 v188, v1, v5
v_mfma_f32_16x16x32_bf16 v[88:91], a[104:107], v[152:155], v[88:91]
ds_read_b128 v[140:143], v227 offset:57600
v_cvt_pk_bf16_f32 v189, v9, v13
v_mfma_f32_16x16x32_bf16 v[120:123], a[108:111], v[152:155], v[120:123]
s_waitcnt lgkmcnt(4)
v_cvt_pk_bf16_f32 v190, v17, v21
v_mfma_f32_16x16x32_bf16 v[92:95], a[104:107], v[156:159], v[92:95]
ds_read_b128 v[144:147], v228 offset:57600
v_cvt_pk_bf16_f32 v191, v25, v29
v_mfma_f32_16x16x32_bf16 v[124:127], a[108:111], v[156:159], v[124:127]
s_waitcnt vmcnt(18) lgkmcnt(4)
buffer_store_dwordx4 v[188:191], v183, s[8:11], s27 offen sc1
v_mfma_f32_16x16x32_bf16 v[64:67], a[120:123], v[128:131], v[64:67]
s_waitcnt vmcnt(18)
s_add_u32 s27, s42, 14336
ds_read_b128 v[148:151], v229 offset:57600
v_mfma_f32_16x16x32_bf16 v[96:99], a[124:127], v[128:131], v[96:99]
s_waitcnt lgkmcnt(4)
v_cvt_pk_bf16_f32 v192, v2, v6
v_cvt_pk_bf16_f32 v193, v10, v14
v_mfma_f32_16x16x32_bf16 v[68:71], a[120:123], v[132:135], v[68:71]
ds_read_b128 v[152:155], v230 offset:57600
v_cvt_pk_bf16_f32 v194, v18, v22
v_mfma_f32_16x16x32_bf16 v[100:103], a[124:127], v[132:135], v[100:103]
s_waitcnt lgkmcnt(4)
v_cvt_pk_bf16_f32 v195, v26, v30
v_mfma_f32_16x16x32_bf16 v[72:75], a[120:123], v[136:139], v[72:75]
ds_read_b128 v[156:159], v231 offset:57600
buffer_store_dwordx4 v[192:195], v183, s[8:11], s27 offen sc1
v_mfma_f32_16x16x32_bf16 v[104:107], a[124:127], v[136:139], v[104:107]
s_waitcnt lgkmcnt(4)
s_add_u32 s27, s42, 21504
v_cvt_pk_bf16_f32 v196, v3, v7
v_mfma_f32_16x16x32_bf16 v[76:79], a[120:123], v[140:143], v[76:79]
ds_read_b128 v[128:131], v216 offset:0
v_cvt_pk_bf16_f32 v197, v11, v15
v_mfma_f32_16x16x32_bf16 v[108:111], a[124:127], v[140:143], v[108:111]
s_waitcnt lgkmcnt(4)
v_cvt_pk_bf16_f32 v198, v19, v23
v_mfma_f32_16x16x32_bf16 v[80:83], a[120:123], v[144:147], v[80:83]
ds_read_b128 v[132:135], v217 offset:0
v_cvt_pk_bf16_f32 v199, v27, v31
v_mfma_f32_16x16x32_bf16 v[112:115], a[124:127], v[144:147], v[112:115]
s_waitcnt lgkmcnt(4)
buffer_store_dwordx4 v[196:199], v183, s[8:11], s27 offen sc1
v_mfma_f32_16x16x32_bf16 v[84:87], a[120:123], v[148:151], v[84:87]
s_add_u32 s27, s42, 114688
ds_read_b128 v[136:139], v218 offset:0
v_cvt_pk_bf16_f32 v200, v32, v36
v_mfma_f32_16x16x32_bf16 v[116:119], a[124:127], v[148:151], v[116:119]
s_waitcnt lgkmcnt(4)
v_cvt_pk_bf16_f32 v201, v40, v44
v_mfma_f32_16x16x32_bf16 v[88:91], a[120:123], v[152:155], v[88:91]
ds_read_b128 v[140:143], v219 offset:0
v_cvt_pk_bf16_f32 v202, v48, v52
v_mfma_f32_16x16x32_bf16 v[120:123], a[124:127], v[152:155], v[120:123]
s_waitcnt lgkmcnt(4)
v_cvt_pk_bf16_f32 v203, v56, v60
v_mfma_f32_16x16x32_bf16 v[92:95], a[120:123], v[156:159], v[92:95]
ds_read_b128 v[144:147], v220 offset:0
buffer_store_dwordx4 v[200:203], v183, s[8:11], s27 offen sc1
v_mfma_f32_16x16x32_bf16 v[124:127], a[124:127], v[156:159], v[124:127]
s_waitcnt vmcnt(20) lgkmcnt(4)
s_add_u32 s27, s42, 121856
v_cvt_pk_bf16_f32 v204, v33, v37
v_mfma_f32_16x16x32_bf16 v[64:67], a[136:139], v[128:131], v[64:67]
s_waitcnt vmcnt(19)
ds_read_b128 v[148:151], v221 offset:0
v_cvt_pk_bf16_f32 v205, v41, v45
v_mfma_f32_16x16x32_bf16 v[96:99], a[140:143], v[128:131], v[96:99]
s_waitcnt lgkmcnt(4)
v_cvt_pk_bf16_f32 v206, v49, v53
v_mfma_f32_16x16x32_bf16 v[68:71], a[136:139], v[132:135], v[68:71]
ds_read_b128 v[152:155], v222 offset:0
v_cvt_pk_bf16_f32 v207, v57, v61
v_mfma_f32_16x16x32_bf16 v[100:103], a[140:143], v[132:135], v[100:103]
s_waitcnt lgkmcnt(4)
buffer_store_dwordx4 v[204:207], v183, s[8:11], s27 offen sc1
v_mfma_f32_16x16x32_bf16 v[72:75], a[136:139], v[136:139], v[72:75]
s_add_u32 s27, s42, 129024
ds_read_b128 v[156:159], v223 offset:0
v_cvt_pk_bf16_f32 v208, v34, v38
v_mfma_f32_16x16x32_bf16 v[104:107], a[140:143], v[136:139], v[104:107]
s_waitcnt lgkmcnt(4)
v_cvt_pk_bf16_f32 v209, v42, v46
v_mfma_f32_16x16x32_bf16 v[76:79], a[136:139], v[140:143], v[76:79]
ds_read_b128 v[128:131], v216 offset:8192
v_cvt_pk_bf16_f32 v210, v50, v54
v_mfma_f32_16x16x32_bf16 v[108:111], a[140:143], v[140:143], v[108:111]
s_waitcnt lgkmcnt(4)
v_cvt_pk_bf16_f32 v211, v58, v62
v_mfma_f32_16x16x32_bf16 v[80:83], a[136:139], v[144:147], v[80:83]
ds_read_b128 v[132:135], v217 offset:8192
buffer_store_dwordx4 v[208:211], v183, s[8:11], s27 offen sc1
v_mfma_f32_16x16x32_bf16 v[112:115], a[140:143], v[144:147], v[112:115]
s_waitcnt lgkmcnt(4)
s_add_u32 s27, s42, 136192
v_cvt_pk_bf16_f32 v212, v35, v39
v_mfma_f32_16x16x32_bf16 v[84:87], a[136:139], v[148:151], v[84:87]
ds_read_b128 v[136:139], v218 offset:8192
v_cvt_pk_bf16_f32 v213, v43, v47
v_mfma_f32_16x16x32_bf16 v[116:119], a[140:143], v[148:151], v[116:119]
s_waitcnt lgkmcnt(4)
v_cvt_pk_bf16_f32 v214, v51, v55
v_mfma_f32_16x16x32_bf16 v[88:91], a[136:139], v[152:155], v[88:91]
ds_read_b128 v[140:143], v219 offset:8192
v_cvt_pk_bf16_f32 v215, v59, v63
v_mfma_f32_16x16x32_bf16 v[120:123], a[140:143], v[152:155], v[120:123]
s_waitcnt lgkmcnt(4)
buffer_store_dwordx4 v[212:215], v183, s[8:11], s27 offen sc1
v_mfma_f32_16x16x32_bf16 v[92:95], a[136:139], v[156:159], v[92:95]
ds_read_b128 v[144:147], v220 offset:8192
v_mfma_f32_16x16x32_bf16 v[124:127], a[140:143], v[156:159], v[124:127]
s_waitcnt vmcnt(21) lgkmcnt(4)
v_mfma_f32_16x16x32_bf16 v[64:67], a[152:155], v[128:131], v[64:67]
s_waitcnt lgkmcnt(3)
ds_read_b128 v[148:151], v221 offset:8192
v_mfma_f32_16x16x32_bf16 v[68:71], a[152:155], v[132:135], v[68:71]
s_waitcnt lgkmcnt(3)
ds_read_b128 v[152:155], v222 offset:8192
v_mfma_f32_16x16x32_bf16 v[72:75], a[152:155], v[136:139], v[72:75]
s_waitcnt lgkmcnt(3)
ds_read_b128 v[156:159], v223 offset:8192
v_mfma_f32_16x16x32_bf16 v[76:79], a[152:155], v[140:143], v[76:79]
s_waitcnt lgkmcnt(3)
ds_read_b128 v[128:131], v216 offset:16384
v_mfma_f32_16x16x32_bf16 v[80:83], a[152:155], v[144:147], v[80:83]
s_waitcnt lgkmcnt(3)
ds_read_b128 v[132:135], v217 offset:16384
v_mfma_f32_16x16x32_bf16 v[84:87], a[152:155], v[148:151], v[84:87]
s_waitcnt lgkmcnt(3)
ds_read_b128 v[136:139], v218 offset:16384
v_mfma_f32_16x16x32_bf16 v[88:91], a[152:155], v[152:155], v[88:91]
s_waitcnt lgkmcnt(3)
ds_read_b128 v[140:143], v219 offset:16384
v_mfma_f32_16x16x32_bf16 v[92:95], a[152:155], v[156:159], v[92:95]
s_waitcnt vmcnt(19) lgkmcnt(3)
ds_read_b128 v[144:147], v220 offset:16384
v_mfma_f32_16x16x32_bf16 v[64:67], a[168:171], v[128:131], v[64:67]
s_waitcnt lgkmcnt(3)
ds_read_b128 v[148:151], v221 offset:16384
v_mfma_f32_16x16x32_bf16 v[68:71], a[168:171], v[132:135], v[68:71]
s_waitcnt lgkmcnt(3)
ds_read_b128 v[152:155], v222 offset:16384
v_mfma_f32_16x16x32_bf16 v[72:75], a[168:171], v[136:139], v[72:75]
s_waitcnt lgkmcnt(3)
ds_read_b128 v[156:159], v223 offset:16384
v_mfma_f32_16x16x32_bf16 v[76:79], a[168:171], v[140:143], v[76:79]
s_waitcnt lgkmcnt(3)
ds_read_b128 v[128:131], v216 offset:24576
v_mfma_f32_16x16x32_bf16 v[80:83], a[168:171], v[144:147], v[80:83]
s_waitcnt lgkmcnt(3)
ds_read_b128 v[132:135], v217 offset:24576
v_mfma_f32_16x16x32_bf16 v[84:87], a[168:171], v[148:151], v[84:87]
s_waitcnt lgkmcnt(3)
ds_read_b128 v[136:139], v218 offset:24576
v_mfma_f32_16x16x32_bf16 v[88:91], a[168:171], v[152:155], v[88:91]
s_waitcnt lgkmcnt(3)
ds_read_b128 v[140:143], v219 offset:24576
v_mfma_f32_16x16x32_bf16 v[92:95], a[168:171], v[156:159], v[92:95]
s_waitcnt vmcnt(17) lgkmcnt(3)
ds_read_b128 v[144:147], v220 offset:24576
v_mfma_f32_16x16x32_bf16 v[64:67], a[184:187], v[128:131], v[64:67]
s_waitcnt lgkmcnt(3)
ds_read_b128 v[148:151], v221 offset:24576
v_mfma_f32_16x16x32_bf16 v[68:71], a[184:187], v[132:135], v[68:71]
s_waitcnt lgkmcnt(3)
ds_read_b128 v[152:155], v222 offset:24576
v_mfma_f32_16x16x32_bf16 v[72:75], a[184:187], v[136:139], v[72:75]
s_waitcnt lgkmcnt(3)
ds_read_b128 v[156:159], v223 offset:24576
v_mfma_f32_16x16x32_bf16 v[76:79], a[184:187], v[140:143], v[76:79]
s_waitcnt lgkmcnt(3)
ds_read_b128 v[128:131], v216 offset:33024
v_mfma_f32_16x16x32_bf16 v[80:83], a[184:187], v[144:147], v[80:83]
s_waitcnt lgkmcnt(3)
ds_read_b128 v[132:135], v217 offset:33024
v_mfma_f32_16x16x32_bf16 v[84:87], a[184:187], v[148:151], v[84:87]
s_waitcnt lgkmcnt(3)
ds_read_b128 v[136:139], v218 offset:33024
v_mfma_f32_16x16x32_bf16 v[88:91], a[184:187], v[152:155], v[88:91]
s_waitcnt lgkmcnt(3)
ds_read_b128 v[140:143], v219 offset:33024
v_mfma_f32_16x16x32_bf16 v[92:95], a[184:187], v[156:159], v[92:95]
s_waitcnt vmcnt(15) lgkmcnt(3)
ds_read_b128 v[144:147], v220 offset:33024
v_mfma_f32_16x16x32_bf16 v[64:67], a[200:203], v[128:131], v[64:67]
s_waitcnt lgkmcnt(3)
ds_read_b128 v[148:151], v221 offset:33024
v_mfma_f32_16x16x32_bf16 v[68:71], a[200:203], v[132:135], v[68:71]
s_waitcnt lgkmcnt(3)
ds_read_b128 v[152:155], v222 offset:33024
v_mfma_f32_16x16x32_bf16 v[72:75], a[200:203], v[136:139], v[72:75]
s_waitcnt lgkmcnt(3)
ds_read_b128 v[156:159], v223 offset:33024
v_mfma_f32_16x16x32_bf16 v[76:79], a[200:203], v[140:143], v[76:79]
s_waitcnt lgkmcnt(3)
ds_read_b128 v[128:131], v216 offset:41216
v_mfma_f32_16x16x32_bf16 v[80:83], a[200:203], v[144:147], v[80:83]
s_waitcnt lgkmcnt(3)
ds_read_b128 v[132:135], v217 offset:41216
v_mfma_f32_16x16x32_bf16 v[84:87], a[200:203], v[148:151], v[84:87]
s_waitcnt lgkmcnt(3)
ds_read_b128 v[136:139], v218 offset:41216
v_mfma_f32_16x16x32_bf16 v[88:91], a[200:203], v[152:155], v[88:91]
s_waitcnt lgkmcnt(3)
ds_read_b128 v[140:143], v219 offset:41216
v_mfma_f32_16x16x32_bf16 v[92:95], a[200:203], v[156:159], v[92:95]
s_waitcnt vmcnt(13) lgkmcnt(3)
ds_read_b128 v[144:147], v220 offset:41216
v_mfma_f32_16x16x32_bf16 v[64:67], a[216:219], v[128:131], v[64:67]
s_waitcnt lgkmcnt(3)
ds_read_b128 v[148:151], v221 offset:41216
v_mfma_f32_16x16x32_bf16 v[68:71], a[216:219], v[132:135], v[68:71]
s_waitcnt lgkmcnt(3)
ds_read_b128 v[152:155], v222 offset:41216
v_mfma_f32_16x16x32_bf16 v[72:75], a[216:219], v[136:139], v[72:75]
s_waitcnt lgkmcnt(3)
ds_read_b128 v[156:159], v223 offset:41216
v_mfma_f32_16x16x32_bf16 v[76:79], a[216:219], v[140:143], v[76:79]
s_waitcnt lgkmcnt(3)
ds_read_b128 v[128:131], v216 offset:49408
v_mfma_f32_16x16x32_bf16 v[80:83], a[216:219], v[144:147], v[80:83]
s_waitcnt lgkmcnt(3)
ds_read_b128 v[132:135], v217 offset:49408
v_mfma_f32_16x16x32_bf16 v[84:87], a[216:219], v[148:151], v[84:87]
s_waitcnt lgkmcnt(3)
ds_read_b128 v[136:139], v218 offset:49408
v_mfma_f32_16x16x32_bf16 v[88:91], a[216:219], v[152:155], v[88:91]
s_waitcnt lgkmcnt(3)
ds_read_b128 v[140:143], v219 offset:49408
v_mfma_f32_16x16x32_bf16 v[92:95], a[216:219], v[156:159], v[92:95]
s_waitcnt vmcnt(11) lgkmcnt(3)
ds_read_b128 v[144:147], v220 offset:49408
v_mfma_f32_16x16x32_bf16 v[64:67], a[232:235], v[128:131], v[64:67]
s_waitcnt lgkmcnt(3)
ds_read_b128 v[148:151], v221 offset:49408
v_mfma_f32_16x16x32_bf16 v[68:71], a[232:235], v[132:135], v[68:71]
s_waitcnt lgkmcnt(3)
ds_read_b128 v[152:155], v222 offset:49408
v_mfma_f32_16x16x32_bf16 v[72:75], a[232:235], v[136:139], v[72:75]
s_waitcnt lgkmcnt(3)
ds_read_b128 v[156:159], v223 offset:49408
v_mfma_f32_16x16x32_bf16 v[76:79], a[232:235], v[140:143], v[76:79]
s_waitcnt lgkmcnt(3)
ds_read_b128 v[128:131], v216 offset:57600
v_mfma_f32_16x16x32_bf16 v[80:83], a[232:235], v[144:147], v[80:83]
s_waitcnt lgkmcnt(3)
ds_read_b128 v[132:135], v217 offset:57600
v_mfma_f32_16x16x32_bf16 v[84:87], a[232:235], v[148:151], v[84:87]
s_waitcnt lgkmcnt(3)
ds_read_b128 v[136:139], v218 offset:57600
v_mfma_f32_16x16x32_bf16 v[88:91], a[232:235], v[152:155], v[88:91]
s_waitcnt lgkmcnt(3)
ds_read_b128 v[140:143], v219 offset:57600
v_mfma_f32_16x16x32_bf16 v[92:95], a[232:235], v[156:159], v[92:95]
s_waitcnt vmcnt(9) lgkmcnt(3)
ds_read_b128 v[144:147], v220 offset:57600
v_mfma_f32_16x16x32_bf16 v[64:67], a[248:251], v[128:131], v[64:67]
s_waitcnt lgkmcnt(3)
ds_read_b128 v[148:151], v221 offset:57600
v_mfma_f32_16x16x32_bf16 v[68:71], a[248:251], v[132:135], v[68:71]
s_waitcnt lgkmcnt(3)
ds_read_b128 v[152:155], v222 offset:57600
v_mfma_f32_16x16x32_bf16 v[72:75], a[248:251], v[136:139], v[72:75]
s_waitcnt lgkmcnt(3)
ds_read_b128 v[156:159], v223 offset:57600
v_mfma_f32_16x16x32_bf16 v[76:79], a[248:251], v[140:143], v[76:79]
s_waitcnt lgkmcnt(3)
ds_read_b128 v[128:131], v216 offset:8192
v_mfma_f32_16x16x32_bf16 v[80:83], a[248:251], v[144:147], v[80:83]
s_waitcnt lgkmcnt(3)
ds_read_b128 v[132:135], v217 offset:8192
v_mfma_f32_16x16x32_bf16 v[84:87], a[248:251], v[148:151], v[84:87]
s_waitcnt lgkmcnt(3)
ds_read_b128 v[136:139], v218 offset:8192
v_mfma_f32_16x16x32_bf16 v[88:91], a[248:251], v[152:155], v[88:91]
s_waitcnt lgkmcnt(3)
ds_read_b128 v[140:143], v219 offset:8192
v_mfma_f32_16x16x32_bf16 v[92:95], a[248:251], v[156:159], v[92:95]
s_waitcnt lgkmcnt(3)
ds_read_b128 v[144:147], v220 offset:8192
v_mfma_f32_16x16x32_bf16 v[96:99], a[156:159], v[128:131], v[96:99]
s_waitcnt lgkmcnt(3)
ds_read_b128 v[148:151], v221 offset:8192
v_mfma_f32_16x16x32_bf16 v[100:103], a[156:159], v[132:135], v[100:103]
s_waitcnt lgkmcnt(3)
ds_read_b128 v[152:155], v222 offset:8192
v_mfma_f32_16x16x32_bf16 v[104:107], a[156:159], v[136:139], v[104:107]
s_waitcnt lgkmcnt(3)
ds_read_b128 v[156:159], v223 offset:8192
v_mfma_f32_16x16x32_bf16 v[108:111], a[156:159], v[140:143], v[108:111]
s_waitcnt lgkmcnt(3)
ds_read_b128 v[128:131], v216 offset:16384
v_mfma_f32_16x16x32_bf16 v[112:115], a[156:159], v[144:147], v[112:115]
s_waitcnt lgkmcnt(3)
ds_read_b128 v[132:135], v217 offset:16384
v_mfma_f32_16x16x32_bf16 v[116:119], a[156:159], v[148:151], v[116:119]
s_waitcnt lgkmcnt(3)
ds_read_b128 v[136:139], v218 offset:16384
v_mfma_f32_16x16x32_bf16 v[120:123], a[156:159], v[152:155], v[120:123]
s_waitcnt lgkmcnt(3)
s_add_u32 s27, s42, 229376
ds_read_b128 v[140:143], v219 offset:16384
v_mfma_f32_16x16x32_bf16 v[124:127], a[156:159], v[156:159], v[124:127]
s_waitcnt lgkmcnt(3)
ds_read_b128 v[144:147], v220 offset:16384
v_cvt_pk_bf16_f32 v184, v64, v68
v_mfma_f32_16x16x32_bf16 v[96:99], a[172:175], v[128:131], v[96:99]
s_waitcnt lgkmcnt(3)
ds_read_b128 v[148:151], v221 offset:16384
v_cvt_pk_bf16_f32 v185, v72, v76
v_mfma_f32_16x16x32_bf16 v[100:103], a[172:175], v[132:135], v[100:103]
s_waitcnt lgkmcnt(3)
ds_read_b128 v[152:155], v222 offset:16384
v_cvt_pk_bf16_f32 v186, v80, v84
v_mfma_f32_16x16x32_bf16 v[104:107], a[172:175], v[136:139], v[104:107]
s_waitcnt lgkmcnt(3)
ds_read_b128 v[156:159], v223 offset:16384
v_cvt_pk_bf16_f32 v187, v88, v92
v_mfma_f32_16x16x32_bf16 v[108:111], a[172:175], v[140:143], v[108:111]
s_waitcnt lgkmcnt(3)
ds_read_b128 v[128:131], v216 offset:24576
buffer_store_dwordx4 v[184:187], v183, s[8:11], s27 offen sc1
v_mfma_f32_16x16x32_bf16 v[112:115], a[172:175], v[144:147], v[112:115]
s_waitcnt lgkmcnt(3)
s_add_u32 s27, s42, 236544
ds_read_b128 v[132:135], v217 offset:24576
v_cvt_pk_bf16_f32 v188, v65, v69
v_mfma_f32_16x16x32_bf16 v[116:119], a[172:175], v[148:151], v[116:119]
s_waitcnt lgkmcnt(3)
ds_read_b128 v[136:139], v218 offset:24576
v_cvt_pk_bf16_f32 v189, v73, v77
v_mfma_f32_16x16x32_bf16 v[120:123], a[172:175], v[152:155], v[120:123]
s_waitcnt lgkmcnt(3)
ds_read_b128 v[140:143], v219 offset:24576
v_cvt_pk_bf16_f32 v190, v81, v85
v_mfma_f32_16x16x32_bf16 v[124:127], a[172:175], v[156:159], v[124:127]
s_waitcnt lgkmcnt(3)
ds_read_b128 v[144:147], v220 offset:24576
v_cvt_pk_bf16_f32 v191, v89, v93
v_mfma_f32_16x16x32_bf16 v[96:99], a[188:191], v[128:131], v[96:99]
s_waitcnt lgkmcnt(3)
ds_read_b128 v[148:151], v221 offset:24576
buffer_store_dwordx4 v[188:191], v183, s[8:11], s27 offen sc1
v_mfma_f32_16x16x32_bf16 v[100:103], a[188:191], v[132:135], v[100:103]
s_waitcnt lgkmcnt(3)
s_add_u32 s27, s42, 243712
ds_read_b128 v[152:155], v222 offset:24576
v_cvt_pk_bf16_f32 v192, v66, v70
v_mfma_f32_16x16x32_bf16 v[104:107], a[188:191], v[136:139], v[104:107]
s_waitcnt lgkmcnt(3)
ds_read_b128 v[156:159], v223 offset:24576
v_cvt_pk_bf16_f32 v193, v74, v78
v_mfma_f32_16x16x32_bf16 v[108:111], a[188:191], v[140:143], v[108:111]
s_waitcnt lgkmcnt(3)
ds_read_b128 v[128:131], v216 offset:33024
v_cvt_pk_bf16_f32 v194, v82, v86
v_mfma_f32_16x16x32_bf16 v[112:115], a[188:191], v[144:147], v[112:115]
s_waitcnt lgkmcnt(3)
ds_read_b128 v[132:135], v217 offset:33024
v_cvt_pk_bf16_f32 v195, v90, v94
v_mfma_f32_16x16x32_bf16 v[116:119], a[188:191], v[148:151], v[116:119]
s_waitcnt lgkmcnt(3)
ds_read_b128 v[136:139], v218 offset:33024
buffer_store_dwordx4 v[192:195], v183, s[8:11], s27 offen sc1
v_mfma_f32_16x16x32_bf16 v[120:123], a[188:191], v[152:155], v[120:123]
s_waitcnt lgkmcnt(3)
s_add_u32 s27, s42, 250880
ds_read_b128 v[140:143], v219 offset:33024
v_cvt_pk_bf16_f32 v196, v67, v71
v_mfma_f32_16x16x32_bf16 v[124:127], a[188:191], v[156:159], v[124:127]
s_waitcnt lgkmcnt(3)
ds_read_b128 v[144:147], v220 offset:33024
v_cvt_pk_bf16_f32 v197, v75, v79
v_mfma_f32_16x16x32_bf16 v[96:99], a[204:207], v[128:131], v[96:99]
s_waitcnt lgkmcnt(3)
ds_read_b128 v[148:151], v221 offset:33024
v_cvt_pk_bf16_f32 v198, v83, v87
v_mfma_f32_16x16x32_bf16 v[100:103], a[204:207], v[132:135], v[100:103]
s_waitcnt lgkmcnt(3)
ds_read_b128 v[152:155], v222 offset:33024
v_cvt_pk_bf16_f32 v199, v91, v95
v_mfma_f32_16x16x32_bf16 v[104:107], a[204:207], v[136:139], v[104:107]
s_waitcnt lgkmcnt(3)
ds_read_b128 v[156:159], v223 offset:33024
buffer_store_dwordx4 v[196:199], v183, s[8:11], s27 offen sc1
v_mfma_f32_16x16x32_bf16 v[108:111], a[204:207], v[140:143], v[108:111]
s_waitcnt lgkmcnt(3)
ds_read_b128 v[128:131], v216 offset:41216
v_mfma_f32_16x16x32_bf16 v[112:115], a[204:207], v[144:147], v[112:115]
s_waitcnt lgkmcnt(3)
ds_read_b128 v[132:135], v217 offset:41216
v_mfma_f32_16x16x32_bf16 v[116:119], a[204:207], v[148:151], v[116:119]
s_waitcnt lgkmcnt(3)
ds_read_b128 v[136:139], v218 offset:41216
v_mfma_f32_16x16x32_bf16 v[120:123], a[204:207], v[152:155], v[120:123]
s_waitcnt lgkmcnt(3)
ds_read_b128 v[140:143], v219 offset:41216
v_mfma_f32_16x16x32_bf16 v[124:127], a[204:207], v[156:159], v[124:127]
s_waitcnt lgkmcnt(3)
ds_read_b128 v[144:147], v220 offset:41216
v_mfma_f32_16x16x32_bf16 v[96:99], a[220:223], v[128:131], v[96:99]
s_waitcnt lgkmcnt(3)
ds_read_b128 v[148:151], v221 offset:41216
v_mfma_f32_16x16x32_bf16 v[100:103], a[220:223], v[132:135], v[100:103]
s_waitcnt lgkmcnt(3)
ds_read_b128 v[152:155], v222 offset:41216
v_mfma_f32_16x16x32_bf16 v[104:107], a[220:223], v[136:139], v[104:107]
s_waitcnt lgkmcnt(3)
ds_read_b128 v[156:159], v223 offset:41216
v_mfma_f32_16x16x32_bf16 v[108:111], a[220:223], v[140:143], v[108:111]
s_waitcnt lgkmcnt(3)
ds_read_b128 v[128:131], v216 offset:49408
v_mfma_f32_16x16x32_bf16 v[112:115], a[220:223], v[144:147], v[112:115]
s_waitcnt lgkmcnt(3)
ds_read_b128 v[132:135], v217 offset:49408
v_mfma_f32_16x16x32_bf16 v[116:119], a[220:223], v[148:151], v[116:119]
s_waitcnt lgkmcnt(3)
ds_read_b128 v[136:139], v218 offset:49408
v_mfma_f32_16x16x32_bf16 v[120:123], a[220:223], v[152:155], v[120:123]
s_waitcnt lgkmcnt(3)
ds_read_b128 v[140:143], v219 offset:49408
v_mfma_f32_16x16x32_bf16 v[124:127], a[220:223], v[156:159], v[124:127]
s_waitcnt lgkmcnt(3)
ds_read_b128 v[144:147], v220 offset:49408
v_mfma_f32_16x16x32_bf16 v[96:99], a[236:239], v[128:131], v[96:99]
s_waitcnt lgkmcnt(3)
ds_read_b128 v[148:151], v221 offset:49408
v_mfma_f32_16x16x32_bf16 v[100:103], a[236:239], v[132:135], v[100:103]
s_waitcnt lgkmcnt(3)
ds_read_b128 v[152:155], v222 offset:49408
v_mfma_f32_16x16x32_bf16 v[104:107], a[236:239], v[136:139], v[104:107]
s_waitcnt lgkmcnt(3)
ds_read_b128 v[156:159], v223 offset:49408
v_mfma_f32_16x16x32_bf16 v[108:111], a[236:239], v[140:143], v[108:111]
s_waitcnt lgkmcnt(3)
ds_read_b128 v[128:131], v216 offset:57600
v_mfma_f32_16x16x32_bf16 v[112:115], a[236:239], v[144:147], v[112:115]
s_waitcnt lgkmcnt(3)
ds_read_b128 v[132:135], v217 offset:57600
v_mfma_f32_16x16x32_bf16 v[116:119], a[236:239], v[148:151], v[116:119]
s_waitcnt lgkmcnt(3)
ds_read_b128 v[136:139], v218 offset:57600
v_mfma_f32_16x16x32_bf16 v[120:123], a[236:239], v[152:155], v[120:123]
s_waitcnt lgkmcnt(3)
ds_read_b128 v[140:143], v219 offset:57600
v_mfma_f32_16x16x32_bf16 v[124:127], a[236:239], v[156:159], v[124:127]
s_waitcnt vmcnt(12) lgkmcnt(3)
ds_read_b128 v[144:147], v220 offset:57600
v_mfma_f32_16x16x32_bf16 v[96:99], a[252:255], v[128:131], v[96:99]
s_waitcnt lgkmcnt(3)
ds_read_b128 v[148:151], v221 offset:57600
v_mfma_f32_16x16x32_bf16 v[100:103], a[252:255], v[132:135], v[100:103]
s_waitcnt lgkmcnt(3)
ds_read_b128 v[152:155], v222 offset:57600
v_mfma_f32_16x16x32_bf16 v[104:107], a[252:255], v[136:139], v[104:107]
s_waitcnt lgkmcnt(3)
ds_read_b128 v[156:159], v223 offset:57600
v_mfma_f32_16x16x32_bf16 v[108:111], a[252:255], v[140:143], v[108:111]
s_waitcnt lgkmcnt(3)
v_mfma_f32_16x16x32_bf16 v[112:115], a[252:255], v[144:147], v[112:115]
s_waitcnt lgkmcnt(2)
v_mfma_f32_16x16x32_bf16 v[116:119], a[252:255], v[148:151], v[116:119]
s_waitcnt lgkmcnt(1)
v_mfma_f32_16x16x32_bf16 v[120:123], a[252:255], v[152:155], v[120:123]
s_waitcnt lgkmcnt(0)
v_mfma_f32_16x16x32_bf16 v[124:127], a[252:255], v[156:159], v[124:127]
s_nop 4
s_add_u32 s27, s42, 344064
v_cvt_pk_bf16_f32 v200, v96, v100
v_cvt_pk_bf16_f32 v201, v104, v108
v_cvt_pk_bf16_f32 v202, v112, v116
v_cvt_pk_bf16_f32 v203, v120, v124
buffer_store_dwordx4 v[200:203], v183, s[8:11], s27 offen sc1
s_add_u32 s27, s42, 351232
v_cvt_pk_bf16_f32 v204, v97, v101
v_cvt_pk_bf16_f32 v205, v105, v109
v_cvt_pk_bf16_f32 v206, v113, v117
v_cvt_pk_bf16_f32 v207, v121, v125
buffer_store_dwordx4 v[204:207], v183, s[8:11], s27 offen sc1
s_add_u32 s27, s42, 358400
v_cvt_pk_bf16_f32 v208, v98, v102
v_cvt_pk_bf16_f32 v209, v106, v110
v_cvt_pk_bf16_f32 v210, v114, v118
v_cvt_pk_bf16_f32 v211, v122, v126
buffer_store_dwordx4 v[208:211], v183, s[8:11], s27 offen sc1
s_add_u32 s27, s42, 365568
v_cvt_pk_bf16_f32 v212, v99, v103
v_cvt_pk_bf16_f32 v213, v107, v111
v_cvt_pk_bf16_f32 v214, v115, v119
v_cvt_pk_bf16_f32 v215, v123, v127
buffer_store_dwordx4 v[212:215], v183, s[8:11], s27 offen sc1
s_endpgm
standalone__weight_only_int_quip__prompt_kernel_init_spin:
buffer_load_dword v251, v248, s[48:51], 0 offen sc1
s_waitcnt vmcnt(0)
s_sub_u32 s96, s96, 1
s_cmp_lt_i32 s96, 1
s_cbranch_scc1 standalone__weight_only_int_quip__prompt_kernel_init_ok
v_cmp_eq_u32 vcc, 0, v251
s_cbranch_vccnz standalone__weight_only_int_quip__prompt_kernel_init_spin
s_branch standalone__weight_only_int_quip__prompt_kernel_init_ok
standalone__weight_only_int_quip__prompt_kernel_h1b_spin:
buffer_load_dword v251, v162, s[44:47], s41 offen sc1
s_waitcnt vmcnt(0)
s_sub_u32 s96, s96, 1
s_cmp_lt_i32 s96, 1
s_cbranch_scc1 standalone__weight_only_int_quip__prompt_kernel_h1b_ok
v_cmp_eq_u32 vcc, 0, v251
s_cbranch_vccnz standalone__weight_only_int_quip__prompt_kernel_h1b_spin
s_branch standalone__weight_only_int_quip__prompt_kernel_h1b_ok
standalone__weight_only_int_quip__prompt_kernel_h4a_spin:
buffer_load_dword v251, v182, s[44:47], s61 offen sc1
s_waitcnt vmcnt(0)
s_sub_u32 s96, s96, 1
s_cmp_lt_i32 s96, 1
s_cbranch_scc1 standalone__weight_only_int_quip__prompt_kernel_h4a_ok
v_cmp_eq_u32 vcc, 0, v251
s_cbranch_vccnz standalone__weight_only_int_quip__prompt_kernel_h4a_spin
s_branch standalone__weight_only_int_quip__prompt_kernel_h4a_ok
standalone__weight_only_int_quip__prompt_kernel_h4b_spin:
buffer_load_dword v251, v182, s[44:47], s61 offen offset:16 sc1
s_waitcnt vmcnt(0)
s_sub_u32 s96, s96, 1
s_cmp_lt_i32 s96, 1
s_cbranch_scc1 standalone__weight_only_int_quip__prompt_kernel_h4b_ok
v_cmp_eq_u32 vcc, 0, v251
s_cbranch_vccnz standalone__weight_only_int_quip__prompt_kernel_h4b_spin
s_branch standalone__weight_only_int_quip__prompt_kernel_h4b_ok
standalone__weight_only_int_quip__prompt_kernel_h3a_spin:
buffer_load_dword v251, v167, s[44:47], s39 offen sc1
s_waitcnt vmcnt(0)
s_sub_u32 s96, s96, 1
s_cmp_lt_i32 s96, 1
s_cbranch_scc1 standalone__weight_only_int_quip__prompt_kernel_h3a_ok
v_cmp_eq_u32 vcc, 0, v251
s_cbranch_vccnz standalone__weight_only_int_quip__prompt_kernel_h3a_spin
s_branch standalone__weight_only_int_quip__prompt_kernel_h3a_ok
standalone__weight_only_int_quip__prompt_kernel_h3m_spin:
buffer_load_dword v251, v242, s[44:47], s39 offen sc1
s_waitcnt vmcnt(0)
s_sub_u32 s96, s96, 1
s_cmp_lt_i32 s96, 1
s_cbranch_scc1 standalone__weight_only_int_quip__prompt_kernel_h3m_ok
v_cmp_eq_u32 vcc, 0, v251
s_cbranch_vccnz standalone__weight_only_int_quip__prompt_kernel_h3m_spin
s_branch standalone__weight_only_int_quip__prompt_kernel_h3m_ok
standalone__weight_only_int_quip__prompt_kernel_h3b_spin:
buffer_load_dword v251, v166, s[44:47], s39 offen sc1
s_waitcnt vmcnt(0)
s_sub_u32 s96, s96, 1
s_cmp_lt_i32 s96, 1
s_cbranch_scc1 standalone__weight_only_int_quip__prompt_kernel_h3b_ok
v_cmp_eq_u32 vcc, 0, v251
s_cbranch_vccnz standalone__weight_only_int_quip__prompt_kernel_h3b_spin
s_branch standalone__weight_only_int_quip__prompt_kernel_h3b_ok
standalone__weight_only_int_quip__prompt_kernel_h20_spin:
buffer_load_dword v251, v248, s[44:47], s55 offen offset:0 sc1
s_waitcnt vmcnt(0)
s_sub_u32 s96, s96, 1
s_cmp_lt_i32 s96, 1
s_cbranch_scc1 standalone__weight_only_int_quip__prompt_kernel_h20_ok
v_cmp_eq_u32 vcc, 0, v251
s_cbranch_vccnz standalone__weight_only_int_quip__prompt_kernel_h20_spin
s_branch standalone__weight_only_int_quip__prompt_kernel_h20_ok
standalone__weight_only_int_quip__prompt_kernel_h21_spin:
buffer_load_dword v251, v248, s[44:47], s55 offen offset:16 sc1
s_waitcnt vmcnt(0)
s_sub_u32 s96, s96, 1
s_cmp_lt_i32 s96, 1
s_cbranch_scc1 standalone__weight_only_int_quip__prompt_kernel_h21_ok
v_cmp_eq_u32 vcc, 0, v251
s_cbranch_vccnz standalone__weight_only_int_quip__prompt_kernel_h21_spin
s_branch standalone__weight_only_int_quip__prompt_kernel_h21_ok
standalone__weight_only_int_quip__prompt_kernel_xr0:
s_cmp_lg_u32 s2, 0
s_cbranch_scc1 standalone__weight_only_int_quip__prompt_kernel_xr
v_mov_b32 v4, 0
v_mov_b32 v5, 0
v_mov_b32 v6, 0
v_mov_b32 v7, 0
v_lshlrev_b32 v10, 4, v0
v_mov_b32 v8, 1
v_lshlrev_b32 v9, 8, v0
s_mov_b32 s46, 32768
s_mov_b32 s47, 0x20000
s_lshl_b32 s26, s2, 12
s_lshl_b32 s27, s2, 2
s_waitcnt lgkmcnt(0)
s_add_u32 s44, s50, 100663296
s_addc_u32 s45, s51, 0
s_mov_b32 s50, 256
s_mov_b32 s51, 0x20000
standalone__weight_only_int_quip__prompt_kernel_zl:
buffer_store_dwordx4 v[4:7], v10, s[44:47], s26 offen sc1
s_add_u32 s26, s26, 4096
s_cmp_lt_u32 s26, 32768
s_cbranch_scc1 standalone__weight_only_int_quip__prompt_kernel_zl
s_waitcnt vmcnt(0)
s_barrier
buffer_store_dword v8, v9, s[48:51], s27 offen sc1
s_branch standalone__weight_only_int_quip__prompt_kernel_xr
standalone__weight_only_int_quip__prompt_kernel_w2:
standalone__weight_only_int_quip__prompt_kernel_xr:
s_waitcnt lgkmcnt(0)
s_load_dwordx2 s[4:5], s[0:1], 0
s_load_dwordx4 s[8:11], s[0:1], 32
s_load_dwordx4 s[48:51], s[0:1], 56
v_lshrrev_b32 v1, 6, v0
v_and_b32 v0, 63, v0
v_readfirstlane_b32 s21, v1
s_and_b32 s22, s2, 6
s_and_b32 s26, s20, 1
s_add_u32 s22, s22, s26
s_and_b32 s23, s2, 1
s_lshl_b32 s23, s23, 1
s_lshr_b32 s26, s20, 1
s_add_u32 s23, s23, s26
v_lshrrev_b32 v2, 3, v0
v_and_b32 v3, 7, v0
v_lshrrev_b32 v4, 4, v0
v_xor_b32 v3, v3, v4
v_lshlrev_b32 v2, 11, v2
v_lshl_add_u32 v168, v3, 4, v2
v_xor_b32 v3, 4, v3
v_lshl_add_u32 v169, v3, 4, v2
v_add_u32 v170, 30720, v168
v_add_u32 v171, 46080, v169
v_add_u32 v169, 15360, v169
s_lshl_b32 s28, s22, 8
s_lshl_b32 s26, s21, 6
s_add_u32 s28, s28, s26
s_lshl_b32 s28, s28, 11
s_lshl_b32 s19, s21, 13
s_lshl_b32 s35, s21, 11
s_add_u32 s35, s35, 65536
v_and_b32 v3, 15, v0
v_lshlrev_b32 v5, 1, v4
v_xor_b32 v5, v5, v3
v_lshlrev_b32 v2, 11, v4
v_lshl_add_u32 v172, v5, 4, v2
v_xor_b32 v5, 8, v5
v_lshl_add_u32 v173, v5, 4, v2
v_add_u32 v173, 15360, v173
s_and_b32 s26, s21, 1
s_lshl_b32 s26, s26, 4
s_lshr_b32 s27, s21, 1
s_lshl_b32 s27, s27, 2
s_add_u32 s26, s26, s27
s_lshl_b32 s32, s26, 11
s_lshl_b32 s26, s23, 9
s_add_u32 s32, s32, s26
s_lshr_b32 s27, s22, 2
s_lshl_b32 s26, s27, 8
s_add_u32 s32, s32, s26
s_mov_b32 s26, s22
s_add_u32 s26, s26, s22
s_and_b32 s26, s22, 6
s_and_b32 s26, s26, 0
s_xor_b32 s42, s22, s23
s_and_b32 s42, s42, 1
s_lshl_b32 s43, s42, 17
s_lshl_b32 s42, s42, 7
s_lshl_b32 s29, s26, 8
s_lshl_b32 s26, s26, 18
s_add_u32 s32, s32, s26
s_xor_b32 s33, s32, 256
s_mov_b32 s6, 4194304
s_mov_b32 s7, 0x20000
s_lshl_b32 s57, s20, 2
s_add_u32 s57, s57, s21
s_waitcnt lgkmcnt(0)
s_and_b32 s26, s22, 1
s_mul_i32 s26, s26, 12845056
s_add_u32 s36, s10, s26
s_addc_u32 s37, s11, 0
s_mov_b32 s38, 12845056
s_mov_b32 s39, 0x20000
s_mov_b32 s10, 2097152
s_mov_b32 s11, 0x20000
s_mov_b32 s24, s50
s_mov_b32 s25, s51
s_mov_b32 s50, 256
s_mov_b32 s51, 0x20000
s_add_u32 s44, s24, 100663296
s_addc_u32 s45, s25, 0
s_mov_b32 s46, 32768
s_mov_b32 s47, 0x20000
s_add_u32 m0, s35, 0
s_xor_b32 s17, s32, s43
s_nop 0
buffer_load_dwordx4 v172, s[8:11], s17 offen offset:0 lds
s_nop 0
buffer_load_dwordx4 v173, s[8:11], s17 offen offset:1024 lds
s_add_u32 s32, s32, 65536
s_and_b32 s32, s32, 2097151
s_add_u32 m0, s35, 8192
s_xor_b32 s17, s33, s43
s_nop 0
buffer_load_dwordx4 v172, s[8:11], s17 offen offset:0 lds
s_nop 0
buffer_load_dwordx4 v173, s[8:11], s17 offen offset:1024 lds
s_add_u32 s33, s33, 65536
s_and_b32 s33, s33, 2097151
v_and_b32 v254, 7, v0
v_lshlrev_b32 v254, 2, v254
v_lshrrev_b32 v4, 3, v0
v_add_u32 v5, 1, v4
v_lshrrev_b32 v5, 3, v5
v_add3_u32 v4, v4, v5, 4
v_and_b32 v5, 7, v0
v_lshlrev_b32 v5, 4, v5
v_lshl_add_u32 v252, v4, 7, v5
v_add_u32 v253, 4096, v252
v_mov_b32 v248, 0
v_mov_b32 v249, 1
v_lshlrev_b32 v250, 24, v0
s_mov_b32 s96, 262144
s_add_u32 m0, s19, 0
s_add_u32 s16, s28, s29
s_xor_b32 s16, s16, s42
s_nop 0
buffer_load_dwordx4 v168, s[4:7], s16 offen offset:0 lds
s_nop 0
buffer_load_dwordx4 v169, s[4:7], s16 offen offset:1024 lds
s_nop 0
buffer_load_dwordx4 v170, s[4:7], s16 offen offset:2048 lds
s_nop 0
buffer_load_dwordx4 v171, s[4:7], s16 offen offset:3072 lds
s_add_u32 s12, s24, 33554432
s_addc_u32 s13, s25, 0
s_mov_b32 s14, 8388608
s_mov_b32 s15, 0x20000
v_lshrrev_b32 v2, 4, v0
v_and_b32 v3, 15, v0
v_lshrrev_b32 v5, 1, v3
v_xor_b32 v5, v5, v2
v_lshlrev_b32 v6, 7, v3
v_lshl_add_u32 v6, v5, 4, v6
s_lshr_b32 s26, s21, 1
s_lshl_b32 s26, s26, 14
v_add_u32 v164, s26, v6
v_xor_b32 v165, 64, v164
v_add_u32 v166, 0x20000, v164
v_add_u32 v167, 0x20000, v165
v_lshrrev_b32 v4, 2, v3
v_and_b32 v5, 3, v0
v_lshl_add_u32 v6, v2, 2, v4
v_and_b32 v7, 7, v6
v_lshlrev_b32 v6, 8, v6
v_lshl_add_u32 v6, v5, 3, v6
v_add_u32 v6, 0x10000, v6
s_and_b32 s26, s21, 1
s_lshl_b32 s26, s26, 2
v_xor_b32 v7, s26, v7
v_xor_b32 v8, 0, v7
v_lshl_add_u32 v160, v8, 5, v6
v_xor_b32 v8, 1, v7
v_lshl_add_u32 v161, v8, 5, v6
v_xor_b32 v8, 2, v7
v_lshl_add_u32 v162, v8, 5, v6
v_xor_b32 v8, 3, v7
v_lshl_add_u32 v163, v8, 5, v6
s_lshl_b32 s56, s20, 2
s_add_u32 s56, s56, s21
s_lshr_b32 s26, s22, 1
s_lshl_b32 s26, s26, 3
s_lshr_b32 s30, 0x15110901, s26
s_lshr_b32 s31, 0x19110d05, s26
s_cmp_lt_u32 s56, 8
s_cselect_b32 s30, s30, s31
s_and_b32 s30, s30, 0xff
s_lshl_b32 s30, s30, 8
s_and_b32 s26, s56, 7
s_mul_i32 s26, s26, 0
s_add_u32 s34, s26, s30
s_add_u32 s34, s34, 1835136
s_mov_b32 s26, 7168
v_mul_lo_u32 v176, v0, s26
v_cmp_gt_u32 vcc, 0, v0
v_mov_b32 v4, 0x70000000
s_lshl_b32 s62, s23, 3
s_add_u32 s62, s62, s22
s_lshl_b32 s62, s62, 5
v_cndmask_b32 v176, v4, v176, vcc
s_add_u32 s62, s62, s21
s_lshl_b32 s62, s62, 2
s_mul_i32 s56, s56, 4864
v_add_u32 v175, 26, v0
v_lshrrev_b32 v175, 6, v175
v_lshlrev_b32 v174, 7, v0
v_lshl_add_u32 v174, v175, 28, v174
s_lshr_b32 s26, s21, 1
s_lshl_b32 s26, s26, 1
s_lshl_b32 s30, s22, 2
s_add_u32 s26, s26, s30
s_mul_i32 s26, s26, 262144
s_and_b32 s30, s21, 1
s_lshl_b32 s30, s30, 1
s_lshl_b32 s31, s23, 3
s_add_u32 s30, s30, s31
s_lshl_b32 s31, s27, 2
s_add_u32 s30, s30, s31
s_mul_i32 s31, s30, 8192
s_add_u32 s40, s26, s31
s_xor_b32 s41, s40, 32768
s_mov_b32 s18, 4
s_add_u32 m0, s19, 4096
s_add_u32 s16, s16, 65536
s_nop 0
buffer_load_dwordx4 v168, s[4:7], s16 offen offset:0 lds
s_nop 0
buffer_load_dwordx4 v169, s[4:7], s16 offen offset:1024 lds
s_nop 0
buffer_load_dwordx4 v170, s[4:7], s16 offen offset:2048 lds
s_nop 0
buffer_load_dwordx4 v171, s[4:7], s16 offen offset:3072 lds
s_add_u32 s29, s29, 128
s_and_b32 s29, s29, 2047
s_add_u32 m0, s35, 16384
s_xor_b32 s17, s32, s43
s_nop 0
buffer_load_dwordx4 v172, s[8:11], s17 offen offset:0 lds
s_nop 0
buffer_load_dwordx4 v173, s[8:11], s17 offen offset:1024 lds
s_add_u32 s32, s32, 65536
s_and_b32 s32, s32, 2097151
s_add_u32 m0, s35, 24576
s_xor_b32 s17, s33, s43
s_nop 0
buffer_load_dwordx4 v172, s[8:11], s17 offen offset:0 lds
s_nop 0
buffer_load_dwordx4 v173, s[8:11], s17 offen offset:1024 lds
s_add_u32 s33, s33, 65536
s_and_b32 s33, s33, 2097151
s_add_u32 m0, s19, 32768
s_add_u32 s16, s28, s29
s_xor_b32 s16, s16, s42
s_nop 0
buffer_load_dwordx4 v168, s[4:7], s16 offen offset:0 lds
s_nop 0
buffer_load_dwordx4 v169, s[4:7], s16 offen offset:1024 lds
s_nop 0
buffer_load_dwordx4 v170, s[4:7], s16 offen offset:2048 lds
s_nop 0
buffer_load_dwordx4 v171, s[4:7], s16 offen offset:3072 lds
s_add_u32 m0, s35, 32768
s_xor_b32 s17, s32, s43
s_nop 0
buffer_load_dwordx4 v172, s[8:11], s17 offen offset:0 lds
s_nop 0
buffer_load_dwordx4 v173, s[8:11], s17 offen offset:1024 lds
s_add_u32 s32, s32, 65536
s_and_b32 s32, s32, 2097151
s_add_u32 m0, s35, 40960
s_xor_b32 s17, s33, s43
s_nop 0
buffer_load_dwordx4 v172, s[8:11], s17 offen offset:0 lds
s_waitcnt vmcnt(11)
s_barrier
ds_read_b64_tr_b16 v[64:65], v160 offset:0
ds_read_b64_tr_b16 v[66:67], v160 offset:4096
ds_read_b128 v[0:3], v164 offset:0
ds_read_b128 v[4:7], v164 offset:2048
ds_read_b128 v[8:11], v164 offset:4096
ds_read_b64_tr_b16 v[68:69], v161 offset:0
ds_read_b64_tr_b16 v[70:71], v161 offset:4096
ds_read_b128 v[12:15], v164 offset:6144
ds_read_b128 v[16:19], v164 offset:8192
ds_read_b128 v[20:23], v164 offset:10240
ds_read_b64_tr_b16 v[72:73], v162 offset:0
ds_read_b64_tr_b16 v[74:75], v162 offset:4096
ds_read_b128 v[24:27], v164 offset:12288
ds_read_b128 v[28:31], v164 offset:14336
s_mov_b32 s18, 2
s_waitcnt lgkmcnt(11)
v_mfma_f32_16x16x32_bf16 a[0:3], v[64:67], v[0:3], 0
s_waitcnt lgkmcnt(10)
ds_read_b64_tr_b16 v[76:77], v163 offset:0
v_mfma_f32_16x16x32_bf16 a[4:7], v[64:67], v[4:7], 0
s_waitcnt lgkmcnt(10)
ds_read_b64_tr_b16 v[78:79], v163 offset:4096
v_mfma_f32_16x16x32_bf16 a[8:11], v[64:67], v[8:11], 0
s_waitcnt lgkmcnt(8)
v_mfma_f32_16x16x32_bf16 a[12:15], v[64:67], v[12:15], 0
s_waitcnt lgkmcnt(7)
buffer_load_dwordx4 v173, s[8:11], s17 offen offset:1024 lds
v_mfma_f32_16x16x32_bf16 a[16:19], v[64:67], v[16:19], 0
s_waitcnt lgkmcnt(6)
s_add_u32 s33, s33, 65536
s_and_b32 s33, s33, 2097151
v_mfma_f32_16x16x32_bf16 a[20:23], v[64:67], v[20:23], 0
s_waitcnt lgkmcnt(3)
ds_read_b128 v[32:35], v165 offset:0
v_mfma_f32_16x16x32_bf16 a[24:27], v[64:67], v[24:27], 0
s_waitcnt lgkmcnt(3)
ds_read_b128 v[36:39], v165 offset:2048
v_mfma_f32_16x16x32_bf16 a[28:31], v[64:67], v[28:31], 0
v_mfma_f32_16x16x32_bf16 a[32:35], v[68:71], v[0:3], 0
ds_read_b64_tr_b16 v[80:81], v160 offset:8192
v_mfma_f32_16x16x32_bf16 a[36:39], v[68:71], v[4:7], 0
ds_read_b64_tr_b16 v[82:83], v160 offset:12288
v_mfma_f32_16x16x32_bf16 a[40:43], v[68:71], v[8:11], 0
s_add_u32 m0, s19, 36864
s_add_u32 s16, s16, 65536
v_mfma_f32_16x16x32_bf16 a[44:47], v[68:71], v[12:15], 0
buffer_load_dwordx4 v168, s[4:7], s16 offen offset:0 lds
v_mfma_f32_16x16x32_bf16 a[48:51], v[68:71], v[16:19], 0
v_mfma_f32_16x16x32_bf16 a[52:55], v[68:71], v[20:23], 0
ds_read_b128 v[40:43], v165 offset:4096
v_mfma_f32_16x16x32_bf16 a[56:59], v[68:71], v[24:27], 0
ds_read_b128 v[44:47], v165 offset:6144
v_mfma_f32_16x16x32_bf16 a[60:63], v[68:71], v[28:31], 0
v_mfma_f32_16x16x32_bf16 a[64:67], v[72:75], v[0:3], 0
ds_read_b64_tr_b16 v[84:85], v161 offset:8192
v_mfma_f32_16x16x32_bf16 a[68:71], v[72:75], v[4:7], 0
ds_read_b64_tr_b16 v[86:87], v161 offset:12288
v_mfma_f32_16x16x32_bf16 a[72:75], v[72:75], v[8:11], 0
v_mfma_f32_16x16x32_bf16 a[76:79], v[72:75], v[12:15], 0
buffer_load_dwordx4 v169, s[4:7], s16 offen offset:1024 lds
v_mfma_f32_16x16x32_bf16 a[80:83], v[72:75], v[16:19], 0
v_mfma_f32_16x16x32_bf16 a[84:87], v[72:75], v[20:23], 0
ds_read_b128 v[48:51], v165 offset:8192
v_mfma_f32_16x16x32_bf16 a[88:91], v[72:75], v[24:27], 0
ds_read_b128 v[52:55], v165 offset:10240
v_mfma_f32_16x16x32_bf16 a[92:95], v[72:75], v[28:31], 0
s_waitcnt lgkmcnt(10)
v_mfma_f32_16x16x32_bf16 a[96:99], v[76:79], v[0:3], 0
ds_read_b64_tr_b16 v[88:89], v162 offset:8192
v_mfma_f32_16x16x32_bf16 a[100:103], v[76:79], v[4:7], 0
ds_read_b64_tr_b16 v[90:91], v162 offset:12288
v_mfma_f32_16x16x32_bf16 a[104:107], v[76:79], v[8:11], 0
v_mfma_f32_16x16x32_bf16 a[108:111], v[76:79], v[12:15], 0
buffer_load_dwordx4 v170, s[4:7], s16 offen offset:2048 lds
v_mfma_f32_16x16x32_bf16 a[112:115], v[76:79], v[16:19], 0
v_mfma_f32_16x16x32_bf16 a[116:119], v[76:79], v[20:23], 0
ds_read_b128 v[56:59], v165 offset:12288
v_mfma_f32_16x16x32_bf16 a[120:123], v[76:79], v[24:27], 0
ds_read_b128 v[60:63], v165 offset:14336
v_mfma_f32_16x16x32_bf16 a[124:127], v[76:79], v[28:31], 0
s_waitcnt lgkmcnt(10)
v_mfma_f32_16x16x32_bf16 a[128:131], v[80:83], v[0:3], 0
ds_read_b64_tr_b16 v[92:93], v163 offset:8192
v_mfma_f32_16x16x32_bf16 a[132:135], v[80:83], v[4:7], 0
ds_read_b64_tr_b16 v[94:95], v163 offset:12288
v_mfma_f32_16x16x32_bf16 a[136:139], v[80:83], v[8:11], 0
v_mfma_f32_16x16x32_bf16 a[140:143], v[80:83], v[12:15], 0
buffer_load_dwordx4 v171, s[4:7], s16 offen offset:3072 lds
v_mfma_f32_16x16x32_bf16 a[144:147], v[80:83], v[16:19], 0
s_add_u32 s29, s29, 128
s_and_b32 s29, s29, 2047
v_mfma_f32_16x16x32_bf16 a[148:151], v[80:83], v[20:23], 0
v_mfma_f32_16x16x32_bf16 a[152:155], v[80:83], v[24:27], 0
v_mfma_f32_16x16x32_bf16 a[156:159], v[80:83], v[28:31], 0
s_waitcnt vmcnt(12) lgkmcnt(2)
s_barrier
v_mfma_f32_16x16x32_bf16 a[160:163], v[84:87], v[0:3], 0
ds_read_b64_tr_b16 v[64:65], v160 offset:16384
v_mfma_f32_16x16x32_bf16 a[164:167], v[84:87], v[4:7], 0
ds_read_b64_tr_b16 v[66:67], v160 offset:20480
v_mfma_f32_16x16x32_bf16 a[168:171], v[84:87], v[8:11], 0
s_add_u32 m0, s35, 49152
s_xor_b32 s17, s32, s43
v_mfma_f32_16x16x32_bf16 a[172:175], v[84:87], v[12:15], 0
buffer_load_dwordx4 v172, s[8:11], s17 offen offset:0 lds
v_mfma_f32_16x16x32_bf16 a[176:179], v[84:87], v[16:19], 0
v_mfma_f32_16x16x32_bf16 a[180:183], v[84:87], v[20:23], 0
v_mfma_f32_16x16x32_bf16 a[184:187], v[84:87], v[24:27], 0
v_mfma_f32_16x16x32_bf16 a[188:191], v[84:87], v[28:31], 0
v_mfma_f32_16x16x32_bf16 a[192:195], v[88:91], v[0:3], 0
ds_read_b64_tr_b16 v[68:69], v161 offset:16384
v_mfma_f32_16x16x32_bf16 a[196:199], v[88:91], v[4:7], 0
ds_read_b64_tr_b16 v[70:71], v161 offset:20480
v_mfma_f32_16x16x32_bf16 a[200:203], v[88:91], v[8:11], 0
v_mfma_f32_16x16x32_bf16 a[204:207], v[88:91], v[12:15], 0
buffer_load_dwordx4 v173, s[8:11], s17 offen offset:1024 lds
v_mfma_f32_16x16x32_bf16 a[208:211], v[88:91], v[16:19], 0
s_add_u32 s32, s32, 65536
s_and_b32 s32, s32, 2097151
v_mfma_f32_16x16x32_bf16 a[212:215], v[88:91], v[20:23], 0
v_mfma_f32_16x16x32_bf16 a[216:219], v[88:91], v[24:27], 0
v_mfma_f32_16x16x32_bf16 a[220:223], v[88:91], v[28:31], 0
s_waitcnt lgkmcnt(4)
v_mfma_f32_16x16x32_bf16 a[224:227], v[92:95], v[0:3], 0
ds_read_b64_tr_b16 v[72:73], v162 offset:16384
v_mfma_f32_16x16x32_bf16 a[228:231], v[92:95], v[4:7], 0
ds_read_b64_tr_b16 v[74:75], v162 offset:20480
v_mfma_f32_16x16x32_bf16 a[232:235], v[92:95], v[8:11], 0
s_add_u32 m0, s35, 57344
s_xor_b32 s17, s33, s43
v_mfma_f32_16x16x32_bf16 a[236:239], v[92:95], v[12:15], 0
buffer_load_dwordx4 v172, s[8:11], s17 offen offset:0 lds
v_mfma_f32_16x16x32_bf16 a[240:243], v[92:95], v[16:19], 0
v_mfma_f32_16x16x32_bf16 a[244:247], v[92:95], v[20:23], 0
v_mfma_f32_16x16x32_bf16 a[248:251], v[92:95], v[24:27], 0
v_mfma_f32_16x16x32_bf16 a[252:255], v[92:95], v[28:31], 0
.p2align 3
standalone__weight_only_int_quip__prompt_kernel_xloop:
s_waitcnt lgkmcnt(4)
v_mfma_f32_16x16x32_bf16 a[0:3], v[64:67], v[32:35], a[0:3]
ds_read_b64_tr_b16 v[76:77], v163 offset:16384
v_mfma_f32_16x16x32_bf16 a[4:7], v[64:67], v[36:39], a[4:7]
ds_read_b64_tr_b16 v[78:79], v163 offset:20480
v_mfma_f32_16x16x32_bf16 a[8:11], v[64:67], v[40:43], a[8:11]
v_mfma_f32_16x16x32_bf16 a[12:15], v[64:67], v[44:47], a[12:15]
buffer_load_dwordx4 v173, s[8:11], s17 offen offset:1024 lds
v_mfma_f32_16x16x32_bf16 a[16:19], v[64:67], v[48:51], a[16:19]
s_add_u32 s33, s33, 65536
s_and_b32 s33, s33, 2097151
v_mfma_f32_16x16x32_bf16 a[20:23], v[64:67], v[52:55], a[20:23]
v_mfma_f32_16x16x32_bf16 a[24:27], v[64:67], v[56:59], a[24:27]
v_mfma_f32_16x16x32_bf16 a[28:31], v[64:67], v[60:63], a[28:31]
s_waitcnt lgkmcnt(4)
v_mfma_f32_16x16x32_bf16 a[32:35], v[68:71], v[32:35], a[32:35]
ds_read_b64_tr_b16 v[80:81], v160 offset:24576
v_mfma_f32_16x16x32_bf16 a[36:39], v[68:71], v[36:39], a[36:39]
ds_read_b64_tr_b16 v[82:83], v160 offset:28672
v_mfma_f32_16x16x32_bf16 a[40:43], v[68:71], v[40:43], a[40:43]
s_add_u32 m0, s19, 0
s_add_u32 s16, s28, s29
s_xor_b32 s16, s16, s42
v_mfma_f32_16x16x32_bf16 a[44:47], v[68:71], v[44:47], a[44:47]
buffer_load_dwordx4 v168, s[4:7], s16 offen offset:0 lds
v_mfma_f32_16x16x32_bf16 a[48:51], v[68:71], v[48:51], a[48:51]
v_mfma_f32_16x16x32_bf16 a[52:55], v[68:71], v[52:55], a[52:55]
v_mfma_f32_16x16x32_bf16 a[56:59], v[68:71], v[56:59], a[56:59]
v_mfma_f32_16x16x32_bf16 a[60:63], v[68:71], v[60:63], a[60:63]
s_waitcnt lgkmcnt(4)
v_mfma_f32_16x16x32_bf16 a[64:67], v[72:75], v[32:35], a[64:67]
ds_read_b64_tr_b16 v[84:85], v161 offset:24576
v_mfma_f32_16x16x32_bf16 a[68:71], v[72:75], v[36:39], a[68:71]
ds_read_b64_tr_b16 v[86:87], v161 offset:28672
v_mfma_f32_16x16x32_bf16 a[72:75], v[72:75], v[40:43], a[72:75]
v_mfma_f32_16x16x32_bf16 a[76:79], v[72:75], v[44:47], a[76:79]
buffer_load_dwordx4 v169, s[4:7], s16 offen offset:1024 lds
v_mfma_f32_16x16x32_bf16 a[80:83], v[72:75], v[48:51], a[80:83]
v_mfma_f32_16x16x32_bf16 a[84:87], v[72:75], v[52:55], a[84:87]
v_mfma_f32_16x16x32_bf16 a[88:91], v[72:75], v[56:59], a[88:91]
v_mfma_f32_16x16x32_bf16 a[92:95], v[72:75], v[60:63], a[92:95]
s_waitcnt lgkmcnt(4)
v_mfma_f32_16x16x32_bf16 a[96:99], v[76:79], v[32:35], a[96:99]
ds_read_b64_tr_b16 v[88:89], v162 offset:24576
v_mfma_f32_16x16x32_bf16 a[100:103], v[76:79], v[36:39], a[100:103]
ds_read_b64_tr_b16 v[90:91], v162 offset:28672
v_mfma_f32_16x16x32_bf16 a[104:107], v[76:79], v[40:43], a[104:107]
v_mfma_f32_16x16x32_bf16 a[108:111], v[76:79], v[44:47], a[108:111]
buffer_load_dwordx4 v170, s[4:7], s16 offen offset:2048 lds
v_mfma_f32_16x16x32_bf16 a[112:115], v[76:79], v[48:51], a[112:115]
v_mfma_f32_16x16x32_bf16 a[116:119], v[76:79], v[52:55], a[116:119]
v_mfma_f32_16x16x32_bf16 a[120:123], v[76:79], v[56:59], a[120:123]
v_mfma_f32_16x16x32_bf16 a[124:127], v[76:79], v[60:63], a[124:127]
s_waitcnt lgkmcnt(4)
v_mfma_f32_16x16x32_bf16 a[128:131], v[80:83], v[32:35], a[128:131]
ds_read_b64_tr_b16 v[92:93], v163 offset:24576
v_mfma_f32_16x16x32_bf16 a[132:135], v[80:83], v[36:39], a[132:135]
ds_read_b64_tr_b16 v[94:95], v163 offset:28672
v_mfma_f32_16x16x32_bf16 a[136:139], v[80:83], v[40:43], a[136:139]
v_mfma_f32_16x16x32_bf16 a[140:143], v[80:83], v[44:47], a[140:143]
buffer_load_dwordx4 v171, s[4:7], s16 offen offset:3072 lds
v_mfma_f32_16x16x32_bf16 a[144:147], v[80:83], v[48:51], a[144:147]
v_mfma_f32_16x16x32_bf16 a[148:151], v[80:83], v[52:55], a[148:151]
v_mfma_f32_16x16x32_bf16 a[152:155], v[80:83], v[56:59], a[152:155]
v_mfma_f32_16x16x32_bf16 a[156:159], v[80:83], v[60:63], a[156:159]
s_waitcnt vmcnt(8) lgkmcnt(4)
s_barrier
v_mfma_f32_16x16x32_bf16 a[160:163], v[84:87], v[32:35], a[160:163]
ds_read_b64_tr_b16 v[64:65], v160 offset:32768
v_mfma_f32_16x16x32_bf16 a[164:167], v[84:87], v[36:39], a[164:167]
ds_read_b64_tr_b16 v[66:67], v160 offset:36864
v_mfma_f32_16x16x32_bf16 a[168:171], v[84:87], v[40:43], a[168:171]
s_add_u32 m0, s35, 0
s_xor_b32 s17, s32, s43
v_mfma_f32_16x16x32_bf16 a[172:175], v[84:87], v[44:47], a[172:175]
buffer_load_dwordx4 v172, s[8:11], s17 offen offset:0 lds
v_mfma_f32_16x16x32_bf16 a[176:179], v[84:87], v[48:51], a[176:179]
ds_read_b128 v[0:3], v164 offset:32768
v_mfma_f32_16x16x32_bf16 a[180:183], v[84:87], v[52:55], a[180:183]
ds_read_b128 v[4:7], v164 offset:34816
v_mfma_f32_16x16x32_bf16 a[184:187], v[84:87], v[56:59], a[184:187]
ds_read_b128 v[8:11], v164 offset:36864
v_mfma_f32_16x16x32_bf16 a[188:191], v[84:87], v[60:63], a[188:191]
s_waitcnt lgkmcnt(7)
v_mfma_f32_16x16x32_bf16 a[192:195], v[88:91], v[32:35], a[192:195]
ds_read_b64_tr_b16 v[68:69], v161 offset:32768
v_mfma_f32_16x16x32_bf16 a[196:199], v[88:91], v[36:39], a[196:199]
ds_read_b64_tr_b16 v[70:71], v161 offset:36864
v_mfma_f32_16x16x32_bf16 a[200:203], v[88:91], v[40:43], a[200:203]
v_mfma_f32_16x16x32_bf16 a[204:207], v[88:91], v[44:47], a[204:207]
buffer_load_dwordx4 v173, s[8:11], s17 offen offset:1024 lds
v_mfma_f32_16x16x32_bf16 a[208:211], v[88:91], v[48:51], a[208:211]
s_add_u32 s32, s32, 65536
s_and_b32 s32, s32, 2097151
ds_read_b128 v[12:15], v164 offset:38912
v_mfma_f32_16x16x32_bf16 a[212:215], v[88:91], v[52:55], a[212:215]
ds_read_b128 v[16:19], v164 offset:40960
v_mfma_f32_16x16x32_bf16 a[216:219], v[88:91], v[56:59], a[216:219]
ds_read_b128 v[20:23], v164 offset:43008
v_mfma_f32_16x16x32_bf16 a[220:223], v[88:91], v[60:63], a[220:223]
s_waitcnt lgkmcnt(10)
v_mfma_f32_16x16x32_bf16 a[224:227], v[92:95], v[32:35], a[224:227]
ds_read_b64_tr_b16 v[72:73], v162 offset:32768
v_mfma_f32_16x16x32_bf16 a[228:231], v[92:95], v[36:39], a[228:231]
ds_read_b64_tr_b16 v[74:75], v162 offset:36864
v_mfma_f32_16x16x32_bf16 a[232:235], v[92:95], v[40:43], a[232:235]
s_add_u32 m0, s35, 8192
s_xor_b32 s17, s33, s43
ds_read_b128 v[24:27], v164 offset:45056
v_mfma_f32_16x16x32_bf16 a[236:239], v[92:95], v[44:47], a[236:239]
buffer_load_dwordx4 v172, s[8:11], s17 offen offset:0 lds
v_mfma_f32_16x16x32_bf16 a[240:243], v[92:95], v[48:51], a[240:243]
ds_read_b128 v[28:31], v164 offset:47104
v_mfma_f32_16x16x32_bf16 a[244:247], v[92:95], v[52:55], a[244:247]
v_mfma_f32_16x16x32_bf16 a[248:251], v[92:95], v[56:59], a[248:251]
v_mfma_f32_16x16x32_bf16 a[252:255], v[92:95], v[60:63], a[252:255]
s_waitcnt lgkmcnt(11)
v_mfma_f32_16x16x32_bf16 a[0:3], v[64:67], v[0:3], a[0:3]
s_waitcnt lgkmcnt(10)
ds_read_b64_tr_b16 v[76:77], v163 offset:32768
v_mfma_f32_16x16x32_bf16 a[4:7], v[64:67], v[4:7], a[4:7]
s_waitcnt lgkmcnt(10)
ds_read_b64_tr_b16 v[78:79], v163 offset:36864
v_mfma_f32_16x16x32_bf16 a[8:11], v[64:67], v[8:11], a[8:11]
s_waitcnt lgkmcnt(8)
v_mfma_f32_16x16x32_bf16 a[12:15], v[64:67], v[12:15], a[12:15]
s_waitcnt lgkmcnt(7)
buffer_load_dwordx4 v173, s[8:11], s17 offen offset:1024 lds
v_mfma_f32_16x16x32_bf16 a[16:19], v[64:67], v[16:19], a[16:19]
s_waitcnt lgkmcnt(6)
s_add_u32 s33, s33, 65536
s_and_b32 s33, s33, 2097151
v_mfma_f32_16x16x32_bf16 a[20:23], v[64:67], v[20:23], a[20:23]
s_waitcnt lgkmcnt(3)
ds_read_b128 v[32:35], v165 offset:32768
v_mfma_f32_16x16x32_bf16 a[24:27], v[64:67], v[24:27], a[24:27]
s_waitcnt lgkmcnt(3)
ds_read_b128 v[36:39], v165 offset:34816
v_mfma_f32_16x16x32_bf16 a[28:31], v[64:67], v[28:31], a[28:31]
v_mfma_f32_16x16x32_bf16 a[32:35], v[68:71], v[0:3], a[32:35]
ds_read_b64_tr_b16 v[80:81], v160 offset:40960
v_mfma_f32_16x16x32_bf16 a[36:39], v[68:71], v[4:7], a[36:39]
ds_read_b64_tr_b16 v[82:83], v160 offset:45056
v_mfma_f32_16x16x32_bf16 a[40:43], v[68:71], v[8:11], a[40:43]
s_add_u32 m0, s19, 4096
s_add_u32 s16, s16, 65536
v_mfma_f32_16x16x32_bf16 a[44:47], v[68:71], v[12:15], a[44:47]
buffer_load_dwordx4 v168, s[4:7], s16 offen offset:0 lds
v_mfma_f32_16x16x32_bf16 a[48:51], v[68:71], v[16:19], a[48:51]
v_mfma_f32_16x16x32_bf16 a[52:55], v[68:71], v[20:23], a[52:55]
ds_read_b128 v[40:43], v165 offset:36864
v_mfma_f32_16x16x32_bf16 a[56:59], v[68:71], v[24:27], a[56:59]
ds_read_b128 v[44:47], v165 offset:38912
v_mfma_f32_16x16x32_bf16 a[60:63], v[68:71], v[28:31], a[60:63]
s_bitcmp1_b32 0, s18
s_cbranch_scc0 standalone__weight_only_int_quip__prompt_kernel_notouch
buffer_load_dword v175, v174, s[52:55], s56 offen
standalone__weight_only_int_quip__prompt_kernel_notouch:
s_waitcnt lgkmcnt(10)
v_mfma_f32_16x16x32_bf16 a[64:67], v[72:75], v[0:3], a[64:67]
ds_read_b64_tr_b16 v[84:85], v161 offset:40960
v_mfma_f32_16x16x32_bf16 a[68:71], v[72:75], v[4:7], a[68:71]
ds_read_b64_tr_b16 v[86:87], v161 offset:45056
v_mfma_f32_16x16x32_bf16 a[72:75], v[72:75], v[8:11], a[72:75]
v_mfma_f32_16x16x32_bf16 a[76:79], v[72:75], v[12:15], a[76:79]
buffer_load_dwordx4 v169, s[4:7], s16 offen offset:1024 lds
v_mfma_f32_16x16x32_bf16 a[80:83], v[72:75], v[16:19], a[80:83]
v_mfma_f32_16x16x32_bf16 a[84:87], v[72:75], v[20:23], a[84:87]
ds_read_b128 v[48:51], v165 offset:40960
v_mfma_f32_16x16x32_bf16 a[88:91], v[72:75], v[24:27], a[88:91]
ds_read_b128 v[52:55], v165 offset:43008
v_mfma_f32_16x16x32_bf16 a[92:95], v[72:75], v[28:31], a[92:95]
s_waitcnt lgkmcnt(10)
v_mfma_f32_16x16x32_bf16 a[96:99], v[76:79], v[0:3], a[96:99]
ds_read_b64_tr_b16 v[88:89], v162 offset:40960
v_mfma_f32_16x16x32_bf16 a[100:103], v[76:79], v[4:7], a[100:103]
ds_read_b64_tr_b16 v[90:91], v162 offset:45056
v_mfma_f32_16x16x32_bf16 a[104:107], v[76:79], v[8:11], a[104:107]
v_mfma_f32_16x16x32_bf16 a[108:111], v[76:79], v[12:15], a[108:111]
buffer_load_dwordx4 v170, s[4:7], s16 offen offset:2048 lds
v_mfma_f32_16x16x32_bf16 a[112:115], v[76:79], v[16:19], a[112:115]
v_mfma_f32_16x16x32_bf16 a[116:119], v[76:79], v[20:23], a[116:119]
ds_read_b128 v[56:59], v165 offset:45056
v_mfma_f32_16x16x32_bf16 a[120:123], v[76:79], v[24:27], a[120:123]
ds_read_b128 v[60:63], v165 offset:47104
v_mfma_f32_16x16x32_bf16 a[124:127], v[76:79], v[28:31], a[124:127]
s_waitcnt lgkmcnt(10)
v_mfma_f32_16x16x32_bf16 a[128:131], v[80:83], v[0:3], a[128:131]
ds_read_b64_tr_b16 v[92:93], v163 offset:40960
v_mfma_f32_16x16x32_bf16 a[132:135], v[80:83], v[4:7], a[132:135]
ds_read_b64_tr_b16 v[94:95], v163 offset:45056
v_mfma_f32_16x16x32_bf16 a[136:139], v[80:83], v[8:11], a[136:139]
v_mfma_f32_16x16x32_bf16 a[140:143], v[80:83], v[12:15], a[140:143]
buffer_load_dwordx4 v171, s[4:7], s16 offen offset:3072 lds
v_mfma_f32_16x16x32_bf16 a[144:147], v[80:83], v[16:19], a[144:147]
s_add_u32 s29, s29, 128
s_and_b32 s29, s29, 2047
v_mfma_f32_16x16x32_bf16 a[148:151], v[80:83], v[20:23], a[148:151]
v_mfma_f32_16x16x32_bf16 a[152:155], v[80:83], v[24:27], a[152:155]
v_mfma_f32_16x16x32_bf16 a[156:159], v[80:83], v[28:31], a[156:159]
s_waitcnt vmcnt(12) lgkmcnt(2)
s_barrier
v_mfma_f32_16x16x32_bf16 a[160:163], v[84:87], v[0:3], a[160:163]
ds_read_b64_tr_b16 v[64:65], v160 offset:49152
v_mfma_f32_16x16x32_bf16 a[164:167], v[84:87], v[4:7], a[164:167]
ds_read_b64_tr_b16 v[66:67], v160 offset:53248
v_mfma_f32_16x16x32_bf16 a[168:171], v[84:87], v[8:11], a[168:171]
s_add_u32 m0, s35, 16384
s_xor_b32 s17, s32, s43
v_mfma_f32_16x16x32_bf16 a[172:175], v[84:87], v[12:15], a[172:175]
buffer_load_dwordx4 v172, s[8:11], s17 offen offset:0 lds
v_mfma_f32_16x16x32_bf16 a[176:179], v[84:87], v[16:19], a[176:179]
v_mfma_f32_16x16x32_bf16 a[180:183], v[84:87], v[20:23], a[180:183]
v_mfma_f32_16x16x32_bf16 a[184:187], v[84:87], v[24:27], a[184:187]
v_mfma_f32_16x16x32_bf16 a[188:191], v[84:87], v[28:31], a[188:191]
v_mfma_f32_16x16x32_bf16 a[192:195], v[88:91], v[0:3], a[192:195]
ds_read_b64_tr_b16 v[68:69], v161 offset:49152
v_mfma_f32_16x16x32_bf16 a[196:199], v[88:91], v[4:7], a[196:199]
ds_read_b64_tr_b16 v[70:71], v161 offset:53248
v_mfma_f32_16x16x32_bf16 a[200:203], v[88:91], v[8:11], a[200:203]
v_mfma_f32_16x16x32_bf16 a[204:207], v[88:91], v[12:15], a[204:207]
buffer_load_dwordx4 v173, s[8:11], s17 offen offset:1024 lds
v_mfma_f32_16x16x32_bf16 a[208:211], v[88:91], v[16:19], a[208:211]
s_add_u32 s32, s32, 65536
s_and_b32 s32, s32, 2097151
v_mfma_f32_16x16x32_bf16 a[212:215], v[88:91], v[20:23], a[212:215]
v_mfma_f32_16x16x32_bf16 a[216:219], v[88:91], v[24:27], a[216:219]
v_mfma_f32_16x16x32_bf16 a[220:223], v[88:91], v[28:31], a[220:223]
s_waitcnt lgkmcnt(4)
v_mfma_f32_16x16x32_bf16 a[224:227], v[92:95], v[0:3], a[224:227]
ds_read_b64_tr_b16 v[72:73], v162 offset:49152
v_mfma_f32_16x16x32_bf16 a[228:231], v[92:95], v[4:7], a[228:231]
ds_read_b64_tr_b16 v[74:75], v162 offset:53248
v_mfma_f32_16x16x32_bf16 a[232:235], v[92:95], v[8:11], a[232:235]
s_add_u32 m0, s35, 24576
s_xor_b32 s17, s33, s43
v_mfma_f32_16x16x32_bf16 a[236:239], v[92:95], v[12:15], a[236:239]
buffer_load_dwordx4 v172, s[8:11], s17 offen offset:0 lds
v_mfma_f32_16x16x32_bf16 a[240:243], v[92:95], v[16:19], a[240:243]
v_mfma_f32_16x16x32_bf16 a[244:247], v[92:95], v[20:23], a[244:247]
v_mfma_f32_16x16x32_bf16 a[248:251], v[92:95], v[24:27], a[248:251]
v_mfma_f32_16x16x32_bf16 a[252:255], v[92:95], v[28:31], a[252:255]
s_waitcnt lgkmcnt(4)
v_mfma_f32_16x16x32_bf16 a[0:3], v[64:67], v[32:35], a[0:3]
ds_read_b64_tr_b16 v[76:77], v163 offset:49152
v_mfma_f32_16x16x32_bf16 a[4:7], v[64:67], v[36:39], a[4:7]
ds_read_b64_tr_b16 v[78:79], v163 offset:53248
v_mfma_f32_16x16x32_bf16 a[8:11], v[64:67], v[40:43], a[8:11]
v_mfma_f32_16x16x32_bf16 a[12:15], v[64:67], v[44:47], a[12:15]
buffer_load_dwordx4 v173, s[8:11], s17 offen offset:1024 lds
v_mfma_f32_16x16x32_bf16 a[16:19], v[64:67], v[48:51], a[16:19]
s_add_u32 s33, s33, 65536
s_and_b32 s33, s33, 2097151
v_mfma_f32_16x16x32_bf16 a[20:23], v[64:67], v[52:55], a[20:23]
v_mfma_f32_16x16x32_bf16 a[24:27], v[64:67], v[56:59], a[24:27]
v_mfma_f32_16x16x32_bf16 a[28:31], v[64:67], v[60:63], a[28:31]
s_waitcnt lgkmcnt(4)
v_mfma_f32_16x16x32_bf16 a[32:35], v[68:71], v[32:35], a[32:35]
ds_read_b64_tr_b16 v[80:81], v160 offset:57344
v_mfma_f32_16x16x32_bf16 a[36:39], v[68:71], v[36:39], a[36:39]
ds_read_b64_tr_b16 v[82:83], v160 offset:61440
v_mfma_f32_16x16x32_bf16 a[40:43], v[68:71], v[40:43], a[40:43]
s_add_u32 m0, s19, 32768
s_add_u32 s16, s28, s29
s_xor_b32 s16, s16, s42
v_mfma_f32_16x16x32_bf16 a[44:47], v[68:71], v[44:47], a[44:47]
buffer_load_dwordx4 v168, s[4:7], s16 offen offset:0 lds
v_mfma_f32_16x16x32_bf16 a[48:51], v[68:71], v[48:51], a[48:51]
v_mfma_f32_16x16x32_bf16 a[52:55], v[68:71], v[52:55], a[52:55]
v_mfma_f32_16x16x32_bf16 a[56:59], v[68:71], v[56:59], a[56:59]
v_mfma_f32_16x16x32_bf16 a[60:63], v[68:71], v[60:63], a[60:63]
s_waitcnt lgkmcnt(4)
v_mfma_f32_16x16x32_bf16 a[64:67], v[72:75], v[32:35], a[64:67]
ds_read_b64_tr_b16 v[84:85], v161 offset:57344
v_mfma_f32_16x16x32_bf16 a[68:71], v[72:75], v[36:39], a[68:71]
ds_read_b64_tr_b16 v[86:87], v161 offset:61440
v_mfma_f32_16x16x32_bf16 a[72:75], v[72:75], v[40:43], a[72:75]
v_mfma_f32_16x16x32_bf16 a[76:79], v[72:75], v[44:47], a[76:79]
buffer_load_dwordx4 v169, s[4:7], s16 offen offset:1024 lds
v_mfma_f32_16x16x32_bf16 a[80:83], v[72:75], v[48:51], a[80:83]
v_mfma_f32_16x16x32_bf16 a[84:87], v[72:75], v[52:55], a[84:87]
v_mfma_f32_16x16x32_bf16 a[88:91], v[72:75], v[56:59], a[88:91]
v_mfma_f32_16x16x32_bf16 a[92:95], v[72:75], v[60:63], a[92:95]
s_waitcnt lgkmcnt(4)
v_mfma_f32_16x16x32_bf16 a[96:99], v[76:79], v[32:35], a[96:99]
ds_read_b64_tr_b16 v[88:89], v162 offset:57344
v_mfma_f32_16x16x32_bf16 a[100:103], v[76:79], v[36:39], a[100:103]
ds_read_b64_tr_b16 v[90:91], v162 offset:61440
v_mfma_f32_16x16x32_bf16 a[104:107], v[76:79], v[40:43], a[104:107]
v_mfma_f32_16x16x32_bf16 a[108:111], v[76:79], v[44:47], a[108:111]
buffer_load_dwordx4 v170, s[4:7], s16 offen offset:2048 lds
v_mfma_f32_16x16x32_bf16 a[112:115], v[76:79], v[48:51], a[112:115]
v_mfma_f32_16x16x32_bf16 a[116:119], v[76:79], v[52:55], a[116:119]
v_mfma_f32_16x16x32_bf16 a[120:123], v[76:79], v[56:59], a[120:123]
v_mfma_f32_16x16x32_bf16 a[124:127], v[76:79], v[60:63], a[124:127]
s_waitcnt lgkmcnt(4)
v_mfma_f32_16x16x32_bf16 a[128:131], v[80:83], v[32:35], a[128:131]
ds_read_b64_tr_b16 v[92:93], v163 offset:57344
v_mfma_f32_16x16x32_bf16 a[132:135], v[80:83], v[36:39], a[132:135]
ds_read_b64_tr_b16 v[94:95], v163 offset:61440
v_mfma_f32_16x16x32_bf16 a[136:139], v[80:83], v[40:43], a[136:139]
v_mfma_f32_16x16x32_bf16 a[140:143], v[80:83], v[44:47], a[140:143]
buffer_load_dwordx4 v171, s[4:7], s16 offen offset:3072 lds
v_mfma_f32_16x16x32_bf16 a[144:147], v[80:83], v[48:51], a[144:147]
v_mfma_f32_16x16x32_bf16 a[148:151], v[80:83], v[52:55], a[148:151]
v_mfma_f32_16x16x32_bf16 a[152:155], v[80:83], v[56:59], a[152:155]
v_mfma_f32_16x16x32_bf16 a[156:159], v[80:83], v[60:63], a[156:159]
s_waitcnt vmcnt(8) lgkmcnt(4)
s_barrier
v_mfma_f32_16x16x32_bf16 a[160:163], v[84:87], v[32:35], a[160:163]
ds_read_b64_tr_b16 v[64:65], v160 offset:0
v_mfma_f32_16x16x32_bf16 a[164:167], v[84:87], v[36:39], a[164:167]
ds_read_b64_tr_b16 v[66:67], v160 offset:4096
v_mfma_f32_16x16x32_bf16 a[168:171], v[84:87], v[40:43], a[168:171]
s_add_u32 m0, s35, 32768
s_xor_b32 s17, s32, s43
v_mfma_f32_16x16x32_bf16 a[172:175], v[84:87], v[44:47], a[172:175]
buffer_load_dwordx4 v172, s[8:11], s17 offen offset:0 lds
v_mfma_f32_16x16x32_bf16 a[176:179], v[84:87], v[48:51], a[176:179]
ds_read_b128 v[0:3], v164 offset:0
v_mfma_f32_16x16x32_bf16 a[180:183], v[84:87], v[52:55], a[180:183]
ds_read_b128 v[4:7], v164 offset:2048
v_mfma_f32_16x16x32_bf16 a[184:187], v[84:87], v[56:59], a[184:187]
ds_read_b128 v[8:11], v164 offset:4096
v_mfma_f32_16x16x32_bf16 a[188:191], v[84:87], v[60:63], a[188:191]
s_waitcnt lgkmcnt(7)
v_mfma_f32_16x16x32_bf16 a[192:195], v[88:91], v[32:35], a[192:195]
ds_read_b64_tr_b16 v[68:69], v161 offset:0
v_mfma_f32_16x16x32_bf16 a[196:199], v[88:91], v[36:39], a[196:199]
ds_read_b64_tr_b16 v[70:71], v161 offset:4096
v_mfma_f32_16x16x32_bf16 a[200:203], v[88:91], v[40:43], a[200:203]
v_mfma_f32_16x16x32_bf16 a[204:207], v[88:91], v[44:47], a[204:207]
buffer_load_dwordx4 v173, s[8:11], s17 offen offset:1024 lds
v_mfma_f32_16x16x32_bf16 a[208:211], v[88:91], v[48:51], a[208:211]
s_add_u32 s32, s32, 65536
s_and_b32 s32, s32, 2097151
ds_read_b128 v[12:15], v164 offset:6144
v_mfma_f32_16x16x32_bf16 a[212:215], v[88:91], v[52:55], a[212:215]
ds_read_b128 v[16:19], v164 offset:8192
v_mfma_f32_16x16x32_bf16 a[216:219], v[88:91], v[56:59], a[216:219]
ds_read_b128 v[20:23], v164 offset:10240
v_mfma_f32_16x16x32_bf16 a[220:223], v[88:91], v[60:63], a[220:223]
s_waitcnt lgkmcnt(10)
v_mfma_f32_16x16x32_bf16 a[224:227], v[92:95], v[32:35], a[224:227]
ds_read_b64_tr_b16 v[72:73], v162 offset:0
v_mfma_f32_16x16x32_bf16 a[228:231], v[92:95], v[36:39], a[228:231]
ds_read_b64_tr_b16 v[74:75], v162 offset:4096
v_mfma_f32_16x16x32_bf16 a[232:235], v[92:95], v[40:43], a[232:235]
s_add_u32 m0, s35, 40960
s_xor_b32 s17, s33, s43
ds_read_b128 v[24:27], v164 offset:12288
v_mfma_f32_16x16x32_bf16 a[236:239], v[92:95], v[44:47], a[236:239]
buffer_load_dwordx4 v172, s[8:11], s17 offen offset:0 lds
v_mfma_f32_16x16x32_bf16 a[240:243], v[92:95], v[48:51], a[240:243]
ds_read_b128 v[28:31], v164 offset:14336
v_mfma_f32_16x16x32_bf16 a[244:247], v[92:95], v[52:55], a[244:247]
v_mfma_f32_16x16x32_bf16 a[248:251], v[92:95], v[56:59], a[248:251]
v_mfma_f32_16x16x32_bf16 a[252:255], v[92:95], v[60:63], a[252:255]
s_waitcnt lgkmcnt(11)
v_mfma_f32_16x16x32_bf16 a[0:3], v[64:67], v[0:3], a[0:3]
s_waitcnt lgkmcnt(10)
ds_read_b64_tr_b16 v[76:77], v163 offset:0
v_mfma_f32_16x16x32_bf16 a[4:7], v[64:67], v[4:7], a[4:7]
s_waitcnt lgkmcnt(10)
ds_read_b64_tr_b16 v[78:79], v163 offset:4096
v_mfma_f32_16x16x32_bf16 a[8:11], v[64:67], v[8:11], a[8:11]
s_waitcnt lgkmcnt(8)
v_mfma_f32_16x16x32_bf16 a[12:15], v[64:67], v[12:15], a[12:15]
s_waitcnt lgkmcnt(7)
buffer_load_dwordx4 v173, s[8:11], s17 offen offset:1024 lds
v_mfma_f32_16x16x32_bf16 a[16:19], v[64:67], v[16:19], a[16:19]
s_waitcnt lgkmcnt(6)
s_add_u32 s33, s33, 65536
s_and_b32 s33, s33, 2097151
v_mfma_f32_16x16x32_bf16 a[20:23], v[64:67], v[20:23], a[20:23]
s_waitcnt lgkmcnt(3)
ds_read_b128 v[32:35], v165 offset:0
v_mfma_f32_16x16x32_bf16 a[24:27], v[64:67], v[24:27], a[24:27]
s_waitcnt lgkmcnt(3)
ds_read_b128 v[36:39], v165 offset:2048
v_mfma_f32_16x16x32_bf16 a[28:31], v[64:67], v[28:31], a[28:31]
v_mfma_f32_16x16x32_bf16 a[32:35], v[68:71], v[0:3], a[32:35]
ds_read_b64_tr_b16 v[80:81], v160 offset:8192
v_mfma_f32_16x16x32_bf16 a[36:39], v[68:71], v[4:7], a[36:39]
ds_read_b64_tr_b16 v[82:83], v160 offset:12288
v_mfma_f32_16x16x32_bf16 a[40:43], v[68:71], v[8:11], a[40:43]
s_add_u32 m0, s19, 36864
s_add_u32 s16, s16, 65536
v_mfma_f32_16x16x32_bf16 a[44:47], v[68:71], v[12:15], a[44:47]
buffer_load_dwordx4 v168, s[4:7], s16 offen offset:0 lds
v_mfma_f32_16x16x32_bf16 a[48:51], v[68:71], v[16:19], a[48:51]
v_mfma_f32_16x16x32_bf16 a[52:55], v[68:71], v[20:23], a[52:55]
ds_read_b128 v[40:43], v165 offset:4096
v_mfma_f32_16x16x32_bf16 a[56:59], v[68:71], v[24:27], a[56:59]
ds_read_b128 v[44:47], v165 offset:6144
v_mfma_f32_16x16x32_bf16 a[60:63], v[68:71], v[28:31], a[60:63]
v_mfma_f32_16x16x32_bf16 a[64:67], v[72:75], v[0:3], a[64:67]
ds_read_b64_tr_b16 v[84:85], v161 offset:8192
v_mfma_f32_16x16x32_bf16 a[68:71], v[72:75], v[4:7], a[68:71]
ds_read_b64_tr_b16 v[86:87], v161 offset:12288
v_mfma_f32_16x16x32_bf16 a[72:75], v[72:75], v[8:11], a[72:75]
v_mfma_f32_16x16x32_bf16 a[76:79], v[72:75], v[12:15], a[76:79]
buffer_load_dwordx4 v169, s[4:7], s16 offen offset:1024 lds
v_mfma_f32_16x16x32_bf16 a[80:83], v[72:75], v[16:19], a[80:83]
v_mfma_f32_16x16x32_bf16 a[84:87], v[72:75], v[20:23], a[84:87]
ds_read_b128 v[48:51], v165 offset:8192
v_mfma_f32_16x16x32_bf16 a[88:91], v[72:75], v[24:27], a[88:91]
ds_read_b128 v[52:55], v165 offset:10240
v_mfma_f32_16x16x32_bf16 a[92:95], v[72:75], v[28:31], a[92:95]
s_waitcnt lgkmcnt(10)
v_mfma_f32_16x16x32_bf16 a[96:99], v[76:79], v[0:3], a[96:99]
ds_read_b64_tr_b16 v[88:89], v162 offset:8192
v_mfma_f32_16x16x32_bf16 a[100:103], v[76:79], v[4:7], a[100:103]
ds_read_b64_tr_b16 v[90:91], v162 offset:12288
v_mfma_f32_16x16x32_bf16 a[104:107], v[76:79], v[8:11], a[104:107]
v_mfma_f32_16x16x32_bf16 a[108:111], v[76:79], v[12:15], a[108:111]
buffer_load_dwordx4 v170, s[4:7], s16 offen offset:2048 lds
v_mfma_f32_16x16x32_bf16 a[112:115], v[76:79], v[16:19], a[112:115]
v_mfma_f32_16x16x32_bf16 a[116:119], v[76:79], v[20:23], a[116:119]
ds_read_b128 v[56:59], v165 offset:12288
v_mfma_f32_16x16x32_bf16 a[120:123], v[76:79], v[24:27], a[120:123]
ds_read_b128 v[60:63], v165 offset:14336
v_mfma_f32_16x16x32_bf16 a[124:127], v[76:79], v[28:31], a[124:127]
s_waitcnt lgkmcnt(10)
v_mfma_f32_16x16x32_bf16 a[128:131], v[80:83], v[0:3], a[128:131]
ds_read_b64_tr_b16 v[92:93], v163 offset:8192
v_mfma_f32_16x16x32_bf16 a[132:135], v[80:83], v[4:7], a[132:135]
ds_read_b64_tr_b16 v[94:95], v163 offset:12288
v_mfma_f32_16x16x32_bf16 a[136:139], v[80:83], v[8:11], a[136:139]
v_mfma_f32_16x16x32_bf16 a[140:143], v[80:83], v[12:15], a[140:143]
buffer_load_dwordx4 v171, s[4:7], s16 offen offset:3072 lds
v_mfma_f32_16x16x32_bf16 a[144:147], v[80:83], v[16:19], a[144:147]
s_add_u32 s29, s29, 128
s_and_b32 s29, s29, 2047
v_mfma_f32_16x16x32_bf16 a[148:151], v[80:83], v[20:23], a[148:151]
v_mfma_f32_16x16x32_bf16 a[152:155], v[80:83], v[24:27], a[152:155]
v_mfma_f32_16x16x32_bf16 a[156:159], v[80:83], v[28:31], a[156:159]
s_waitcnt vmcnt(12) lgkmcnt(2)
s_barrier
v_mfma_f32_16x16x32_bf16 a[160:163], v[84:87], v[0:3], a[160:163]
ds_read_b64_tr_b16 v[64:65], v160 offset:16384
v_mfma_f32_16x16x32_bf16 a[164:167], v[84:87], v[4:7], a[164:167]
ds_read_b64_tr_b16 v[66:67], v160 offset:20480
v_mfma_f32_16x16x32_bf16 a[168:171], v[84:87], v[8:11], a[168:171]
s_add_u32 m0, s35, 49152
s_xor_b32 s17, s32, s43
v_mfma_f32_16x16x32_bf16 a[172:175], v[84:87], v[12:15], a[172:175]
buffer_load_dwordx4 v172, s[8:11], s17 offen offset:0 lds
v_mfma_f32_16x16x32_bf16 a[176:179], v[84:87], v[16:19], a[176:179]
v_mfma_f32_16x16x32_bf16 a[180:183], v[84:87], v[20:23], a[180:183]
v_mfma_f32_16x16x32_bf16 a[184:187], v[84:87], v[24:27], a[184:187]
v_mfma_f32_16x16x32_bf16 a[188:191], v[84:87], v[28:31], a[188:191]
v_mfma_f32_16x16x32_bf16 a[192:195], v[88:91], v[0:3], a[192:195]
ds_read_b64_tr_b16 v[68:69], v161 offset:16384
v_mfma_f32_16x16x32_bf16 a[196:199], v[88:91], v[4:7], a[196:199]
ds_read_b64_tr_b16 v[70:71], v161 offset:20480
v_mfma_f32_16x16x32_bf16 a[200:203], v[88:91], v[8:11], a[200:203]
v_mfma_f32_16x16x32_bf16 a[204:207], v[88:91], v[12:15], a[204:207]
buffer_load_dwordx4 v173, s[8:11], s17 offen offset:1024 lds
v_mfma_f32_16x16x32_bf16 a[208:211], v[88:91], v[16:19], a[208:211]
s_add_u32 s32, s32, 65536
s_and_b32 s32, s32, 2097151
v_mfma_f32_16x16x32_bf16 a[212:215], v[88:91], v[20:23], a[212:215]
v_mfma_f32_16x16x32_bf16 a[216:219], v[88:91], v[24:27], a[216:219]
v_mfma_f32_16x16x32_bf16 a[220:223], v[88:91], v[28:31], a[220:223]
s_waitcnt lgkmcnt(4)
v_mfma_f32_16x16x32_bf16 a[224:227], v[92:95], v[0:3], a[224:227]
ds_read_b64_tr_b16 v[72:73], v162 offset:16384
v_mfma_f32_16x16x32_bf16 a[228:231], v[92:95], v[4:7], a[228:231]
ds_read_b64_tr_b16 v[74:75], v162 offset:20480
v_mfma_f32_16x16x32_bf16 a[232:235], v[92:95], v[8:11], a[232:235]
s_add_u32 m0, s35, 57344
s_xor_b32 s17, s33, s43
v_mfma_f32_16x16x32_bf16 a[236:239], v[92:95], v[12:15], a[236:239]
buffer_load_dwordx4 v172, s[8:11], s17 offen offset:0 lds
v_mfma_f32_16x16x32_bf16 a[240:243], v[92:95], v[16:19], a[240:243]
v_mfma_f32_16x16x32_bf16 a[244:247], v[92:95], v[20:23], a[244:247]
v_mfma_f32_16x16x32_bf16 a[248:251], v[92:95], v[24:27], a[248:251]
s_sub_u32 s18, s18, 1
v_mfma_f32_16x16x32_bf16 a[252:255], v[92:95], v[28:31], a[252:255]
s_cmp_lg_u32 s18, 0
s_cbranch_scc1 standalone__weight_only_int_quip__prompt_kernel_xloop
s_waitcnt lgkmcnt(4)
v_mfma_f32_16x16x32_bf16 a[0:3], v[64:67], v[32:35], a[0:3]
ds_read_b64_tr_b16 v[76:77], v163 offset:16384
v_mfma_f32_16x16x32_bf16 a[4:7], v[64:67], v[36:39], a[4:7]
ds_read_b64_tr_b16 v[78:79], v163 offset:20480
v_mfma_f32_16x16x32_bf16 a[8:11], v[64:67], v[40:43], a[8:11]
v_mfma_f32_16x16x32_bf16 a[12:15], v[64:67], v[44:47], a[12:15]
buffer_load_dwordx4 v173, s[8:11], s17 offen offset:1024 lds
v_mfma_f32_16x16x32_bf16 a[16:19], v[64:67], v[48:51], a[16:19]
s_add_u32 s33, s33, 65536
s_and_b32 s33, s33, 2097151
v_mfma_f32_16x16x32_bf16 a[20:23], v[64:67], v[52:55], a[20:23]
v_mfma_f32_16x16x32_bf16 a[24:27], v[64:67], v[56:59], a[24:27]
v_mfma_f32_16x16x32_bf16 a[28:31], v[64:67], v[60:63], a[28:31]
s_waitcnt lgkmcnt(4)
v_mfma_f32_16x16x32_bf16 a[32:35], v[68:71], v[32:35], a[32:35]
ds_read_b64_tr_b16 v[80:81], v160 offset:24576
v_mfma_f32_16x16x32_bf16 a[36:39], v[68:71], v[36:39], a[36:39]
ds_read_b64_tr_b16 v[82:83], v160 offset:28672
v_mfma_f32_16x16x32_bf16 a[40:43], v[68:71], v[40:43], a[40:43]
s_add_u32 m0, s19, 0
s_add_u32 s16, s28, s29
s_xor_b32 s16, s16, s42
v_mfma_f32_16x16x32_bf16 a[44:47], v[68:71], v[44:47], a[44:47]
buffer_load_dwordx4 v168, s[4:7], s16 offen offset:0 lds
v_mfma_f32_16x16x32_bf16 a[48:51], v[68:71], v[48:51], a[48:51]
v_mfma_f32_16x16x32_bf16 a[52:55], v[68:71], v[52:55], a[52:55]
v_mfma_f32_16x16x32_bf16 a[56:59], v[68:71], v[56:59], a[56:59]
v_mfma_f32_16x16x32_bf16 a[60:63], v[68:71], v[60:63], a[60:63]
s_waitcnt lgkmcnt(4)
v_mfma_f32_16x16x32_bf16 a[64:67], v[72:75], v[32:35], a[64:67]
ds_read_b64_tr_b16 v[84:85], v161 offset:24576
v_mfma_f32_16x16x32_bf16 a[68:71], v[72:75], v[36:39], a[68:71]
ds_read_b64_tr_b16 v[86:87], v161 offset:28672
v_mfma_f32_16x16x32_bf16 a[72:75], v[72:75], v[40:43], a[72:75]
v_mfma_f32_16x16x32_bf16 a[76:79], v[72:75], v[44:47], a[76:79]
buffer_load_dwordx4 v169, s[4:7], s16 offen offset:1024 lds
v_mfma_f32_16x16x32_bf16 a[80:83], v[72:75], v[48:51], a[80:83]
v_mfma_f32_16x16x32_bf16 a[84:87], v[72:75], v[52:55], a[84:87]
v_mfma_f32_16x16x32_bf16 a[88:91], v[72:75], v[56:59], a[88:91]
v_mfma_f32_16x16x32_bf16 a[92:95], v[72:75], v[60:63], a[92:95]
s_waitcnt lgkmcnt(4)
v_mfma_f32_16x16x32_bf16 a[96:99], v[76:79], v[32:35], a[96:99]
ds_read_b64_tr_b16 v[88:89], v162 offset:24576
v_mfma_f32_16x16x32_bf16 a[100:103], v[76:79], v[36:39], a[100:103]
ds_read_b64_tr_b16 v[90:91], v162 offset:28672
v_mfma_f32_16x16x32_bf16 a[104:107], v[76:79], v[40:43], a[104:107]
v_mfma_f32_16x16x32_bf16 a[108:111], v[76:79], v[44:47], a[108:111]
buffer_load_dwordx4 v170, s[4:7], s16 offen offset:2048 lds
v_mfma_f32_16x16x32_bf16 a[112:115], v[76:79], v[48:51], a[112:115]
v_mfma_f32_16x16x32_bf16 a[116:119], v[76:79], v[52:55], a[116:119]
v_mfma_f32_16x16x32_bf16 a[120:123], v[76:79], v[56:59], a[120:123]
v_mfma_f32_16x16x32_bf16 a[124:127], v[76:79], v[60:63], a[124:127]
s_waitcnt lgkmcnt(4)
v_mfma_f32_16x16x32_bf16 a[128:131], v[80:83], v[32:35], a[128:131]
ds_read_b64_tr_b16 v[92:93], v163 offset:24576
v_mfma_f32_16x16x32_bf16 a[132:135], v[80:83], v[36:39], a[132:135]
ds_read_b64_tr_b16 v[94:95], v163 offset:28672
v_mfma_f32_16x16x32_bf16 a[136:139], v[80:83], v[40:43], a[136:139]
v_mfma_f32_16x16x32_bf16 a[140:143], v[80:83], v[44:47], a[140:143]
buffer_load_dwordx4 v171, s[4:7], s16 offen offset:3072 lds
v_mfma_f32_16x16x32_bf16 a[144:147], v[80:83], v[48:51], a[144:147]
v_mfma_f32_16x16x32_bf16 a[148:151], v[80:83], v[52:55], a[148:151]
v_mfma_f32_16x16x32_bf16 a[152:155], v[80:83], v[56:59], a[152:155]
v_mfma_f32_16x16x32_bf16 a[156:159], v[80:83], v[60:63], a[156:159]
s_waitcnt vmcnt(8) lgkmcnt(4)
s_barrier
v_mfma_f32_16x16x32_bf16 a[160:163], v[84:87], v[32:35], a[160:163]
ds_read_b64_tr_b16 v[64:65], v160 offset:32768
v_mfma_f32_16x16x32_bf16 a[164:167], v[84:87], v[36:39], a[164:167]
ds_read_b64_tr_b16 v[66:67], v160 offset:36864
v_mfma_f32_16x16x32_bf16 a[168:171], v[84:87], v[40:43], a[168:171]
s_add_u32 m0, s35, 0
s_xor_b32 s17, s32, s43
v_mfma_f32_16x16x32_bf16 a[172:175], v[84:87], v[44:47], a[172:175]
buffer_load_dwordx4 v172, s[8:11], s17 offen offset:0 lds
v_mfma_f32_16x16x32_bf16 a[176:179], v[84:87], v[48:51], a[176:179]
ds_read_b128 v[0:3], v164 offset:32768
v_mfma_f32_16x16x32_bf16 a[180:183], v[84:87], v[52:55], a[180:183]
ds_read_b128 v[4:7], v164 offset:34816
v_mfma_f32_16x16x32_bf16 a[184:187], v[84:87], v[56:59], a[184:187]
ds_read_b128 v[8:11], v164 offset:36864
v_mfma_f32_16x16x32_bf16 a[188:191], v[84:87], v[60:63], a[188:191]
s_waitcnt lgkmcnt(7)
v_mfma_f32_16x16x32_bf16 a[192:195], v[88:91], v[32:35], a[192:195]
ds_read_b64_tr_b16 v[68:69], v161 offset:32768
v_mfma_f32_16x16x32_bf16 a[196:199], v[88:91], v[36:39], a[196:199]
ds_read_b64_tr_b16 v[70:71], v161 offset:36864
v_mfma_f32_16x16x32_bf16 a[200:203], v[88:91], v[40:43], a[200:203]
v_mfma_f32_16x16x32_bf16 a[204:207], v[88:91], v[44:47], a[204:207]
buffer_load_dwordx4 v173, s[8:11], s17 offen offset:1024 lds
v_mfma_f32_16x16x32_bf16 a[208:211], v[88:91], v[48:51], a[208:211]
s_add_u32 s32, s32, 65536
s_and_b32 s32, s32, 2097151
ds_read_b128 v[12:15], v164 offset:38912
v_mfma_f32_16x16x32_bf16 a[212:215], v[88:91], v[52:55], a[212:215]
ds_read_b128 v[16:19], v164 offset:40960
v_mfma_f32_16x16x32_bf16 a[216:219], v[88:91], v[56:59], a[216:219]
ds_read_b128 v[20:23], v164 offset:43008
v_mfma_f32_16x16x32_bf16 a[220:223], v[88:91], v[60:63], a[220:223]
s_waitcnt lgkmcnt(10)
v_mfma_f32_16x16x32_bf16 a[224:227], v[92:95], v[32:35], a[224:227]
ds_read_b64_tr_b16 v[72:73], v162 offset:32768
v_mfma_f32_16x16x32_bf16 a[228:231], v[92:95], v[36:39], a[228:231]
ds_read_b64_tr_b16 v[74:75], v162 offset:36864
v_mfma_f32_16x16x32_bf16 a[232:235], v[92:95], v[40:43], a[232:235]
s_add_u32 m0, s35, 8192
s_xor_b32 s17, s32, s43
ds_read_b128 v[24:27], v164 offset:45056
v_mfma_f32_16x16x32_bf16 a[236:239], v[92:95], v[44:47], a[236:239]
buffer_load_dwordx4 v172, s[8:11], s17 offen offset:0 lds
v_mfma_f32_16x16x32_bf16 a[240:243], v[92:95], v[48:51], a[240:243]
ds_read_b128 v[28:31], v164 offset:47104
v_mfma_f32_16x16x32_bf16 a[244:247], v[92:95], v[52:55], a[244:247]
v_mfma_f32_16x16x32_bf16 a[248:251], v[92:95], v[56:59], a[248:251]
v_mfma_f32_16x16x32_bf16 a[252:255], v[92:95], v[60:63], a[252:255]
s_waitcnt lgkmcnt(11)
v_mfma_f32_16x16x32_bf16 a[0:3], v[64:67], v[0:3], a[0:3]
s_waitcnt lgkmcnt(10)
ds_read_b64_tr_b16 v[76:77], v163 offset:32768
v_mfma_f32_16x16x32_bf16 a[4:7], v[64:67], v[4:7], a[4:7]
s_waitcnt lgkmcnt(10)
ds_read_b64_tr_b16 v[78:79], v163 offset:36864
v_mfma_f32_16x16x32_bf16 a[8:11], v[64:67], v[8:11], a[8:11]
s_waitcnt lgkmcnt(8)
v_mfma_f32_16x16x32_bf16 a[12:15], v[64:67], v[12:15], a[12:15]
s_waitcnt lgkmcnt(7)
buffer_load_dwordx4 v173, s[8:11], s17 offen offset:1024 lds
v_mfma_f32_16x16x32_bf16 a[16:19], v[64:67], v[16:19], a[16:19]
s_waitcnt lgkmcnt(6)
s_add_u32 s32, s32, 65536
s_and_b32 s32, s32, 2097151
v_mfma_f32_16x16x32_bf16 a[20:23], v[64:67], v[20:23], a[20:23]
s_waitcnt lgkmcnt(3)
ds_read_b128 v[32:35], v165 offset:32768
v_mfma_f32_16x16x32_bf16 a[24:27], v[64:67], v[24:27], a[24:27]
s_waitcnt lgkmcnt(3)
ds_read_b128 v[36:39], v165 offset:34816
v_mfma_f32_16x16x32_bf16 a[28:31], v[64:67], v[28:31], a[28:31]
v_mfma_f32_16x16x32_bf16 a[32:35], v[68:71], v[0:3], a[32:35]
ds_read_b64_tr_b16 v[80:81], v160 offset:40960
v_mfma_f32_16x16x32_bf16 a[36:39], v[68:71], v[4:7], a[36:39]
ds_read_b64_tr_b16 v[82:83], v160 offset:45056
v_mfma_f32_16x16x32_bf16 a[40:43], v[68:71], v[8:11], a[40:43]
s_add_u32 m0, s19, 4096
s_add_u32 s16, s16, 65536
v_mfma_f32_16x16x32_bf16 a[44:47], v[68:71], v[12:15], a[44:47]
buffer_load_dwordx4 v168, s[4:7], s16 offen offset:0 lds
v_mfma_f32_16x16x32_bf16 a[48:51], v[68:71], v[16:19], a[48:51]
v_mfma_f32_16x16x32_bf16 a[52:55], v[68:71], v[20:23], a[52:55]
ds_read_b128 v[40:43], v165 offset:36864
v_mfma_f32_16x16x32_bf16 a[56:59], v[68:71], v[24:27], a[56:59]
ds_read_b128 v[44:47], v165 offset:38912
v_mfma_f32_16x16x32_bf16 a[60:63], v[68:71], v[28:31], a[60:63]
v_mfma_f32_16x16x32_bf16 a[64:67], v[72:75], v[0:3], a[64:67]
ds_read_b64_tr_b16 v[84:85], v161 offset:40960
v_mfma_f32_16x16x32_bf16 a[68:71], v[72:75], v[4:7], a[68:71]
ds_read_b64_tr_b16 v[86:87], v161 offset:45056
v_mfma_f32_16x16x32_bf16 a[72:75], v[72:75], v[8:11], a[72:75]
v_mfma_f32_16x16x32_bf16 a[76:79], v[72:75], v[12:15], a[76:79]
buffer_load_dwordx4 v169, s[4:7], s16 offen offset:1024 lds
v_mfma_f32_16x16x32_bf16 a[80:83], v[72:75], v[16:19], a[80:83]
v_mfma_f32_16x16x32_bf16 a[84:87], v[72:75], v[20:23], a[84:87]
ds_read_b128 v[48:51], v165 offset:40960
v_mfma_f32_16x16x32_bf16 a[88:91], v[72:75], v[24:27], a[88:91]
ds_read_b128 v[52:55], v165 offset:43008
v_mfma_f32_16x16x32_bf16 a[92:95], v[72:75], v[28:31], a[92:95]
s_waitcnt lgkmcnt(10)
v_mfma_f32_16x16x32_bf16 a[96:99], v[76:79], v[0:3], a[96:99]
ds_read_b64_tr_b16 v[88:89], v162 offset:40960
v_mfma_f32_16x16x32_bf16 a[100:103], v[76:79], v[4:7], a[100:103]
ds_read_b64_tr_b16 v[90:91], v162 offset:45056
v_mfma_f32_16x16x32_bf16 a[104:107], v[76:79], v[8:11], a[104:107]
v_mfma_f32_16x16x32_bf16 a[108:111], v[76:79], v[12:15], a[108:111]
buffer_load_dwordx4 v170, s[4:7], s16 offen offset:2048 lds
v_mfma_f32_16x16x32_bf16 a[112:115], v[76:79], v[16:19], a[112:115]
v_mfma_f32_16x16x32_bf16 a[116:119], v[76:79], v[20:23], a[116:119]
ds_read_b128 v[56:59], v165 offset:45056
v_mfma_f32_16x16x32_bf16 a[120:123], v[76:79], v[24:27], a[120:123]
ds_read_b128 v[60:63], v165 offset:47104
v_mfma_f32_16x16x32_bf16 a[124:127], v[76:79], v[28:31], a[124:127]
s_waitcnt lgkmcnt(10)
v_mfma_f32_16x16x32_bf16 a[128:131], v[80:83], v[0:3], a[128:131]
ds_read_b64_tr_b16 v[92:93], v163 offset:40960
v_mfma_f32_16x16x32_bf16 a[132:135], v[80:83], v[4:7], a[132:135]
ds_read_b64_tr_b16 v[94:95], v163 offset:45056
v_mfma_f32_16x16x32_bf16 a[136:139], v[80:83], v[8:11], a[136:139]
v_mfma_f32_16x16x32_bf16 a[140:143], v[80:83], v[12:15], a[140:143]
buffer_load_dwordx4 v171, s[4:7], s16 offen offset:3072 lds
v_mfma_f32_16x16x32_bf16 a[144:147], v[80:83], v[16:19], a[144:147]
s_add_u32 s29, s29, 128
s_and_b32 s29, s29, 2047
v_mfma_f32_16x16x32_bf16 a[148:151], v[80:83], v[20:23], a[148:151]
v_mfma_f32_16x16x32_bf16 a[152:155], v[80:83], v[24:27], a[152:155]
v_mfma_f32_16x16x32_bf16 a[156:159], v[80:83], v[28:31], a[156:159]
s_waitcnt vmcnt(12) lgkmcnt(2)
s_barrier
v_mfma_f32_16x16x32_bf16 a[160:163], v[84:87], v[0:3], a[160:163]
ds_read_b64_tr_b16 v[64:65], v160 offset:49152
v_mfma_f32_16x16x32_bf16 a[164:167], v[84:87], v[4:7], a[164:167]
ds_read_b64_tr_b16 v[66:67], v160 offset:53248
v_mfma_f32_16x16x32_bf16 a[168:171], v[84:87], v[8:11], a[168:171]
s_add_u32 m0, s19, 32768
s_add_u32 s16, s28, s29
s_xor_b32 s16, s16, s42
v_mfma_f32_16x16x32_bf16 a[172:175], v[84:87], v[12:15], a[172:175]
buffer_load_dwordx4 v168, s[4:7], s16 offen offset:0 lds
v_mfma_f32_16x16x32_bf16 a[176:179], v[84:87], v[16:19], a[176:179]
v_mfma_f32_16x16x32_bf16 a[180:183], v[84:87], v[20:23], a[180:183]
v_mfma_f32_16x16x32_bf16 a[184:187], v[84:87], v[24:27], a[184:187]
v_mfma_f32_16x16x32_bf16 a[188:191], v[84:87], v[28:31], a[188:191]
buffer_load_dwordx4 v169, s[4:7], s16 offen offset:1024 lds
v_mfma_f32_16x16x32_bf16 a[192:195], v[88:91], v[0:3], a[192:195]
ds_read_b64_tr_b16 v[68:69], v161 offset:49152
v_mfma_f32_16x16x32_bf16 a[196:199], v[88:91], v[4:7], a[196:199]
ds_read_b64_tr_b16 v[70:71], v161 offset:53248
v_mfma_f32_16x16x32_bf16 a[200:203], v[88:91], v[8:11], a[200:203]
v_mfma_f32_16x16x32_bf16 a[204:207], v[88:91], v[12:15], a[204:207]
buffer_load_dwordx4 v170, s[4:7], s16 offen offset:2048 lds
v_mfma_f32_16x16x32_bf16 a[208:211], v[88:91], v[16:19], a[208:211]
v_mfma_f32_16x16x32_bf16 a[212:215], v[88:91], v[20:23], a[212:215]
v_mfma_f32_16x16x32_bf16 a[216:219], v[88:91], v[24:27], a[216:219]
v_mfma_f32_16x16x32_bf16 a[220:223], v[88:91], v[28:31], a[220:223]
s_waitcnt lgkmcnt(4)
buffer_load_dwordx4 v171, s[4:7], s16 offen offset:3072 lds
v_mfma_f32_16x16x32_bf16 a[224:227], v[92:95], v[0:3], a[224:227]
ds_read_b64_tr_b16 v[72:73], v162 offset:49152
v_mfma_f32_16x16x32_bf16 a[228:231], v[92:95], v[4:7], a[228:231]
ds_read_b64_tr_b16 v[74:75], v162 offset:53248
v_mfma_f32_16x16x32_bf16 a[232:235], v[92:95], v[8:11], a[232:235]
s_add_u32 m0, s19, 36864
s_add_u32 s16, s16, 65536
v_mfma_f32_16x16x32_bf16 a[236:239], v[92:95], v[12:15], a[236:239]
buffer_load_dwordx4 v168, s[4:7], s16 offen offset:0 lds
v_mfma_f32_16x16x32_bf16 a[240:243], v[92:95], v[16:19], a[240:243]
v_mfma_f32_16x16x32_bf16 a[244:247], v[92:95], v[20:23], a[244:247]
v_mfma_f32_16x16x32_bf16 a[248:251], v[92:95], v[24:27], a[248:251]
v_mfma_f32_16x16x32_bf16 a[252:255], v[92:95], v[28:31], a[252:255]
s_waitcnt lgkmcnt(4)
v_mfma_f32_16x16x32_bf16 a[0:3], v[64:67], v[32:35], a[0:3]
ds_read_b64_tr_b16 v[76:77], v163 offset:49152
v_mfma_f32_16x16x32_bf16 a[4:7], v[64:67], v[36:39], a[4:7]
ds_read_b64_tr_b16 v[78:79], v163 offset:53248
v_mfma_f32_16x16x32_bf16 a[8:11], v[64:67], v[40:43], a[8:11]
v_mfma_f32_16x16x32_bf16 a[12:15], v[64:67], v[44:47], a[12:15]
buffer_load_dwordx4 v169, s[4:7], s16 offen offset:1024 lds
v_mfma_f32_16x16x32_bf16 a[16:19], v[64:67], v[48:51], a[16:19]
v_mfma_f32_16x16x32_bf16 a[20:23], v[64:67], v[52:55], a[20:23]
v_mfma_f32_16x16x32_bf16 a[24:27], v[64:67], v[56:59], a[24:27]
v_mfma_f32_16x16x32_bf16 a[28:31], v[64:67], v[60:63], a[28:31]
s_waitcnt lgkmcnt(4)
buffer_load_dwordx4 v170, s[4:7], s16 offen offset:2048 lds
v_mfma_f32_16x16x32_bf16 a[32:35], v[68:71], v[32:35], a[32:35]
ds_read_b64_tr_b16 v[80:81], v160 offset:57344
v_mfma_f32_16x16x32_bf16 a[36:39], v[68:71], v[36:39], a[36:39]
ds_read_b64_tr_b16 v[82:83], v160 offset:61440
v_mfma_f32_16x16x32_bf16 a[40:43], v[68:71], v[40:43], a[40:43]
v_mfma_f32_16x16x32_bf16 a[44:47], v[68:71], v[44:47], a[44:47]
buffer_load_dwordx4 v171, s[4:7], s16 offen offset:3072 lds
v_mfma_f32_16x16x32_bf16 a[48:51], v[68:71], v[48:51], a[48:51]
s_add_u32 s29, s29, 128
s_and_b32 s29, s29, 2047
v_mfma_f32_16x16x32_bf16 a[52:55], v[68:71], v[52:55], a[52:55]
v_mfma_f32_16x16x32_bf16 a[56:59], v[68:71], v[56:59], a[56:59]
v_mfma_f32_16x16x32_bf16 a[60:63], v[68:71], v[60:63], a[60:63]
s_waitcnt lgkmcnt(4)
v_mfma_f32_16x16x32_bf16 a[64:67], v[72:75], v[32:35], a[64:67]
ds_read_b64_tr_b16 v[84:85], v161 offset:57344
v_mfma_f32_16x16x32_bf16 a[68:71], v[72:75], v[36:39], a[68:71]
ds_read_b64_tr_b16 v[86:87], v161 offset:61440
v_mfma_f32_16x16x32_bf16 a[72:75], v[72:75], v[40:43], a[72:75]
s_add_u32 m0, s35, 16384
s_xor_b32 s17, s32, s43
v_mfma_f32_16x16x32_bf16 a[76:79], v[72:75], v[44:47], a[76:79]
buffer_load_dwordx4 v172, s[8:11], s17 offen offset:0 lds
v_mfma_f32_16x16x32_bf16 a[80:83], v[72:75], v[48:51], a[80:83]
v_mfma_f32_16x16x32_bf16 a[84:87], v[72:75], v[52:55], a[84:87]
v_mfma_f32_16x16x32_bf16 a[88:91], v[72:75], v[56:59], a[88:91]
v_mfma_f32_16x16x32_bf16 a[92:95], v[72:75], v[60:63], a[92:95]
s_waitcnt lgkmcnt(4)
buffer_load_dwordx4 v173, s[8:11], s17 offen offset:1024 lds
v_mfma_f32_16x16x32_bf16 a[96:99], v[76:79], v[32:35], a[96:99]
s_add_u32 s32, s32, 65536
s_and_b32 s32, s32, 2097151
ds_read_b64_tr_b16 v[88:89], v162 offset:57344
v_mfma_f32_16x16x32_bf16 a[100:103], v[76:79], v[36:39], a[100:103]
ds_read_b64_tr_b16 v[90:91], v162 offset:61440
v_mfma_f32_16x16x32_bf16 a[104:107], v[76:79], v[40:43], a[104:107]
s_add_u32 m0, s35, 24576
s_xor_b32 s17, s32, s43
v_mfma_f32_16x16x32_bf16 a[108:111], v[76:79], v[44:47], a[108:111]
buffer_load_dwordx4 v172, s[8:11], s17 offen offset:0 lds
v_mfma_f32_16x16x32_bf16 a[112:115], v[76:79], v[48:51], a[112:115]
v_mfma_f32_16x16x32_bf16 a[116:119], v[76:79], v[52:55], a[116:119]
v_mfma_f32_16x16x32_bf16 a[120:123], v[76:79], v[56:59], a[120:123]
v_mfma_f32_16x16x32_bf16 a[124:127], v[76:79], v[60:63], a[124:127]
s_waitcnt lgkmcnt(4)
v_mfma_f32_16x16x32_bf16 a[128:131], v[80:83], v[32:35], a[128:131]
ds_read_b64_tr_b16 v[92:93], v163 offset:57344
v_mfma_f32_16x16x32_bf16 a[132:135], v[80:83], v[36:39], a[132:135]
ds_read_b64_tr_b16 v[94:95], v163 offset:61440
v_mfma_f32_16x16x32_bf16 a[136:139], v[80:83], v[40:43], a[136:139]
v_mfma_f32_16x16x32_bf16 a[140:143], v[80:83], v[44:47], a[140:143]
buffer_load_dwordx4 v173, s[8:11], s17 offen offset:1024 lds
v_mfma_f32_16x16x32_bf16 a[144:147], v[80:83], v[48:51], a[144:147]
s_add_u32 s32, s32, 65536
s_and_b32 s32, s32, 2097151
v_mfma_f32_16x16x32_bf16 a[148:151], v[80:83], v[52:55], a[148:151]
v_mfma_f32_16x16x32_bf16 a[152:155], v[80:83], v[56:59], a[152:155]
v_mfma_f32_16x16x32_bf16 a[156:159], v[80:83], v[60:63], a[156:159]
s_waitcnt vmcnt(12) lgkmcnt(4)
s_barrier
v_mfma_f32_16x16x32_bf16 a[160:163], v[84:87], v[32:35], a[160:163]
ds_read_b64_tr_b16 v[64:65], v160 offset:0
v_mfma_f32_16x16x32_bf16 a[164:167], v[84:87], v[36:39], a[164:167]
ds_read_b64_tr_b16 v[66:67], v160 offset:4096
v_mfma_f32_16x16x32_bf16 a[168:171], v[84:87], v[40:43], a[168:171]
s_add_u32 m0, s19, 131072
s_add_u32 s16, s28, s29
s_xor_b32 s16, s16, s42
v_mfma_f32_16x16x32_bf16 a[172:175], v[84:87], v[44:47], a[172:175]
buffer_load_dwordx4 v168, s[4:7], s16 offen offset:0 lds
v_mfma_f32_16x16x32_bf16 a[176:179], v[84:87], v[48:51], a[176:179]
ds_read_b128 v[0:3], v164 offset:0
v_mfma_f32_16x16x32_bf16 a[180:183], v[84:87], v[52:55], a[180:183]
ds_read_b128 v[4:7], v164 offset:2048
v_mfma_f32_16x16x32_bf16 a[184:187], v[84:87], v[56:59], a[184:187]
ds_read_b128 v[8:11], v164 offset:4096
v_mfma_f32_16x16x32_bf16 a[188:191], v[84:87], v[60:63], a[188:191]
s_waitcnt lgkmcnt(7)
buffer_load_dwordx4 v169, s[4:7], s16 offen offset:1024 lds
v_mfma_f32_16x16x32_bf16 a[192:195], v[88:91], v[32:35], a[192:195]
ds_read_b64_tr_b16 v[68:69], v161 offset:0
v_mfma_f32_16x16x32_bf16 a[196:199], v[88:91], v[36:39], a[196:199]
ds_read_b64_tr_b16 v[70:71], v161 offset:4096
v_mfma_f32_16x16x32_bf16 a[200:203], v[88:91], v[40:43], a[200:203]
v_mfma_f32_16x16x32_bf16 a[204:207], v[88:91], v[44:47], a[204:207]
buffer_load_dwordx4 v170, s[4:7], s16 offen offset:2048 lds
v_mfma_f32_16x16x32_bf16 a[208:211], v[88:91], v[48:51], a[208:211]
ds_read_b128 v[12:15], v164 offset:6144
v_mfma_f32_16x16x32_bf16 a[212:215], v[88:91], v[52:55], a[212:215]
ds_read_b128 v[16:19], v164 offset:8192
v_mfma_f32_16x16x32_bf16 a[216:219], v[88:91], v[56:59], a[216:219]
ds_read_b128 v[20:23], v164 offset:10240
v_mfma_f32_16x16x32_bf16 a[220:223], v[88:91], v[60:63], a[220:223]
s_waitcnt lgkmcnt(10)
buffer_load_dwordx4 v171, s[4:7], s16 offen offset:3072 lds
v_mfma_f32_16x16x32_bf16 a[224:227], v[92:95], v[32:35], a[224:227]
ds_read_b64_tr_b16 v[72:73], v162 offset:0
v_mfma_f32_16x16x32_bf16 a[228:231], v[92:95], v[36:39], a[228:231]
ds_read_b64_tr_b16 v[74:75], v162 offset:4096
v_mfma_f32_16x16x32_bf16 a[232:235], v[92:95], v[40:43], a[232:235]
s_add_u32 m0, s19, 135168
s_add_u32 s16, s16, 65536
ds_read_b128 v[24:27], v164 offset:12288
v_mfma_f32_16x16x32_bf16 a[236:239], v[92:95], v[44:47], a[236:239]
buffer_load_dwordx4 v168, s[4:7], s16 offen offset:0 lds
v_mfma_f32_16x16x32_bf16 a[240:243], v[92:95], v[48:51], a[240:243]
ds_read_b128 v[28:31], v164 offset:14336
v_mfma_f32_16x16x32_bf16 a[244:247], v[92:95], v[52:55], a[244:247]
v_mfma_f32_16x16x32_bf16 a[248:251], v[92:95], v[56:59], a[248:251]
v_mfma_f32_16x16x32_bf16 a[252:255], v[92:95], v[60:63], a[252:255]
s_waitcnt lgkmcnt(11)
v_mfma_f32_16x16x32_bf16 a[0:3], v[64:67], v[0:3], a[0:3]
s_waitcnt lgkmcnt(10)
ds_read_b64_tr_b16 v[76:77], v163 offset:0
v_mfma_f32_16x16x32_bf16 a[4:7], v[64:67], v[4:7], a[4:7]
s_waitcnt lgkmcnt(10)
ds_read_b64_tr_b16 v[78:79], v163 offset:4096
v_mfma_f32_16x16x32_bf16 a[8:11], v[64:67], v[8:11], a[8:11]
s_waitcnt lgkmcnt(8)
v_mfma_f32_16x16x32_bf16 a[12:15], v[64:67], v[12:15], a[12:15]
s_waitcnt lgkmcnt(7)
buffer_load_dwordx4 v169, s[4:7], s16 offen offset:1024 lds
v_mfma_f32_16x16x32_bf16 a[16:19], v[64:67], v[16:19], a[16:19]
s_waitcnt lgkmcnt(6)
ds_read_b128 v[32:35], v165 offset:0
v_mfma_f32_16x16x32_bf16 a[20:23], v[64:67], v[20:23], a[20:23]
s_waitcnt lgkmcnt(4)
ds_read_b128 v[36:39], v165 offset:2048
v_mfma_f32_16x16x32_bf16 a[24:27], v[64:67], v[24:27], a[24:27]
s_waitcnt lgkmcnt(4)
ds_read_b128 v[40:43], v165 offset:4096
v_mfma_f32_16x16x32_bf16 a[28:31], v[64:67], v[28:31], a[28:31]
buffer_load_dwordx4 v170, s[4:7], s16 offen offset:2048 lds
v_mfma_f32_16x16x32_bf16 a[32:35], v[68:71], v[0:3], a[32:35]
ds_read_b64_tr_b16 v[80:81], v160 offset:8192
v_mfma_f32_16x16x32_bf16 a[36:39], v[68:71], v[4:7], a[36:39]
ds_read_b64_tr_b16 v[82:83], v160 offset:12288
v_mfma_f32_16x16x32_bf16 a[40:43], v[68:71], v[8:11], a[40:43]
v_mfma_f32_16x16x32_bf16 a[44:47], v[68:71], v[12:15], a[44:47]
buffer_load_dwordx4 v171, s[4:7], s16 offen offset:3072 lds
v_mfma_f32_16x16x32_bf16 a[48:51], v[68:71], v[16:19], a[48:51]
s_add_u32 s29, s29, 128
s_and_b32 s29, s29, 2047
ds_read_b128 v[44:47], v165 offset:6144
v_mfma_f32_16x16x32_bf16 a[52:55], v[68:71], v[20:23], a[52:55]
ds_read_b128 v[48:51], v165 offset:8192
v_mfma_f32_16x16x32_bf16 a[56:59], v[68:71], v[24:27], a[56:59]
ds_read_b128 v[52:55], v165 offset:10240
v_mfma_f32_16x16x32_bf16 a[60:63], v[68:71], v[28:31], a[60:63]
v_mfma_f32_16x16x32_bf16 a[64:67], v[72:75], v[0:3], a[64:67]
ds_read_b64_tr_b16 v[84:85], v161 offset:8192
v_mfma_f32_16x16x32_bf16 a[68:71], v[72:75], v[4:7], a[68:71]
ds_read_b64_tr_b16 v[86:87], v161 offset:12288
v_mfma_f32_16x16x32_bf16 a[72:75], v[72:75], v[8:11], a[72:75]
s_add_u32 m0, s35, 32768
s_xor_b32 s17, s32, s43
v_mfma_f32_16x16x32_bf16 a[76:79], v[72:75], v[12:15], a[76:79]
buffer_load_dwordx4 v172, s[8:11], s17 offen offset:0 lds
v_mfma_f32_16x16x32_bf16 a[80:83], v[72:75], v[16:19], a[80:83]
ds_read_b128 v[56:59], v165 offset:12288
v_mfma_f32_16x16x32_bf16 a[84:87], v[72:75], v[20:23], a[84:87]
ds_read_b128 v[60:63], v165 offset:14336
v_mfma_f32_16x16x32_bf16 a[88:91], v[72:75], v[24:27], a[88:91]
v_mfma_f32_16x16x32_bf16 a[92:95], v[72:75], v[28:31], a[92:95]
s_waitcnt lgkmcnt(12)
buffer_load_dwordx4 v173, s[8:11], s17 offen offset:1024 lds
v_mfma_f32_16x16x32_bf16 a[96:99], v[76:79], v[0:3], a[96:99]
s_add_u32 s32, s32, 65536
s_and_b32 s32, s32, 2097151
ds_read_b64_tr_b16 v[88:89], v162 offset:8192
v_mfma_f32_16x16x32_bf16 a[100:103], v[76:79], v[4:7], a[100:103]
ds_read_b64_tr_b16 v[90:91], v162 offset:12288
v_mfma_f32_16x16x32_bf16 a[104:107], v[76:79], v[8:11], a[104:107]
s_add_u32 m0, s35, 40960
s_xor_b32 s17, s32, s43
v_mfma_f32_16x16x32_bf16 a[108:111], v[76:79], v[12:15], a[108:111]
buffer_load_dwordx4 v172, s[8:11], s17 offen offset:0 lds
v_mfma_f32_16x16x32_bf16 a[112:115], v[76:79], v[16:19], a[112:115]
v_mfma_f32_16x16x32_bf16 a[116:119], v[76:79], v[20:23], a[116:119]
v_mfma_f32_16x16x32_bf16 a[120:123], v[76:79], v[24:27], a[120:123]
v_mfma_f32_16x16x32_bf16 a[124:127], v[76:79], v[28:31], a[124:127]
s_waitcnt lgkmcnt(9)
v_mfma_f32_16x16x32_bf16 a[0:3], v[80:83], v[32:35], a[0:3]
ds_read_b64_tr_b16 v[92:93], v163 offset:8192
v_mfma_f32_16x16x32_bf16 a[4:7], v[80:83], v[36:39], a[4:7]
ds_read_b64_tr_b16 v[94:95], v163 offset:12288
v_mfma_f32_16x16x32_bf16 a[8:11], v[80:83], v[40:43], a[8:11]
s_waitcnt lgkmcnt(10)
v_mfma_f32_16x16x32_bf16 a[12:15], v[80:83], v[44:47], a[12:15]
s_waitcnt lgkmcnt(9)
buffer_load_dwordx4 v173, s[8:11], s17 offen offset:1024 lds
v_mfma_f32_16x16x32_bf16 a[16:19], v[80:83], v[48:51], a[16:19]
s_waitcnt lgkmcnt(8)
s_add_u32 s32, s32, 65536
s_and_b32 s32, s32, 2097151
v_mfma_f32_16x16x32_bf16 a[20:23], v[80:83], v[52:55], a[20:23]
s_waitcnt lgkmcnt(5)
v_mfma_f32_16x16x32_bf16 a[24:27], v[80:83], v[56:59], a[24:27]
s_waitcnt lgkmcnt(4)
v_mfma_f32_16x16x32_bf16 a[28:31], v[80:83], v[60:63], a[28:31]
s_waitcnt vmcnt(12)
s_barrier
v_mfma_f32_16x16x32_bf16 a[32:35], v[84:87], v[32:35], a[32:35]
ds_read_b64_tr_b16 v[64:65], v160 offset:16384
v_mfma_f32_16x16x32_bf16 a[36:39], v[84:87], v[36:39], a[36:39]
ds_read_b64_tr_b16 v[66:67], v160 offset:20480
v_mfma_f32_16x16x32_bf16 a[40:43], v[84:87], v[40:43], a[40:43]
s_add_u32 m0, s19, 0
s_add_u32 s16, s28, s29
s_xor_b32 s16, s16, s42
v_mfma_f32_16x16x32_bf16 a[44:47], v[84:87], v[44:47], a[44:47]
buffer_load_dwordx4 v168, s[4:7], s16 offen offset:0 lds
v_mfma_f32_16x16x32_bf16 a[48:51], v[84:87], v[48:51], a[48:51]
ds_read_b128 v[0:3], v164 offset:32768
v_mfma_f32_16x16x32_bf16 a[52:55], v[84:87], v[52:55], a[52:55]
ds_read_b128 v[4:7], v164 offset:34816
v_mfma_f32_16x16x32_bf16 a[56:59], v[84:87], v[56:59], a[56:59]
ds_read_b128 v[8:11], v164 offset:36864
v_mfma_f32_16x16x32_bf16 a[60:63], v[84:87], v[60:63], a[60:63]
s_waitcnt lgkmcnt(7)
buffer_load_dwordx4 v169, s[4:7], s16 offen offset:1024 lds
v_mfma_f32_16x16x32_bf16 a[64:67], v[88:91], v[32:35], a[64:67]
ds_read_b64_tr_b16 v[68:69], v161 offset:16384
v_mfma_f32_16x16x32_bf16 a[68:71], v[88:91], v[36:39], a[68:71]
ds_read_b64_tr_b16 v[70:71], v161 offset:20480
v_mfma_f32_16x16x32_bf16 a[72:75], v[88:91], v[40:43], a[72:75]
v_mfma_f32_16x16x32_bf16 a[76:79], v[88:91], v[44:47], a[76:79]
buffer_load_dwordx4 v170, s[4:7], s16 offen offset:2048 lds
v_mfma_f32_16x16x32_bf16 a[80:83], v[88:91], v[48:51], a[80:83]
ds_read_b128 v[12:15], v164 offset:38912
v_mfma_f32_16x16x32_bf16 a[84:87], v[88:91], v[52:55], a[84:87]
ds_read_b128 v[16:19], v164 offset:40960
v_mfma_f32_16x16x32_bf16 a[88:91], v[88:91], v[56:59], a[88:91]
ds_read_b128 v[20:23], v164 offset:43008
v_mfma_f32_16x16x32_bf16 a[92:95], v[88:91], v[60:63], a[92:95]
s_waitcnt lgkmcnt(10)
buffer_load_dwordx4 v171, s[4:7], s16 offen offset:3072 lds
v_mfma_f32_16x16x32_bf16 a[96:99], v[92:95], v[32:35], a[96:99]
ds_read_b64_tr_b16 v[72:73], v162 offset:16384
v_mfma_f32_16x16x32_bf16 a[100:103], v[92:95], v[36:39], a[100:103]
ds_read_b64_tr_b16 v[74:75], v162 offset:20480
v_mfma_f32_16x16x32_bf16 a[104:107], v[92:95], v[40:43], a[104:107]
s_add_u32 m0, s19, 4096
s_add_u32 s16, s16, 65536
ds_read_b128 v[24:27], v164 offset:45056
v_mfma_f32_16x16x32_bf16 a[108:111], v[92:95], v[44:47], a[108:111]
buffer_load_dwordx4 v168, s[4:7], s16 offen offset:0 lds
v_mfma_f32_16x16x32_bf16 a[112:115], v[92:95], v[48:51], a[112:115]
ds_read_b128 v[28:31], v164 offset:47104
v_mfma_f32_16x16x32_bf16 a[116:119], v[92:95], v[52:55], a[116:119]
v_mfma_f32_16x16x32_bf16 a[120:123], v[92:95], v[56:59], a[120:123]
v_mfma_f32_16x16x32_bf16 a[124:127], v[92:95], v[60:63], a[124:127]
s_waitcnt lgkmcnt(11)
v_mfma_f32_16x16x32_bf16 a[0:3], v[64:67], v[0:3], a[0:3]
s_waitcnt lgkmcnt(10)
ds_read_b64_tr_b16 v[76:77], v163 offset:16384
v_mfma_f32_16x16x32_bf16 a[4:7], v[64:67], v[4:7], a[4:7]
s_waitcnt lgkmcnt(10)
ds_read_b64_tr_b16 v[78:79], v163 offset:20480
v_mfma_f32_16x16x32_bf16 a[8:11], v[64:67], v[8:11], a[8:11]
s_waitcnt lgkmcnt(8)
v_mfma_f32_16x16x32_bf16 a[12:15], v[64:67], v[12:15], a[12:15]
s_waitcnt lgkmcnt(7)
buffer_load_dwordx4 v169, s[4:7], s16 offen offset:1024 lds
v_mfma_f32_16x16x32_bf16 a[16:19], v[64:67], v[16:19], a[16:19]
s_waitcnt lgkmcnt(6)
ds_read_b128 v[32:35], v165 offset:32768
v_mfma_f32_16x16x32_bf16 a[20:23], v[64:67], v[20:23], a[20:23]
s_waitcnt lgkmcnt(4)
ds_read_b128 v[36:39], v165 offset:34816
v_mfma_f32_16x16x32_bf16 a[24:27], v[64:67], v[24:27], a[24:27]
s_waitcnt lgkmcnt(4)
ds_read_b128 v[40:43], v165 offset:36864
v_mfma_f32_16x16x32_bf16 a[28:31], v[64:67], v[28:31], a[28:31]
buffer_load_dwordx4 v170, s[4:7], s16 offen offset:2048 lds
v_mfma_f32_16x16x32_bf16 a[32:35], v[68:71], v[0:3], a[32:35]
ds_read_b64_tr_b16 v[80:81], v160 offset:24576
v_mfma_f32_16x16x32_bf16 a[36:39], v[68:71], v[4:7], a[36:39]
ds_read_b64_tr_b16 v[82:83], v160 offset:28672
v_mfma_f32_16x16x32_bf16 a[40:43], v[68:71], v[8:11], a[40:43]
v_mfma_f32_16x16x32_bf16 a[44:47], v[68:71], v[12:15], a[44:47]
buffer_load_dwordx4 v171, s[4:7], s16 offen offset:3072 lds
v_mfma_f32_16x16x32_bf16 a[48:51], v[68:71], v[16:19], a[48:51]
s_add_u32 s29, s29, 128
s_and_b32 s29, s29, 2047
ds_read_b128 v[44:47], v165 offset:38912
v_mfma_f32_16x16x32_bf16 a[52:55], v[68:71], v[20:23], a[52:55]
ds_read_b128 v[48:51], v165 offset:40960
v_mfma_f32_16x16x32_bf16 a[56:59], v[68:71], v[24:27], a[56:59]
ds_read_b128 v[52:55], v165 offset:43008
v_mfma_f32_16x16x32_bf16 a[60:63], v[68:71], v[28:31], a[60:63]
v_mfma_f32_16x16x32_bf16 a[64:67], v[72:75], v[0:3], a[64:67]
ds_read_b64_tr_b16 v[84:85], v161 offset:24576
v_mfma_f32_16x16x32_bf16 a[68:71], v[72:75], v[4:7], a[68:71]
ds_read_b64_tr_b16 v[86:87], v161 offset:28672
v_mfma_f32_16x16x32_bf16 a[72:75], v[72:75], v[8:11], a[72:75]
s_add_u32 m0, s35, 49152
s_xor_b32 s17, s32, s43
v_mfma_f32_16x16x32_bf16 a[76:79], v[72:75], v[12:15], a[76:79]
buffer_load_dwordx4 v172, s[8:11], s17 offen offset:0 lds
v_mfma_f32_16x16x32_bf16 a[80:83], v[72:75], v[16:19], a[80:83]
ds_read_b128 v[56:59], v165 offset:45056
v_mfma_f32_16x16x32_bf16 a[84:87], v[72:75], v[20:23], a[84:87]
ds_read_b128 v[60:63], v165 offset:47104
v_mfma_f32_16x16x32_bf16 a[88:91], v[72:75], v[24:27], a[88:91]
v_mfma_f32_16x16x32_bf16 a[92:95], v[72:75], v[28:31], a[92:95]
s_waitcnt lgkmcnt(12)
buffer_load_dwordx4 v173, s[8:11], s17 offen offset:1024 lds
v_mfma_f32_16x16x32_bf16 a[96:99], v[76:79], v[0:3], a[96:99]
s_add_u32 s32, s32, 65536
s_and_b32 s32, s32, 2097151
ds_read_b64_tr_b16 v[88:89], v162 offset:24576
v_mfma_f32_16x16x32_bf16 a[100:103], v[76:79], v[4:7], a[100:103]
ds_read_b64_tr_b16 v[90:91], v162 offset:28672
v_mfma_f32_16x16x32_bf16 a[104:107], v[76:79], v[8:11], a[104:107]
s_add_u32 m0, s35, 57344
s_xor_b32 s17, s32, s43
v_mfma_f32_16x16x32_bf16 a[108:111], v[76:79], v[12:15], a[108:111]
buffer_load_dwordx4 v172, s[8:11], s17 offen offset:0 lds
v_mfma_f32_16x16x32_bf16 a[112:115], v[76:79], v[16:19], a[112:115]
v_mfma_f32_16x16x32_bf16 a[116:119], v[76:79], v[20:23], a[116:119]
v_mfma_f32_16x16x32_bf16 a[120:123], v[76:79], v[24:27], a[120:123]
v_mfma_f32_16x16x32_bf16 a[124:127], v[76:79], v[28:31], a[124:127]
s_waitcnt lgkmcnt(9)
v_mfma_f32_16x16x32_bf16 a[0:3], v[80:83], v[32:35], a[0:3]
ds_read_b64_tr_b16 v[92:93], v163 offset:24576
v_mfma_f32_16x16x32_bf16 a[4:7], v[80:83], v[36:39], a[4:7]
ds_read_b64_tr_b16 v[94:95], v163 offset:28672
v_mfma_f32_16x16x32_bf16 a[8:11], v[80:83], v[40:43], a[8:11]
s_waitcnt lgkmcnt(10)
v_mfma_f32_16x16x32_bf16 a[12:15], v[80:83], v[44:47], a[12:15]
s_waitcnt lgkmcnt(9)
buffer_load_dwordx4 v173, s[8:11], s17 offen offset:1024 lds
v_mfma_f32_16x16x32_bf16 a[16:19], v[80:83], v[48:51], a[16:19]
s_waitcnt lgkmcnt(8)
s_add_u32 s32, s32, 65536
s_and_b32 s32, s32, 2097151
v_mfma_f32_16x16x32_bf16 a[20:23], v[80:83], v[52:55], a[20:23]
s_waitcnt lgkmcnt(5)
v_mfma_f32_16x16x32_bf16 a[24:27], v[80:83], v[56:59], a[24:27]
s_waitcnt lgkmcnt(4)
v_mfma_f32_16x16x32_bf16 a[28:31], v[80:83], v[60:63], a[28:31]
s_waitcnt vmcnt(12)
s_barrier
v_mfma_f32_16x16x32_bf16 a[32:35], v[84:87], v[32:35], a[32:35]
ds_read_b64_tr_b16 v[64:65], v160 offset:32768
v_mfma_f32_16x16x32_bf16 a[36:39], v[84:87], v[36:39], a[36:39]
ds_read_b64_tr_b16 v[66:67], v160 offset:36864
v_mfma_f32_16x16x32_bf16 a[40:43], v[84:87], v[40:43], a[40:43]
s_add_u32 m0, s19, 32768
s_add_u32 s16, s28, s29
s_xor_b32 s16, s16, s42
v_mfma_f32_16x16x32_bf16 a[44:47], v[84:87], v[44:47], a[44:47]
buffer_load_dwordx4 v168, s[4:7], s16 offen offset:0 lds
v_mfma_f32_16x16x32_bf16 a[48:51], v[84:87], v[48:51], a[48:51]
ds_read_b128 v[0:3], v166 offset:0
v_mfma_f32_16x16x32_bf16 a[52:55], v[84:87], v[52:55], a[52:55]
ds_read_b128 v[4:7], v166 offset:2048
v_mfma_f32_16x16x32_bf16 a[56:59], v[84:87], v[56:59], a[56:59]
ds_read_b128 v[8:11], v166 offset:4096
v_mfma_f32_16x16x32_bf16 a[60:63], v[84:87], v[60:63], a[60:63]
s_waitcnt lgkmcnt(7)
buffer_load_dwordx4 v169, s[4:7], s16 offen offset:1024 lds
v_mfma_f32_16x16x32_bf16 a[64:67], v[88:91], v[32:35], a[64:67]
ds_read_b64_tr_b16 v[68:69], v161 offset:32768
v_mfma_f32_16x16x32_bf16 a[68:71], v[88:91], v[36:39], a[68:71]
ds_read_b64_tr_b16 v[70:71], v161 offset:36864
v_mfma_f32_16x16x32_bf16 a[72:75], v[88:91], v[40:43], a[72:75]
v_mfma_f32_16x16x32_bf16 a[76:79], v[88:91], v[44:47], a[76:79]
buffer_load_dwordx4 v170, s[4:7], s16 offen offset:2048 lds
v_mfma_f32_16x16x32_bf16 a[80:83], v[88:91], v[48:51], a[80:83]
ds_read_b128 v[12:15], v166 offset:6144
v_mfma_f32_16x16x32_bf16 a[84:87], v[88:91], v[52:55], a[84:87]
ds_read_b128 v[16:19], v166 offset:8192
v_mfma_f32_16x16x32_bf16 a[88:91], v[88:91], v[56:59], a[88:91]
ds_read_b128 v[20:23], v166 offset:10240
v_mfma_f32_16x16x32_bf16 a[92:95], v[88:91], v[60:63], a[92:95]
s_waitcnt lgkmcnt(10)
buffer_load_dwordx4 v171, s[4:7], s16 offen offset:3072 lds
v_mfma_f32_16x16x32_bf16 a[96:99], v[92:95], v[32:35], a[96:99]
ds_read_b64_tr_b16 v[72:73], v162 offset:32768
v_mfma_f32_16x16x32_bf16 a[100:103], v[92:95], v[36:39], a[100:103]
ds_read_b64_tr_b16 v[74:75], v162 offset:36864
v_mfma_f32_16x16x32_bf16 a[104:107], v[92:95], v[40:43], a[104:107]
s_add_u32 m0, s19, 36864
s_add_u32 s16, s16, 65536
ds_read_b128 v[24:27], v166 offset:12288
v_mfma_f32_16x16x32_bf16 a[108:111], v[92:95], v[44:47], a[108:111]
buffer_load_dwordx4 v168, s[4:7], s16 offen offset:0 lds
v_mfma_f32_16x16x32_bf16 a[112:115], v[92:95], v[48:51], a[112:115]
ds_read_b128 v[28:31], v166 offset:14336
v_mfma_f32_16x16x32_bf16 a[116:119], v[92:95], v[52:55], a[116:119]
v_mfma_f32_16x16x32_bf16 a[120:123], v[92:95], v[56:59], a[120:123]
v_mfma_f32_16x16x32_bf16 a[124:127], v[92:95], v[60:63], a[124:127]
s_waitcnt lgkmcnt(11)
v_mfma_f32_16x16x32_bf16 a[0:3], v[64:67], v[0:3], a[0:3]
s_waitcnt lgkmcnt(10)
ds_read_b64_tr_b16 v[76:77], v163 offset:32768
v_mfma_f32_16x16x32_bf16 a[4:7], v[64:67], v[4:7], a[4:7]
s_waitcnt lgkmcnt(10)
ds_read_b64_tr_b16 v[78:79], v163 offset:36864
v_mfma_f32_16x16x32_bf16 a[8:11], v[64:67], v[8:11], a[8:11]
s_waitcnt lgkmcnt(8)
v_mfma_f32_16x16x32_bf16 a[12:15], v[64:67], v[12:15], a[12:15]
s_waitcnt lgkmcnt(7)
buffer_load_dwordx4 v169, s[4:7], s16 offen offset:1024 lds
v_mfma_f32_16x16x32_bf16 a[16:19], v[64:67], v[16:19], a[16:19]
s_waitcnt lgkmcnt(6)
ds_read_b128 v[32:35], v167 offset:0
v_mfma_f32_16x16x32_bf16 a[20:23], v[64:67], v[20:23], a[20:23]
s_waitcnt lgkmcnt(4)
ds_read_b128 v[36:39], v167 offset:2048
v_mfma_f32_16x16x32_bf16 a[24:27], v[64:67], v[24:27], a[24:27]
s_waitcnt lgkmcnt(4)
ds_read_b128 v[40:43], v167 offset:4096
v_mfma_f32_16x16x32_bf16 a[28:31], v[64:67], v[28:31], a[28:31]
buffer_load_dwordx4 v170, s[4:7], s16 offen offset:2048 lds
v_mfma_f32_16x16x32_bf16 a[32:35], v[68:71], v[0:3], a[32:35]
ds_read_b64_tr_b16 v[80:81], v160 offset:40960
v_mfma_f32_16x16x32_bf16 a[36:39], v[68:71], v[4:7], a[36:39]
ds_read_b64_tr_b16 v[82:83], v160 offset:45056
v_mfma_f32_16x16x32_bf16 a[40:43], v[68:71], v[8:11], a[40:43]
v_mfma_f32_16x16x32_bf16 a[44:47], v[68:71], v[12:15], a[44:47]
buffer_load_dwordx4 v171, s[4:7], s16 offen offset:3072 lds
v_mfma_f32_16x16x32_bf16 a[48:51], v[68:71], v[16:19], a[48:51]
s_add_u32 s29, s29, 128
s_and_b32 s29, s29, 2047
ds_read_b128 v[44:47], v167 offset:6144
v_mfma_f32_16x16x32_bf16 a[52:55], v[68:71], v[20:23], a[52:55]
ds_read_b128 v[48:51], v167 offset:8192
v_mfma_f32_16x16x32_bf16 a[56:59], v[68:71], v[24:27], a[56:59]
ds_read_b128 v[52:55], v167 offset:10240
v_mfma_f32_16x16x32_bf16 a[60:63], v[68:71], v[28:31], a[60:63]
v_mfma_f32_16x16x32_bf16 a[64:67], v[72:75], v[0:3], a[64:67]
ds_read_b64_tr_b16 v[84:85], v161 offset:40960
v_mfma_f32_16x16x32_bf16 a[68:71], v[72:75], v[4:7], a[68:71]
ds_read_b64_tr_b16 v[86:87], v161 offset:45056
v_mfma_f32_16x16x32_bf16 a[72:75], v[72:75], v[8:11], a[72:75]
s_add_u32 m0, s35, 0
s_xor_b32 s17, s32, s43
v_mfma_f32_16x16x32_bf16 a[76:79], v[72:75], v[12:15], a[76:79]
buffer_load_dwordx4 v172, s[8:11], s17 offen offset:0 lds
v_mfma_f32_16x16x32_bf16 a[80:83], v[72:75], v[16:19], a[80:83]
ds_read_b128 v[56:59], v167 offset:12288
v_mfma_f32_16x16x32_bf16 a[84:87], v[72:75], v[20:23], a[84:87]
ds_read_b128 v[60:63], v167 offset:14336
v_mfma_f32_16x16x32_bf16 a[88:91], v[72:75], v[24:27], a[88:91]
v_mfma_f32_16x16x32_bf16 a[92:95], v[72:75], v[28:31], a[92:95]
s_waitcnt lgkmcnt(12)
buffer_load_dwordx4 v173, s[8:11], s17 offen offset:1024 lds
v_mfma_f32_16x16x32_bf16 a[96:99], v[76:79], v[0:3], a[96:99]
s_add_u32 s32, s32, 65536
s_and_b32 s32, s32, 2097151
ds_read_b64_tr_b16 v[88:89], v162 offset:40960
v_mfma_f32_16x16x32_bf16 a[100:103], v[76:79], v[4:7], a[100:103]
ds_read_b64_tr_b16 v[90:91], v162 offset:45056
v_mfma_f32_16x16x32_bf16 a[104:107], v[76:79], v[8:11], a[104:107]
s_add_u32 m0, s35, 8192
s_xor_b32 s17, s32, s43
v_mfma_f32_16x16x32_bf16 a[108:111], v[76:79], v[12:15], a[108:111]
buffer_load_dwordx4 v172, s[8:11], s17 offen offset:0 lds
v_mfma_f32_16x16x32_bf16 a[112:115], v[76:79], v[16:19], a[112:115]
v_mfma_f32_16x16x32_bf16 a[116:119], v[76:79], v[20:23], a[116:119]
v_mfma_f32_16x16x32_bf16 a[120:123], v[76:79], v[24:27], a[120:123]
v_mfma_f32_16x16x32_bf16 a[124:127], v[76:79], v[28:31], a[124:127]
s_waitcnt lgkmcnt(9)
v_mfma_f32_16x16x32_bf16 a[0:3], v[80:83], v[32:35], a[0:3]
ds_read_b64_tr_b16 v[92:93], v163 offset:40960
v_mfma_f32_16x16x32_bf16 a[4:7], v[80:83], v[36:39], a[4:7]
ds_read_b64_tr_b16 v[94:95], v163 offset:45056
v_mfma_f32_16x16x32_bf16 a[8:11], v[80:83], v[40:43], a[8:11]
s_waitcnt lgkmcnt(10)
v_mfma_f32_16x16x32_bf16 a[12:15], v[80:83], v[44:47], a[12:15]
s_waitcnt lgkmcnt(9)
buffer_load_dwordx4 v173, s[8:11], s17 offen offset:1024 lds
v_mfma_f32_16x16x32_bf16 a[16:19], v[80:83], v[48:51], a[16:19]
s_waitcnt lgkmcnt(8)
s_add_u32 s32, s32, 65536
s_and_b32 s32, s32, 2097151
v_mfma_f32_16x16x32_bf16 a[20:23], v[80:83], v[52:55], a[20:23]
s_waitcnt lgkmcnt(5)
v_mfma_f32_16x16x32_bf16 a[24:27], v[80:83], v[56:59], a[24:27]
s_waitcnt lgkmcnt(4)
v_mfma_f32_16x16x32_bf16 a[28:31], v[80:83], v[60:63], a[28:31]
s_waitcnt vmcnt(12)
s_barrier
v_mfma_f32_16x16x32_bf16 a[32:35], v[84:87], v[32:35], a[32:35]
ds_read_b64_tr_b16 v[64:65], v160 offset:49152
v_mfma_f32_16x16x32_bf16 a[36:39], v[84:87], v[36:39], a[36:39]
ds_read_b64_tr_b16 v[66:67], v160 offset:53248
v_mfma_f32_16x16x32_bf16 a[40:43], v[84:87], v[40:43], a[40:43]
s_add_u32 m0, s19, 131072
s_add_u32 s16, s28, s29
s_xor_b32 s16, s16, s42
v_mfma_f32_16x16x32_bf16 a[44:47], v[84:87], v[44:47], a[44:47]
buffer_load_dwordx4 v168, s[4:7], s16 offen offset:0 lds
v_mfma_f32_16x16x32_bf16 a[48:51], v[84:87], v[48:51], a[48:51]
ds_read_b128 v[0:3], v164 offset:0
v_mfma_f32_16x16x32_bf16 a[52:55], v[84:87], v[52:55], a[52:55]
ds_read_b128 v[4:7], v164 offset:2048
v_mfma_f32_16x16x32_bf16 a[56:59], v[84:87], v[56:59], a[56:59]
ds_read_b128 v[8:11], v164 offset:4096
v_mfma_f32_16x16x32_bf16 a[60:63], v[84:87], v[60:63], a[60:63]
s_waitcnt lgkmcnt(7)
buffer_load_dwordx4 v169, s[4:7], s16 offen offset:1024 lds
v_mfma_f32_16x16x32_bf16 a[64:67], v[88:91], v[32:35], a[64:67]
ds_read_b64_tr_b16 v[68:69], v161 offset:49152
v_mfma_f32_16x16x32_bf16 a[68:71], v[88:91], v[36:39], a[68:71]
ds_read_b64_tr_b16 v[70:71], v161 offset:53248
v_mfma_f32_16x16x32_bf16 a[72:75], v[88:91], v[40:43], a[72:75]
v_mfma_f32_16x16x32_bf16 a[76:79], v[88:91], v[44:47], a[76:79]
buffer_load_dwordx4 v170, s[4:7], s16 offen offset:2048 lds
v_mfma_f32_16x16x32_bf16 a[80:83], v[88:91], v[48:51], a[80:83]
ds_read_b128 v[12:15], v164 offset:6144
v_mfma_f32_16x16x32_bf16 a[84:87], v[88:91], v[52:55], a[84:87]
ds_read_b128 v[16:19], v164 offset:8192
v_mfma_f32_16x16x32_bf16 a[88:91], v[88:91], v[56:59], a[88:91]
ds_read_b128 v[20:23], v164 offset:10240
v_mfma_f32_16x16x32_bf16 a[92:95], v[88:91], v[60:63], a[92:95]
s_waitcnt lgkmcnt(10)
buffer_load_dwordx4 v171, s[4:7], s16 offen offset:3072 lds
v_mfma_f32_16x16x32_bf16 a[96:99], v[92:95], v[32:35], a[96:99]
ds_read_b64_tr_b16 v[72:73], v162 offset:49152
v_mfma_f32_16x16x32_bf16 a[100:103], v[92:95], v[36:39], a[100:103]
ds_read_b64_tr_b16 v[74:75], v162 offset:53248
v_mfma_f32_16x16x32_bf16 a[104:107], v[92:95], v[40:43], a[104:107]
s_add_u32 m0, s19, 135168
s_add_u32 s16, s16, 65536
ds_read_b128 v[24:27], v164 offset:12288
v_mfma_f32_16x16x32_bf16 a[108:111], v[92:95], v[44:47], a[108:111]
buffer_load_dwordx4 v168, s[4:7], s16 offen offset:0 lds
v_mfma_f32_16x16x32_bf16 a[112:115], v[92:95], v[48:51], a[112:115]
ds_read_b128 v[28:31], v164 offset:14336
v_mfma_f32_16x16x32_bf16 a[116:119], v[92:95], v[52:55], a[116:119]
v_mfma_f32_16x16x32_bf16 a[120:123], v[92:95], v[56:59], a[120:123]
v_mfma_f32_16x16x32_bf16 a[124:127], v[92:95], v[60:63], a[124:127]
s_waitcnt lgkmcnt(11)
v_mfma_f32_16x16x32_bf16 a[0:3], v[64:67], v[0:3], a[0:3]
s_waitcnt lgkmcnt(10)
ds_read_b64_tr_b16 v[76:77], v163 offset:49152
v_mfma_f32_16x16x32_bf16 a[4:7], v[64:67], v[4:7], a[4:7]
s_waitcnt lgkmcnt(10)
ds_read_b64_tr_b16 v[78:79], v163 offset:53248
v_mfma_f32_16x16x32_bf16 a[8:11], v[64:67], v[8:11], a[8:11]
s_waitcnt lgkmcnt(8)
v_mfma_f32_16x16x32_bf16 a[12:15], v[64:67], v[12:15], a[12:15]
s_waitcnt lgkmcnt(7)
buffer_load_dwordx4 v169, s[4:7], s16 offen offset:1024 lds
v_mfma_f32_16x16x32_bf16 a[16:19], v[64:67], v[16:19], a[16:19]
s_waitcnt lgkmcnt(6)
ds_read_b128 v[32:35], v165 offset:0
v_mfma_f32_16x16x32_bf16 a[20:23], v[64:67], v[20:23], a[20:23]
s_waitcnt lgkmcnt(4)
ds_read_b128 v[36:39], v165 offset:2048
v_mfma_f32_16x16x32_bf16 a[24:27], v[64:67], v[24:27], a[24:27]
s_waitcnt lgkmcnt(4)
ds_read_b128 v[40:43], v165 offset:4096
v_mfma_f32_16x16x32_bf16 a[28:31], v[64:67], v[28:31], a[28:31]
buffer_load_dwordx4 v170, s[4:7], s16 offen offset:2048 lds
v_mfma_f32_16x16x32_bf16 a[32:35], v[68:71], v[0:3], a[32:35]
ds_read_b64_tr_b16 v[80:81], v160 offset:57344
v_mfma_f32_16x16x32_bf16 a[36:39], v[68:71], v[4:7], a[36:39]
ds_read_b64_tr_b16 v[82:83], v160 offset:61440
v_mfma_f32_16x16x32_bf16 a[40:43], v[68:71], v[8:11], a[40:43]
v_mfma_f32_16x16x32_bf16 a[44:47], v[68:71], v[12:15], a[44:47]
buffer_load_dwordx4 v171, s[4:7], s16 offen offset:3072 lds
v_mfma_f32_16x16x32_bf16 a[48:51], v[68:71], v[16:19], a[48:51]
s_add_u32 s29, s29, 128
s_and_b32 s29, s29, 2047
ds_read_b128 v[44:47], v165 offset:6144
v_mfma_f32_16x16x32_bf16 a[52:55], v[68:71], v[20:23], a[52:55]
ds_read_b128 v[48:51], v165 offset:8192
v_mfma_f32_16x16x32_bf16 a[56:59], v[68:71], v[24:27], a[56:59]
ds_read_b128 v[52:55], v165 offset:10240
v_mfma_f32_16x16x32_bf16 a[60:63], v[68:71], v[28:31], a[60:63]
v_mfma_f32_16x16x32_bf16 a[64:67], v[72:75], v[0:3], a[64:67]
ds_read_b64_tr_b16 v[84:85], v161 offset:57344
v_mfma_f32_16x16x32_bf16 a[68:71], v[72:75], v[4:7], a[68:71]
ds_read_b64_tr_b16 v[86:87], v161 offset:61440
v_mfma_f32_16x16x32_bf16 a[72:75], v[72:75], v[8:11], a[72:75]
s_add_u32 m0, s35, 16384
s_xor_b32 s17, s32, s43
v_mfma_f32_16x16x32_bf16 a[76:79], v[72:75], v[12:15], a[76:79]
buffer_load_dwordx4 v172, s[8:11], s17 offen offset:0 lds
v_mfma_f32_16x16x32_bf16 a[80:83], v[72:75], v[16:19], a[80:83]
ds_read_b128 v[56:59], v165 offset:12288
v_mfma_f32_16x16x32_bf16 a[84:87], v[72:75], v[20:23], a[84:87]
ds_read_b128 v[60:63], v165 offset:14336
v_mfma_f32_16x16x32_bf16 a[88:91], v[72:75], v[24:27], a[88:91]
v_mfma_f32_16x16x32_bf16 a[92:95], v[72:75], v[28:31], a[92:95]
s_waitcnt lgkmcnt(12)
buffer_load_dwordx4 v173, s[8:11], s17 offen offset:1024 lds
v_mfma_f32_16x16x32_bf16 a[96:99], v[76:79], v[0:3], a[96:99]
s_add_u32 s32, s32, 65536
s_and_b32 s32, s32, 2097151
ds_read_b64_tr_b16 v[88:89], v162 offset:57344
v_mfma_f32_16x16x32_bf16 a[100:103], v[76:79], v[4:7], a[100:103]
ds_read_b64_tr_b16 v[90:91], v162 offset:61440
v_mfma_f32_16x16x32_bf16 a[104:107], v[76:79], v[8:11], a[104:107]
s_add_u32 m0, s35, 24576
s_xor_b32 s17, s32, s43
v_mfma_f32_16x16x32_bf16 a[108:111], v[76:79], v[12:15], a[108:111]
buffer_load_dwordx4 v172, s[8:11], s17 offen offset:0 lds
v_mfma_f32_16x16x32_bf16 a[112:115], v[76:79], v[16:19], a[112:115]
v_mfma_f32_16x16x32_bf16 a[116:119], v[76:79], v[20:23], a[116:119]
v_mfma_f32_16x16x32_bf16 a[120:123], v[76:79], v[24:27], a[120:123]
v_mfma_f32_16x16x32_bf16 a[124:127], v[76:79], v[28:31], a[124:127]
s_waitcnt lgkmcnt(9)
v_mfma_f32_16x16x32_bf16 a[0:3], v[80:83], v[32:35], a[0:3]
ds_read_b64_tr_b16 v[92:93], v163 offset:57344
v_mfma_f32_16x16x32_bf16 a[4:7], v[80:83], v[36:39], a[4:7]
ds_read_b64_tr_b16 v[94:95], v163 offset:61440
v_mfma_f32_16x16x32_bf16 a[8:11], v[80:83], v[40:43], a[8:11]
s_waitcnt lgkmcnt(10)
v_mfma_f32_16x16x32_bf16 a[12:15], v[80:83], v[44:47], a[12:15]
s_waitcnt lgkmcnt(9)
buffer_load_dwordx4 v173, s[8:11], s17 offen offset:1024 lds
v_mfma_f32_16x16x32_bf16 a[16:19], v[80:83], v[48:51], a[16:19]
s_waitcnt lgkmcnt(8)
s_add_u32 s32, s32, 65536
s_and_b32 s32, s32, 2097151
v_mfma_f32_16x16x32_bf16 a[20:23], v[80:83], v[52:55], a[20:23]
s_waitcnt lgkmcnt(5)
v_mfma_f32_16x16x32_bf16 a[24:27], v[80:83], v[56:59], a[24:27]
s_waitcnt lgkmcnt(4)
v_mfma_f32_16x16x32_bf16 a[28:31], v[80:83], v[60:63], a[28:31]
s_waitcnt vmcnt(12)
s_barrier
v_mfma_f32_16x16x32_bf16 a[32:35], v[84:87], v[32:35], a[32:35]
ds_read_b64_tr_b16 v[64:65], v160 offset:0
v_mfma_f32_16x16x32_bf16 a[36:39], v[84:87], v[36:39], a[36:39]
ds_read_b64_tr_b16 v[66:67], v160 offset:4096
v_mfma_f32_16x16x32_bf16 a[40:43], v[84:87], v[40:43], a[40:43]
s_add_u32 m0, s19, 0
s_add_u32 s16, s28, s29
s_xor_b32 s16, s16, s42
v_mfma_f32_16x16x32_bf16 a[44:47], v[84:87], v[44:47], a[44:47]
buffer_load_dwordx4 v168, s[4:7], s16 offen offset:0 lds
v_mfma_f32_16x16x32_bf16 a[48:51], v[84:87], v[48:51], a[48:51]
ds_read_b128 v[0:3], v164 offset:32768
v_mfma_f32_16x16x32_bf16 a[52:55], v[84:87], v[52:55], a[52:55]
ds_read_b128 v[4:7], v164 offset:34816
v_mfma_f32_16x16x32_bf16 a[56:59], v[84:87], v[56:59], a[56:59]
ds_read_b128 v[8:11], v164 offset:36864
v_mfma_f32_16x16x32_bf16 a[60:63], v[84:87], v[60:63], a[60:63]
s_waitcnt lgkmcnt(7)
buffer_load_dwordx4 v169, s[4:7], s16 offen offset:1024 lds
v_mfma_f32_16x16x32_bf16 a[64:67], v[88:91], v[32:35], a[64:67]
ds_read_b64_tr_b16 v[68:69], v161 offset:0
v_mfma_f32_16x16x32_bf16 a[68:71], v[88:91], v[36:39], a[68:71]
ds_read_b64_tr_b16 v[70:71], v161 offset:4096
v_mfma_f32_16x16x32_bf16 a[72:75], v[88:91], v[40:43], a[72:75]
v_mfma_f32_16x16x32_bf16 a[76:79], v[88:91], v[44:47], a[76:79]
buffer_load_dwordx4 v170, s[4:7], s16 offen offset:2048 lds
v_mfma_f32_16x16x32_bf16 a[80:83], v[88:91], v[48:51], a[80:83]
ds_read_b128 v[12:15], v164 offset:38912
v_mfma_f32_16x16x32_bf16 a[84:87], v[88:91], v[52:55], a[84:87]
ds_read_b128 v[16:19], v164 offset:40960
v_mfma_f32_16x16x32_bf16 a[88:91], v[88:91], v[56:59], a[88:91]
ds_read_b128 v[20:23], v164 offset:43008
v_mfma_f32_16x16x32_bf16 a[92:95], v[88:91], v[60:63], a[92:95]
s_waitcnt lgkmcnt(10)
buffer_load_dwordx4 v171, s[4:7], s16 offen offset:3072 lds
v_mfma_f32_16x16x32_bf16 a[96:99], v[92:95], v[32:35], a[96:99]
ds_read_b64_tr_b16 v[72:73], v162 offset:0
v_mfma_f32_16x16x32_bf16 a[100:103], v[92:95], v[36:39], a[100:103]
ds_read_b64_tr_b16 v[74:75], v162 offset:4096
v_mfma_f32_16x16x32_bf16 a[104:107], v[92:95], v[40:43], a[104:107]
s_add_u32 m0, s19, 4096
s_add_u32 s16, s16, 65536
ds_read_b128 v[24:27], v164 offset:45056
v_mfma_f32_16x16x32_bf16 a[108:111], v[92:95], v[44:47], a[108:111]
buffer_load_dwordx4 v168, s[4:7], s16 offen offset:0 lds
v_mfma_f32_16x16x32_bf16 a[112:115], v[92:95], v[48:51], a[112:115]
ds_read_b128 v[28:31], v164 offset:47104
v_mfma_f32_16x16x32_bf16 a[116:119], v[92:95], v[52:55], a[116:119]
v_mfma_f32_16x16x32_bf16 a[120:123], v[92:95], v[56:59], a[120:123]
v_mfma_f32_16x16x32_bf16 a[124:127], v[92:95], v[60:63], a[124:127]
s_waitcnt lgkmcnt(11)
v_mfma_f32_16x16x32_bf16 a[0:3], v[64:67], v[0:3], a[0:3]
s_waitcnt lgkmcnt(10)
ds_read_b64_tr_b16 v[76:77], v163 offset:0
v_mfma_f32_16x16x32_bf16 a[4:7], v[64:67], v[4:7], a[4:7]
s_waitcnt lgkmcnt(10)
ds_read_b64_tr_b16 v[78:79], v163 offset:4096
v_mfma_f32_16x16x32_bf16 a[8:11], v[64:67], v[8:11], a[8:11]
s_waitcnt lgkmcnt(8)
v_mfma_f32_16x16x32_bf16 a[12:15], v[64:67], v[12:15], a[12:15]
s_waitcnt lgkmcnt(7)
buffer_load_dwordx4 v169, s[4:7], s16 offen offset:1024 lds
v_mfma_f32_16x16x32_bf16 a[16:19], v[64:67], v[16:19], a[16:19]
s_waitcnt lgkmcnt(6)
ds_read_b128 v[32:35], v165 offset:32768
v_mfma_f32_16x16x32_bf16 a[20:23], v[64:67], v[20:23], a[20:23]
s_waitcnt lgkmcnt(4)
ds_read_b128 v[36:39], v165 offset:34816
v_mfma_f32_16x16x32_bf16 a[24:27], v[64:67], v[24:27], a[24:27]
s_waitcnt lgkmcnt(4)
ds_read_b128 v[40:43], v165 offset:36864
v_mfma_f32_16x16x32_bf16 a[28:31], v[64:67], v[28:31], a[28:31]
buffer_load_dwordx4 v170, s[4:7], s16 offen offset:2048 lds
v_mfma_f32_16x16x32_bf16 a[32:35], v[68:71], v[0:3], a[32:35]
ds_read_b64_tr_b16 v[80:81], v160 offset:8192
v_mfma_f32_16x16x32_bf16 a[36:39], v[68:71], v[4:7], a[36:39]
ds_read_b64_tr_b16 v[82:83], v160 offset:12288
v_mfma_f32_16x16x32_bf16 a[40:43], v[68:71], v[8:11], a[40:43]
v_mfma_f32_16x16x32_bf16 a[44:47], v[68:71], v[12:15], a[44:47]
buffer_load_dwordx4 v171, s[4:7], s16 offen offset:3072 lds
v_mfma_f32_16x16x32_bf16 a[48:51], v[68:71], v[16:19], a[48:51]
s_add_u32 s29, s29, 128
s_and_b32 s29, s29, 2047
ds_read_b128 v[44:47], v165 offset:38912
v_mfma_f32_16x16x32_bf16 a[52:55], v[68:71], v[20:23], a[52:55]
ds_read_b128 v[48:51], v165 offset:40960
v_mfma_f32_16x16x32_bf16 a[56:59], v[68:71], v[24:27], a[56:59]
ds_read_b128 v[52:55], v165 offset:43008
v_mfma_f32_16x16x32_bf16 a[60:63], v[68:71], v[28:31], a[60:63]
v_mfma_f32_16x16x32_bf16 a[64:67], v[72:75], v[0:3], a[64:67]
ds_read_b64_tr_b16 v[84:85], v161 offset:8192
v_mfma_f32_16x16x32_bf16 a[68:71], v[72:75], v[4:7], a[68:71]
ds_read_b64_tr_b16 v[86:87], v161 offset:12288
v_mfma_f32_16x16x32_bf16 a[72:75], v[72:75], v[8:11], a[72:75]
s_add_u32 m0, s35, 32768
s_xor_b32 s17, s32, s43
v_mfma_f32_16x16x32_bf16 a[76:79], v[72:75], v[12:15], a[76:79]
buffer_load_dwordx4 v172, s[8:11], s17 offen offset:0 lds
v_mfma_f32_16x16x32_bf16 a[80:83], v[72:75], v[16:19], a[80:83]
ds_read_b128 v[56:59], v165 offset:45056
v_mfma_f32_16x16x32_bf16 a[84:87], v[72:75], v[20:23], a[84:87]
ds_read_b128 v[60:63], v165 offset:47104
v_mfma_f32_16x16x32_bf16 a[88:91], v[72:75], v[24:27], a[88:91]
v_mfma_f32_16x16x32_bf16 a[92:95], v[72:75], v[28:31], a[92:95]
s_waitcnt lgkmcnt(12)
buffer_load_dwordx4 v173, s[8:11], s17 offen offset:1024 lds
v_mfma_f32_16x16x32_bf16 a[96:99], v[76:79], v[0:3], a[96:99]
s_add_u32 s32, s32, 65536
s_and_b32 s32, s32, 2097151
ds_read_b64_tr_b16 v[88:89], v162 offset:8192
v_mfma_f32_16x16x32_bf16 a[100:103], v[76:79], v[4:7], a[100:103]
ds_read_b64_tr_b16 v[90:91], v162 offset:12288
v_mfma_f32_16x16x32_bf16 a[104:107], v[76:79], v[8:11], a[104:107]
s_add_u32 m0, s35, 40960
s_xor_b32 s17, s32, s43
v_mfma_f32_16x16x32_bf16 a[108:111], v[76:79], v[12:15], a[108:111]
buffer_load_dwordx4 v172, s[8:11], s17 offen offset:0 lds
v_mfma_f32_16x16x32_bf16 a[112:115], v[76:79], v[16:19], a[112:115]
v_mfma_f32_16x16x32_bf16 a[116:119], v[76:79], v[20:23], a[116:119]
v_mfma_f32_16x16x32_bf16 a[120:123], v[76:79], v[24:27], a[120:123]
v_mfma_f32_16x16x32_bf16 a[124:127], v[76:79], v[28:31], a[124:127]
s_waitcnt lgkmcnt(9)
v_mfma_f32_16x16x32_bf16 a[0:3], v[80:83], v[32:35], a[0:3]
ds_read_b64_tr_b16 v[92:93], v163 offset:8192
v_mfma_f32_16x16x32_bf16 a[4:7], v[80:83], v[36:39], a[4:7]
ds_read_b64_tr_b16 v[94:95], v163 offset:12288
v_mfma_f32_16x16x32_bf16 a[8:11], v[80:83], v[40:43], a[8:11]
s_waitcnt lgkmcnt(10)
v_mfma_f32_16x16x32_bf16 a[12:15], v[80:83], v[44:47], a[12:15]
s_waitcnt lgkmcnt(9)
buffer_load_dwordx4 v173, s[8:11], s17 offen offset:1024 lds
v_mfma_f32_16x16x32_bf16 a[16:19], v[80:83], v[48:51], a[16:19]
s_waitcnt lgkmcnt(8)
s_add_u32 s32, s32, 65536
s_and_b32 s32, s32, 2097151
v_mfma_f32_16x16x32_bf16 a[20:23], v[80:83], v[52:55], a[20:23]
s_waitcnt lgkmcnt(5)
v_mfma_f32_16x16x32_bf16 a[24:27], v[80:83], v[56:59], a[24:27]
s_waitcnt lgkmcnt(4)
v_mfma_f32_16x16x32_bf16 a[28:31], v[80:83], v[60:63], a[28:31]
s_waitcnt vmcnt(12)
s_barrier
v_mfma_f32_16x16x32_bf16 a[32:35], v[84:87], v[32:35], a[32:35]
ds_read_b64_tr_b16 v[64:65], v160 offset:16384
v_mfma_f32_16x16x32_bf16 a[36:39], v[84:87], v[36:39], a[36:39]
ds_read_b64_tr_b16 v[66:67], v160 offset:20480
v_mfma_f32_16x16x32_bf16 a[40:43], v[84:87], v[40:43], a[40:43]
s_add_u32 m0, s19, 32768
s_add_u32 s16, s28, s29
s_xor_b32 s16, s16, s42
v_mfma_f32_16x16x32_bf16 a[44:47], v[84:87], v[44:47], a[44:47]
buffer_load_dwordx4 v168, s[4:7], s16 offen offset:0 lds
v_mfma_f32_16x16x32_bf16 a[48:51], v[84:87], v[48:51], a[48:51]
ds_read_b128 v[0:3], v166 offset:0
v_mfma_f32_16x16x32_bf16 a[52:55], v[84:87], v[52:55], a[52:55]
ds_read_b128 v[4:7], v166 offset:2048
v_mfma_f32_16x16x32_bf16 a[56:59], v[84:87], v[56:59], a[56:59]
ds_read_b128 v[8:11], v166 offset:4096
v_mfma_f32_16x16x32_bf16 a[60:63], v[84:87], v[60:63], a[60:63]
s_waitcnt lgkmcnt(7)
buffer_load_dwordx4 v169, s[4:7], s16 offen offset:1024 lds
v_mfma_f32_16x16x32_bf16 a[64:67], v[88:91], v[32:35], a[64:67]
ds_read_b64_tr_b16 v[68:69], v161 offset:16384
v_mfma_f32_16x16x32_bf16 a[68:71], v[88:91], v[36:39], a[68:71]
ds_read_b64_tr_b16 v[70:71], v161 offset:20480
v_mfma_f32_16x16x32_bf16 a[72:75], v[88:91], v[40:43], a[72:75]
v_mfma_f32_16x16x32_bf16 a[76:79], v[88:91], v[44:47], a[76:79]
buffer_load_dwordx4 v170, s[4:7], s16 offen offset:2048 lds
v_mfma_f32_16x16x32_bf16 a[80:83], v[88:91], v[48:51], a[80:83]
ds_read_b128 v[12:15], v166 offset:6144
v_mfma_f32_16x16x32_bf16 a[84:87], v[88:91], v[52:55], a[84:87]
ds_read_b128 v[16:19], v166 offset:8192
v_mfma_f32_16x16x32_bf16 a[88:91], v[88:91], v[56:59], a[88:91]
ds_read_b128 v[20:23], v166 offset:10240
v_mfma_f32_16x16x32_bf16 a[92:95], v[88:91], v[60:63], a[92:95]
s_waitcnt lgkmcnt(10)
buffer_load_dwordx4 v171, s[4:7], s16 offen offset:3072 lds
v_mfma_f32_16x16x32_bf16 a[96:99], v[92:95], v[32:35], a[96:99]
ds_read_b64_tr_b16 v[72:73], v162 offset:16384
v_mfma_f32_16x16x32_bf16 a[100:103], v[92:95], v[36:39], a[100:103]
ds_read_b64_tr_b16 v[74:75], v162 offset:20480
v_mfma_f32_16x16x32_bf16 a[104:107], v[92:95], v[40:43], a[104:107]
s_add_u32 m0, s19, 36864
s_add_u32 s16, s16, 65536
ds_read_b128 v[24:27], v166 offset:12288
v_mfma_f32_16x16x32_bf16 a[108:111], v[92:95], v[44:47], a[108:111]
buffer_load_dwordx4 v168, s[4:7], s16 offen offset:0 lds
v_mfma_f32_16x16x32_bf16 a[112:115], v[92:95], v[48:51], a[112:115]
ds_read_b128 v[28:31], v166 offset:14336
v_mfma_f32_16x16x32_bf16 a[116:119], v[92:95], v[52:55], a[116:119]
v_mfma_f32_16x16x32_bf16 a[120:123], v[92:95], v[56:59], a[120:123]
v_mfma_f32_16x16x32_bf16 a[124:127], v[92:95], v[60:63], a[124:127]
s_waitcnt lgkmcnt(11)
v_mfma_f32_16x16x32_bf16 a[0:3], v[64:67], v[0:3], a[0:3]
s_waitcnt lgkmcnt(10)
ds_read_b64_tr_b16 v[76:77], v163 offset:16384
v_mfma_f32_16x16x32_bf16 a[4:7], v[64:67], v[4:7], a[4:7]
s_waitcnt lgkmcnt(10)
ds_read_b64_tr_b16 v[78:79], v163 offset:20480
v_mfma_f32_16x16x32_bf16 a[8:11], v[64:67], v[8:11], a[8:11]
s_waitcnt lgkmcnt(8)
v_mfma_f32_16x16x32_bf16 a[12:15], v[64:67], v[12:15], a[12:15]
s_waitcnt lgkmcnt(7)
buffer_load_dwordx4 v169, s[4:7], s16 offen offset:1024 lds
v_mfma_f32_16x16x32_bf16 a[16:19], v[64:67], v[16:19], a[16:19]
s_waitcnt lgkmcnt(6)
ds_read_b128 v[32:35], v167 offset:0
v_mfma_f32_16x16x32_bf16 a[20:23], v[64:67], v[20:23], a[20:23]
s_waitcnt lgkmcnt(4)
ds_read_b128 v[36:39], v167 offset:2048
v_mfma_f32_16x16x32_bf16 a[24:27], v[64:67], v[24:27], a[24:27]
s_waitcnt lgkmcnt(4)
ds_read_b128 v[40:43], v167 offset:4096
v_mfma_f32_16x16x32_bf16 a[28:31], v[64:67], v[28:31], a[28:31]
buffer_load_dwordx4 v170, s[4:7], s16 offen offset:2048 lds
v_mfma_f32_16x16x32_bf16 a[32:35], v[68:71], v[0:3], a[32:35]
ds_read_b64_tr_b16 v[80:81], v160 offset:24576
v_mfma_f32_16x16x32_bf16 a[36:39], v[68:71], v[4:7], a[36:39]
ds_read_b64_tr_b16 v[82:83], v160 offset:28672
v_mfma_f32_16x16x32_bf16 a[40:43], v[68:71], v[8:11], a[40:43]
v_mfma_f32_16x16x32_bf16 a[44:47], v[68:71], v[12:15], a[44:47]
buffer_load_dwordx4 v171, s[4:7], s16 offen offset:3072 lds
v_mfma_f32_16x16x32_bf16 a[48:51], v[68:71], v[16:19], a[48:51]
s_add_u32 s29, s29, 128
s_and_b32 s29, s29, 2047
ds_read_b128 v[44:47], v167 offset:6144
v_mfma_f32_16x16x32_bf16 a[52:55], v[68:71], v[20:23], a[52:55]
ds_read_b128 v[48:51], v167 offset:8192
v_mfma_f32_16x16x32_bf16 a[56:59], v[68:71], v[24:27], a[56:59]
ds_read_b128 v[52:55], v167 offset:10240
v_mfma_f32_16x16x32_bf16 a[60:63], v[68:71], v[28:31], a[60:63]
v_mfma_f32_16x16x32_bf16 a[64:67], v[72:75], v[0:3], a[64:67]
ds_read_b64_tr_b16 v[84:85], v161 offset:24576
v_mfma_f32_16x16x32_bf16 a[68:71], v[72:75], v[4:7], a[68:71]
ds_read_b64_tr_b16 v[86:87], v161 offset:28672
v_mfma_f32_16x16x32_bf16 a[72:75], v[72:75], v[8:11], a[72:75]
s_add_u32 m0, s35, 49152
s_xor_b32 s17, s32, s43
v_mfma_f32_16x16x32_bf16 a[76:79], v[72:75], v[12:15], a[76:79]
buffer_load_dwordx4 v172, s[8:11], s17 offen offset:0 lds
v_mfma_f32_16x16x32_bf16 a[80:83], v[72:75], v[16:19], a[80:83]
ds_read_b128 v[56:59], v167 offset:12288
v_mfma_f32_16x16x32_bf16 a[84:87], v[72:75], v[20:23], a[84:87]
ds_read_b128 v[60:63], v167 offset:14336
v_mfma_f32_16x16x32_bf16 a[88:91], v[72:75], v[24:27], a[88:91]
v_mfma_f32_16x16x32_bf16 a[92:95], v[72:75], v[28:31], a[92:95]
s_waitcnt lgkmcnt(12)
buffer_load_dwordx4 v173, s[8:11], s17 offen offset:1024 lds
v_mfma_f32_16x16x32_bf16 a[96:99], v[76:79], v[0:3], a[96:99]
s_add_u32 s32, s32, 65536
s_and_b32 s32, s32, 2097151
ds_read_b64_tr_b16 v[88:89], v162 offset:24576
v_mfma_f32_16x16x32_bf16 a[100:103], v[76:79], v[4:7], a[100:103]
ds_read_b64_tr_b16 v[90:91], v162 offset:28672
v_mfma_f32_16x16x32_bf16 a[104:107], v[76:79], v[8:11], a[104:107]
s_add_u32 m0, s35, 57344
s_xor_b32 s17, s32, s43
v_mfma_f32_16x16x32_bf16 a[108:111], v[76:79], v[12:15], a[108:111]
buffer_load_dwordx4 v172, s[8:11], s17 offen offset:0 lds
v_mfma_f32_16x16x32_bf16 a[112:115], v[76:79], v[16:19], a[112:115]
v_mfma_f32_16x16x32_bf16 a[116:119], v[76:79], v[20:23], a[116:119]
v_mfma_f32_16x16x32_bf16 a[120:123], v[76:79], v[24:27], a[120:123]
v_mfma_f32_16x16x32_bf16 a[124:127], v[76:79], v[28:31], a[124:127]
s_waitcnt lgkmcnt(9)
v_mfma_f32_16x16x32_bf16 a[0:3], v[80:83], v[32:35], a[0:3]
ds_read_b64_tr_b16 v[92:93], v163 offset:24576
v_mfma_f32_16x16x32_bf16 a[4:7], v[80:83], v[36:39], a[4:7]
ds_read_b64_tr_b16 v[94:95], v163 offset:28672
v_mfma_f32_16x16x32_bf16 a[8:11], v[80:83], v[40:43], a[8:11]
s_waitcnt lgkmcnt(10)
v_mfma_f32_16x16x32_bf16 a[12:15], v[80:83], v[44:47], a[12:15]
s_waitcnt lgkmcnt(9)
buffer_load_dwordx4 v173, s[8:11], s17 offen offset:1024 lds
v_mfma_f32_16x16x32_bf16 a[16:19], v[80:83], v[48:51], a[16:19]
s_waitcnt lgkmcnt(8)
s_add_u32 s32, s32, 65536
s_and_b32 s32, s32, 2097151
v_mfma_f32_16x16x32_bf16 a[20:23], v[80:83], v[52:55], a[20:23]
s_waitcnt lgkmcnt(5)
v_mfma_f32_16x16x32_bf16 a[24:27], v[80:83], v[56:59], a[24:27]
s_waitcnt lgkmcnt(4)
v_mfma_f32_16x16x32_bf16 a[28:31], v[80:83], v[60:63], a[28:31]
s_waitcnt vmcnt(12)
s_barrier
v_mfma_f32_16x16x32_bf16 a[32:35], v[84:87], v[32:35], a[32:35]
ds_read_b64_tr_b16 v[64:65], v160 offset:32768
v_mfma_f32_16x16x32_bf16 a[36:39], v[84:87], v[36:39], a[36:39]
ds_read_b64_tr_b16 v[66:67], v160 offset:36864
v_mfma_f32_16x16x32_bf16 a[40:43], v[84:87], v[40:43], a[40:43]
s_add_u32 m0, s19, 131072
s_add_u32 s16, s28, s29
s_xor_b32 s16, s16, s42
v_mfma_f32_16x16x32_bf16 a[44:47], v[84:87], v[44:47], a[44:47]
buffer_load_dwordx4 v168, s[4:7], s16 offen offset:0 lds
v_mfma_f32_16x16x32_bf16 a[48:51], v[84:87], v[48:51], a[48:51]
ds_read_b128 v[0:3], v164 offset:0
v_mfma_f32_16x16x32_bf16 a[52:55], v[84:87], v[52:55], a[52:55]
ds_read_b128 v[4:7], v164 offset:2048
v_mfma_f32_16x16x32_bf16 a[56:59], v[84:87], v[56:59], a[56:59]
ds_read_b128 v[8:11], v164 offset:4096
v_mfma_f32_16x16x32_bf16 a[60:63], v[84:87], v[60:63], a[60:63]
s_waitcnt lgkmcnt(7)
buffer_load_dwordx4 v169, s[4:7], s16 offen offset:1024 lds
v_mfma_f32_16x16x32_bf16 a[64:67], v[88:91], v[32:35], a[64:67]
ds_read_b64_tr_b16 v[68:69], v161 offset:32768
v_mfma_f32_16x16x32_bf16 a[68:71], v[88:91], v[36:39], a[68:71]
ds_read_b64_tr_b16 v[70:71], v161 offset:36864
v_mfma_f32_16x16x32_bf16 a[72:75], v[88:91], v[40:43], a[72:75]
v_mfma_f32_16x16x32_bf16 a[76:79], v[88:91], v[44:47], a[76:79]
buffer_load_dwordx4 v170, s[4:7], s16 offen offset:2048 lds
v_mfma_f32_16x16x32_bf16 a[80:83], v[88:91], v[48:51], a[80:83]
ds_read_b128 v[12:15], v164 offset:6144
v_mfma_f32_16x16x32_bf16 a[84:87], v[88:91], v[52:55], a[84:87]
ds_read_b128 v[16:19], v164 offset:8192
v_mfma_f32_16x16x32_bf16 a[88:91], v[88:91], v[56:59], a[88:91]
ds_read_b128 v[20:23], v164 offset:10240
v_mfma_f32_16x16x32_bf16 a[92:95], v[88:91], v[60:63], a[92:95]
s_waitcnt lgkmcnt(10)
buffer_load_dwordx4 v171, s[4:7], s16 offen offset:3072 lds
v_mfma_f32_16x16x32_bf16 a[96:99], v[92:95], v[32:35], a[96:99]
ds_read_b64_tr_b16 v[72:73], v162 offset:32768
v_mfma_f32_16x16x32_bf16 a[100:103], v[92:95], v[36:39], a[100:103]
ds_read_b64_tr_b16 v[74:75], v162 offset:36864
v_mfma_f32_16x16x32_bf16 a[104:107], v[92:95], v[40:43], a[104:107]
s_add_u32 m0, s19, 135168
s_add_u32 s16, s16, 65536
ds_read_b128 v[24:27], v164 offset:12288
v_mfma_f32_16x16x32_bf16 a[108:111], v[92:95], v[44:47], a[108:111]
buffer_load_dwordx4 v168, s[4:7], s16 offen offset:0 lds
v_mfma_f32_16x16x32_bf16 a[112:115], v[92:95], v[48:51], a[112:115]
ds_read_b128 v[28:31], v164 offset:14336
v_mfma_f32_16x16x32_bf16 a[116:119], v[92:95], v[52:55], a[116:119]
v_mfma_f32_16x16x32_bf16 a[120:123], v[92:95], v[56:59], a[120:123]
v_mfma_f32_16x16x32_bf16 a[124:127], v[92:95], v[60:63], a[124:127]
s_waitcnt lgkmcnt(11)
v_mfma_f32_16x16x32_bf16 a[0:3], v[64:67], v[0:3], a[0:3]
s_waitcnt lgkmcnt(10)
ds_read_b64_tr_b16 v[76:77], v163 offset:32768
v_mfma_f32_16x16x32_bf16 a[4:7], v[64:67], v[4:7], a[4:7]
s_waitcnt lgkmcnt(10)
ds_read_b64_tr_b16 v[78:79], v163 offset:36864
v_mfma_f32_16x16x32_bf16 a[8:11], v[64:67], v[8:11], a[8:11]
s_waitcnt lgkmcnt(8)
v_mfma_f32_16x16x32_bf16 a[12:15], v[64:67], v[12:15], a[12:15]
s_waitcnt lgkmcnt(7)
buffer_load_dwordx4 v169, s[4:7], s16 offen offset:1024 lds
v_mfma_f32_16x16x32_bf16 a[16:19], v[64:67], v[16:19], a[16:19]
s_waitcnt lgkmcnt(6)
ds_read_b128 v[32:35], v165 offset:0
v_mfma_f32_16x16x32_bf16 a[20:23], v[64:67], v[20:23], a[20:23]
s_waitcnt lgkmcnt(4)
ds_read_b128 v[36:39], v165 offset:2048
v_mfma_f32_16x16x32_bf16 a[24:27], v[64:67], v[24:27], a[24:27]
s_waitcnt lgkmcnt(4)
ds_read_b128 v[40:43], v165 offset:4096
v_mfma_f32_16x16x32_bf16 a[28:31], v[64:67], v[28:31], a[28:31]
buffer_load_dwordx4 v170, s[4:7], s16 offen offset:2048 lds
v_mfma_f32_16x16x32_bf16 a[32:35], v[68:71], v[0:3], a[32:35]
ds_read_b64_tr_b16 v[80:81], v160 offset:40960
v_mfma_f32_16x16x32_bf16 a[36:39], v[68:71], v[4:7], a[36:39]
ds_read_b64_tr_b16 v[82:83], v160 offset:45056
v_mfma_f32_16x16x32_bf16 a[40:43], v[68:71], v[8:11], a[40:43]
v_mfma_f32_16x16x32_bf16 a[44:47], v[68:71], v[12:15], a[44:47]
buffer_load_dwordx4 v171, s[4:7], s16 offen offset:3072 lds
v_mfma_f32_16x16x32_bf16 a[48:51], v[68:71], v[16:19], a[48:51]
s_add_u32 s29, s29, 128
s_and_b32 s29, s29, 2047
ds_read_b128 v[44:47], v165 offset:6144
v_mfma_f32_16x16x32_bf16 a[52:55], v[68:71], v[20:23], a[52:55]
ds_read_b128 v[48:51], v165 offset:8192
v_mfma_f32_16x16x32_bf16 a[56:59], v[68:71], v[24:27], a[56:59]
ds_read_b128 v[52:55], v165 offset:10240
v_mfma_f32_16x16x32_bf16 a[60:63], v[68:71], v[28:31], a[60:63]
v_mfma_f32_16x16x32_bf16 a[64:67], v[72:75], v[0:3], a[64:67]
ds_read_b64_tr_b16 v[84:85], v161 offset:40960
v_mfma_f32_16x16x32_bf16 a[68:71], v[72:75], v[4:7], a[68:71]
ds_read_b64_tr_b16 v[86:87], v161 offset:45056
v_mfma_f32_16x16x32_bf16 a[72:75], v[72:75], v[8:11], a[72:75]
s_add_u32 m0, s35, 0
s_xor_b32 s17, s32, s43
v_mfma_f32_16x16x32_bf16 a[76:79], v[72:75], v[12:15], a[76:79]
buffer_load_dwordx4 v172, s[8:11], s17 offen offset:0 lds
v_mfma_f32_16x16x32_bf16 a[80:83], v[72:75], v[16:19], a[80:83]
ds_read_b128 v[56:59], v165 offset:12288
v_mfma_f32_16x16x32_bf16 a[84:87], v[72:75], v[20:23], a[84:87]
ds_read_b128 v[60:63], v165 offset:14336
v_mfma_f32_16x16x32_bf16 a[88:91], v[72:75], v[24:27], a[88:91]
v_mfma_f32_16x16x32_bf16 a[92:95], v[72:75], v[28:31], a[92:95]
s_waitcnt lgkmcnt(12)
buffer_load_dwordx4 v173, s[8:11], s17 offen offset:1024 lds
v_mfma_f32_16x16x32_bf16 a[96:99], v[76:79], v[0:3], a[96:99]
s_add_u32 s32, s32, 65536
s_and_b32 s32, s32, 2097151
ds_read_b64_tr_b16 v[88:89], v162 offset:40960
v_mfma_f32_16x16x32_bf16 a[100:103], v[76:79], v[4:7], a[100:103]
ds_read_b64_tr_b16 v[90:91], v162 offset:45056
v_mfma_f32_16x16x32_bf16 a[104:107], v[76:79], v[8:11], a[104:107]
s_add_u32 m0, s35, 8192
s_xor_b32 s17, s32, s43
v_mfma_f32_16x16x32_bf16 a[108:111], v[76:79], v[12:15], a[108:111]
buffer_load_dwordx4 v172, s[8:11], s17 offen offset:0 lds
v_mfma_f32_16x16x32_bf16 a[112:115], v[76:79], v[16:19], a[112:115]
v_mfma_f32_16x16x32_bf16 a[116:119], v[76:79], v[20:23], a[116:119]
v_mfma_f32_16x16x32_bf16 a[120:123], v[76:79], v[24:27], a[120:123]
v_mfma_f32_16x16x32_bf16 a[124:127], v[76:79], v[28:31], a[124:127]
s_waitcnt lgkmcnt(9)
v_mfma_f32_16x16x32_bf16 a[0:3], v[80:83], v[32:35], a[0:3]
ds_read_b64_tr_b16 v[92:93], v163 offset:40960
v_mfma_f32_16x16x32_bf16 a[4:7], v[80:83], v[36:39], a[4:7]
ds_read_b64_tr_b16 v[94:95], v163 offset:45056
v_mfma_f32_16x16x32_bf16 a[8:11], v[80:83], v[40:43], a[8:11]
s_waitcnt lgkmcnt(10)
v_mfma_f32_16x16x32_bf16 a[12:15], v[80:83], v[44:47], a[12:15]
s_waitcnt lgkmcnt(9)
buffer_load_dwordx4 v173, s[8:11], s17 offen offset:1024 lds
v_mfma_f32_16x16x32_bf16 a[16:19], v[80:83], v[48:51], a[16:19]
s_waitcnt lgkmcnt(8)
s_add_u32 s32, s32, 65536
s_and_b32 s32, s32, 2097151
v_mfma_f32_16x16x32_bf16 a[20:23], v[80:83], v[52:55], a[20:23]
s_waitcnt lgkmcnt(5)
v_mfma_f32_16x16x32_bf16 a[24:27], v[80:83], v[56:59], a[24:27]
s_waitcnt lgkmcnt(4)
v_mfma_f32_16x16x32_bf16 a[28:31], v[80:83], v[60:63], a[28:31]
s_waitcnt vmcnt(12)
s_barrier
v_mfma_f32_16x16x32_bf16 a[32:35], v[84:87], v[32:35], a[32:35]
ds_read_b64_tr_b16 v[64:65], v160 offset:49152
v_mfma_f32_16x16x32_bf16 a[36:39], v[84:87], v[36:39], a[36:39]
ds_read_b64_tr_b16 v[66:67], v160 offset:53248
v_mfma_f32_16x16x32_bf16 a[40:43], v[84:87], v[40:43], a[40:43]
s_add_u32 m0, s19, 0
s_add_u32 s16, s28, s29
s_xor_b32 s16, s16, s42
v_mfma_f32_16x16x32_bf16 a[44:47], v[84:87], v[44:47], a[44:47]
buffer_load_dwordx4 v168, s[4:7], s16 offen offset:0 lds
v_mfma_f32_16x16x32_bf16 a[48:51], v[84:87], v[48:51], a[48:51]
ds_read_b128 v[0:3], v164 offset:32768
v_mfma_f32_16x16x32_bf16 a[52:55], v[84:87], v[52:55], a[52:55]
ds_read_b128 v[4:7], v164 offset:34816
v_mfma_f32_16x16x32_bf16 a[56:59], v[84:87], v[56:59], a[56:59]
ds_read_b128 v[8:11], v164 offset:36864
v_mfma_f32_16x16x32_bf16 a[60:63], v[84:87], v[60:63], a[60:63]
s_waitcnt lgkmcnt(7)
buffer_load_dwordx4 v169, s[4:7], s16 offen offset:1024 lds
v_mfma_f32_16x16x32_bf16 a[64:67], v[88:91], v[32:35], a[64:67]
ds_read_b64_tr_b16 v[68:69], v161 offset:49152
v_mfma_f32_16x16x32_bf16 a[68:71], v[88:91], v[36:39], a[68:71]
ds_read_b64_tr_b16 v[70:71], v161 offset:53248
v_mfma_f32_16x16x32_bf16 a[72:75], v[88:91], v[40:43], a[72:75]
v_mfma_f32_16x16x32_bf16 a[76:79], v[88:91], v[44:47], a[76:79]
buffer_load_dwordx4 v170, s[4:7], s16 offen offset:2048 lds
v_mfma_f32_16x16x32_bf16 a[80:83], v[88:91], v[48:51], a[80:83]
ds_read_b128 v[12:15], v164 offset:38912
v_mfma_f32_16x16x32_bf16 a[84:87], v[88:91], v[52:55], a[84:87]
ds_read_b128 v[16:19], v164 offset:40960
v_mfma_f32_16x16x32_bf16 a[88:91], v[88:91], v[56:59], a[88:91]
ds_read_b128 v[20:23], v164 offset:43008
v_mfma_f32_16x16x32_bf16 a[92:95], v[88:91], v[60:63], a[92:95]
s_waitcnt lgkmcnt(10)
buffer_load_dwordx4 v171, s[4:7], s16 offen offset:3072 lds
v_mfma_f32_16x16x32_bf16 a[96:99], v[92:95], v[32:35], a[96:99]
ds_read_b64_tr_b16 v[72:73], v162 offset:49152
v_mfma_f32_16x16x32_bf16 a[100:103], v[92:95], v[36:39], a[100:103]
ds_read_b64_tr_b16 v[74:75], v162 offset:53248
v_mfma_f32_16x16x32_bf16 a[104:107], v[92:95], v[40:43], a[104:107]
s_add_u32 m0, s19, 4096
s_add_u32 s16, s16, 65536
ds_read_b128 v[24:27], v164 offset:45056
v_mfma_f32_16x16x32_bf16 a[108:111], v[92:95], v[44:47], a[108:111]
buffer_load_dwordx4 v168, s[4:7], s16 offen offset:0 lds
v_mfma_f32_16x16x32_bf16 a[112:115], v[92:95], v[48:51], a[112:115]
ds_read_b128 v[28:31], v164 offset:47104
v_mfma_f32_16x16x32_bf16 a[116:119], v[92:95], v[52:55], a[116:119]
v_mfma_f32_16x16x32_bf16 a[120:123], v[92:95], v[56:59], a[120:123]
v_mfma_f32_16x16x32_bf16 a[124:127], v[92:95], v[60:63], a[124:127]
s_waitcnt lgkmcnt(11)
buffer_load_dword v175, v174, s[52:55], s56 offen
v_mfma_f32_16x16x32_bf16 a[0:3], v[64:67], v[0:3], a[0:3]
s_waitcnt lgkmcnt(10)
ds_read_b64_tr_b16 v[76:77], v163 offset:49152
v_mfma_f32_16x16x32_bf16 a[4:7], v[64:67], v[4:7], a[4:7]
s_waitcnt lgkmcnt(10)
ds_read_b64_tr_b16 v[78:79], v163 offset:53248
v_mfma_f32_16x16x32_bf16 a[8:11], v[64:67], v[8:11], a[8:11]
s_waitcnt lgkmcnt(8)
v_mfma_f32_16x16x32_bf16 a[12:15], v[64:67], v[12:15], a[12:15]
s_waitcnt lgkmcnt(7)
buffer_load_dwordx4 v169, s[4:7], s16 offen offset:1024 lds
v_mfma_f32_16x16x32_bf16 a[16:19], v[64:67], v[16:19], a[16:19]
s_waitcnt lgkmcnt(6)
ds_read_b128 v[32:35], v165 offset:32768
v_mfma_f32_16x16x32_bf16 a[20:23], v[64:67], v[20:23], a[20:23]
s_waitcnt lgkmcnt(4)
ds_read_b128 v[36:39], v165 offset:34816
v_mfma_f32_16x16x32_bf16 a[24:27], v[64:67], v[24:27], a[24:27]
s_waitcnt lgkmcnt(4)
ds_read_b128 v[40:43], v165 offset:36864
v_mfma_f32_16x16x32_bf16 a[28:31], v[64:67], v[28:31], a[28:31]
buffer_load_dwordx4 v170, s[4:7], s16 offen offset:2048 lds
v_mfma_f32_16x16x32_bf16 a[32:35], v[68:71], v[0:3], a[32:35]
ds_read_b64_tr_b16 v[80:81], v160 offset:57344
v_mfma_f32_16x16x32_bf16 a[36:39], v[68:71], v[4:7], a[36:39]
ds_read_b64_tr_b16 v[82:83], v160 offset:61440
v_mfma_f32_16x16x32_bf16 a[40:43], v[68:71], v[8:11], a[40:43]
v_mfma_f32_16x16x32_bf16 a[44:47], v[68:71], v[12:15], a[44:47]
buffer_load_dwordx4 v171, s[4:7], s16 offen offset:3072 lds
v_mfma_f32_16x16x32_bf16 a[48:51], v[68:71], v[16:19], a[48:51]
s_add_u32 s29, s29, 896
s_and_b32 s29, s29, 2047
ds_read_b128 v[44:47], v165 offset:38912
v_mfma_f32_16x16x32_bf16 a[52:55], v[68:71], v[20:23], a[52:55]
ds_read_b128 v[48:51], v165 offset:40960
v_mfma_f32_16x16x32_bf16 a[56:59], v[68:71], v[24:27], a[56:59]
ds_read_b128 v[52:55], v165 offset:43008
v_mfma_f32_16x16x32_bf16 a[60:63], v[68:71], v[28:31], a[60:63]
v_mfma_f32_16x16x32_bf16 a[64:67], v[72:75], v[0:3], a[64:67]
ds_read_b64_tr_b16 v[84:85], v161 offset:57344
v_mfma_f32_16x16x32_bf16 a[68:71], v[72:75], v[4:7], a[68:71]
ds_read_b64_tr_b16 v[86:87], v161 offset:61440
v_mfma_f32_16x16x32_bf16 a[72:75], v[72:75], v[8:11], a[72:75]
s_add_u32 m0, s35, 16384
s_xor_b32 s17, s32, s43
v_mfma_f32_16x16x32_bf16 a[76:79], v[72:75], v[12:15], a[76:79]
buffer_load_dwordx4 v172, s[8:11], s17 offen offset:0 lds
v_mfma_f32_16x16x32_bf16 a[80:83], v[72:75], v[16:19], a[80:83]
ds_read_b128 v[56:59], v165 offset:45056
v_mfma_f32_16x16x32_bf16 a[84:87], v[72:75], v[20:23], a[84:87]
ds_read_b128 v[60:63], v165 offset:47104
v_mfma_f32_16x16x32_bf16 a[88:91], v[72:75], v[24:27], a[88:91]
v_mfma_f32_16x16x32_bf16 a[92:95], v[72:75], v[28:31], a[92:95]
s_waitcnt lgkmcnt(12)
buffer_load_dwordx4 v173, s[8:11], s17 offen offset:1024 lds
v_mfma_f32_16x16x32_bf16 a[96:99], v[76:79], v[0:3], a[96:99]
s_add_u32 s32, s32, 65536
s_and_b32 s32, s32, 2097151
ds_read_b64_tr_b16 v[88:89], v162 offset:57344
v_mfma_f32_16x16x32_bf16 a[100:103], v[76:79], v[4:7], a[100:103]
ds_read_b64_tr_b16 v[90:91], v162 offset:61440
v_mfma_f32_16x16x32_bf16 a[104:107], v[76:79], v[8:11], a[104:107]
s_add_u32 m0, s35, 24576
s_xor_b32 s17, s32, s43
v_mfma_f32_16x16x32_bf16 a[108:111], v[76:79], v[12:15], a[108:111]
buffer_load_dwordx4 v172, s[8:11], s17 offen offset:0 lds
v_mfma_f32_16x16x32_bf16 a[112:115], v[76:79], v[16:19], a[112:115]
v_mfma_f32_16x16x32_bf16 a[116:119], v[76:79], v[20:23], a[116:119]
v_mfma_f32_16x16x32_bf16 a[120:123], v[76:79], v[24:27], a[120:123]
v_mfma_f32_16x16x32_bf16 a[124:127], v[76:79], v[28:31], a[124:127]
s_waitcnt lgkmcnt(9)
v_mfma_f32_16x16x32_bf16 a[0:3], v[80:83], v[32:35], a[0:3]
ds_read_b64_tr_b16 v[92:93], v163 offset:57344
v_mfma_f32_16x16x32_bf16 a[4:7], v[80:83], v[36:39], a[4:7]
ds_read_b64_tr_b16 v[94:95], v163 offset:61440
v_mfma_f32_16x16x32_bf16 a[8:11], v[80:83], v[40:43], a[8:11]
s_waitcnt lgkmcnt(10)
v_mfma_f32_16x16x32_bf16 a[12:15], v[80:83], v[44:47], a[12:15]
s_waitcnt lgkmcnt(9)
buffer_load_dwordx4 v173, s[8:11], s17 offen offset:1024 lds
v_mfma_f32_16x16x32_bf16 a[16:19], v[80:83], v[48:51], a[16:19]
s_waitcnt lgkmcnt(8)
s_add_u32 s32, s32, 65536
s_and_b32 s32, s32, 2097151
v_mfma_f32_16x16x32_bf16 a[20:23], v[80:83], v[52:55], a[20:23]
s_waitcnt lgkmcnt(5)
v_mfma_f32_16x16x32_bf16 a[24:27], v[80:83], v[56:59], a[24:27]
s_waitcnt lgkmcnt(4)
v_mfma_f32_16x16x32_bf16 a[28:31], v[80:83], v[60:63], a[28:31]
s_waitcnt vmcnt(13)
s_barrier
v_mfma_f32_16x16x32_bf16 a[32:35], v[84:87], v[32:35], a[32:35]
ds_read_b64_tr_b16 v[64:65], v160 offset:0
v_mfma_f32_16x16x32_bf16 a[36:39], v[84:87], v[36:39], a[36:39]
ds_read_b64_tr_b16 v[66:67], v160 offset:4096
v_mfma_f32_16x16x32_bf16 a[40:43], v[84:87], v[40:43], a[40:43]
s_add_u32 m0, s19, 32768
s_add_u32 s16, s28, s29
s_xor_b32 s16, s16, s42
v_mfma_f32_16x16x32_bf16 a[44:47], v[84:87], v[44:47], a[44:47]
buffer_load_dwordx4 v168, s[4:7], s16 offen offset:0 lds
v_mfma_f32_16x16x32_bf16 a[48:51], v[84:87], v[48:51], a[48:51]
ds_read_b128 v[0:3], v166 offset:0
v_mfma_f32_16x16x32_bf16 a[52:55], v[84:87], v[52:55], a[52:55]
ds_read_b128 v[4:7], v166 offset:2048
v_mfma_f32_16x16x32_bf16 a[56:59], v[84:87], v[56:59], a[56:59]
ds_read_b128 v[8:11], v166 offset:4096
v_mfma_f32_16x16x32_bf16 a[60:63], v[84:87], v[60:63], a[60:63]
s_waitcnt lgkmcnt(7)
buffer_load_dwordx4 v169, s[4:7], s16 offen offset:1024 lds
v_mfma_f32_16x16x32_bf16 a[64:67], v[88:91], v[32:35], a[64:67]
ds_read_b64_tr_b16 v[68:69], v161 offset:0
v_mfma_f32_16x16x32_bf16 a[68:71], v[88:91], v[36:39], a[68:71]
ds_read_b64_tr_b16 v[70:71], v161 offset:4096
v_mfma_f32_16x16x32_bf16 a[72:75], v[88:91], v[40:43], a[72:75]
v_mfma_f32_16x16x32_bf16 a[76:79], v[88:91], v[44:47], a[76:79]
buffer_load_dwordx4 v170, s[4:7], s16 offen offset:2048 lds
v_mfma_f32_16x16x32_bf16 a[80:83], v[88:91], v[48:51], a[80:83]
ds_read_b128 v[12:15], v166 offset:6144
v_mfma_f32_16x16x32_bf16 a[84:87], v[88:91], v[52:55], a[84:87]
ds_read_b128 v[16:19], v166 offset:8192
v_mfma_f32_16x16x32_bf16 a[88:91], v[88:91], v[56:59], a[88:91]
ds_read_b128 v[20:23], v166 offset:10240
v_mfma_f32_16x16x32_bf16 a[92:95], v[88:91], v[60:63], a[92:95]
s_waitcnt lgkmcnt(10)
buffer_load_dwordx4 v171, s[4:7], s16 offen offset:3072 lds
v_mfma_f32_16x16x32_bf16 a[96:99], v[92:95], v[32:35], a[96:99]
ds_read_b64_tr_b16 v[72:73], v162 offset:0
v_mfma_f32_16x16x32_bf16 a[100:103], v[92:95], v[36:39], a[100:103]
ds_read_b64_tr_b16 v[74:75], v162 offset:4096
v_mfma_f32_16x16x32_bf16 a[104:107], v[92:95], v[40:43], a[104:107]
s_add_u32 m0, s19, 36864
s_add_u32 s16, s16, 65536
ds_read_b128 v[24:27], v166 offset:12288
v_mfma_f32_16x16x32_bf16 a[108:111], v[92:95], v[44:47], a[108:111]
buffer_load_dwordx4 v168, s[4:7], s16 offen offset:0 lds
v_mfma_f32_16x16x32_bf16 a[112:115], v[92:95], v[48:51], a[112:115]
ds_read_b128 v[28:31], v166 offset:14336
v_mfma_f32_16x16x32_bf16 a[116:119], v[92:95], v[52:55], a[116:119]
v_mfma_f32_16x16x32_bf16 a[120:123], v[92:95], v[56:59], a[120:123]
v_mfma_f32_16x16x32_bf16 a[124:127], v[92:95], v[60:63], a[124:127]
s_waitcnt lgkmcnt(11)
v_mfma_f32_16x16x32_bf16 a[0:3], v[64:67], v[0:3], a[0:3]
s_waitcnt lgkmcnt(10)
ds_read_b64_tr_b16 v[76:77], v163 offset:0
v_mfma_f32_16x16x32_bf16 a[4:7], v[64:67], v[4:7], a[4:7]
s_waitcnt lgkmcnt(10)
ds_read_b64_tr_b16 v[78:79], v163 offset:4096
v_mfma_f32_16x16x32_bf16 a[8:11], v[64:67], v[8:11], a[8:11]
s_waitcnt lgkmcnt(8)
v_mfma_f32_16x16x32_bf16 a[12:15], v[64:67], v[12:15], a[12:15]
s_waitcnt lgkmcnt(7)
buffer_load_dwordx4 v169, s[4:7], s16 offen offset:1024 lds
v_mfma_f32_16x16x32_bf16 a[16:19], v[64:67], v[16:19], a[16:19]
s_waitcnt lgkmcnt(6)
ds_read_b128 v[32:35], v167 offset:0
v_mfma_f32_16x16x32_bf16 a[20:23], v[64:67], v[20:23], a[20:23]
s_waitcnt lgkmcnt(4)
ds_read_b128 v[36:39], v167 offset:2048
v_mfma_f32_16x16x32_bf16 a[24:27], v[64:67], v[24:27], a[24:27]
s_waitcnt lgkmcnt(4)
ds_read_b128 v[40:43], v167 offset:4096
v_mfma_f32_16x16x32_bf16 a[28:31], v[64:67], v[28:31], a[28:31]
buffer_load_dwordx4 v170, s[4:7], s16 offen offset:2048 lds
v_mfma_f32_16x16x32_bf16 a[32:35], v[68:71], v[0:3], a[32:35]
ds_read_b64_tr_b16 v[80:81], v160 offset:8192
v_mfma_f32_16x16x32_bf16 a[36:39], v[68:71], v[4:7], a[36:39]
ds_read_b64_tr_b16 v[82:83], v160 offset:12288
v_mfma_f32_16x16x32_bf16 a[40:43], v[68:71], v[8:11], a[40:43]
v_mfma_f32_16x16x32_bf16 a[44:47], v[68:71], v[12:15], a[44:47]
buffer_load_dwordx4 v171, s[4:7], s16 offen offset:3072 lds
v_mfma_f32_16x16x32_bf16 a[48:51], v[68:71], v[16:19], a[48:51]
s_add_u32 s29, s29, 128
s_and_b32 s29, s29, 2047
ds_read_b128 v[44:47], v167 offset:6144
v_mfma_f32_16x16x32_bf16 a[52:55], v[68:71], v[20:23], a[52:55]
ds_read_b128 v[48:51], v167 offset:8192
v_mfma_f32_16x16x32_bf16 a[56:59], v[68:71], v[24:27], a[56:59]
ds_read_b128 v[52:55], v167 offset:10240
v_mfma_f32_16x16x32_bf16 a[60:63], v[68:71], v[28:31], a[60:63]
v_mfma_f32_16x16x32_bf16 a[64:67], v[72:75], v[0:3], a[64:67]
ds_read_b64_tr_b16 v[84:85], v161 offset:8192
v_mfma_f32_16x16x32_bf16 a[68:71], v[72:75], v[4:7], a[68:71]
ds_read_b64_tr_b16 v[86:87], v161 offset:12288
v_mfma_f32_16x16x32_bf16 a[72:75], v[72:75], v[8:11], a[72:75]
s_add_u32 m0, s35, 32768
s_xor_b32 s17, s33, s43
v_mfma_f32_16x16x32_bf16 a[76:79], v[72:75], v[12:15], a[76:79]
buffer_load_dwordx4 v172, s[8:11], s17 offen offset:0 lds
v_mfma_f32_16x16x32_bf16 a[80:83], v[72:75], v[16:19], a[80:83]
ds_read_b128 v[56:59], v167 offset:12288
v_mfma_f32_16x16x32_bf16 a[84:87], v[72:75], v[20:23], a[84:87]
ds_read_b128 v[60:63], v167 offset:14336
v_mfma_f32_16x16x32_bf16 a[88:91], v[72:75], v[24:27], a[88:91]
v_mfma_f32_16x16x32_bf16 a[92:95], v[72:75], v[28:31], a[92:95]
s_waitcnt lgkmcnt(12)
buffer_load_dwordx4 v173, s[8:11], s17 offen offset:1024 lds
v_mfma_f32_16x16x32_bf16 a[96:99], v[76:79], v[0:3], a[96:99]
s_add_u32 s33, s33, 65536
s_and_b32 s33, s33, 2097151
ds_read_b64_tr_b16 v[88:89], v162 offset:8192
v_mfma_f32_16x16x32_bf16 a[100:103], v[76:79], v[4:7], a[100:103]
ds_read_b64_tr_b16 v[90:91], v162 offset:12288
v_mfma_f32_16x16x32_bf16 a[104:107], v[76:79], v[8:11], a[104:107]
s_add_u32 m0, s35, 40960
s_xor_b32 s17, s33, s43
v_mfma_f32_16x16x32_bf16 a[108:111], v[76:79], v[12:15], a[108:111]
buffer_load_dwordx4 v172, s[8:11], s17 offen offset:0 lds
v_mfma_f32_16x16x32_bf16 a[112:115], v[76:79], v[16:19], a[112:115]
v_mfma_f32_16x16x32_bf16 a[116:119], v[76:79], v[20:23], a[116:119]
v_mfma_f32_16x16x32_bf16 a[120:123], v[76:79], v[24:27], a[120:123]
v_mfma_f32_16x16x32_bf16 a[124:127], v[76:79], v[28:31], a[124:127]
s_waitcnt lgkmcnt(9)
v_mfma_f32_16x16x32_bf16 a[0:3], v[80:83], v[32:35], a[0:3]
ds_read_b64_tr_b16 v[92:93], v163 offset:8192
v_mfma_f32_16x16x32_bf16 a[4:7], v[80:83], v[36:39], a[4:7]
ds_read_b64_tr_b16 v[94:95], v163 offset:12288
v_mfma_f32_16x16x32_bf16 a[8:11], v[80:83], v[40:43], a[8:11]
s_waitcnt lgkmcnt(10)
v_mfma_f32_16x16x32_bf16 a[12:15], v[80:83], v[44:47], a[12:15]
s_waitcnt lgkmcnt(9)
buffer_load_dwordx4 v173, s[8:11], s17 offen offset:1024 lds
v_mfma_f32_16x16x32_bf16 a[16:19], v[80:83], v[48:51], a[16:19]
s_waitcnt lgkmcnt(8)
s_add_u32 s33, s33, 65536
s_and_b32 s33, s33, 2097151
v_mfma_f32_16x16x32_bf16 a[20:23], v[80:83], v[52:55], a[20:23]
s_waitcnt lgkmcnt(5)
v_mfma_f32_16x16x32_bf16 a[24:27], v[80:83], v[56:59], a[24:27]
s_waitcnt lgkmcnt(4)
v_mfma_f32_16x16x32_bf16 a[28:31], v[80:83], v[60:63], a[28:31]
s_waitcnt vmcnt(12)
s_barrier
v_mfma_f32_16x16x32_bf16 a[32:35], v[84:87], v[32:35], a[32:35]
ds_read_b64_tr_b16 v[64:65], v160 offset:16384
v_mfma_f32_16x16x32_bf16 a[36:39], v[84:87], v[36:39], a[36:39]
ds_read_b64_tr_b16 v[66:67], v160 offset:20480
v_mfma_f32_16x16x32_bf16 a[40:43], v[84:87], v[40:43], a[40:43]
s_add_u32 m0, s19, 131072
s_add_u32 s16, s28, s29
s_xor_b32 s16, s16, s42
v_mfma_f32_16x16x32_bf16 a[44:47], v[84:87], v[44:47], a[44:47]
buffer_load_dwordx4 v168, s[4:7], s16 offen offset:0 lds
v_mfma_f32_16x16x32_bf16 a[48:51], v[84:87], v[48:51], a[48:51]
ds_read_b128 v[0:3], v164 offset:0
v_mfma_f32_16x16x32_bf16 a[52:55], v[84:87], v[52:55], a[52:55]
ds_read_b128 v[4:7], v164 offset:2048
v_mfma_f32_16x16x32_bf16 a[56:59], v[84:87], v[56:59], a[56:59]
ds_read_b128 v[8:11], v164 offset:4096
v_mfma_f32_16x16x32_bf16 a[60:63], v[84:87], v[60:63], a[60:63]
s_waitcnt lgkmcnt(7)
buffer_load_dwordx4 v169, s[4:7], s16 offen offset:1024 lds
v_mfma_f32_16x16x32_bf16 a[64:67], v[88:91], v[32:35], a[64:67]
ds_read_b64_tr_b16 v[68:69], v161 offset:16384
v_mfma_f32_16x16x32_bf16 a[68:71], v[88:91], v[36:39], a[68:71]
ds_read_b64_tr_b16 v[70:71], v161 offset:20480
v_mfma_f32_16x16x32_bf16 a[72:75], v[88:91], v[40:43], a[72:75]
v_mfma_f32_16x16x32_bf16 a[76:79], v[88:91], v[44:47], a[76:79]
buffer_load_dwordx4 v170, s[4:7], s16 offen offset:2048 lds
v_mfma_f32_16x16x32_bf16 a[80:83], v[88:91], v[48:51], a[80:83]
ds_read_b128 v[12:15], v164 offset:6144
v_mfma_f32_16x16x32_bf16 a[84:87], v[88:91], v[52:55], a[84:87]
ds_read_b128 v[16:19], v164 offset:8192
v_mfma_f32_16x16x32_bf16 a[88:91], v[88:91], v[56:59], a[88:91]
ds_read_b128 v[20:23], v164 offset:10240
v_mfma_f32_16x16x32_bf16 a[92:95], v[88:91], v[60:63], a[92:95]
s_waitcnt lgkmcnt(10)
buffer_load_dwordx4 v171, s[4:7], s16 offen offset:3072 lds
v_mfma_f32_16x16x32_bf16 a[96:99], v[92:95], v[32:35], a[96:99]
ds_read_b64_tr_b16 v[72:73], v162 offset:16384
v_mfma_f32_16x16x32_bf16 a[100:103], v[92:95], v[36:39], a[100:103]
ds_read_b64_tr_b16 v[74:75], v162 offset:20480
v_mfma_f32_16x16x32_bf16 a[104:107], v[92:95], v[40:43], a[104:107]
s_add_u32 m0, s19, 135168
s_add_u32 s16, s16, 65536
ds_read_b128 v[24:27], v164 offset:12288
v_mfma_f32_16x16x32_bf16 a[108:111], v[92:95], v[44:47], a[108:111]
buffer_load_dwordx4 v168, s[4:7], s16 offen offset:0 lds
v_mfma_f32_16x16x32_bf16 a[112:115], v[92:95], v[48:51], a[112:115]
ds_read_b128 v[28:31], v164 offset:14336
v_mfma_f32_16x16x32_bf16 a[116:119], v[92:95], v[52:55], a[116:119]
v_mfma_f32_16x16x32_bf16 a[120:123], v[92:95], v[56:59], a[120:123]
v_mfma_f32_16x16x32_bf16 a[124:127], v[92:95], v[60:63], a[124:127]
s_waitcnt lgkmcnt(11)
v_mfma_f32_16x16x32_bf16 a[0:3], v[64:67], v[0:3], a[0:3]
s_waitcnt lgkmcnt(10)
ds_read_b64_tr_b16 v[76:77], v163 offset:16384
v_mfma_f32_16x16x32_bf16 a[4:7], v[64:67], v[4:7], a[4:7]
s_waitcnt lgkmcnt(10)
ds_read_b64_tr_b16 v[78:79], v163 offset:20480
v_mfma_f32_16x16x32_bf16 a[8:11], v[64:67], v[8:11], a[8:11]
s_waitcnt lgkmcnt(8)
v_mfma_f32_16x16x32_bf16 a[12:15], v[64:67], v[12:15], a[12:15]
s_waitcnt lgkmcnt(7)
buffer_load_dwordx4 v169, s[4:7], s16 offen offset:1024 lds
v_mfma_f32_16x16x32_bf16 a[16:19], v[64:67], v[16:19], a[16:19]
s_waitcnt lgkmcnt(6)
ds_read_b128 v[32:35], v165 offset:0
v_mfma_f32_16x16x32_bf16 a[20:23], v[64:67], v[20:23], a[20:23]
s_waitcnt lgkmcnt(4)
ds_read_b128 v[36:39], v165 offset:2048
v_mfma_f32_16x16x32_bf16 a[24:27], v[64:67], v[24:27], a[24:27]
s_waitcnt lgkmcnt(4)
ds_read_b128 v[40:43], v165 offset:4096
v_mfma_f32_16x16x32_bf16 a[28:31], v[64:67], v[28:31], a[28:31]
buffer_load_dwordx4 v170, s[4:7], s16 offen offset:2048 lds
v_mfma_f32_16x16x32_bf16 a[32:35], v[68:71], v[0:3], a[32:35]
ds_read_b64_tr_b16 v[80:81], v160 offset:24576
v_mfma_f32_16x16x32_bf16 a[36:39], v[68:71], v[4:7], a[36:39]
ds_read_b64_tr_b16 v[82:83], v160 offset:28672
v_mfma_f32_16x16x32_bf16 a[40:43], v[68:71], v[8:11], a[40:43]
v_mfma_f32_16x16x32_bf16 a[44:47], v[68:71], v[12:15], a[44:47]
buffer_load_dwordx4 v171, s[4:7], s16 offen offset:3072 lds
v_mfma_f32_16x16x32_bf16 a[48:51], v[68:71], v[16:19], a[48:51]
s_add_u32 s29, s29, 128
s_and_b32 s29, s29, 2047
ds_read_b128 v[44:47], v165 offset:6144
v_mfma_f32_16x16x32_bf16 a[52:55], v[68:71], v[20:23], a[52:55]
ds_read_b128 v[48:51], v165 offset:8192
v_mfma_f32_16x16x32_bf16 a[56:59], v[68:71], v[24:27], a[56:59]
ds_read_b128 v[52:55], v165 offset:10240
v_mfma_f32_16x16x32_bf16 a[60:63], v[68:71], v[28:31], a[60:63]
v_mfma_f32_16x16x32_bf16 a[64:67], v[72:75], v[0:3], a[64:67]
ds_read_b64_tr_b16 v[84:85], v161 offset:24576
v_mfma_f32_16x16x32_bf16 a[68:71], v[72:75], v[4:7], a[68:71]
ds_read_b64_tr_b16 v[86:87], v161 offset:28672
v_mfma_f32_16x16x32_bf16 a[72:75], v[72:75], v[8:11], a[72:75]
s_add_u32 m0, s35, 49152
s_xor_b32 s17, s33, s43
v_mfma_f32_16x16x32_bf16 a[76:79], v[72:75], v[12:15], a[76:79]
buffer_load_dwordx4 v172, s[8:11], s17 offen offset:0 lds
v_mfma_f32_16x16x32_bf16 a[80:83], v[72:75], v[16:19], a[80:83]
ds_read_b128 v[56:59], v165 offset:12288
v_mfma_f32_16x16x32_bf16 a[84:87], v[72:75], v[20:23], a[84:87]
ds_read_b128 v[60:63], v165 offset:14336
v_mfma_f32_16x16x32_bf16 a[88:91], v[72:75], v[24:27], a[88:91]
v_mfma_f32_16x16x32_bf16 a[92:95], v[72:75], v[28:31], a[92:95]
s_waitcnt lgkmcnt(12)
buffer_load_dwordx4 v173, s[8:11], s17 offen offset:1024 lds
v_mfma_f32_16x16x32_bf16 a[96:99], v[76:79], v[0:3], a[96:99]
s_add_u32 s33, s33, 65536
s_and_b32 s33, s33, 2097151
ds_read_b64_tr_b16 v[88:89], v162 offset:24576
v_mfma_f32_16x16x32_bf16 a[100:103], v[76:79], v[4:7], a[100:103]
ds_read_b64_tr_b16 v[90:91], v162 offset:28672
v_mfma_f32_16x16x32_bf16 a[104:107], v[76:79], v[8:11], a[104:107]
s_add_u32 m0, s35, 57344
s_xor_b32 s17, s33, s43
v_mfma_f32_16x16x32_bf16 a[108:111], v[76:79], v[12:15], a[108:111]
buffer_load_dwordx4 v172, s[8:11], s17 offen offset:0 lds
v_mfma_f32_16x16x32_bf16 a[112:115], v[76:79], v[16:19], a[112:115]
v_mfma_f32_16x16x32_bf16 a[116:119], v[76:79], v[20:23], a[116:119]
v_mfma_f32_16x16x32_bf16 a[120:123], v[76:79], v[24:27], a[120:123]
v_mfma_f32_16x16x32_bf16 a[124:127], v[76:79], v[28:31], a[124:127]
s_waitcnt lgkmcnt(9)
v_mfma_f32_16x16x32_bf16 a[0:3], v[80:83], v[32:35], a[0:3]
ds_read_b64_tr_b16 v[92:93], v163 offset:24576
v_mfma_f32_16x16x32_bf16 a[4:7], v[80:83], v[36:39], a[4:7]
ds_read_b64_tr_b16 v[94:95], v163 offset:28672
v_mfma_f32_16x16x32_bf16 a[8:11], v[80:83], v[40:43], a[8:11]
s_waitcnt lgkmcnt(10)
v_mfma_f32_16x16x32_bf16 a[12:15], v[80:83], v[44:47], a[12:15]
s_waitcnt lgkmcnt(9)
buffer_load_dwordx4 v173, s[8:11], s17 offen offset:1024 lds
v_mfma_f32_16x16x32_bf16 a[16:19], v[80:83], v[48:51], a[16:19]
s_waitcnt lgkmcnt(8)
s_add_u32 s33, s33, 65536
s_and_b32 s33, s33, 2097151
v_mfma_f32_16x16x32_bf16 a[20:23], v[80:83], v[52:55], a[20:23]
s_waitcnt lgkmcnt(5)
v_mfma_f32_16x16x32_bf16 a[24:27], v[80:83], v[56:59], a[24:27]
s_waitcnt lgkmcnt(4)
v_mfma_f32_16x16x32_bf16 a[28:31], v[80:83], v[60:63], a[28:31]
s_waitcnt vmcnt(12)
s_barrier
v_mfma_f32_16x16x32_bf16 a[32:35], v[84:87], v[32:35], a[32:35]
ds_read_b64_tr_b16 v[64:65], v160 offset:32768
v_mfma_f32_16x16x32_bf16 a[36:39], v[84:87], v[36:39], a[36:39]
ds_read_b64_tr_b16 v[66:67], v160 offset:36864
v_mfma_f32_16x16x32_bf16 a[40:43], v[84:87], v[40:43], a[40:43]
s_add_u32 m0, s19, 0
s_add_u32 s16, s28, s29
s_xor_b32 s16, s16, s42
v_mfma_f32_16x16x32_bf16 a[44:47], v[84:87], v[44:47], a[44:47]
buffer_load_dwordx4 v168, s[4:7], s16 offen offset:0 lds
v_mfma_f32_16x16x32_bf16 a[48:51], v[84:87], v[48:51], a[48:51]
ds_read_b128 v[0:3], v164 offset:32768
v_mfma_f32_16x16x32_bf16 a[52:55], v[84:87], v[52:55], a[52:55]
ds_read_b128 v[4:7], v164 offset:34816
v_mfma_f32_16x16x32_bf16 a[56:59], v[84:87], v[56:59], a[56:59]
ds_read_b128 v[8:11], v164 offset:36864
v_mfma_f32_16x16x32_bf16 a[60:63], v[84:87], v[60:63], a[60:63]
s_waitcnt lgkmcnt(7)
buffer_load_dwordx4 v169, s[4:7], s16 offen offset:1024 lds
v_mfma_f32_16x16x32_bf16 a[64:67], v[88:91], v[32:35], a[64:67]
ds_read_b64_tr_b16 v[68:69], v161 offset:32768
v_mfma_f32_16x16x32_bf16 a[68:71], v[88:91], v[36:39], a[68:71]
ds_read_b64_tr_b16 v[70:71], v161 offset:36864
v_mfma_f32_16x16x32_bf16 a[72:75], v[88:91], v[40:43], a[72:75]
v_mfma_f32_16x16x32_bf16 a[76:79], v[88:91], v[44:47], a[76:79]
buffer_load_dwordx4 v170, s[4:7], s16 offen offset:2048 lds
v_mfma_f32_16x16x32_bf16 a[80:83], v[88:91], v[48:51], a[80:83]
ds_read_b128 v[12:15], v164 offset:38912
v_mfma_f32_16x16x32_bf16 a[84:87], v[88:91], v[52:55], a[84:87]
ds_read_b128 v[16:19], v164 offset:40960
v_mfma_f32_16x16x32_bf16 a[88:91], v[88:91], v[56:59], a[88:91]
ds_read_b128 v[20:23], v164 offset:43008
v_mfma_f32_16x16x32_bf16 a[92:95], v[88:91], v[60:63], a[92:95]
s_waitcnt lgkmcnt(10)
buffer_load_dwordx4 v171, s[4:7], s16 offen offset:3072 lds
v_mfma_f32_16x16x32_bf16 a[96:99], v[92:95], v[32:35], a[96:99]
ds_read_b64_tr_b16 v[72:73], v162 offset:32768
v_mfma_f32_16x16x32_bf16 a[100:103], v[92:95], v[36:39], a[100:103]
ds_read_b64_tr_b16 v[74:75], v162 offset:36864
v_mfma_f32_16x16x32_bf16 a[104:107], v[92:95], v[40:43], a[104:107]
s_add_u32 m0, s19, 4096
s_add_u32 s16, s16, 65536
ds_read_b128 v[24:27], v164 offset:45056
v_mfma_f32_16x16x32_bf16 a[108:111], v[92:95], v[44:47], a[108:111]
buffer_load_dwordx4 v168, s[4:7], s16 offen offset:0 lds
v_mfma_f32_16x16x32_bf16 a[112:115], v[92:95], v[48:51], a[112:115]
ds_read_b128 v[28:31], v164 offset:47104
v_mfma_f32_16x16x32_bf16 a[116:119], v[92:95], v[52:55], a[116:119]
v_mfma_f32_16x16x32_bf16 a[120:123], v[92:95], v[56:59], a[120:123]
v_mfma_f32_16x16x32_bf16 a[124:127], v[92:95], v[60:63], a[124:127]
buffer_load_dword v251, v248, s[48:51], 0 offen sc1
s_add_u32 s27, s40, 0
v_accvgpr_read_b32 v100, a0
v_accvgpr_read_b32 v101, a1
v_accvgpr_read_b32 v102, a2
v_accvgpr_read_b32 v103, a3
v_accvgpr_read_b32 v104, a32
v_accvgpr_read_b32 v105, a33
v_accvgpr_read_b32 v106, a34
v_accvgpr_read_b32 v107, a35
v_cvt_pk_bf16_f32 v96, v100, v101
v_cvt_pk_bf16_f32 v97, v102, v103
v_cvt_pk_bf16_f32 v98, v104, v105
v_cvt_pk_bf16_f32 v99, v106, v107
buffer_store_dwordx4 v[96:99], v252, s[12:15], s27 offen offset:0 sc1
v_accvgpr_read_b32 v112, a4
v_accvgpr_read_b32 v113, a5
v_accvgpr_read_b32 v114, a6
v_accvgpr_read_b32 v115, a7
v_accvgpr_read_b32 v116, a36
v_accvgpr_read_b32 v117, a37
v_accvgpr_read_b32 v118, a38
v_accvgpr_read_b32 v119, a39
v_cvt_pk_bf16_f32 v108, v112, v113
v_cvt_pk_bf16_f32 v109, v114, v115
v_cvt_pk_bf16_f32 v110, v116, v117
v_cvt_pk_bf16_f32 v111, v118, v119
buffer_store_dwordx4 v[108:111], v252, s[12:15], s27 offen offset:2048 sc1
v_accvgpr_read_b32 v124, a8
v_accvgpr_read_b32 v125, a9
v_accvgpr_read_b32 v126, a10
v_accvgpr_read_b32 v127, a11
v_accvgpr_read_b32 v128, a40
v_accvgpr_read_b32 v129, a41
v_accvgpr_read_b32 v130, a42
v_accvgpr_read_b32 v131, a43
v_cvt_pk_bf16_f32 v120, v124, v125
v_cvt_pk_bf16_f32 v121, v126, v127
v_cvt_pk_bf16_f32 v122, v128, v129
v_cvt_pk_bf16_f32 v123, v130, v131
buffer_store_dwordx4 v[120:123], v253, s[12:15], s27 offen offset:0 sc1
v_accvgpr_read_b32 v136, a12
v_accvgpr_read_b32 v137, a13
v_accvgpr_read_b32 v138, a14
v_accvgpr_read_b32 v139, a15
v_accvgpr_read_b32 v140, a44
v_accvgpr_read_b32 v141, a45
v_accvgpr_read_b32 v142, a46
v_accvgpr_read_b32 v143, a47
v_cvt_pk_bf16_f32 v132, v136, v137
v_cvt_pk_bf16_f32 v133, v138, v139
v_cvt_pk_bf16_f32 v134, v140, v141
v_cvt_pk_bf16_f32 v135, v142, v143
buffer_store_dwordx4 v[132:135], v253, s[12:15], s27 offen offset:2048 sc1
s_add_u32 s27, s40, 262144
v_accvgpr_read_b32 v148, a16
v_accvgpr_read_b32 v149, a17
v_accvgpr_read_b32 v150, a18
v_accvgpr_read_b32 v151, a19
v_accvgpr_read_b32 v152, a48
v_accvgpr_read_b32 v153, a49
v_accvgpr_read_b32 v154, a50
v_accvgpr_read_b32 v155, a51
v_cvt_pk_bf16_f32 v144, v148, v149
v_cvt_pk_bf16_f32 v145, v150, v151
v_cvt_pk_bf16_f32 v146, v152, v153
v_cvt_pk_bf16_f32 v147, v154, v155
buffer_store_dwordx4 v[144:147], v252, s[12:15], s27 offen offset:0 sc1
v_accvgpr_read_b32 v100, a20
v_accvgpr_read_b32 v101, a21
v_accvgpr_read_b32 v102, a22
v_accvgpr_read_b32 v103, a23
v_accvgpr_read_b32 v104, a52
v_accvgpr_read_b32 v105, a53
v_accvgpr_read_b32 v106, a54
v_accvgpr_read_b32 v107, a55
v_cvt_pk_bf16_f32 v96, v100, v101
v_cvt_pk_bf16_f32 v97, v102, v103
v_cvt_pk_bf16_f32 v98, v104, v105
v_cvt_pk_bf16_f32 v99, v106, v107
buffer_store_dwordx4 v[96:99], v252, s[12:15], s27 offen offset:2048 sc1
v_accvgpr_read_b32 v112, a24
v_accvgpr_read_b32 v113, a25
v_accvgpr_read_b32 v114, a26
v_accvgpr_read_b32 v115, a27
v_accvgpr_read_b32 v116, a56
v_accvgpr_read_b32 v117, a57
v_accvgpr_read_b32 v118, a58
v_accvgpr_read_b32 v119, a59
v_cvt_pk_bf16_f32 v108, v112, v113
v_cvt_pk_bf16_f32 v109, v114, v115
v_cvt_pk_bf16_f32 v110, v116, v117
v_cvt_pk_bf16_f32 v111, v118, v119
buffer_store_dwordx4 v[108:111], v253, s[12:15], s27 offen offset:0 sc1
v_accvgpr_read_b32 v124, a28
v_accvgpr_read_b32 v125, a29
v_accvgpr_read_b32 v126, a30
v_accvgpr_read_b32 v127, a31
v_accvgpr_read_b32 v128, a60
v_accvgpr_read_b32 v129, a61
v_accvgpr_read_b32 v130, a62
v_accvgpr_read_b32 v131, a63
v_cvt_pk_bf16_f32 v120, v124, v125
v_cvt_pk_bf16_f32 v121, v126, v127
v_cvt_pk_bf16_f32 v122, v128, v129
v_cvt_pk_bf16_f32 v123, v130, v131
buffer_store_dwordx4 v[120:123], v253, s[12:15], s27 offen offset:2048 sc1
s_add_u32 s27, s40, 8192
v_accvgpr_read_b32 v136, a64
v_accvgpr_read_b32 v137, a65
v_accvgpr_read_b32 v138, a66
v_accvgpr_read_b32 v139, a67
v_accvgpr_read_b32 v140, a96
v_accvgpr_read_b32 v141, a97
v_accvgpr_read_b32 v142, a98
v_accvgpr_read_b32 v143, a99
v_cvt_pk_bf16_f32 v132, v136, v137
v_cvt_pk_bf16_f32 v133, v138, v139
v_cvt_pk_bf16_f32 v134, v140, v141
v_cvt_pk_bf16_f32 v135, v142, v143
buffer_store_dwordx4 v[132:135], v252, s[12:15], s27 offen offset:0 sc1
v_accvgpr_read_b32 v148, a68
v_accvgpr_read_b32 v149, a69
v_accvgpr_read_b32 v150, a70
v_accvgpr_read_b32 v151, a71
v_accvgpr_read_b32 v152, a100
v_accvgpr_read_b32 v153, a101
v_accvgpr_read_b32 v154, a102
v_accvgpr_read_b32 v155, a103
v_cvt_pk_bf16_f32 v144, v148, v149
v_cvt_pk_bf16_f32 v145, v150, v151
v_cvt_pk_bf16_f32 v146, v152, v153
v_cvt_pk_bf16_f32 v147, v154, v155
buffer_store_dwordx4 v[144:147], v252, s[12:15], s27 offen offset:2048 sc1
v_accvgpr_read_b32 v100, a72
v_accvgpr_read_b32 v101, a73
v_accvgpr_read_b32 v102, a74
v_accvgpr_read_b32 v103, a75
v_accvgpr_read_b32 v104, a104
v_accvgpr_read_b32 v105, a105
v_accvgpr_read_b32 v106, a106
v_accvgpr_read_b32 v107, a107
v_cvt_pk_bf16_f32 v96, v100, v101
v_cvt_pk_bf16_f32 v97, v102, v103
v_cvt_pk_bf16_f32 v98, v104, v105
v_cvt_pk_bf16_f32 v99, v106, v107
buffer_store_dwordx4 v[96:99], v253, s[12:15], s27 offen offset:0 sc1
v_accvgpr_read_b32 v112, a76
v_accvgpr_read_b32 v113, a77
v_accvgpr_read_b32 v114, a78
v_accvgpr_read_b32 v115, a79
v_accvgpr_read_b32 v116, a108
v_accvgpr_read_b32 v117, a109
v_accvgpr_read_b32 v118, a110
v_accvgpr_read_b32 v119, a111
v_cvt_pk_bf16_f32 v108, v112, v113
v_cvt_pk_bf16_f32 v109, v114, v115
v_cvt_pk_bf16_f32 v110, v116, v117
v_cvt_pk_bf16_f32 v111, v118, v119
buffer_store_dwordx4 v[108:111], v253, s[12:15], s27 offen offset:2048 sc1
s_add_u32 s27, s40, 270336
v_accvgpr_read_b32 v124, a80
v_accvgpr_read_b32 v125, a81
v_accvgpr_read_b32 v126, a82
v_accvgpr_read_b32 v127, a83
v_accvgpr_read_b32 v128, a112
v_accvgpr_read_b32 v129, a113
v_accvgpr_read_b32 v130, a114
v_accvgpr_read_b32 v131, a115
v_cvt_pk_bf16_f32 v120, v124, v125
v_cvt_pk_bf16_f32 v121, v126, v127
v_cvt_pk_bf16_f32 v122, v128, v129
v_cvt_pk_bf16_f32 v123, v130, v131
buffer_store_dwordx4 v[120:123], v252, s[12:15], s27 offen offset:0 sc1
v_accvgpr_read_b32 v136, a84
v_accvgpr_read_b32 v137, a85
v_accvgpr_read_b32 v138, a86
v_accvgpr_read_b32 v139, a87
v_accvgpr_read_b32 v140, a116
v_accvgpr_read_b32 v141, a117
v_accvgpr_read_b32 v142, a118
v_accvgpr_read_b32 v143, a119
v_cvt_pk_bf16_f32 v132, v136, v137
v_cvt_pk_bf16_f32 v133, v138, v139
v_cvt_pk_bf16_f32 v134, v140, v141
v_cvt_pk_bf16_f32 v135, v142, v143
buffer_store_dwordx4 v[132:135], v252, s[12:15], s27 offen offset:2048 sc1
v_accvgpr_read_b32 v148, a88
v_accvgpr_read_b32 v149, a89
v_accvgpr_read_b32 v150, a90
v_accvgpr_read_b32 v151, a91
v_accvgpr_read_b32 v152, a120
v_accvgpr_read_b32 v153, a121
v_accvgpr_read_b32 v154, a122
v_accvgpr_read_b32 v155, a123
v_cvt_pk_bf16_f32 v144, v148, v149
v_cvt_pk_bf16_f32 v145, v150, v151
v_cvt_pk_bf16_f32 v146, v152, v153
v_cvt_pk_bf16_f32 v147, v154, v155
buffer_store_dwordx4 v[144:147], v253, s[12:15], s27 offen offset:0 sc1
v_accvgpr_read_b32 v100, a92
v_accvgpr_read_b32 v101, a93
v_accvgpr_read_b32 v102, a94
v_accvgpr_read_b32 v103, a95
v_accvgpr_read_b32 v104, a124
v_accvgpr_read_b32 v105, a125
v_accvgpr_read_b32 v106, a126
v_accvgpr_read_b32 v107, a127
v_cvt_pk_bf16_f32 v96, v100, v101
v_cvt_pk_bf16_f32 v97, v102, v103
v_cvt_pk_bf16_f32 v98, v104, v105
v_cvt_pk_bf16_f32 v99, v106, v107
buffer_store_dwordx4 v[96:99], v253, s[12:15], s27 offen offset:2048 sc1
s_waitcnt lgkmcnt(11)
v_mfma_f32_16x16x32_bf16 a[128:131], v[64:67], v[0:3], a[128:131]
s_waitcnt lgkmcnt(10)
ds_read_b64_tr_b16 v[76:77], v163 offset:32768
v_mfma_f32_16x16x32_bf16 a[132:135], v[64:67], v[4:7], a[132:135]
s_waitcnt lgkmcnt(10)
ds_read_b64_tr_b16 v[78:79], v163 offset:36864
v_mfma_f32_16x16x32_bf16 a[136:139], v[64:67], v[8:11], a[136:139]
s_waitcnt lgkmcnt(8)
v_mfma_f32_16x16x32_bf16 a[140:143], v[64:67], v[12:15], a[140:143]
s_waitcnt lgkmcnt(7)
buffer_load_dwordx4 v169, s[4:7], s16 offen offset:1024 lds
v_mfma_f32_16x16x32_bf16 a[144:147], v[64:67], v[16:19], a[144:147]
s_waitcnt lgkmcnt(6)
ds_read_b128 v[32:35], v165 offset:32768
v_mfma_f32_16x16x32_bf16 a[148:151], v[64:67], v[20:23], a[148:151]
s_waitcnt lgkmcnt(4)
ds_read_b128 v[36:39], v165 offset:34816
v_mfma_f32_16x16x32_bf16 a[152:155], v[64:67], v[24:27], a[152:155]
s_waitcnt lgkmcnt(4)
ds_read_b128 v[40:43], v165 offset:36864
v_mfma_f32_16x16x32_bf16 a[156:159], v[64:67], v[28:31], a[156:159]
buffer_load_dwordx4 v170, s[4:7], s16 offen offset:2048 lds
v_mfma_f32_16x16x32_bf16 a[160:163], v[68:71], v[0:3], a[160:163]
ds_read_b64_tr_b16 v[80:81], v160 offset:40960
v_mfma_f32_16x16x32_bf16 a[164:167], v[68:71], v[4:7], a[164:167]
ds_read_b64_tr_b16 v[82:83], v160 offset:45056
v_mfma_f32_16x16x32_bf16 a[168:171], v[68:71], v[8:11], a[168:171]
v_mfma_f32_16x16x32_bf16 a[172:175], v[68:71], v[12:15], a[172:175]
buffer_load_dwordx4 v171, s[4:7], s16 offen offset:3072 lds
v_mfma_f32_16x16x32_bf16 a[176:179], v[68:71], v[16:19], a[176:179]
s_add_u32 s29, s29, 128
s_and_b32 s29, s29, 2047
ds_read_b128 v[44:47], v165 offset:38912
v_mfma_f32_16x16x32_bf16 a[180:183], v[68:71], v[20:23], a[180:183]
ds_read_b128 v[48:51], v165 offset:40960
v_mfma_f32_16x16x32_bf16 a[184:187], v[68:71], v[24:27], a[184:187]
ds_read_b128 v[52:55], v165 offset:43008
v_mfma_f32_16x16x32_bf16 a[188:191], v[68:71], v[28:31], a[188:191]
v_mfma_f32_16x16x32_bf16 a[192:195], v[72:75], v[0:3], a[192:195]
ds_read_b64_tr_b16 v[84:85], v161 offset:40960
v_mfma_f32_16x16x32_bf16 a[196:199], v[72:75], v[4:7], a[196:199]
ds_read_b64_tr_b16 v[86:87], v161 offset:45056
v_mfma_f32_16x16x32_bf16 a[200:203], v[72:75], v[8:11], a[200:203]
s_add_u32 m0, s35, 0
s_xor_b32 s17, s33, s43
v_mfma_f32_16x16x32_bf16 a[204:207], v[72:75], v[12:15], a[204:207]
buffer_load_dwordx4 v172, s[8:11], s17 offen offset:0 lds
v_mfma_f32_16x16x32_bf16 a[208:211], v[72:75], v[16:19], a[208:211]
ds_read_b128 v[56:59], v165 offset:45056
v_mfma_f32_16x16x32_bf16 a[212:215], v[72:75], v[20:23], a[212:215]
ds_read_b128 v[60:63], v165 offset:47104
v_mfma_f32_16x16x32_bf16 a[216:219], v[72:75], v[24:27], a[216:219]
v_mfma_f32_16x16x32_bf16 a[220:223], v[72:75], v[28:31], a[220:223]
s_waitcnt lgkmcnt(12)
buffer_load_dwordx4 v173, s[8:11], s17 offen offset:1024 lds
v_mfma_f32_16x16x32_bf16 a[224:227], v[76:79], v[0:3], a[224:227]
s_add_u32 s33, s33, 65536
s_and_b32 s33, s33, 2097151
ds_read_b64_tr_b16 v[88:89], v162 offset:40960
v_mfma_f32_16x16x32_bf16 a[228:231], v[76:79], v[4:7], a[228:231]
ds_read_b64_tr_b16 v[90:91], v162 offset:45056
v_mfma_f32_16x16x32_bf16 a[232:235], v[76:79], v[8:11], a[232:235]
s_add_u32 m0, s35, 8192
s_xor_b32 s17, s33, s43
v_mfma_f32_16x16x32_bf16 a[236:239], v[76:79], v[12:15], a[236:239]
buffer_load_dwordx4 v172, s[8:11], s17 offen offset:0 lds
v_mfma_f32_16x16x32_bf16 a[240:243], v[76:79], v[16:19], a[240:243]
v_mfma_f32_16x16x32_bf16 a[244:247], v[76:79], v[20:23], a[244:247]
v_mfma_f32_16x16x32_bf16 a[248:251], v[76:79], v[24:27], a[248:251]
v_mfma_f32_16x16x32_bf16 a[252:255], v[76:79], v[28:31], a[252:255]
s_waitcnt lgkmcnt(9)
v_mfma_f32_16x16x32_bf16 a[128:131], v[80:83], v[32:35], a[128:131]
ds_read_b64_tr_b16 v[92:93], v163 offset:40960
v_mfma_f32_16x16x32_bf16 a[132:135], v[80:83], v[36:39], a[132:135]
ds_read_b64_tr_b16 v[94:95], v163 offset:45056
v_mfma_f32_16x16x32_bf16 a[136:139], v[80:83], v[40:43], a[136:139]
s_waitcnt lgkmcnt(10)
v_mfma_f32_16x16x32_bf16 a[140:143], v[80:83], v[44:47], a[140:143]
s_waitcnt lgkmcnt(9)
buffer_load_dwordx4 v173, s[8:11], s17 offen offset:1024 lds
v_mfma_f32_16x16x32_bf16 a[144:147], v[80:83], v[48:51], a[144:147]
s_waitcnt lgkmcnt(8)
s_add_u32 s33, s33, 65536
s_and_b32 s33, s33, 2097151
v_mfma_f32_16x16x32_bf16 a[148:151], v[80:83], v[52:55], a[148:151]
s_waitcnt lgkmcnt(5)
v_mfma_f32_16x16x32_bf16 a[152:155], v[80:83], v[56:59], a[152:155]
s_waitcnt lgkmcnt(4)
v_mfma_f32_16x16x32_bf16 a[156:159], v[80:83], v[60:63], a[156:159]
s_waitcnt vmcnt(29)
s_barrier
v_mfma_f32_16x16x32_bf16 a[160:163], v[84:87], v[32:35], a[160:163]
ds_read_b64_tr_b16 v[64:65], v160 offset:49152
v_mfma_f32_16x16x32_bf16 a[164:167], v[84:87], v[36:39], a[164:167]
ds_read_b64_tr_b16 v[66:67], v160 offset:53248
v_mfma_f32_16x16x32_bf16 a[168:171], v[84:87], v[40:43], a[168:171]
s_add_u32 m0, s19, 32768
s_add_u32 s16, s28, s29
s_xor_b32 s16, s16, s42
v_mfma_f32_16x16x32_bf16 a[172:175], v[84:87], v[44:47], a[172:175]
buffer_load_dwordx4 v168, s[4:7], s16 offen offset:0 lds
v_mfma_f32_16x16x32_bf16 a[176:179], v[84:87], v[48:51], a[176:179]
ds_read_b128 v[0:3], v166 offset:0
v_mfma_f32_16x16x32_bf16 a[180:183], v[84:87], v[52:55], a[180:183]
ds_read_b128 v[4:7], v166 offset:2048
v_mfma_f32_16x16x32_bf16 a[184:187], v[84:87], v[56:59], a[184:187]
ds_read_b128 v[8:11], v166 offset:4096
v_mfma_f32_16x16x32_bf16 a[188:191], v[84:87], v[60:63], a[188:191]
s_waitcnt lgkmcnt(7)
buffer_load_dwordx4 v169, s[4:7], s16 offen offset:1024 lds
v_mfma_f32_16x16x32_bf16 a[192:195], v[88:91], v[32:35], a[192:195]
ds_read_b64_tr_b16 v[68:69], v161 offset:49152
v_mfma_f32_16x16x32_bf16 a[196:199], v[88:91], v[36:39], a[196:199]
ds_read_b64_tr_b16 v[70:71], v161 offset:53248
v_mfma_f32_16x16x32_bf16 a[200:203], v[88:91], v[40:43], a[200:203]
v_mfma_f32_16x16x32_bf16 a[204:207], v[88:91], v[44:47], a[204:207]
buffer_load_dwordx4 v170, s[4:7], s16 offen offset:2048 lds
v_mfma_f32_16x16x32_bf16 a[208:211], v[88:91], v[48:51], a[208:211]
ds_read_b128 v[12:15], v166 offset:6144
v_mfma_f32_16x16x32_bf16 a[212:215], v[88:91], v[52:55], a[212:215]
ds_read_b128 v[16:19], v166 offset:8192
v_mfma_f32_16x16x32_bf16 a[216:219], v[88:91], v[56:59], a[216:219]
ds_read_b128 v[20:23], v166 offset:10240
v_mfma_f32_16x16x32_bf16 a[220:223], v[88:91], v[60:63], a[220:223]
s_waitcnt lgkmcnt(10)
buffer_load_dwordx4 v171, s[4:7], s16 offen offset:3072 lds
v_mfma_f32_16x16x32_bf16 a[224:227], v[92:95], v[32:35], a[224:227]
ds_read_b64_tr_b16 v[72:73], v162 offset:49152
v_mfma_f32_16x16x32_bf16 a[228:231], v[92:95], v[36:39], a[228:231]
s_waitcnt vmcnt(11)
ds_read_b64_tr_b16 v[74:75], v162 offset:53248
v_cmp_eq_u32 vcc, 0, v251
s_cbranch_vccnz standalone__weight_only_int_quip__prompt_kernel_xinit_spin
standalone__weight_only_int_quip__prompt_kernel_xinit_ok:
buffer_store_dword v249, v250, s[44:47], s62 offen sc1
v_mfma_f32_16x16x32_bf16 a[232:235], v[92:95], v[40:43], a[232:235]
s_add_u32 m0, s19, 36864
s_add_u32 s16, s16, 65536
ds_read_b128 v[24:27], v166 offset:12288
v_mfma_f32_16x16x32_bf16 a[236:239], v[92:95], v[44:47], a[236:239]
buffer_load_dwordx4 v168, s[4:7], s16 offen offset:0 lds
v_mfma_f32_16x16x32_bf16 a[240:243], v[92:95], v[48:51], a[240:243]
ds_read_b128 v[28:31], v166 offset:14336
v_mfma_f32_16x16x32_bf16 a[244:247], v[92:95], v[52:55], a[244:247]
v_mfma_f32_16x16x32_bf16 a[248:251], v[92:95], v[56:59], a[248:251]
v_mfma_f32_16x16x32_bf16 a[252:255], v[92:95], v[60:63], a[252:255]
s_waitcnt lgkmcnt(11)
v_mfma_f32_16x16x32_bf16 a[128:131], v[64:67], v[0:3], a[128:131]
s_waitcnt lgkmcnt(10)
ds_read_b64_tr_b16 v[76:77], v163 offset:49152
v_mfma_f32_16x16x32_bf16 a[132:135], v[64:67], v[4:7], a[132:135]
s_waitcnt lgkmcnt(10)
ds_read_b64_tr_b16 v[78:79], v163 offset:53248
v_mfma_f32_16x16x32_bf16 a[136:139], v[64:67], v[8:11], a[136:139]
s_waitcnt lgkmcnt(8)
v_mfma_f32_16x16x32_bf16 a[140:143], v[64:67], v[12:15], a[140:143]
s_waitcnt lgkmcnt(7)
buffer_load_dwordx4 v169, s[4:7], s16 offen offset:1024 lds
v_mfma_f32_16x16x32_bf16 a[144:147], v[64:67], v[16:19], a[144:147]
s_waitcnt lgkmcnt(6)
ds_read_b128 v[32:35], v167 offset:0
v_mfma_f32_16x16x32_bf16 a[148:151], v[64:67], v[20:23], a[148:151]
s_waitcnt lgkmcnt(4)
ds_read_b128 v[36:39], v167 offset:2048
v_mfma_f32_16x16x32_bf16 a[152:155], v[64:67], v[24:27], a[152:155]
s_waitcnt lgkmcnt(4)
ds_read_b128 v[40:43], v167 offset:4096
v_mfma_f32_16x16x32_bf16 a[156:159], v[64:67], v[28:31], a[156:159]
buffer_load_dwordx4 v170, s[4:7], s16 offen offset:2048 lds
v_mfma_f32_16x16x32_bf16 a[160:163], v[68:71], v[0:3], a[160:163]
ds_read_b64_tr_b16 v[80:81], v160 offset:57344
v_mfma_f32_16x16x32_bf16 a[164:167], v[68:71], v[4:7], a[164:167]
ds_read_b64_tr_b16 v[82:83], v160 offset:61440
v_mfma_f32_16x16x32_bf16 a[168:171], v[68:71], v[8:11], a[168:171]
v_mfma_f32_16x16x32_bf16 a[172:175], v[68:71], v[12:15], a[172:175]
buffer_load_dwordx4 v171, s[4:7], s16 offen offset:3072 lds
v_mfma_f32_16x16x32_bf16 a[176:179], v[68:71], v[16:19], a[176:179]
s_add_u32 s29, s29, 128
s_and_b32 s29, s29, 2047
ds_read_b128 v[44:47], v167 offset:6144
v_mfma_f32_16x16x32_bf16 a[180:183], v[68:71], v[20:23], a[180:183]
ds_read_b128 v[48:51], v167 offset:8192
v_mfma_f32_16x16x32_bf16 a[184:187], v[68:71], v[24:27], a[184:187]
ds_read_b128 v[52:55], v167 offset:10240
v_mfma_f32_16x16x32_bf16 a[188:191], v[68:71], v[28:31], a[188:191]
v_mfma_f32_16x16x32_bf16 a[192:195], v[72:75], v[0:3], a[192:195]
ds_read_b64_tr_b16 v[84:85], v161 offset:57344
v_mfma_f32_16x16x32_bf16 a[196:199], v[72:75], v[4:7], a[196:199]
ds_read_b64_tr_b16 v[86:87], v161 offset:61440
v_mfma_f32_16x16x32_bf16 a[200:203], v[72:75], v[8:11], a[200:203]
s_add_u32 m0, s35, 16384
s_xor_b32 s17, s33, s43
v_mfma_f32_16x16x32_bf16 a[204:207], v[72:75], v[12:15], a[204:207]
buffer_load_dwordx4 v172, s[8:11], s17 offen offset:0 lds
v_mfma_f32_16x16x32_bf16 a[208:211], v[72:75], v[16:19], a[208:211]
ds_read_b128 v[56:59], v167 offset:12288
v_mfma_f32_16x16x32_bf16 a[212:215], v[72:75], v[20:23], a[212:215]
ds_read_b128 v[60:63], v167 offset:14336
v_mfma_f32_16x16x32_bf16 a[216:219], v[72:75], v[24:27], a[216:219]
v_mfma_f32_16x16x32_bf16 a[220:223], v[72:75], v[28:31], a[220:223]
s_waitcnt lgkmcnt(12)
buffer_load_dwordx4 v173, s[8:11], s17 offen offset:1024 lds
v_mfma_f32_16x16x32_bf16 a[224:227], v[76:79], v[0:3], a[224:227]
s_add_u32 s33, s33, 65536
s_and_b32 s33, s33, 2097151
ds_read_b64_tr_b16 v[88:89], v162 offset:57344
v_mfma_f32_16x16x32_bf16 a[228:231], v[76:79], v[4:7], a[228:231]
ds_read_b64_tr_b16 v[90:91], v162 offset:61440
v_mfma_f32_16x16x32_bf16 a[232:235], v[76:79], v[8:11], a[232:235]
s_add_u32 m0, s35, 24576
s_xor_b32 s17, s33, s43
v_mfma_f32_16x16x32_bf16 a[236:239], v[76:79], v[12:15], a[236:239]
buffer_load_dwordx4 v172, s[8:11], s17 offen offset:0 lds
v_mfma_f32_16x16x32_bf16 a[240:243], v[76:79], v[16:19], a[240:243]
v_mfma_f32_16x16x32_bf16 a[244:247], v[76:79], v[20:23], a[244:247]
v_mfma_f32_16x16x32_bf16 a[248:251], v[76:79], v[24:27], a[248:251]
v_mfma_f32_16x16x32_bf16 a[252:255], v[76:79], v[28:31], a[252:255]
s_waitcnt lgkmcnt(9)
v_mfma_f32_16x16x32_bf16 a[128:131], v[80:83], v[32:35], a[128:131]
ds_read_b64_tr_b16 v[92:93], v163 offset:57344
v_mfma_f32_16x16x32_bf16 a[132:135], v[80:83], v[36:39], a[132:135]
ds_read_b64_tr_b16 v[94:95], v163 offset:61440
v_mfma_f32_16x16x32_bf16 a[136:139], v[80:83], v[40:43], a[136:139]
s_waitcnt lgkmcnt(10)
v_mfma_f32_16x16x32_bf16 a[140:143], v[80:83], v[44:47], a[140:143]
s_waitcnt lgkmcnt(9)
buffer_load_dwordx4 v173, s[8:11], s17 offen offset:1024 lds
v_mfma_f32_16x16x32_bf16 a[144:147], v[80:83], v[48:51], a[144:147]
s_waitcnt lgkmcnt(8)
s_add_u32 s33, s33, 65536
s_and_b32 s33, s33, 2097151
v_mfma_f32_16x16x32_bf16 a[148:151], v[80:83], v[52:55], a[148:151]
s_waitcnt lgkmcnt(5)
v_mfma_f32_16x16x32_bf16 a[152:155], v[80:83], v[56:59], a[152:155]
s_waitcnt lgkmcnt(4)
v_mfma_f32_16x16x32_bf16 a[156:159], v[80:83], v[60:63], a[156:159]
s_waitcnt vmcnt(13)
s_barrier
v_mfma_f32_16x16x32_bf16 a[160:163], v[84:87], v[32:35], a[160:163]
ds_read_b64_tr_b16 v[64:65], v160 offset:0
v_mfma_f32_16x16x32_bf16 a[164:167], v[84:87], v[36:39], a[164:167]
ds_read_b64_tr_b16 v[66:67], v160 offset:4096
v_mfma_f32_16x16x32_bf16 a[168:171], v[84:87], v[40:43], a[168:171]
s_add_u32 m0, s19, 131072
s_add_u32 s16, s28, s29
s_xor_b32 s16, s16, s42
v_mfma_f32_16x16x32_bf16 a[172:175], v[84:87], v[44:47], a[172:175]
buffer_load_dwordx4 v168, s[4:7], s16 offen offset:0 lds
v_mfma_f32_16x16x32_bf16 a[176:179], v[84:87], v[48:51], a[176:179]
ds_read_b128 v[0:3], v164 offset:0
v_mfma_f32_16x16x32_bf16 a[180:183], v[84:87], v[52:55], a[180:183]
ds_read_b128 v[4:7], v164 offset:2048
v_mfma_f32_16x16x32_bf16 a[184:187], v[84:87], v[56:59], a[184:187]
ds_read_b128 v[8:11], v164 offset:4096
v_mfma_f32_16x16x32_bf16 a[188:191], v[84:87], v[60:63], a[188:191]
s_waitcnt lgkmcnt(7)
buffer_load_dwordx4 v169, s[4:7], s16 offen offset:1024 lds
v_mfma_f32_16x16x32_bf16 a[192:195], v[88:91], v[32:35], a[192:195]
ds_read_b64_tr_b16 v[68:69], v161 offset:0
v_mfma_f32_16x16x32_bf16 a[196:199], v[88:91], v[36:39], a[196:199]
ds_read_b64_tr_b16 v[70:71], v161 offset:4096
v_mfma_f32_16x16x32_bf16 a[200:203], v[88:91], v[40:43], a[200:203]
v_mfma_f32_16x16x32_bf16 a[204:207], v[88:91], v[44:47], a[204:207]
buffer_load_dwordx4 v170, s[4:7], s16 offen offset:2048 lds
v_mfma_f32_16x16x32_bf16 a[208:211], v[88:91], v[48:51], a[208:211]
ds_read_b128 v[12:15], v164 offset:6144
v_mfma_f32_16x16x32_bf16 a[212:215], v[88:91], v[52:55], a[212:215]
ds_read_b128 v[16:19], v164 offset:8192
v_mfma_f32_16x16x32_bf16 a[216:219], v[88:91], v[56:59], a[216:219]
ds_read_b128 v[20:23], v164 offset:10240
v_mfma_f32_16x16x32_bf16 a[220:223], v[88:91], v[60:63], a[220:223]
s_waitcnt lgkmcnt(10)
buffer_load_dwordx4 v171, s[4:7], s16 offen offset:3072 lds
v_mfma_f32_16x16x32_bf16 a[224:227], v[92:95], v[32:35], a[224:227]
ds_read_b64_tr_b16 v[72:73], v162 offset:0
v_mfma_f32_16x16x32_bf16 a[228:231], v[92:95], v[36:39], a[228:231]
ds_read_b64_tr_b16 v[74:75], v162 offset:4096
v_mfma_f32_16x16x32_bf16 a[232:235], v[92:95], v[40:43], a[232:235]
s_add_u32 m0, s19, 135168
s_add_u32 s16, s16, 65536
ds_read_b128 v[24:27], v164 offset:12288
v_mfma_f32_16x16x32_bf16 a[236:239], v[92:95], v[44:47], a[236:239]
buffer_load_dwordx4 v168, s[4:7], s16 offen offset:0 lds
v_mfma_f32_16x16x32_bf16 a[240:243], v[92:95], v[48:51], a[240:243]
ds_read_b128 v[28:31], v164 offset:14336
v_mfma_f32_16x16x32_bf16 a[244:247], v[92:95], v[52:55], a[244:247]
v_mfma_f32_16x16x32_bf16 a[248:251], v[92:95], v[56:59], a[248:251]
v_mfma_f32_16x16x32_bf16 a[252:255], v[92:95], v[60:63], a[252:255]
s_waitcnt lgkmcnt(11)
v_mfma_f32_16x16x32_bf16 a[128:131], v[64:67], v[0:3], a[128:131]
s_waitcnt lgkmcnt(10)
ds_read_b64_tr_b16 v[76:77], v163 offset:0
v_mfma_f32_16x16x32_bf16 a[132:135], v[64:67], v[4:7], a[132:135]
s_waitcnt lgkmcnt(10)
ds_read_b64_tr_b16 v[78:79], v163 offset:4096
v_mfma_f32_16x16x32_bf16 a[136:139], v[64:67], v[8:11], a[136:139]
s_waitcnt lgkmcnt(8)
v_mfma_f32_16x16x32_bf16 a[140:143], v[64:67], v[12:15], a[140:143]
s_waitcnt lgkmcnt(7)
buffer_load_dwordx4 v169, s[4:7], s16 offen offset:1024 lds
v_mfma_f32_16x16x32_bf16 a[144:147], v[64:67], v[16:19], a[144:147]
s_waitcnt lgkmcnt(6)
ds_read_b128 v[32:35], v165 offset:0
v_mfma_f32_16x16x32_bf16 a[148:151], v[64:67], v[20:23], a[148:151]
s_waitcnt lgkmcnt(4)
ds_read_b128 v[36:39], v165 offset:2048
v_mfma_f32_16x16x32_bf16 a[152:155], v[64:67], v[24:27], a[152:155]
s_waitcnt lgkmcnt(4)
ds_read_b128 v[40:43], v165 offset:4096
v_mfma_f32_16x16x32_bf16 a[156:159], v[64:67], v[28:31], a[156:159]
buffer_load_dwordx4 v170, s[4:7], s16 offen offset:2048 lds
v_mfma_f32_16x16x32_bf16 a[160:163], v[68:71], v[0:3], a[160:163]
ds_read_b64_tr_b16 v[80:81], v160 offset:8192
v_mfma_f32_16x16x32_bf16 a[164:167], v[68:71], v[4:7], a[164:167]
ds_read_b64_tr_b16 v[82:83], v160 offset:12288
v_mfma_f32_16x16x32_bf16 a[168:171], v[68:71], v[8:11], a[168:171]
v_mfma_f32_16x16x32_bf16 a[172:175], v[68:71], v[12:15], a[172:175]
buffer_load_dwordx4 v171, s[4:7], s16 offen offset:3072 lds
v_mfma_f32_16x16x32_bf16 a[176:179], v[68:71], v[16:19], a[176:179]
s_add_u32 s29, s29, 128
s_and_b32 s29, s29, 2047
ds_read_b128 v[44:47], v165 offset:6144
v_mfma_f32_16x16x32_bf16 a[180:183], v[68:71], v[20:23], a[180:183]
ds_read_b128 v[48:51], v165 offset:8192
v_mfma_f32_16x16x32_bf16 a[184:187], v[68:71], v[24:27], a[184:187]
ds_read_b128 v[52:55], v165 offset:10240
v_mfma_f32_16x16x32_bf16 a[188:191], v[68:71], v[28:31], a[188:191]
v_mfma_f32_16x16x32_bf16 a[192:195], v[72:75], v[0:3], a[192:195]
ds_read_b64_tr_b16 v[84:85], v161 offset:8192
v_mfma_f32_16x16x32_bf16 a[196:199], v[72:75], v[4:7], a[196:199]
ds_read_b64_tr_b16 v[86:87], v161 offset:12288
v_mfma_f32_16x16x32_bf16 a[200:203], v[72:75], v[8:11], a[200:203]
s_add_u32 m0, s35, 32768
s_xor_b32 s17, s33, s43
v_mfma_f32_16x16x32_bf16 a[204:207], v[72:75], v[12:15], a[204:207]
buffer_load_dwordx4 v172, s[8:11], s17 offen offset:0 lds
v_mfma_f32_16x16x32_bf16 a[208:211], v[72:75], v[16:19], a[208:211]
ds_read_b128 v[56:59], v165 offset:12288
v_mfma_f32_16x16x32_bf16 a[212:215], v[72:75], v[20:23], a[212:215]
ds_read_b128 v[60:63], v165 offset:14336
v_mfma_f32_16x16x32_bf16 a[216:219], v[72:75], v[24:27], a[216:219]
v_mfma_f32_16x16x32_bf16 a[220:223], v[72:75], v[28:31], a[220:223]
s_waitcnt lgkmcnt(12)
buffer_load_dwordx4 v173, s[8:11], s17 offen offset:1024 lds
v_mfma_f32_16x16x32_bf16 a[224:227], v[76:79], v[0:3], a[224:227]
s_add_u32 s33, s33, 65536
s_and_b32 s33, s33, 2097151
ds_read_b64_tr_b16 v[88:89], v162 offset:8192
v_mfma_f32_16x16x32_bf16 a[228:231], v[76:79], v[4:7], a[228:231]
ds_read_b64_tr_b16 v[90:91], v162 offset:12288
v_mfma_f32_16x16x32_bf16 a[232:235], v[76:79], v[8:11], a[232:235]
s_add_u32 m0, s35, 40960
s_xor_b32 s17, s33, s43
v_mfma_f32_16x16x32_bf16 a[236:239], v[76:79], v[12:15], a[236:239]
buffer_load_dwordx4 v172, s[8:11], s17 offen offset:0 lds
v_mfma_f32_16x16x32_bf16 a[240:243], v[76:79], v[16:19], a[240:243]
v_mfma_f32_16x16x32_bf16 a[244:247], v[76:79], v[20:23], a[244:247]
v_mfma_f32_16x16x32_bf16 a[248:251], v[76:79], v[24:27], a[248:251]
v_mfma_f32_16x16x32_bf16 a[252:255], v[76:79], v[28:31], a[252:255]
s_waitcnt lgkmcnt(9)
v_mfma_f32_16x16x32_bf16 a[128:131], v[80:83], v[32:35], a[128:131]
ds_read_b64_tr_b16 v[92:93], v163 offset:8192
v_mfma_f32_16x16x32_bf16 a[132:135], v[80:83], v[36:39], a[132:135]
ds_read_b64_tr_b16 v[94:95], v163 offset:12288
v_mfma_f32_16x16x32_bf16 a[136:139], v[80:83], v[40:43], a[136:139]
s_waitcnt lgkmcnt(10)
v_mfma_f32_16x16x32_bf16 a[140:143], v[80:83], v[44:47], a[140:143]
s_waitcnt lgkmcnt(9)
buffer_load_dwordx4 v173, s[8:11], s17 offen offset:1024 lds
v_mfma_f32_16x16x32_bf16 a[144:147], v[80:83], v[48:51], a[144:147]
s_waitcnt lgkmcnt(8)
s_add_u32 s33, s33, 65536
s_and_b32 s33, s33, 2097151
v_mfma_f32_16x16x32_bf16 a[148:151], v[80:83], v[52:55], a[148:151]
s_waitcnt lgkmcnt(5)
v_mfma_f32_16x16x32_bf16 a[152:155], v[80:83], v[56:59], a[152:155]
s_waitcnt lgkmcnt(4)
v_mfma_f32_16x16x32_bf16 a[156:159], v[80:83], v[60:63], a[156:159]
s_waitcnt vmcnt(12)
s_barrier
v_mfma_f32_16x16x32_bf16 a[160:163], v[84:87], v[32:35], a[160:163]
ds_read_b64_tr_b16 v[64:65], v160 offset:16384
v_mfma_f32_16x16x32_bf16 a[164:167], v[84:87], v[36:39], a[164:167]
ds_read_b64_tr_b16 v[66:67], v160 offset:20480
v_mfma_f32_16x16x32_bf16 a[168:171], v[84:87], v[40:43], a[168:171]
s_add_u32 m0, s19, 0
s_add_u32 s16, s28, s29
s_xor_b32 s16, s16, s42
v_mfma_f32_16x16x32_bf16 a[172:175], v[84:87], v[44:47], a[172:175]
buffer_load_dwordx4 v168, s[4:7], s16 offen offset:0 lds
v_mfma_f32_16x16x32_bf16 a[176:179], v[84:87], v[48:51], a[176:179]
ds_read_b128 v[0:3], v164 offset:32768
v_mfma_f32_16x16x32_bf16 a[180:183], v[84:87], v[52:55], a[180:183]
ds_read_b128 v[4:7], v164 offset:34816
v_mfma_f32_16x16x32_bf16 a[184:187], v[84:87], v[56:59], a[184:187]
ds_read_b128 v[8:11], v164 offset:36864
v_mfma_f32_16x16x32_bf16 a[188:191], v[84:87], v[60:63], a[188:191]
s_waitcnt lgkmcnt(7)
buffer_load_dwordx4 v169, s[4:7], s16 offen offset:1024 lds
v_mfma_f32_16x16x32_bf16 a[192:195], v[88:91], v[32:35], a[192:195]
ds_read_b64_tr_b16 v[68:69], v161 offset:16384
v_mfma_f32_16x16x32_bf16 a[196:199], v[88:91], v[36:39], a[196:199]
ds_read_b64_tr_b16 v[70:71], v161 offset:20480
v_mfma_f32_16x16x32_bf16 a[200:203], v[88:91], v[40:43], a[200:203]
v_mfma_f32_16x16x32_bf16 a[204:207], v[88:91], v[44:47], a[204:207]
buffer_load_dwordx4 v170, s[4:7], s16 offen offset:2048 lds
v_mfma_f32_16x16x32_bf16 a[208:211], v[88:91], v[48:51], a[208:211]
ds_read_b128 v[12:15], v164 offset:38912
v_mfma_f32_16x16x32_bf16 a[212:215], v[88:91], v[52:55], a[212:215]
ds_read_b128 v[16:19], v164 offset:40960
v_mfma_f32_16x16x32_bf16 a[216:219], v[88:91], v[56:59], a[216:219]
ds_read_b128 v[20:23], v164 offset:43008
v_mfma_f32_16x16x32_bf16 a[220:223], v[88:91], v[60:63], a[220:223]
s_waitcnt lgkmcnt(10)
buffer_load_dwordx4 v171, s[4:7], s16 offen offset:3072 lds
v_mfma_f32_16x16x32_bf16 a[224:227], v[92:95], v[32:35], a[224:227]
ds_read_b64_tr_b16 v[72:73], v162 offset:16384
v_mfma_f32_16x16x32_bf16 a[228:231], v[92:95], v[36:39], a[228:231]
ds_read_b64_tr_b16 v[74:75], v162 offset:20480
v_mfma_f32_16x16x32_bf16 a[232:235], v[92:95], v[40:43], a[232:235]
s_add_u32 m0, s19, 4096
s_add_u32 s16, s16, 65536
ds_read_b128 v[24:27], v164 offset:45056
v_mfma_f32_16x16x32_bf16 a[236:239], v[92:95], v[44:47], a[236:239]
buffer_load_dwordx4 v168, s[4:7], s16 offen offset:0 lds
v_mfma_f32_16x16x32_bf16 a[240:243], v[92:95], v[48:51], a[240:243]
ds_read_b128 v[28:31], v164 offset:47104
v_mfma_f32_16x16x32_bf16 a[244:247], v[92:95], v[52:55], a[244:247]
v_mfma_f32_16x16x32_bf16 a[248:251], v[92:95], v[56:59], a[248:251]
v_mfma_f32_16x16x32_bf16 a[252:255], v[92:95], v[60:63], a[252:255]
s_waitcnt lgkmcnt(11)
v_mfma_f32_16x16x32_bf16 a[128:131], v[64:67], v[0:3], a[128:131]
s_waitcnt lgkmcnt(10)
ds_read_b64_tr_b16 v[76:77], v163 offset:16384
v_mfma_f32_16x16x32_bf16 a[132:135], v[64:67], v[4:7], a[132:135]
s_waitcnt lgkmcnt(10)
ds_read_b64_tr_b16 v[78:79], v163 offset:20480
v_mfma_f32_16x16x32_bf16 a[136:139], v[64:67], v[8:11], a[136:139]
s_waitcnt lgkmcnt(8)
v_mfma_f32_16x16x32_bf16 a[140:143], v[64:67], v[12:15], a[140:143]
s_waitcnt lgkmcnt(7)
buffer_load_dwordx4 v169, s[4:7], s16 offen offset:1024 lds
v_mfma_f32_16x16x32_bf16 a[144:147], v[64:67], v[16:19], a[144:147]
s_waitcnt lgkmcnt(6)
ds_read_b128 v[32:35], v165 offset:32768
v_mfma_f32_16x16x32_bf16 a[148:151], v[64:67], v[20:23], a[148:151]
s_waitcnt lgkmcnt(4)
ds_read_b128 v[36:39], v165 offset:34816
v_mfma_f32_16x16x32_bf16 a[152:155], v[64:67], v[24:27], a[152:155]
s_waitcnt lgkmcnt(4)
ds_read_b128 v[40:43], v165 offset:36864
v_mfma_f32_16x16x32_bf16 a[156:159], v[64:67], v[28:31], a[156:159]
buffer_load_dwordx4 v170, s[4:7], s16 offen offset:2048 lds
v_mfma_f32_16x16x32_bf16 a[160:163], v[68:71], v[0:3], a[160:163]
ds_read_b64_tr_b16 v[80:81], v160 offset:24576
v_mfma_f32_16x16x32_bf16 a[164:167], v[68:71], v[4:7], a[164:167]
ds_read_b64_tr_b16 v[82:83], v160 offset:28672
v_mfma_f32_16x16x32_bf16 a[168:171], v[68:71], v[8:11], a[168:171]
v_mfma_f32_16x16x32_bf16 a[172:175], v[68:71], v[12:15], a[172:175]
buffer_load_dwordx4 v171, s[4:7], s16 offen offset:3072 lds
v_mfma_f32_16x16x32_bf16 a[176:179], v[68:71], v[16:19], a[176:179]
s_add_u32 s29, s29, 128
s_and_b32 s29, s29, 2047
ds_read_b128 v[44:47], v165 offset:38912
v_mfma_f32_16x16x32_bf16 a[180:183], v[68:71], v[20:23], a[180:183]
ds_read_b128 v[48:51], v165 offset:40960
v_mfma_f32_16x16x32_bf16 a[184:187], v[68:71], v[24:27], a[184:187]
ds_read_b128 v[52:55], v165 offset:43008
v_mfma_f32_16x16x32_bf16 a[188:191], v[68:71], v[28:31], a[188:191]
v_mfma_f32_16x16x32_bf16 a[192:195], v[72:75], v[0:3], a[192:195]
ds_read_b64_tr_b16 v[84:85], v161 offset:24576
v_mfma_f32_16x16x32_bf16 a[196:199], v[72:75], v[4:7], a[196:199]
ds_read_b64_tr_b16 v[86:87], v161 offset:28672
v_mfma_f32_16x16x32_bf16 a[200:203], v[72:75], v[8:11], a[200:203]
s_add_u32 m0, s35, 49152
s_xor_b32 s17, s33, s43
v_mfma_f32_16x16x32_bf16 a[204:207], v[72:75], v[12:15], a[204:207]
buffer_load_dwordx4 v172, s[8:11], s17 offen offset:0 lds
v_mfma_f32_16x16x32_bf16 a[208:211], v[72:75], v[16:19], a[208:211]
ds_read_b128 v[56:59], v165 offset:45056
v_mfma_f32_16x16x32_bf16 a[212:215], v[72:75], v[20:23], a[212:215]
ds_read_b128 v[60:63], v165 offset:47104
v_mfma_f32_16x16x32_bf16 a[216:219], v[72:75], v[24:27], a[216:219]
v_mfma_f32_16x16x32_bf16 a[220:223], v[72:75], v[28:31], a[220:223]
s_waitcnt lgkmcnt(12)
buffer_load_dwordx4 v173, s[8:11], s17 offen offset:1024 lds
v_mfma_f32_16x16x32_bf16 a[224:227], v[76:79], v[0:3], a[224:227]
s_add_u32 s33, s33, 65536
s_and_b32 s33, s33, 2097151
ds_read_b64_tr_b16 v[88:89], v162 offset:24576
v_mfma_f32_16x16x32_bf16 a[228:231], v[76:79], v[4:7], a[228:231]
ds_read_b64_tr_b16 v[90:91], v162 offset:28672
v_mfma_f32_16x16x32_bf16 a[232:235], v[76:79], v[8:11], a[232:235]
s_add_u32 m0, s35, 57344
s_xor_b32 s17, s33, s43
v_mfma_f32_16x16x32_bf16 a[236:239], v[76:79], v[12:15], a[236:239]
buffer_load_dwordx4 v172, s[8:11], s17 offen offset:0 lds
v_mfma_f32_16x16x32_bf16 a[240:243], v[76:79], v[16:19], a[240:243]
v_mfma_f32_16x16x32_bf16 a[244:247], v[76:79], v[20:23], a[244:247]
v_mfma_f32_16x16x32_bf16 a[248:251], v[76:79], v[24:27], a[248:251]
v_mfma_f32_16x16x32_bf16 a[252:255], v[76:79], v[28:31], a[252:255]
s_waitcnt lgkmcnt(9)
v_mfma_f32_16x16x32_bf16 a[128:131], v[80:83], v[32:35], a[128:131]
ds_read_b64_tr_b16 v[92:93], v163 offset:24576
v_mfma_f32_16x16x32_bf16 a[132:135], v[80:83], v[36:39], a[132:135]
ds_read_b64_tr_b16 v[94:95], v163 offset:28672
v_mfma_f32_16x16x32_bf16 a[136:139], v[80:83], v[40:43], a[136:139]
s_waitcnt lgkmcnt(10)
v_mfma_f32_16x16x32_bf16 a[140:143], v[80:83], v[44:47], a[140:143]
s_waitcnt lgkmcnt(9)
buffer_load_dwordx4 v173, s[8:11], s17 offen offset:1024 lds
v_mfma_f32_16x16x32_bf16 a[144:147], v[80:83], v[48:51], a[144:147]
s_waitcnt lgkmcnt(8)
s_add_u32 s33, s33, 65536
s_and_b32 s33, s33, 2097151
v_mfma_f32_16x16x32_bf16 a[148:151], v[80:83], v[52:55], a[148:151]
s_waitcnt lgkmcnt(5)
v_mfma_f32_16x16x32_bf16 a[152:155], v[80:83], v[56:59], a[152:155]
s_waitcnt lgkmcnt(4)
v_mfma_f32_16x16x32_bf16 a[156:159], v[80:83], v[60:63], a[156:159]
s_waitcnt vmcnt(12)
s_barrier
v_mfma_f32_16x16x32_bf16 a[160:163], v[84:87], v[32:35], a[160:163]
ds_read_b64_tr_b16 v[64:65], v160 offset:32768
v_mfma_f32_16x16x32_bf16 a[164:167], v[84:87], v[36:39], a[164:167]
ds_read_b64_tr_b16 v[66:67], v160 offset:36864
v_mfma_f32_16x16x32_bf16 a[168:171], v[84:87], v[40:43], a[168:171]
s_add_u32 m0, s19, 32768
s_add_u32 s16, s28, s29
s_xor_b32 s16, s16, s42
v_mfma_f32_16x16x32_bf16 a[172:175], v[84:87], v[44:47], a[172:175]
buffer_load_dwordx4 v168, s[4:7], s16 offen offset:0 lds
v_mfma_f32_16x16x32_bf16 a[176:179], v[84:87], v[48:51], a[176:179]
ds_read_b128 v[0:3], v166 offset:0
v_mfma_f32_16x16x32_bf16 a[180:183], v[84:87], v[52:55], a[180:183]
ds_read_b128 v[4:7], v166 offset:2048
v_mfma_f32_16x16x32_bf16 a[184:187], v[84:87], v[56:59], a[184:187]
ds_read_b128 v[8:11], v166 offset:4096
v_mfma_f32_16x16x32_bf16 a[188:191], v[84:87], v[60:63], a[188:191]
s_waitcnt lgkmcnt(7)
buffer_load_dwordx4 v169, s[4:7], s16 offen offset:1024 lds
v_mfma_f32_16x16x32_bf16 a[192:195], v[88:91], v[32:35], a[192:195]
ds_read_b64_tr_b16 v[68:69], v161 offset:32768
v_mfma_f32_16x16x32_bf16 a[196:199], v[88:91], v[36:39], a[196:199]
ds_read_b64_tr_b16 v[70:71], v161 offset:36864
v_mfma_f32_16x16x32_bf16 a[200:203], v[88:91], v[40:43], a[200:203]
v_mfma_f32_16x16x32_bf16 a[204:207], v[88:91], v[44:47], a[204:207]
buffer_load_dwordx4 v170, s[4:7], s16 offen offset:2048 lds
v_mfma_f32_16x16x32_bf16 a[208:211], v[88:91], v[48:51], a[208:211]
ds_read_b128 v[12:15], v166 offset:6144
v_mfma_f32_16x16x32_bf16 a[212:215], v[88:91], v[52:55], a[212:215]
ds_read_b128 v[16:19], v166 offset:8192
v_mfma_f32_16x16x32_bf16 a[216:219], v[88:91], v[56:59], a[216:219]
ds_read_b128 v[20:23], v166 offset:10240
v_mfma_f32_16x16x32_bf16 a[220:223], v[88:91], v[60:63], a[220:223]
s_waitcnt lgkmcnt(10)
buffer_load_dwordx4 v171, s[4:7], s16 offen offset:3072 lds
v_mfma_f32_16x16x32_bf16 a[224:227], v[92:95], v[32:35], a[224:227]
ds_read_b64_tr_b16 v[72:73], v162 offset:32768
v_mfma_f32_16x16x32_bf16 a[228:231], v[92:95], v[36:39], a[228:231]
ds_read_b64_tr_b16 v[74:75], v162 offset:36864
v_mfma_f32_16x16x32_bf16 a[232:235], v[92:95], v[40:43], a[232:235]
s_add_u32 m0, s19, 36864
s_add_u32 s16, s16, 65536
ds_read_b128 v[24:27], v166 offset:12288
v_mfma_f32_16x16x32_bf16 a[236:239], v[92:95], v[44:47], a[236:239]
buffer_load_dwordx4 v168, s[4:7], s16 offen offset:0 lds
v_mfma_f32_16x16x32_bf16 a[240:243], v[92:95], v[48:51], a[240:243]
ds_read_b128 v[28:31], v166 offset:14336
v_mfma_f32_16x16x32_bf16 a[244:247], v[92:95], v[52:55], a[244:247]
v_mfma_f32_16x16x32_bf16 a[248:251], v[92:95], v[56:59], a[248:251]
v_mfma_f32_16x16x32_bf16 a[252:255], v[92:95], v[60:63], a[252:255]
s_waitcnt lgkmcnt(11)
v_mfma_f32_16x16x32_bf16 a[128:131], v[64:67], v[0:3], a[128:131]
s_waitcnt lgkmcnt(10)
ds_read_b64_tr_b16 v[76:77], v163 offset:32768
v_mfma_f32_16x16x32_bf16 a[132:135], v[64:67], v[4:7], a[132:135]
s_waitcnt lgkmcnt(10)
ds_read_b64_tr_b16 v[78:79], v163 offset:36864
v_mfma_f32_16x16x32_bf16 a[136:139], v[64:67], v[8:11], a[136:139]
s_waitcnt lgkmcnt(8)
v_mfma_f32_16x16x32_bf16 a[140:143], v[64:67], v[12:15], a[140:143]
s_waitcnt lgkmcnt(7)
buffer_load_dwordx4 v169, s[4:7], s16 offen offset:1024 lds
v_mfma_f32_16x16x32_bf16 a[144:147], v[64:67], v[16:19], a[144:147]
s_waitcnt lgkmcnt(6)
ds_read_b128 v[32:35], v167 offset:0
v_mfma_f32_16x16x32_bf16 a[148:151], v[64:67], v[20:23], a[148:151]
s_waitcnt lgkmcnt(4)
ds_read_b128 v[36:39], v167 offset:2048
v_mfma_f32_16x16x32_bf16 a[152:155], v[64:67], v[24:27], a[152:155]
s_waitcnt lgkmcnt(4)
ds_read_b128 v[40:43], v167 offset:4096
v_mfma_f32_16x16x32_bf16 a[156:159], v[64:67], v[28:31], a[156:159]
buffer_load_dwordx4 v170, s[4:7], s16 offen offset:2048 lds
v_mfma_f32_16x16x32_bf16 a[160:163], v[68:71], v[0:3], a[160:163]
ds_read_b64_tr_b16 v[80:81], v160 offset:40960
v_mfma_f32_16x16x32_bf16 a[164:167], v[68:71], v[4:7], a[164:167]
ds_read_b64_tr_b16 v[82:83], v160 offset:45056
v_mfma_f32_16x16x32_bf16 a[168:171], v[68:71], v[8:11], a[168:171]
v_mfma_f32_16x16x32_bf16 a[172:175], v[68:71], v[12:15], a[172:175]
buffer_load_dwordx4 v171, s[4:7], s16 offen offset:3072 lds
v_mfma_f32_16x16x32_bf16 a[176:179], v[68:71], v[16:19], a[176:179]
s_add_u32 s29, s29, 128
s_and_b32 s29, s29, 2047
ds_read_b128 v[44:47], v167 offset:6144
v_mfma_f32_16x16x32_bf16 a[180:183], v[68:71], v[20:23], a[180:183]
ds_read_b128 v[48:51], v167 offset:8192
v_mfma_f32_16x16x32_bf16 a[184:187], v[68:71], v[24:27], a[184:187]
ds_read_b128 v[52:55], v167 offset:10240
v_mfma_f32_16x16x32_bf16 a[188:191], v[68:71], v[28:31], a[188:191]
v_mfma_f32_16x16x32_bf16 a[192:195], v[72:75], v[0:3], a[192:195]
ds_read_b64_tr_b16 v[84:85], v161 offset:40960
v_mfma_f32_16x16x32_bf16 a[196:199], v[72:75], v[4:7], a[196:199]
ds_read_b64_tr_b16 v[86:87], v161 offset:45056
v_mfma_f32_16x16x32_bf16 a[200:203], v[72:75], v[8:11], a[200:203]
s_add_u32 m0, s35, 0
s_xor_b32 s17, s33, s43
v_mfma_f32_16x16x32_bf16 a[204:207], v[72:75], v[12:15], a[204:207]
buffer_load_dwordx4 v172, s[8:11], s17 offen offset:0 lds
v_mfma_f32_16x16x32_bf16 a[208:211], v[72:75], v[16:19], a[208:211]
ds_read_b128 v[56:59], v167 offset:12288
v_mfma_f32_16x16x32_bf16 a[212:215], v[72:75], v[20:23], a[212:215]
ds_read_b128 v[60:63], v167 offset:14336
v_mfma_f32_16x16x32_bf16 a[216:219], v[72:75], v[24:27], a[216:219]
v_mfma_f32_16x16x32_bf16 a[220:223], v[72:75], v[28:31], a[220:223]
s_waitcnt lgkmcnt(12)
buffer_load_dwordx4 v173, s[8:11], s17 offen offset:1024 lds
v_mfma_f32_16x16x32_bf16 a[224:227], v[76:79], v[0:3], a[224:227]
s_add_u32 s33, s33, 65536
s_and_b32 s33, s33, 2097151
ds_read_b64_tr_b16 v[88:89], v162 offset:40960
v_mfma_f32_16x16x32_bf16 a[228:231], v[76:79], v[4:7], a[228:231]
ds_read_b64_tr_b16 v[90:91], v162 offset:45056
v_mfma_f32_16x16x32_bf16 a[232:235], v[76:79], v[8:11], a[232:235]
s_add_u32 m0, s35, 8192
s_xor_b32 s17, s33, s43
v_mfma_f32_16x16x32_bf16 a[236:239], v[76:79], v[12:15], a[236:239]
buffer_load_dwordx4 v172, s[8:11], s17 offen offset:0 lds
v_mfma_f32_16x16x32_bf16 a[240:243], v[76:79], v[16:19], a[240:243]
v_mfma_f32_16x16x32_bf16 a[244:247], v[76:79], v[20:23], a[244:247]
v_mfma_f32_16x16x32_bf16 a[248:251], v[76:79], v[24:27], a[248:251]
v_mfma_f32_16x16x32_bf16 a[252:255], v[76:79], v[28:31], a[252:255]
s_waitcnt lgkmcnt(9)
v_mfma_f32_16x16x32_bf16 a[128:131], v[80:83], v[32:35], a[128:131]
ds_read_b64_tr_b16 v[92:93], v163 offset:40960
v_mfma_f32_16x16x32_bf16 a[132:135], v[80:83], v[36:39], a[132:135]
ds_read_b64_tr_b16 v[94:95], v163 offset:45056
v_mfma_f32_16x16x32_bf16 a[136:139], v[80:83], v[40:43], a[136:139]
s_waitcnt lgkmcnt(10)
v_mfma_f32_16x16x32_bf16 a[140:143], v[80:83], v[44:47], a[140:143]
s_waitcnt lgkmcnt(9)
buffer_load_dwordx4 v173, s[8:11], s17 offen offset:1024 lds
v_mfma_f32_16x16x32_bf16 a[144:147], v[80:83], v[48:51], a[144:147]
s_waitcnt lgkmcnt(8)
s_add_u32 s33, s33, 65536
s_and_b32 s33, s33, 2097151
v_mfma_f32_16x16x32_bf16 a[148:151], v[80:83], v[52:55], a[148:151]
s_waitcnt lgkmcnt(5)
v_mfma_f32_16x16x32_bf16 a[152:155], v[80:83], v[56:59], a[152:155]
s_waitcnt lgkmcnt(4)
v_mfma_f32_16x16x32_bf16 a[156:159], v[80:83], v[60:63], a[156:159]
s_waitcnt vmcnt(12)
s_barrier
v_mfma_f32_16x16x32_bf16 a[160:163], v[84:87], v[32:35], a[160:163]
ds_read_b64_tr_b16 v[64:65], v160 offset:49152
v_mfma_f32_16x16x32_bf16 a[164:167], v[84:87], v[36:39], a[164:167]
ds_read_b64_tr_b16 v[66:67], v160 offset:53248
v_mfma_f32_16x16x32_bf16 a[168:171], v[84:87], v[40:43], a[168:171]
s_add_u32 m0, s19, 131072
s_add_u32 s16, s28, s29
s_xor_b32 s16, s16, s42
v_mfma_f32_16x16x32_bf16 a[172:175], v[84:87], v[44:47], a[172:175]
buffer_load_dwordx4 v168, s[4:7], s16 offen offset:0 lds
v_mfma_f32_16x16x32_bf16 a[176:179], v[84:87], v[48:51], a[176:179]
ds_read_b128 v[0:3], v164 offset:0
v_mfma_f32_16x16x32_bf16 a[180:183], v[84:87], v[52:55], a[180:183]
ds_read_b128 v[4:7], v164 offset:2048
v_mfma_f32_16x16x32_bf16 a[184:187], v[84:87], v[56:59], a[184:187]
ds_read_b128 v[8:11], v164 offset:4096
v_mfma_f32_16x16x32_bf16 a[188:191], v[84:87], v[60:63], a[188:191]
s_waitcnt lgkmcnt(7)
buffer_load_dwordx4 v169, s[4:7], s16 offen offset:1024 lds
v_mfma_f32_16x16x32_bf16 a[192:195], v[88:91], v[32:35], a[192:195]
ds_read_b64_tr_b16 v[68:69], v161 offset:49152
v_mfma_f32_16x16x32_bf16 a[196:199], v[88:91], v[36:39], a[196:199]
ds_read_b64_tr_b16 v[70:71], v161 offset:53248
v_mfma_f32_16x16x32_bf16 a[200:203], v[88:91], v[40:43], a[200:203]
v_mfma_f32_16x16x32_bf16 a[204:207], v[88:91], v[44:47], a[204:207]
buffer_load_dwordx4 v170, s[4:7], s16 offen offset:2048 lds
v_mfma_f32_16x16x32_bf16 a[208:211], v[88:91], v[48:51], a[208:211]
ds_read_b128 v[12:15], v164 offset:6144
v_mfma_f32_16x16x32_bf16 a[212:215], v[88:91], v[52:55], a[212:215]
ds_read_b128 v[16:19], v164 offset:8192
v_mfma_f32_16x16x32_bf16 a[216:219], v[88:91], v[56:59], a[216:219]
ds_read_b128 v[20:23], v164 offset:10240
v_mfma_f32_16x16x32_bf16 a[220:223], v[88:91], v[60:63], a[220:223]
s_waitcnt lgkmcnt(10)
buffer_load_dwordx4 v171, s[4:7], s16 offen offset:3072 lds
v_mfma_f32_16x16x32_bf16 a[224:227], v[92:95], v[32:35], a[224:227]
ds_read_b64_tr_b16 v[72:73], v162 offset:49152
v_mfma_f32_16x16x32_bf16 a[228:231], v[92:95], v[36:39], a[228:231]
ds_read_b64_tr_b16 v[74:75], v162 offset:53248
v_mfma_f32_16x16x32_bf16 a[232:235], v[92:95], v[40:43], a[232:235]
s_add_u32 m0, s19, 135168
s_add_u32 s16, s16, 65536
ds_read_b128 v[24:27], v164 offset:12288
v_mfma_f32_16x16x32_bf16 a[236:239], v[92:95], v[44:47], a[236:239]
buffer_load_dwordx4 v168, s[4:7], s16 offen offset:0 lds
v_mfma_f32_16x16x32_bf16 a[240:243], v[92:95], v[48:51], a[240:243]
ds_read_b128 v[28:31], v164 offset:14336
v_mfma_f32_16x16x32_bf16 a[244:247], v[92:95], v[52:55], a[244:247]
v_mfma_f32_16x16x32_bf16 a[248:251], v[92:95], v[56:59], a[248:251]
v_mfma_f32_16x16x32_bf16 a[252:255], v[92:95], v[60:63], a[252:255]
s_waitcnt lgkmcnt(11)
v_mfma_f32_16x16x32_bf16 a[128:131], v[64:67], v[0:3], a[128:131]
s_waitcnt lgkmcnt(10)
ds_read_b64_tr_b16 v[76:77], v163 offset:49152
v_mfma_f32_16x16x32_bf16 a[132:135], v[64:67], v[4:7], a[132:135]
s_waitcnt lgkmcnt(10)
ds_read_b64_tr_b16 v[78:79], v163 offset:53248
v_mfma_f32_16x16x32_bf16 a[136:139], v[64:67], v[8:11], a[136:139]
s_waitcnt lgkmcnt(8)
v_mfma_f32_16x16x32_bf16 a[140:143], v[64:67], v[12:15], a[140:143]
s_waitcnt lgkmcnt(7)
buffer_load_dwordx4 v169, s[4:7], s16 offen offset:1024 lds
v_mfma_f32_16x16x32_bf16 a[144:147], v[64:67], v[16:19], a[144:147]
s_waitcnt lgkmcnt(6)
ds_read_b128 v[32:35], v165 offset:0
v_mfma_f32_16x16x32_bf16 a[148:151], v[64:67], v[20:23], a[148:151]
s_waitcnt lgkmcnt(4)
ds_read_b128 v[36:39], v165 offset:2048
v_mfma_f32_16x16x32_bf16 a[152:155], v[64:67], v[24:27], a[152:155]
s_waitcnt lgkmcnt(4)
ds_read_b128 v[40:43], v165 offset:4096
v_mfma_f32_16x16x32_bf16 a[156:159], v[64:67], v[28:31], a[156:159]
buffer_load_dwordx4 v170, s[4:7], s16 offen offset:2048 lds
v_mfma_f32_16x16x32_bf16 a[160:163], v[68:71], v[0:3], a[160:163]
ds_read_b64_tr_b16 v[80:81], v160 offset:57344
v_mfma_f32_16x16x32_bf16 a[164:167], v[68:71], v[4:7], a[164:167]
ds_read_b64_tr_b16 v[82:83], v160 offset:61440
v_mfma_f32_16x16x32_bf16 a[168:171], v[68:71], v[8:11], a[168:171]
v_mfma_f32_16x16x32_bf16 a[172:175], v[68:71], v[12:15], a[172:175]
buffer_load_dwordx4 v171, s[4:7], s16 offen offset:3072 lds
v_mfma_f32_16x16x32_bf16 a[176:179], v[68:71], v[16:19], a[176:179]
s_add_u32 s29, s29, 128
s_and_b32 s29, s29, 2047
ds_read_b128 v[44:47], v165 offset:6144
v_mfma_f32_16x16x32_bf16 a[180:183], v[68:71], v[20:23], a[180:183]
ds_read_b128 v[48:51], v165 offset:8192
v_mfma_f32_16x16x32_bf16 a[184:187], v[68:71], v[24:27], a[184:187]
ds_read_b128 v[52:55], v165 offset:10240
v_mfma_f32_16x16x32_bf16 a[188:191], v[68:71], v[28:31], a[188:191]
v_mfma_f32_16x16x32_bf16 a[192:195], v[72:75], v[0:3], a[192:195]
ds_read_b64_tr_b16 v[84:85], v161 offset:57344
v_mfma_f32_16x16x32_bf16 a[196:199], v[72:75], v[4:7], a[196:199]
ds_read_b64_tr_b16 v[86:87], v161 offset:61440
v_mfma_f32_16x16x32_bf16 a[200:203], v[72:75], v[8:11], a[200:203]
s_add_u32 m0, s35, 16384
s_xor_b32 s17, s33, s43
v_mfma_f32_16x16x32_bf16 a[204:207], v[72:75], v[12:15], a[204:207]
buffer_load_dwordx4 v172, s[8:11], s17 offen offset:0 lds
v_mfma_f32_16x16x32_bf16 a[208:211], v[72:75], v[16:19], a[208:211]
ds_read_b128 v[56:59], v165 offset:12288
v_mfma_f32_16x16x32_bf16 a[212:215], v[72:75], v[20:23], a[212:215]
ds_read_b128 v[60:63], v165 offset:14336
v_mfma_f32_16x16x32_bf16 a[216:219], v[72:75], v[24:27], a[216:219]
v_mfma_f32_16x16x32_bf16 a[220:223], v[72:75], v[28:31], a[220:223]
s_waitcnt lgkmcnt(12)
buffer_load_dwordx4 v173, s[8:11], s17 offen offset:1024 lds
v_mfma_f32_16x16x32_bf16 a[224:227], v[76:79], v[0:3], a[224:227]
s_add_u32 s33, s33, 65536
s_and_b32 s33, s33, 2097151
ds_read_b64_tr_b16 v[88:89], v162 offset:57344
v_mfma_f32_16x16x32_bf16 a[228:231], v[76:79], v[4:7], a[228:231]
ds_read_b64_tr_b16 v[90:91], v162 offset:61440
v_mfma_f32_16x16x32_bf16 a[232:235], v[76:79], v[8:11], a[232:235]
s_add_u32 m0, s35, 24576
s_xor_b32 s17, s33, s43
v_mfma_f32_16x16x32_bf16 a[236:239], v[76:79], v[12:15], a[236:239]
buffer_load_dwordx4 v172, s[8:11], s17 offen offset:0 lds
v_mfma_f32_16x16x32_bf16 a[240:243], v[76:79], v[16:19], a[240:243]
v_mfma_f32_16x16x32_bf16 a[244:247], v[76:79], v[20:23], a[244:247]
v_mfma_f32_16x16x32_bf16 a[248:251], v[76:79], v[24:27], a[248:251]
v_mfma_f32_16x16x32_bf16 a[252:255], v[76:79], v[28:31], a[252:255]
s_waitcnt lgkmcnt(9)
v_mfma_f32_16x16x32_bf16 a[128:131], v[80:83], v[32:35], a[128:131]
ds_read_b64_tr_b16 v[92:93], v163 offset:57344
v_mfma_f32_16x16x32_bf16 a[132:135], v[80:83], v[36:39], a[132:135]
ds_read_b64_tr_b16 v[94:95], v163 offset:61440
v_mfma_f32_16x16x32_bf16 a[136:139], v[80:83], v[40:43], a[136:139]
s_waitcnt lgkmcnt(10)
v_mfma_f32_16x16x32_bf16 a[140:143], v[80:83], v[44:47], a[140:143]
s_waitcnt lgkmcnt(9)
buffer_load_dwordx4 v173, s[8:11], s17 offen offset:1024 lds
v_mfma_f32_16x16x32_bf16 a[144:147], v[80:83], v[48:51], a[144:147]
s_waitcnt lgkmcnt(8)
s_add_u32 s33, s33, 65536
s_and_b32 s33, s33, 2097151
v_mfma_f32_16x16x32_bf16 a[148:151], v[80:83], v[52:55], a[148:151]
s_waitcnt lgkmcnt(5)
v_mfma_f32_16x16x32_bf16 a[152:155], v[80:83], v[56:59], a[152:155]
s_waitcnt lgkmcnt(4)
v_mfma_f32_16x16x32_bf16 a[156:159], v[80:83], v[60:63], a[156:159]
s_waitcnt vmcnt(12)
s_barrier
v_mfma_f32_16x16x32_bf16 a[160:163], v[84:87], v[32:35], a[160:163]
ds_read_b64_tr_b16 v[64:65], v160 offset:0
v_mfma_f32_16x16x32_bf16 a[164:167], v[84:87], v[36:39], a[164:167]
ds_read_b64_tr_b16 v[66:67], v160 offset:4096
v_mfma_f32_16x16x32_bf16 a[168:171], v[84:87], v[40:43], a[168:171]
s_add_u32 m0, s19, 0
s_add_u32 s16, s28, s29
s_xor_b32 s16, s16, s42
v_mfma_f32_16x16x32_bf16 a[172:175], v[84:87], v[44:47], a[172:175]
buffer_load_dwordx4 v168, s[4:7], s16 offen offset:0 lds
v_mfma_f32_16x16x32_bf16 a[176:179], v[84:87], v[48:51], a[176:179]
ds_read_b128 v[0:3], v164 offset:32768
v_mfma_f32_16x16x32_bf16 a[180:183], v[84:87], v[52:55], a[180:183]
ds_read_b128 v[4:7], v164 offset:34816
v_mfma_f32_16x16x32_bf16 a[184:187], v[84:87], v[56:59], a[184:187]
ds_read_b128 v[8:11], v164 offset:36864
v_mfma_f32_16x16x32_bf16 a[188:191], v[84:87], v[60:63], a[188:191]
s_waitcnt lgkmcnt(7)
buffer_load_dwordx4 v169, s[4:7], s16 offen offset:1024 lds
v_mfma_f32_16x16x32_bf16 a[192:195], v[88:91], v[32:35], a[192:195]
ds_read_b64_tr_b16 v[68:69], v161 offset:0
v_mfma_f32_16x16x32_bf16 a[196:199], v[88:91], v[36:39], a[196:199]
ds_read_b64_tr_b16 v[70:71], v161 offset:4096
v_mfma_f32_16x16x32_bf16 a[200:203], v[88:91], v[40:43], a[200:203]
v_mfma_f32_16x16x32_bf16 a[204:207], v[88:91], v[44:47], a[204:207]
buffer_load_dwordx4 v170, s[4:7], s16 offen offset:2048 lds
v_mfma_f32_16x16x32_bf16 a[208:211], v[88:91], v[48:51], a[208:211]
ds_read_b128 v[12:15], v164 offset:38912
v_mfma_f32_16x16x32_bf16 a[212:215], v[88:91], v[52:55], a[212:215]
ds_read_b128 v[16:19], v164 offset:40960
v_mfma_f32_16x16x32_bf16 a[216:219], v[88:91], v[56:59], a[216:219]
ds_read_b128 v[20:23], v164 offset:43008
v_mfma_f32_16x16x32_bf16 a[220:223], v[88:91], v[60:63], a[220:223]
s_waitcnt lgkmcnt(10)
buffer_load_dwordx4 v171, s[4:7], s16 offen offset:3072 lds
v_mfma_f32_16x16x32_bf16 a[224:227], v[92:95], v[32:35], a[224:227]
ds_read_b64_tr_b16 v[72:73], v162 offset:0
v_mfma_f32_16x16x32_bf16 a[228:231], v[92:95], v[36:39], a[228:231]
ds_read_b64_tr_b16 v[74:75], v162 offset:4096
v_mfma_f32_16x16x32_bf16 a[232:235], v[92:95], v[40:43], a[232:235]
s_add_u32 m0, s19, 4096
s_add_u32 s16, s16, 65536
ds_read_b128 v[24:27], v164 offset:45056
v_mfma_f32_16x16x32_bf16 a[236:239], v[92:95], v[44:47], a[236:239]
buffer_load_dwordx4 v168, s[4:7], s16 offen offset:0 lds
v_mfma_f32_16x16x32_bf16 a[240:243], v[92:95], v[48:51], a[240:243]
ds_read_b128 v[28:31], v164 offset:47104
v_mfma_f32_16x16x32_bf16 a[244:247], v[92:95], v[52:55], a[244:247]
v_mfma_f32_16x16x32_bf16 a[248:251], v[92:95], v[56:59], a[248:251]
v_mfma_f32_16x16x32_bf16 a[252:255], v[92:95], v[60:63], a[252:255]
s_waitcnt lgkmcnt(11)
buffer_load_dword v175, v174, s[52:55], s56 offen
v_mfma_f32_16x16x32_bf16 a[128:131], v[64:67], v[0:3], a[128:131]
s_waitcnt lgkmcnt(10)
ds_read_b64_tr_b16 v[76:77], v163 offset:0
v_mfma_f32_16x16x32_bf16 a[132:135], v[64:67], v[4:7], a[132:135]
s_waitcnt lgkmcnt(10)
ds_read_b64_tr_b16 v[78:79], v163 offset:4096
v_mfma_f32_16x16x32_bf16 a[136:139], v[64:67], v[8:11], a[136:139]
s_waitcnt lgkmcnt(8)
v_mfma_f32_16x16x32_bf16 a[140:143], v[64:67], v[12:15], a[140:143]
s_waitcnt lgkmcnt(7)
buffer_load_dwordx4 v169, s[4:7], s16 offen offset:1024 lds
v_mfma_f32_16x16x32_bf16 a[144:147], v[64:67], v[16:19], a[144:147]
s_waitcnt lgkmcnt(6)
ds_read_b128 v[32:35], v165 offset:32768
v_mfma_f32_16x16x32_bf16 a[148:151], v[64:67], v[20:23], a[148:151]
s_waitcnt lgkmcnt(4)
ds_read_b128 v[36:39], v165 offset:34816
v_mfma_f32_16x16x32_bf16 a[152:155], v[64:67], v[24:27], a[152:155]
s_waitcnt lgkmcnt(4)
ds_read_b128 v[40:43], v165 offset:36864
v_mfma_f32_16x16x32_bf16 a[156:159], v[64:67], v[28:31], a[156:159]
buffer_load_dwordx4 v170, s[4:7], s16 offen offset:2048 lds
v_mfma_f32_16x16x32_bf16 a[160:163], v[68:71], v[0:3], a[160:163]
ds_read_b64_tr_b16 v[80:81], v160 offset:8192
v_mfma_f32_16x16x32_bf16 a[164:167], v[68:71], v[4:7], a[164:167]
ds_read_b64_tr_b16 v[82:83], v160 offset:12288
v_mfma_f32_16x16x32_bf16 a[168:171], v[68:71], v[8:11], a[168:171]
v_mfma_f32_16x16x32_bf16 a[172:175], v[68:71], v[12:15], a[172:175]
buffer_load_dwordx4 v171, s[4:7], s16 offen offset:3072 lds
v_mfma_f32_16x16x32_bf16 a[176:179], v[68:71], v[16:19], a[176:179]
s_add_u32 s29, s29, 128
s_and_b32 s29, s29, 2047
ds_read_b128 v[44:47], v165 offset:38912
v_mfma_f32_16x16x32_bf16 a[180:183], v[68:71], v[20:23], a[180:183]
ds_read_b128 v[48:51], v165 offset:40960
v_mfma_f32_16x16x32_bf16 a[184:187], v[68:71], v[24:27], a[184:187]
ds_read_b128 v[52:55], v165 offset:43008
v_mfma_f32_16x16x32_bf16 a[188:191], v[68:71], v[28:31], a[188:191]
v_mfma_f32_16x16x32_bf16 a[192:195], v[72:75], v[0:3], a[192:195]
ds_read_b64_tr_b16 v[84:85], v161 offset:8192
v_mfma_f32_16x16x32_bf16 a[196:199], v[72:75], v[4:7], a[196:199]
ds_read_b64_tr_b16 v[86:87], v161 offset:12288
v_mfma_f32_16x16x32_bf16 a[200:203], v[72:75], v[8:11], a[200:203]
s_add_u32 m0, s35, 32768
s_xor_b32 s17, s33, s43
v_mfma_f32_16x16x32_bf16 a[204:207], v[72:75], v[12:15], a[204:207]
buffer_load_dwordx4 v172, s[8:11], s17 offen offset:0 lds
v_mfma_f32_16x16x32_bf16 a[208:211], v[72:75], v[16:19], a[208:211]
ds_read_b128 v[56:59], v165 offset:45056
v_mfma_f32_16x16x32_bf16 a[212:215], v[72:75], v[20:23], a[212:215]
ds_read_b128 v[60:63], v165 offset:47104
v_mfma_f32_16x16x32_bf16 a[216:219], v[72:75], v[24:27], a[216:219]
v_mfma_f32_16x16x32_bf16 a[220:223], v[72:75], v[28:31], a[220:223]
s_waitcnt lgkmcnt(12)
buffer_load_dwordx4 v173, s[8:11], s17 offen offset:1024 lds
v_mfma_f32_16x16x32_bf16 a[224:227], v[76:79], v[0:3], a[224:227]
s_add_u32 s33, s33, 65536
s_and_b32 s33, s33, 2097151
ds_read_b64_tr_b16 v[88:89], v162 offset:8192
v_mfma_f32_16x16x32_bf16 a[228:231], v[76:79], v[4:7], a[228:231]
ds_read_b64_tr_b16 v[90:91], v162 offset:12288
v_mfma_f32_16x16x32_bf16 a[232:235], v[76:79], v[8:11], a[232:235]
s_add_u32 m0, s35, 40960
s_xor_b32 s17, s33, s43
v_mfma_f32_16x16x32_bf16 a[236:239], v[76:79], v[12:15], a[236:239]
buffer_load_dwordx4 v172, s[8:11], s17 offen offset:0 lds
v_mfma_f32_16x16x32_bf16 a[240:243], v[76:79], v[16:19], a[240:243]
v_mfma_f32_16x16x32_bf16 a[244:247], v[76:79], v[20:23], a[244:247]
v_mfma_f32_16x16x32_bf16 a[248:251], v[76:79], v[24:27], a[248:251]
v_mfma_f32_16x16x32_bf16 a[252:255], v[76:79], v[28:31], a[252:255]
s_waitcnt lgkmcnt(9)
v_mfma_f32_16x16x32_bf16 a[128:131], v[80:83], v[32:35], a[128:131]
ds_read_b64_tr_b16 v[92:93], v163 offset:8192
v_mfma_f32_16x16x32_bf16 a[132:135], v[80:83], v[36:39], a[132:135]
ds_read_b64_tr_b16 v[94:95], v163 offset:12288
v_mfma_f32_16x16x32_bf16 a[136:139], v[80:83], v[40:43], a[136:139]
s_waitcnt lgkmcnt(10)
v_mfma_f32_16x16x32_bf16 a[140:143], v[80:83], v[44:47], a[140:143]
s_waitcnt lgkmcnt(9)
buffer_load_dwordx4 v173, s[8:11], s17 offen offset:1024 lds
v_mfma_f32_16x16x32_bf16 a[144:147], v[80:83], v[48:51], a[144:147]
s_waitcnt lgkmcnt(8)
s_add_u32 s33, s33, 65536
s_and_b32 s33, s33, 2097151
v_mfma_f32_16x16x32_bf16 a[148:151], v[80:83], v[52:55], a[148:151]
s_waitcnt lgkmcnt(5)
v_mfma_f32_16x16x32_bf16 a[152:155], v[80:83], v[56:59], a[152:155]
s_waitcnt lgkmcnt(4)
v_mfma_f32_16x16x32_bf16 a[156:159], v[80:83], v[60:63], a[156:159]
s_waitcnt vmcnt(13)
s_barrier
v_mfma_f32_16x16x32_bf16 a[160:163], v[84:87], v[32:35], a[160:163]
ds_read_b64_tr_b16 v[64:65], v160 offset:16384
v_mfma_f32_16x16x32_bf16 a[164:167], v[84:87], v[36:39], a[164:167]
ds_read_b64_tr_b16 v[66:67], v160 offset:20480
v_mfma_f32_16x16x32_bf16 a[168:171], v[84:87], v[40:43], a[168:171]
s_add_u32 m0, s19, 32768
s_add_u32 s16, s28, s29
s_xor_b32 s16, s16, s42
v_mfma_f32_16x16x32_bf16 a[172:175], v[84:87], v[44:47], a[172:175]
buffer_load_dwordx4 v168, s[4:7], s16 offen offset:0 lds
v_mfma_f32_16x16x32_bf16 a[176:179], v[84:87], v[48:51], a[176:179]
ds_read_b128 v[0:3], v166 offset:0
v_mfma_f32_16x16x32_bf16 a[180:183], v[84:87], v[52:55], a[180:183]
ds_read_b128 v[4:7], v166 offset:2048
v_mfma_f32_16x16x32_bf16 a[184:187], v[84:87], v[56:59], a[184:187]
ds_read_b128 v[8:11], v166 offset:4096
v_mfma_f32_16x16x32_bf16 a[188:191], v[84:87], v[60:63], a[188:191]
s_waitcnt lgkmcnt(7)
buffer_load_dwordx4 v169, s[4:7], s16 offen offset:1024 lds
v_mfma_f32_16x16x32_bf16 a[192:195], v[88:91], v[32:35], a[192:195]
ds_read_b64_tr_b16 v[68:69], v161 offset:16384
v_mfma_f32_16x16x32_bf16 a[196:199], v[88:91], v[36:39], a[196:199]
ds_read_b64_tr_b16 v[70:71], v161 offset:20480
v_mfma_f32_16x16x32_bf16 a[200:203], v[88:91], v[40:43], a[200:203]
v_mfma_f32_16x16x32_bf16 a[204:207], v[88:91], v[44:47], a[204:207]
buffer_load_dwordx4 v170, s[4:7], s16 offen offset:2048 lds
v_mfma_f32_16x16x32_bf16 a[208:211], v[88:91], v[48:51], a[208:211]
ds_read_b128 v[12:15], v166 offset:6144
v_mfma_f32_16x16x32_bf16 a[212:215], v[88:91], v[52:55], a[212:215]
ds_read_b128 v[16:19], v166 offset:8192
v_mfma_f32_16x16x32_bf16 a[216:219], v[88:91], v[56:59], a[216:219]
ds_read_b128 v[20:23], v166 offset:10240
v_mfma_f32_16x16x32_bf16 a[220:223], v[88:91], v[60:63], a[220:223]
s_waitcnt lgkmcnt(10)
buffer_load_dwordx4 v171, s[4:7], s16 offen offset:3072 lds
v_mfma_f32_16x16x32_bf16 a[224:227], v[92:95], v[32:35], a[224:227]
ds_read_b64_tr_b16 v[72:73], v162 offset:16384
v_mfma_f32_16x16x32_bf16 a[228:231], v[92:95], v[36:39], a[228:231]
ds_read_b64_tr_b16 v[74:75], v162 offset:20480
v_mfma_f32_16x16x32_bf16 a[232:235], v[92:95], v[40:43], a[232:235]
s_add_u32 m0, s19, 36864
s_add_u32 s16, s16, 65536
ds_read_b128 v[24:27], v166 offset:12288
v_mfma_f32_16x16x32_bf16 a[236:239], v[92:95], v[44:47], a[236:239]
buffer_load_dwordx4 v168, s[4:7], s16 offen offset:0 lds
v_mfma_f32_16x16x32_bf16 a[240:243], v[92:95], v[48:51], a[240:243]
ds_read_b128 v[28:31], v166 offset:14336
v_mfma_f32_16x16x32_bf16 a[244:247], v[92:95], v[52:55], a[244:247]
v_mfma_f32_16x16x32_bf16 a[248:251], v[92:95], v[56:59], a[248:251]
v_mfma_f32_16x16x32_bf16 a[252:255], v[92:95], v[60:63], a[252:255]
s_waitcnt lgkmcnt(11)
v_mfma_f32_16x16x32_bf16 a[128:131], v[64:67], v[0:3], a[128:131]
s_waitcnt lgkmcnt(10)
ds_read_b64_tr_b16 v[76:77], v163 offset:16384
v_mfma_f32_16x16x32_bf16 a[132:135], v[64:67], v[4:7], a[132:135]
s_waitcnt lgkmcnt(10)
ds_read_b64_tr_b16 v[78:79], v163 offset:20480
v_mfma_f32_16x16x32_bf16 a[136:139], v[64:67], v[8:11], a[136:139]
s_waitcnt lgkmcnt(8)
v_mfma_f32_16x16x32_bf16 a[140:143], v[64:67], v[12:15], a[140:143]
s_waitcnt lgkmcnt(7)
buffer_load_dwordx4 v169, s[4:7], s16 offen offset:1024 lds
v_mfma_f32_16x16x32_bf16 a[144:147], v[64:67], v[16:19], a[144:147]
s_waitcnt lgkmcnt(6)
ds_read_b128 v[32:35], v167 offset:0
v_mfma_f32_16x16x32_bf16 a[148:151], v[64:67], v[20:23], a[148:151]
s_waitcnt lgkmcnt(4)
ds_read_b128 v[36:39], v167 offset:2048
v_mfma_f32_16x16x32_bf16 a[152:155], v[64:67], v[24:27], a[152:155]
s_waitcnt lgkmcnt(4)
ds_read_b128 v[40:43], v167 offset:4096
v_mfma_f32_16x16x32_bf16 a[156:159], v[64:67], v[28:31], a[156:159]
buffer_load_dwordx4 v170, s[4:7], s16 offen offset:2048 lds
v_mfma_f32_16x16x32_bf16 a[160:163], v[68:71], v[0:3], a[160:163]
ds_read_b64_tr_b16 v[80:81], v160 offset:24576
v_mfma_f32_16x16x32_bf16 a[164:167], v[68:71], v[4:7], a[164:167]
ds_read_b64_tr_b16 v[82:83], v160 offset:28672
v_mfma_f32_16x16x32_bf16 a[168:171], v[68:71], v[8:11], a[168:171]
v_mfma_f32_16x16x32_bf16 a[172:175], v[68:71], v[12:15], a[172:175]
buffer_load_dwordx4 v171, s[4:7], s16 offen offset:3072 lds
v_mfma_f32_16x16x32_bf16 a[176:179], v[68:71], v[16:19], a[176:179]
s_add_u32 s29, s29, 128
s_and_b32 s29, s29, 2047
ds_read_b128 v[44:47], v167 offset:6144
v_mfma_f32_16x16x32_bf16 a[180:183], v[68:71], v[20:23], a[180:183]
ds_read_b128 v[48:51], v167 offset:8192
v_mfma_f32_16x16x32_bf16 a[184:187], v[68:71], v[24:27], a[184:187]
ds_read_b128 v[52:55], v167 offset:10240
v_mfma_f32_16x16x32_bf16 a[188:191], v[68:71], v[28:31], a[188:191]
v_mfma_f32_16x16x32_bf16 a[192:195], v[72:75], v[0:3], a[192:195]
ds_read_b64_tr_b16 v[84:85], v161 offset:24576
v_mfma_f32_16x16x32_bf16 a[196:199], v[72:75], v[4:7], a[196:199]
ds_read_b64_tr_b16 v[86:87], v161 offset:28672
v_mfma_f32_16x16x32_bf16 a[200:203], v[72:75], v[8:11], a[200:203]
s_add_u32 m0, s35, 49152
s_xor_b32 s17, s33, s43
v_mfma_f32_16x16x32_bf16 a[204:207], v[72:75], v[12:15], a[204:207]
buffer_load_dwordx4 v172, s[8:11], s17 offen offset:0 lds
v_mfma_f32_16x16x32_bf16 a[208:211], v[72:75], v[16:19], a[208:211]
ds_read_b128 v[56:59], v167 offset:12288
v_mfma_f32_16x16x32_bf16 a[212:215], v[72:75], v[20:23], a[212:215]
ds_read_b128 v[60:63], v167 offset:14336
v_mfma_f32_16x16x32_bf16 a[216:219], v[72:75], v[24:27], a[216:219]
v_mfma_f32_16x16x32_bf16 a[220:223], v[72:75], v[28:31], a[220:223]
s_waitcnt lgkmcnt(12)
buffer_load_dwordx4 v173, s[8:11], s17 offen offset:1024 lds
v_mfma_f32_16x16x32_bf16 a[224:227], v[76:79], v[0:3], a[224:227]
s_add_u32 s33, s33, 65536
s_and_b32 s33, s33, 2097151
ds_read_b64_tr_b16 v[88:89], v162 offset:24576
v_mfma_f32_16x16x32_bf16 a[228:231], v[76:79], v[4:7], a[228:231]
ds_read_b64_tr_b16 v[90:91], v162 offset:28672
v_mfma_f32_16x16x32_bf16 a[232:235], v[76:79], v[8:11], a[232:235]
s_add_u32 m0, s35, 57344
s_xor_b32 s17, s33, s43
v_mfma_f32_16x16x32_bf16 a[236:239], v[76:79], v[12:15], a[236:239]
buffer_load_dwordx4 v172, s[8:11], s17 offen offset:0 lds
v_mfma_f32_16x16x32_bf16 a[240:243], v[76:79], v[16:19], a[240:243]
v_mfma_f32_16x16x32_bf16 a[244:247], v[76:79], v[20:23], a[244:247]
v_mfma_f32_16x16x32_bf16 a[248:251], v[76:79], v[24:27], a[248:251]
v_mfma_f32_16x16x32_bf16 a[252:255], v[76:79], v[28:31], a[252:255]
s_waitcnt lgkmcnt(9)
v_mfma_f32_16x16x32_bf16 a[128:131], v[80:83], v[32:35], a[128:131]
ds_read_b64_tr_b16 v[92:93], v163 offset:24576
v_mfma_f32_16x16x32_bf16 a[132:135], v[80:83], v[36:39], a[132:135]
ds_read_b64_tr_b16 v[94:95], v163 offset:28672
v_mfma_f32_16x16x32_bf16 a[136:139], v[80:83], v[40:43], a[136:139]
s_waitcnt lgkmcnt(10)
v_mfma_f32_16x16x32_bf16 a[140:143], v[80:83], v[44:47], a[140:143]
s_waitcnt lgkmcnt(9)
buffer_load_dwordx4 v173, s[8:11], s17 offen offset:1024 lds
v_mfma_f32_16x16x32_bf16 a[144:147], v[80:83], v[48:51], a[144:147]
s_waitcnt lgkmcnt(8)
s_add_u32 s33, s33, 65536
s_and_b32 s33, s33, 2097151
v_mfma_f32_16x16x32_bf16 a[148:151], v[80:83], v[52:55], a[148:151]
s_waitcnt lgkmcnt(5)
v_mfma_f32_16x16x32_bf16 a[152:155], v[80:83], v[56:59], a[152:155]
s_waitcnt lgkmcnt(4)
v_mfma_f32_16x16x32_bf16 a[156:159], v[80:83], v[60:63], a[156:159]
s_waitcnt vmcnt(12)
s_barrier
v_mfma_f32_16x16x32_bf16 a[160:163], v[84:87], v[32:35], a[160:163]
ds_read_b64_tr_b16 v[64:65], v160 offset:32768
v_mfma_f32_16x16x32_bf16 a[164:167], v[84:87], v[36:39], a[164:167]
ds_read_b64_tr_b16 v[66:67], v160 offset:36864
v_mfma_f32_16x16x32_bf16 a[168:171], v[84:87], v[40:43], a[168:171]
v_mfma_f32_16x16x32_bf16 a[172:175], v[84:87], v[44:47], a[172:175]
v_mfma_f32_16x16x32_bf16 a[176:179], v[84:87], v[48:51], a[176:179]
ds_read_b128 v[0:3], v164 offset:0
v_mfma_f32_16x16x32_bf16 a[180:183], v[84:87], v[52:55], a[180:183]
ds_read_b128 v[4:7], v164 offset:2048
v_mfma_f32_16x16x32_bf16 a[184:187], v[84:87], v[56:59], a[184:187]
ds_read_b128 v[8:11], v164 offset:4096
v_mfma_f32_16x16x32_bf16 a[188:191], v[84:87], v[60:63], a[188:191]
s_waitcnt lgkmcnt(7)
v_mfma_f32_16x16x32_bf16 a[192:195], v[88:91], v[32:35], a[192:195]
ds_read_b64_tr_b16 v[68:69], v161 offset:32768
v_mfma_f32_16x16x32_bf16 a[196:199], v[88:91], v[36:39], a[196:199]
ds_read_b64_tr_b16 v[70:71], v161 offset:36864
v_mfma_f32_16x16x32_bf16 a[200:203], v[88:91], v[40:43], a[200:203]
v_mfma_f32_16x16x32_bf16 a[204:207], v[88:91], v[44:47], a[204:207]
v_mfma_f32_16x16x32_bf16 a[208:211], v[88:91], v[48:51], a[208:211]
ds_read_b128 v[12:15], v164 offset:6144
v_mfma_f32_16x16x32_bf16 a[212:215], v[88:91], v[52:55], a[212:215]
ds_read_b128 v[16:19], v164 offset:8192
v_mfma_f32_16x16x32_bf16 a[216:219], v[88:91], v[56:59], a[216:219]
ds_read_b128 v[20:23], v164 offset:10240
v_mfma_f32_16x16x32_bf16 a[220:223], v[88:91], v[60:63], a[220:223]
s_waitcnt lgkmcnt(10)
v_mfma_f32_16x16x32_bf16 a[224:227], v[92:95], v[32:35], a[224:227]
ds_read_b64_tr_b16 v[72:73], v162 offset:32768
v_mfma_f32_16x16x32_bf16 a[228:231], v[92:95], v[36:39], a[228:231]
ds_read_b64_tr_b16 v[74:75], v162 offset:36864
v_mfma_f32_16x16x32_bf16 a[232:235], v[92:95], v[40:43], a[232:235]
ds_read_b128 v[24:27], v164 offset:12288
v_mfma_f32_16x16x32_bf16 a[236:239], v[92:95], v[44:47], a[236:239]
v_mfma_f32_16x16x32_bf16 a[240:243], v[92:95], v[48:51], a[240:243]
ds_read_b128 v[28:31], v164 offset:14336
v_mfma_f32_16x16x32_bf16 a[244:247], v[92:95], v[52:55], a[244:247]
v_mfma_f32_16x16x32_bf16 a[248:251], v[92:95], v[56:59], a[248:251]
v_mfma_f32_16x16x32_bf16 a[252:255], v[92:95], v[60:63], a[252:255]
s_waitcnt lgkmcnt(11)
v_mfma_f32_16x16x32_bf16 a[128:131], v[64:67], v[0:3], a[128:131]
s_waitcnt lgkmcnt(10)
ds_read_b64_tr_b16 v[76:77], v163 offset:32768
v_mfma_f32_16x16x32_bf16 a[132:135], v[64:67], v[4:7], a[132:135]
s_waitcnt lgkmcnt(10)
ds_read_b64_tr_b16 v[78:79], v163 offset:36864
v_mfma_f32_16x16x32_bf16 a[136:139], v[64:67], v[8:11], a[136:139]
s_waitcnt lgkmcnt(8)
v_mfma_f32_16x16x32_bf16 a[140:143], v[64:67], v[12:15], a[140:143]
s_waitcnt lgkmcnt(7)
v_mfma_f32_16x16x32_bf16 a[144:147], v[64:67], v[16:19], a[144:147]
s_waitcnt lgkmcnt(6)
ds_read_b128 v[32:35], v165 offset:0
v_mfma_f32_16x16x32_bf16 a[148:151], v[64:67], v[20:23], a[148:151]
s_waitcnt lgkmcnt(4)
ds_read_b128 v[36:39], v165 offset:2048
v_mfma_f32_16x16x32_bf16 a[152:155], v[64:67], v[24:27], a[152:155]
s_waitcnt lgkmcnt(4)
ds_read_b128 v[40:43], v165 offset:4096
v_mfma_f32_16x16x32_bf16 a[156:159], v[64:67], v[28:31], a[156:159]
v_mfma_f32_16x16x32_bf16 a[160:163], v[68:71], v[0:3], a[160:163]
ds_read_b64_tr_b16 v[80:81], v160 offset:40960
v_mfma_f32_16x16x32_bf16 a[164:167], v[68:71], v[4:7], a[164:167]
ds_read_b64_tr_b16 v[82:83], v160 offset:45056
v_mfma_f32_16x16x32_bf16 a[168:171], v[68:71], v[8:11], a[168:171]
v_mfma_f32_16x16x32_bf16 a[172:175], v[68:71], v[12:15], a[172:175]
v_mfma_f32_16x16x32_bf16 a[176:179], v[68:71], v[16:19], a[176:179]
ds_read_b128 v[44:47], v165 offset:6144
v_mfma_f32_16x16x32_bf16 a[180:183], v[68:71], v[20:23], a[180:183]
ds_read_b128 v[48:51], v165 offset:8192
v_mfma_f32_16x16x32_bf16 a[184:187], v[68:71], v[24:27], a[184:187]
ds_read_b128 v[52:55], v165 offset:10240
v_mfma_f32_16x16x32_bf16 a[188:191], v[68:71], v[28:31], a[188:191]
v_mfma_f32_16x16x32_bf16 a[192:195], v[72:75], v[0:3], a[192:195]
ds_read_b64_tr_b16 v[84:85], v161 offset:40960
v_mfma_f32_16x16x32_bf16 a[196:199], v[72:75], v[4:7], a[196:199]
ds_read_b64_tr_b16 v[86:87], v161 offset:45056
v_mfma_f32_16x16x32_bf16 a[200:203], v[72:75], v[8:11], a[200:203]
v_mfma_f32_16x16x32_bf16 a[204:207], v[72:75], v[12:15], a[204:207]
v_mfma_f32_16x16x32_bf16 a[208:211], v[72:75], v[16:19], a[208:211]
ds_read_b128 v[56:59], v165 offset:12288
v_mfma_f32_16x16x32_bf16 a[212:215], v[72:75], v[20:23], a[212:215]
ds_read_b128 v[60:63], v165 offset:14336
v_mfma_f32_16x16x32_bf16 a[216:219], v[72:75], v[24:27], a[216:219]
v_mfma_f32_16x16x32_bf16 a[220:223], v[72:75], v[28:31], a[220:223]
s_waitcnt lgkmcnt(12)
v_mfma_f32_16x16x32_bf16 a[224:227], v[76:79], v[0:3], a[224:227]
ds_read_b64_tr_b16 v[88:89], v162 offset:40960
v_mfma_f32_16x16x32_bf16 a[228:231], v[76:79], v[4:7], a[228:231]
ds_read_b64_tr_b16 v[90:91], v162 offset:45056
v_mfma_f32_16x16x32_bf16 a[232:235], v[76:79], v[8:11], a[232:235]
v_mfma_f32_16x16x32_bf16 a[236:239], v[76:79], v[12:15], a[236:239]
v_mfma_f32_16x16x32_bf16 a[240:243], v[76:79], v[16:19], a[240:243]
v_mfma_f32_16x16x32_bf16 a[244:247], v[76:79], v[20:23], a[244:247]
v_mfma_f32_16x16x32_bf16 a[248:251], v[76:79], v[24:27], a[248:251]
v_mfma_f32_16x16x32_bf16 a[252:255], v[76:79], v[28:31], a[252:255]
s_waitcnt lgkmcnt(9)
v_mfma_f32_16x16x32_bf16 a[128:131], v[80:83], v[32:35], a[128:131]
ds_read_b64_tr_b16 v[92:93], v163 offset:40960
v_mfma_f32_16x16x32_bf16 a[132:135], v[80:83], v[36:39], a[132:135]
ds_read_b64_tr_b16 v[94:95], v163 offset:45056
v_mfma_f32_16x16x32_bf16 a[136:139], v[80:83], v[40:43], a[136:139]
s_waitcnt lgkmcnt(10)
v_mfma_f32_16x16x32_bf16 a[140:143], v[80:83], v[44:47], a[140:143]
s_waitcnt lgkmcnt(9)
v_mfma_f32_16x16x32_bf16 a[144:147], v[80:83], v[48:51], a[144:147]
s_waitcnt lgkmcnt(8)
v_mfma_f32_16x16x32_bf16 a[148:151], v[80:83], v[52:55], a[148:151]
s_waitcnt lgkmcnt(5)
v_mfma_f32_16x16x32_bf16 a[152:155], v[80:83], v[56:59], a[152:155]
s_waitcnt lgkmcnt(4)
v_mfma_f32_16x16x32_bf16 a[156:159], v[80:83], v[60:63], a[156:159]
s_waitcnt vmcnt(0)
s_barrier
v_mfma_f32_16x16x32_bf16 a[160:163], v[84:87], v[32:35], a[160:163]
ds_read_b64_tr_b16 v[64:65], v160 offset:49152
v_mfma_f32_16x16x32_bf16 a[164:167], v[84:87], v[36:39], a[164:167]
ds_read_b64_tr_b16 v[66:67], v160 offset:53248
v_mfma_f32_16x16x32_bf16 a[168:171], v[84:87], v[40:43], a[168:171]
v_mfma_f32_16x16x32_bf16 a[172:175], v[84:87], v[44:47], a[172:175]
v_mfma_f32_16x16x32_bf16 a[176:179], v[84:87], v[48:51], a[176:179]
ds_read_b128 v[0:3], v164 offset:32768
v_mfma_f32_16x16x32_bf16 a[180:183], v[84:87], v[52:55], a[180:183]
ds_read_b128 v[4:7], v164 offset:34816
v_mfma_f32_16x16x32_bf16 a[184:187], v[84:87], v[56:59], a[184:187]
ds_read_b128 v[8:11], v164 offset:36864
v_mfma_f32_16x16x32_bf16 a[188:191], v[84:87], v[60:63], a[188:191]
s_waitcnt lgkmcnt(7)
v_mfma_f32_16x16x32_bf16 a[192:195], v[88:91], v[32:35], a[192:195]
ds_read_b64_tr_b16 v[68:69], v161 offset:49152
v_mfma_f32_16x16x32_bf16 a[196:199], v[88:91], v[36:39], a[196:199]
ds_read_b64_tr_b16 v[70:71], v161 offset:53248
v_mfma_f32_16x16x32_bf16 a[200:203], v[88:91], v[40:43], a[200:203]
v_mfma_f32_16x16x32_bf16 a[204:207], v[88:91], v[44:47], a[204:207]
v_mfma_f32_16x16x32_bf16 a[208:211], v[88:91], v[48:51], a[208:211]
ds_read_b128 v[12:15], v164 offset:38912
v_mfma_f32_16x16x32_bf16 a[212:215], v[88:91], v[52:55], a[212:215]
ds_read_b128 v[16:19], v164 offset:40960
v_mfma_f32_16x16x32_bf16 a[216:219], v[88:91], v[56:59], a[216:219]
ds_read_b128 v[20:23], v164 offset:43008
v_mfma_f32_16x16x32_bf16 a[220:223], v[88:91], v[60:63], a[220:223]
s_waitcnt lgkmcnt(10)
v_mfma_f32_16x16x32_bf16 a[224:227], v[92:95], v[32:35], a[224:227]
ds_read_b64_tr_b16 v[72:73], v162 offset:49152
v_mfma_f32_16x16x32_bf16 a[228:231], v[92:95], v[36:39], a[228:231]
ds_read_b64_tr_b16 v[74:75], v162 offset:53248
v_mfma_f32_16x16x32_bf16 a[232:235], v[92:95], v[40:43], a[232:235]
ds_read_b128 v[24:27], v164 offset:45056
v_mfma_f32_16x16x32_bf16 a[236:239], v[92:95], v[44:47], a[236:239]
v_mfma_f32_16x16x32_bf16 a[240:243], v[92:95], v[48:51], a[240:243]
ds_read_b128 v[28:31], v164 offset:47104
v_mfma_f32_16x16x32_bf16 a[244:247], v[92:95], v[52:55], a[244:247]
v_mfma_f32_16x16x32_bf16 a[248:251], v[92:95], v[56:59], a[248:251]
v_mfma_f32_16x16x32_bf16 a[252:255], v[92:95], v[60:63], a[252:255]
s_waitcnt lgkmcnt(11)
v_mfma_f32_16x16x32_bf16 a[128:131], v[64:67], v[0:3], a[128:131]
s_waitcnt lgkmcnt(10)
ds_read_b64_tr_b16 v[76:77], v163 offset:49152
v_mfma_f32_16x16x32_bf16 a[132:135], v[64:67], v[4:7], a[132:135]
s_waitcnt lgkmcnt(10)
ds_read_b64_tr_b16 v[78:79], v163 offset:53248
v_mfma_f32_16x16x32_bf16 a[136:139], v[64:67], v[8:11], a[136:139]
s_waitcnt lgkmcnt(8)
v_mfma_f32_16x16x32_bf16 a[140:143], v[64:67], v[12:15], a[140:143]
s_waitcnt lgkmcnt(7)
v_mfma_f32_16x16x32_bf16 a[144:147], v[64:67], v[16:19], a[144:147]
s_waitcnt lgkmcnt(6)
ds_read_b128 v[32:35], v165 offset:32768
v_mfma_f32_16x16x32_bf16 a[148:151], v[64:67], v[20:23], a[148:151]
s_waitcnt lgkmcnt(4)
ds_read_b128 v[36:39], v165 offset:34816
v_mfma_f32_16x16x32_bf16 a[152:155], v[64:67], v[24:27], a[152:155]
s_waitcnt lgkmcnt(4)
ds_read_b128 v[40:43], v165 offset:36864
v_mfma_f32_16x16x32_bf16 a[156:159], v[64:67], v[28:31], a[156:159]
v_mfma_f32_16x16x32_bf16 a[160:163], v[68:71], v[0:3], a[160:163]
ds_read_b64_tr_b16 v[80:81], v160 offset:57344
v_mfma_f32_16x16x32_bf16 a[164:167], v[68:71], v[4:7], a[164:167]
ds_read_b64_tr_b16 v[82:83], v160 offset:61440
v_mfma_f32_16x16x32_bf16 a[168:171], v[68:71], v[8:11], a[168:171]
v_mfma_f32_16x16x32_bf16 a[172:175], v[68:71], v[12:15], a[172:175]
v_mfma_f32_16x16x32_bf16 a[176:179], v[68:71], v[16:19], a[176:179]
ds_read_b128 v[44:47], v165 offset:38912
v_mfma_f32_16x16x32_bf16 a[180:183], v[68:71], v[20:23], a[180:183]
ds_read_b128 v[48:51], v165 offset:40960
v_mfma_f32_16x16x32_bf16 a[184:187], v[68:71], v[24:27], a[184:187]
ds_read_b128 v[52:55], v165 offset:43008
v_mfma_f32_16x16x32_bf16 a[188:191], v[68:71], v[28:31], a[188:191]
v_mfma_f32_16x16x32_bf16 a[192:195], v[72:75], v[0:3], a[192:195]
ds_read_b64_tr_b16 v[84:85], v161 offset:57344
v_mfma_f32_16x16x32_bf16 a[196:199], v[72:75], v[4:7], a[196:199]
ds_read_b64_tr_b16 v[86:87], v161 offset:61440
v_mfma_f32_16x16x32_bf16 a[200:203], v[72:75], v[8:11], a[200:203]
v_mfma_f32_16x16x32_bf16 a[204:207], v[72:75], v[12:15], a[204:207]
v_mfma_f32_16x16x32_bf16 a[208:211], v[72:75], v[16:19], a[208:211]
ds_read_b128 v[56:59], v165 offset:45056
v_mfma_f32_16x16x32_bf16 a[212:215], v[72:75], v[20:23], a[212:215]
ds_read_b128 v[60:63], v165 offset:47104
v_mfma_f32_16x16x32_bf16 a[216:219], v[72:75], v[24:27], a[216:219]
v_mfma_f32_16x16x32_bf16 a[220:223], v[72:75], v[28:31], a[220:223]
s_waitcnt lgkmcnt(12)
v_mfma_f32_16x16x32_bf16 a[224:227], v[76:79], v[0:3], a[224:227]
ds_read_b64_tr_b16 v[88:89], v162 offset:57344
v_mfma_f32_16x16x32_bf16 a[228:231], v[76:79], v[4:7], a[228:231]
ds_read_b64_tr_b16 v[90:91], v162 offset:61440
v_mfma_f32_16x16x32_bf16 a[232:235], v[76:79], v[8:11], a[232:235]
v_mfma_f32_16x16x32_bf16 a[236:239], v[76:79], v[12:15], a[236:239]
v_mfma_f32_16x16x32_bf16 a[240:243], v[76:79], v[16:19], a[240:243]
v_mfma_f32_16x16x32_bf16 a[244:247], v[76:79], v[20:23], a[244:247]
v_mfma_f32_16x16x32_bf16 a[248:251], v[76:79], v[24:27], a[248:251]
v_mfma_f32_16x16x32_bf16 a[252:255], v[76:79], v[28:31], a[252:255]
s_waitcnt lgkmcnt(9)
v_mfma_f32_16x16x32_bf16 a[128:131], v[80:83], v[32:35], a[128:131]
ds_read_b64_tr_b16 v[92:93], v163 offset:57344
v_mfma_f32_16x16x32_bf16 a[132:135], v[80:83], v[36:39], a[132:135]
ds_read_b64_tr_b16 v[94:95], v163 offset:61440
v_mfma_f32_16x16x32_bf16 a[136:139], v[80:83], v[40:43], a[136:139]
s_waitcnt lgkmcnt(10)
v_mfma_f32_16x16x32_bf16 a[140:143], v[80:83], v[44:47], a[140:143]
s_waitcnt lgkmcnt(9)
v_mfma_f32_16x16x32_bf16 a[144:147], v[80:83], v[48:51], a[144:147]
s_waitcnt lgkmcnt(8)
v_mfma_f32_16x16x32_bf16 a[148:151], v[80:83], v[52:55], a[148:151]
s_waitcnt lgkmcnt(5)
v_mfma_f32_16x16x32_bf16 a[152:155], v[80:83], v[56:59], a[152:155]
s_waitcnt lgkmcnt(4)
v_mfma_f32_16x16x32_bf16 a[156:159], v[80:83], v[60:63], a[156:159]
v_mfma_f32_16x16x32_bf16 a[160:163], v[84:87], v[32:35], a[160:163]
v_mfma_f32_16x16x32_bf16 a[164:167], v[84:87], v[36:39], a[164:167]
v_mfma_f32_16x16x32_bf16 a[168:171], v[84:87], v[40:43], a[168:171]
v_mfma_f32_16x16x32_bf16 a[172:175], v[84:87], v[44:47], a[172:175]
v_mfma_f32_16x16x32_bf16 a[176:179], v[84:87], v[48:51], a[176:179]
v_mfma_f32_16x16x32_bf16 a[180:183], v[84:87], v[52:55], a[180:183]
v_mfma_f32_16x16x32_bf16 a[184:187], v[84:87], v[56:59], a[184:187]
v_mfma_f32_16x16x32_bf16 a[188:191], v[84:87], v[60:63], a[188:191]
s_waitcnt lgkmcnt(2)
v_mfma_f32_16x16x32_bf16 a[192:195], v[88:91], v[32:35], a[192:195]
v_mfma_f32_16x16x32_bf16 a[196:199], v[88:91], v[36:39], a[196:199]
v_mfma_f32_16x16x32_bf16 a[200:203], v[88:91], v[40:43], a[200:203]
v_mfma_f32_16x16x32_bf16 a[204:207], v[88:91], v[44:47], a[204:207]
v_mfma_f32_16x16x32_bf16 a[208:211], v[88:91], v[48:51], a[208:211]
v_mfma_f32_16x16x32_bf16 a[212:215], v[88:91], v[52:55], a[212:215]
v_mfma_f32_16x16x32_bf16 a[216:219], v[88:91], v[56:59], a[216:219]
v_mfma_f32_16x16x32_bf16 a[220:223], v[88:91], v[60:63], a[220:223]
s_waitcnt lgkmcnt(0)
v_mfma_f32_16x16x32_bf16 a[224:227], v[92:95], v[32:35], a[224:227]
v_mfma_f32_16x16x32_bf16 a[228:231], v[92:95], v[36:39], a[228:231]
v_mfma_f32_16x16x32_bf16 a[232:235], v[92:95], v[40:43], a[232:235]
v_mfma_f32_16x16x32_bf16 a[236:239], v[92:95], v[44:47], a[236:239]
v_mfma_f32_16x16x32_bf16 a[240:243], v[92:95], v[48:51], a[240:243]
v_mfma_f32_16x16x32_bf16 a[244:247], v[92:95], v[52:55], a[244:247]
v_mfma_f32_16x16x32_bf16 a[248:251], v[92:95], v[56:59], a[248:251]
v_mfma_f32_16x16x32_bf16 a[252:255], v[92:95], v[60:63], a[252:255]
s_add_u32 s27, s41, 0
v_accvgpr_read_b32 v100, a128
v_accvgpr_read_b32 v101, a129
v_accvgpr_read_b32 v102, a130
v_accvgpr_read_b32 v103, a131
v_accvgpr_read_b32 v104, a160
v_accvgpr_read_b32 v105, a161
v_accvgpr_read_b32 v106, a162
v_accvgpr_read_b32 v107, a163
v_cvt_pk_bf16_f32 v96, v100, v101
v_cvt_pk_bf16_f32 v97, v102, v103
v_cvt_pk_bf16_f32 v98, v104, v105
v_cvt_pk_bf16_f32 v99, v106, v107
buffer_store_dwordx4 v[96:99], v252, s[12:15], s27 offen offset:0 sc1
v_accvgpr_read_b32 v112, a132
v_accvgpr_read_b32 v113, a133
v_accvgpr_read_b32 v114, a134
v_accvgpr_read_b32 v115, a135
v_accvgpr_read_b32 v116, a164
v_accvgpr_read_b32 v117, a165
v_accvgpr_read_b32 v118, a166
v_accvgpr_read_b32 v119, a167
v_cvt_pk_bf16_f32 v108, v112, v113
v_cvt_pk_bf16_f32 v109, v114, v115
v_cvt_pk_bf16_f32 v110, v116, v117
v_cvt_pk_bf16_f32 v111, v118, v119
buffer_store_dwordx4 v[108:111], v252, s[12:15], s27 offen offset:2048 sc1
v_accvgpr_read_b32 v124, a136
v_accvgpr_read_b32 v125, a137
v_accvgpr_read_b32 v126, a138
v_accvgpr_read_b32 v127, a139
v_accvgpr_read_b32 v128, a168
v_accvgpr_read_b32 v129, a169
v_accvgpr_read_b32 v130, a170
v_accvgpr_read_b32 v131, a171
v_cvt_pk_bf16_f32 v120, v124, v125
v_cvt_pk_bf16_f32 v121, v126, v127
v_cvt_pk_bf16_f32 v122, v128, v129
v_cvt_pk_bf16_f32 v123, v130, v131
buffer_store_dwordx4 v[120:123], v253, s[12:15], s27 offen offset:0 sc1
v_accvgpr_read_b32 v136, a140
v_accvgpr_read_b32 v137, a141
v_accvgpr_read_b32 v138, a142
v_accvgpr_read_b32 v139, a143
v_accvgpr_read_b32 v140, a172
v_accvgpr_read_b32 v141, a173
v_accvgpr_read_b32 v142, a174
v_accvgpr_read_b32 v143, a175
v_cvt_pk_bf16_f32 v132, v136, v137
v_cvt_pk_bf16_f32 v133, v138, v139
v_cvt_pk_bf16_f32 v134, v140, v141
v_cvt_pk_bf16_f32 v135, v142, v143
buffer_store_dwordx4 v[132:135], v253, s[12:15], s27 offen offset:2048 sc1
s_add_u32 s27, s41, 262144
v_accvgpr_read_b32 v148, a144
v_accvgpr_read_b32 v149, a145
v_accvgpr_read_b32 v150, a146
v_accvgpr_read_b32 v151, a147
v_accvgpr_read_b32 v152, a176
v_accvgpr_read_b32 v153, a177
v_accvgpr_read_b32 v154, a178
v_accvgpr_read_b32 v155, a179
v_cvt_pk_bf16_f32 v144, v148, v149
v_cvt_pk_bf16_f32 v145, v150, v151
v_cvt_pk_bf16_f32 v146, v152, v153
v_cvt_pk_bf16_f32 v147, v154, v155
buffer_store_dwordx4 v[144:147], v252, s[12:15], s27 offen offset:0 sc1
v_accvgpr_read_b32 v100, a148
v_accvgpr_read_b32 v101, a149
v_accvgpr_read_b32 v102, a150
v_accvgpr_read_b32 v103, a151
v_accvgpr_read_b32 v104, a180
v_accvgpr_read_b32 v105, a181
v_accvgpr_read_b32 v106, a182
v_accvgpr_read_b32 v107, a183
v_cvt_pk_bf16_f32 v96, v100, v101
v_cvt_pk_bf16_f32 v97, v102, v103
v_cvt_pk_bf16_f32 v98, v104, v105
v_cvt_pk_bf16_f32 v99, v106, v107
buffer_store_dwordx4 v[96:99], v252, s[12:15], s27 offen offset:2048 sc1
v_accvgpr_read_b32 v112, a152
v_accvgpr_read_b32 v113, a153
v_accvgpr_read_b32 v114, a154
v_accvgpr_read_b32 v115, a155
v_accvgpr_read_b32 v116, a184
v_accvgpr_read_b32 v117, a185
v_accvgpr_read_b32 v118, a186
v_accvgpr_read_b32 v119, a187
v_cvt_pk_bf16_f32 v108, v112, v113
v_cvt_pk_bf16_f32 v109, v114, v115
v_cvt_pk_bf16_f32 v110, v116, v117
v_cvt_pk_bf16_f32 v111, v118, v119
buffer_store_dwordx4 v[108:111], v253, s[12:15], s27 offen offset:0 sc1
v_accvgpr_read_b32 v124, a156
v_accvgpr_read_b32 v125, a157
v_accvgpr_read_b32 v126, a158
v_accvgpr_read_b32 v127, a159
v_accvgpr_read_b32 v128, a188
v_accvgpr_read_b32 v129, a189
v_accvgpr_read_b32 v130, a190
v_accvgpr_read_b32 v131, a191
v_cvt_pk_bf16_f32 v120, v124, v125
v_cvt_pk_bf16_f32 v121, v126, v127
v_cvt_pk_bf16_f32 v122, v128, v129
v_cvt_pk_bf16_f32 v123, v130, v131
buffer_store_dwordx4 v[120:123], v253, s[12:15], s27 offen offset:2048 sc1
s_add_u32 s27, s41, 8192
v_accvgpr_read_b32 v136, a192
v_accvgpr_read_b32 v137, a193
v_accvgpr_read_b32 v138, a194
v_accvgpr_read_b32 v139, a195
v_accvgpr_read_b32 v140, a224
v_accvgpr_read_b32 v141, a225
v_accvgpr_read_b32 v142, a226
v_accvgpr_read_b32 v143, a227
v_cvt_pk_bf16_f32 v132, v136, v137
v_cvt_pk_bf16_f32 v133, v138, v139
v_cvt_pk_bf16_f32 v134, v140, v141
v_cvt_pk_bf16_f32 v135, v142, v143
buffer_store_dwordx4 v[132:135], v252, s[12:15], s27 offen offset:0 sc1
v_accvgpr_read_b32 v148, a196
v_accvgpr_read_b32 v149, a197
v_accvgpr_read_b32 v150, a198
v_accvgpr_read_b32 v151, a199
v_accvgpr_read_b32 v152, a228
v_accvgpr_read_b32 v153, a229
v_accvgpr_read_b32 v154, a230
v_accvgpr_read_b32 v155, a231
v_cvt_pk_bf16_f32 v144, v148, v149
v_cvt_pk_bf16_f32 v145, v150, v151
v_cvt_pk_bf16_f32 v146, v152, v153
v_cvt_pk_bf16_f32 v147, v154, v155
buffer_store_dwordx4 v[144:147], v252, s[12:15], s27 offen offset:2048 sc1
v_accvgpr_read_b32 v100, a200
v_accvgpr_read_b32 v101, a201
v_accvgpr_read_b32 v102, a202
v_accvgpr_read_b32 v103, a203
v_accvgpr_read_b32 v104, a232
v_accvgpr_read_b32 v105, a233
v_accvgpr_read_b32 v106, a234
v_accvgpr_read_b32 v107, a235
v_cvt_pk_bf16_f32 v96, v100, v101
v_cvt_pk_bf16_f32 v97, v102, v103
v_cvt_pk_bf16_f32 v98, v104, v105
v_cvt_pk_bf16_f32 v99, v106, v107
buffer_store_dwordx4 v[96:99], v253, s[12:15], s27 offen offset:0 sc1
v_accvgpr_read_b32 v112, a204
v_accvgpr_read_b32 v113, a205
v_accvgpr_read_b32 v114, a206
v_accvgpr_read_b32 v115, a207
v_accvgpr_read_b32 v116, a236
v_accvgpr_read_b32 v117, a237
v_accvgpr_read_b32 v118, a238
v_accvgpr_read_b32 v119, a239
v_cvt_pk_bf16_f32 v108, v112, v113
v_cvt_pk_bf16_f32 v109, v114, v115
v_cvt_pk_bf16_f32 v110, v116, v117
v_cvt_pk_bf16_f32 v111, v118, v119
buffer_store_dwordx4 v[108:111], v253, s[12:15], s27 offen offset:2048 sc1
s_add_u32 s27, s41, 270336
v_accvgpr_read_b32 v124, a208
v_accvgpr_read_b32 v125, a209
v_accvgpr_read_b32 v126, a210
v_accvgpr_read_b32 v127, a211
v_accvgpr_read_b32 v128, a240
v_accvgpr_read_b32 v129, a241
v_accvgpr_read_b32 v130, a242
v_accvgpr_read_b32 v131, a243
v_cvt_pk_bf16_f32 v120, v124, v125
v_cvt_pk_bf16_f32 v121, v126, v127
v_cvt_pk_bf16_f32 v122, v128, v129
v_cvt_pk_bf16_f32 v123, v130, v131
buffer_store_dwordx4 v[120:123], v252, s[12:15], s27 offen offset:0 sc1
v_accvgpr_read_b32 v136, a212
v_accvgpr_read_b32 v137, a213
v_accvgpr_read_b32 v138, a214
v_accvgpr_read_b32 v139, a215
v_accvgpr_read_b32 v140, a244
v_accvgpr_read_b32 v141, a245
v_accvgpr_read_b32 v142, a246
v_accvgpr_read_b32 v143, a247
v_cvt_pk_bf16_f32 v132, v136, v137
v_cvt_pk_bf16_f32 v133, v138, v139
v_cvt_pk_bf16_f32 v134, v140, v141
v_cvt_pk_bf16_f32 v135, v142, v143
buffer_store_dwordx4 v[132:135], v252, s[12:15], s27 offen offset:2048 sc1
v_accvgpr_read_b32 v148, a216
v_accvgpr_read_b32 v149, a217
v_accvgpr_read_b32 v150, a218
v_accvgpr_read_b32 v151, a219
v_accvgpr_read_b32 v152, a248
v_accvgpr_read_b32 v153, a249
v_accvgpr_read_b32 v154, a250
v_accvgpr_read_b32 v155, a251
v_cvt_pk_bf16_f32 v144, v148, v149
v_cvt_pk_bf16_f32 v145, v150, v151
v_cvt_pk_bf16_f32 v146, v152, v153
v_cvt_pk_bf16_f32 v147, v154, v155
buffer_store_dwordx4 v[144:147], v253, s[12:15], s27 offen offset:0 sc1
v_accvgpr_read_b32 v100, a220
v_accvgpr_read_b32 v101, a221
v_accvgpr_read_b32 v102, a222
v_accvgpr_read_b32 v103, a223
v_accvgpr_read_b32 v104, a252
v_accvgpr_read_b32 v105, a253
v_accvgpr_read_b32 v106, a254
v_accvgpr_read_b32 v107, a255
v_cvt_pk_bf16_f32 v96, v100, v101
v_cvt_pk_bf16_f32 v97, v102, v103
v_cvt_pk_bf16_f32 v98, v104, v105
v_cvt_pk_bf16_f32 v99, v106, v107
buffer_store_dwordx4 v[96:99], v253, s[12:15], s27 offen offset:2048 sc1
s_add_u32 s62, s62, 16
s_waitcnt vmcnt(0)
buffer_store_dword v249, v250, s[44:47], s62 offen sc1
buffer_load_dword v175, v174, s[52:55], s56 offen
s_endpgm
standalone__weight_only_int_quip__prompt_kernel_xinit_spin:
buffer_load_dword v251, v248, s[48:51], 0 offen sc1
s_waitcnt vmcnt(0)
s_sub_u32 s96, s96, 1
s_cmp_lt_i32 s96, 1
s_cbranch_scc1 standalone__weight_only_int_quip__prompt_kernel_xinit_ok
v_cmp_eq_u32 vcc, 0, v251
s_cbranch_vccnz standalone__weight_only_int_quip__prompt_kernel_xinit_spin
s_branch standalone__weight_only_int_quip__prompt_kernel_xinit_ok
standalone__weight_only_int_quip__prompt_kernel_codeend:
s_endpgm
.section .rodata,"a"
.p2align 6
.amdhsa_kernel standalone__weight_only_int_quip__prompt_kernel
  .amdhsa_next_free_vgpr 512
  .amdhsa_next_free_sgpr 102
  .amdhsa_accum_offset 256
  .amdhsa_group_segment_fixed_size 0
  .amdhsa_kernarg_size 72
  .amdhsa_user_sgpr_count 2
  .amdhsa_user_sgpr_kernarg_segment_ptr 1
  .amdhsa_system_sgpr_workgroup_id_x 1
  .amdhsa_float_denorm_mode_32 3
.end_amdhsa_kernel
```
